```python
import torch

def _softmax(x, axis=-1):
    return torch.softmax(x, dim=axis)
def _gelu(x):
    return torch.nn.functional.gelu(x, approximate="tanh")
def _silu(x):
    return torch.nn.functional.silu(x)
def _sigmoid(x):
    return torch.sigmoid(x)
def _layernorm(x, axis=-1, eps=1e-5):
    m = x.mean(dim=axis, keepdim=True)
    v = x.var(dim=axis, keepdim=True, unbiased=False)
    return (x - m) / torch.sqrt(v + eps)
def _scatter_add(tgt, idx, src, axis=0):
    return tgt.clone().index_add_(axis, idx, src)
def _segment_sum(src, seg, n):
    out = torch.zeros((n,) + src.shape[1:], dtype=src.dtype)
    return out.index_add_(0, seg, src)
def _pad(x, pw):
    flat = tuple(v for pair in reversed(pw) for v in pair)
    return torch.nn.functional.pad(x, flat)

kernel_name = 'interleave_layers__gqa_block_cached__mha_block_cached__decode'

def setup_inputs():

    _w = (lambda a: (lambda t: t.to(torch.bfloat16) if t.is_floating_point() else t)(torch.as_tensor(a)))
    def _A_setup():
        B, Sq, D = 8, 1, 512
        Hq, Hkv, Sk, Dh = 32, 8, 4096, 128
        assert Hq % Hkv == 0, (Hq, Hkv)
        return {
            "x": _w((lambda *s: torch.randn(*s, dtype=torch.bfloat16) * 0.1)(B, Sq, D)),
            "k_cache": _w((lambda *s: torch.randn(*s, dtype=torch.bfloat16) * 0.8)(B, Hkv, Sk, Dh)),
            "v_cache": _w((lambda *s: torch.randn(*s, dtype=torch.bfloat16) * 6.4)(B, Hkv, Sk, Dh)),
            "wq": _w((lambda *s: torch.randn(*s, dtype=torch.bfloat16) * 0.8)(D, Hq * Dh) * (D ** -0.5)),
            "wo": _w((lambda *s: torch.randn(*s, dtype=torch.bfloat16) * 6.4)(Hq * Dh, D) * ((Hq * Dh) ** -0.5)),
        }
    _A_in = _A_setup()

    def _B_setup():
        B, Sq, D = 8, 1, 512
        H, Sk, Dh = 32, 4096, 128
        return {
            "x": _w((lambda *s: torch.randn(*s, dtype=torch.bfloat16) * 0.1)(B, Sq, D)),
            "k_cache": _w((lambda *s: torch.randn(*s, dtype=torch.bfloat16) * 1.6)(B, H, Sk, Dh)),
            "v_cache": _w((lambda *s: torch.randn(*s, dtype=torch.bfloat16) * 3.2)(B, H, Sk, Dh)),
            "wq": _w((lambda *s: torch.randn(*s, dtype=torch.bfloat16) * 1.6)(D, H * Dh) * (D ** -0.5)),
            "wo": _w((lambda *s: torch.randn(*s, dtype=torch.bfloat16) * 3.2)(H * Dh, D) * ((H * Dh) ** -0.5)),
        }
    _B_in = _B_setup()

    return {
        "A_x": _A_in["x"],
        "A_k_cache": _A_in["k_cache"],
        "A_v_cache": _A_in["v_cache"],
        "A_wq": _A_in["wq"],
        "A_wo": _A_in["wo"],
        "B_x": _B_in["x"],
        "B_k_cache": _B_in["k_cache"],
        "B_v_cache": _B_in["v_cache"],
        "B_wq": _B_in["wq"],
        "B_wo": _B_in["wo"],
    }

def reference(A_x, A_k_cache, A_v_cache, A_wq, A_wo, B_x, B_k_cache, B_v_cache, B_wq, B_wo):
    def _A_ref(x, k_cache, v_cache, wq, wo):
        B, Sq, D = x.shape
        Hq, Dh = 32, 128
        Hkv = k_cache.shape[1]
        rep = Hq // Hkv
        q = (lambda x, *d: x.permute(*d))((x @ wq).reshape(B, Sq, Hq, Dh), 0, 2, 1, 3)
        k = (lambda x, n, axis: torch.repeat_interleave(x, n, dim=axis))(k_cache, rep, axis=1)
        v = (lambda x, n, axis: torch.repeat_interleave(x, n, dim=axis))(v_cache, rep, axis=1)
        scores = torch.einsum("bhqd,bhkd->bhqk", q, k) * (Dh ** -0.5)
        p = _softmax(scores, axis=-1)
        o = torch.einsum("bhqk,bhkd->bhqd", p, v)
        return (lambda x, *d: x.permute(*d))(o, 0, 2, 1, 3).reshape(B, Sq, Hq * Dh) @ wo

    def _B_ref(x, k_cache, v_cache, wq, wo):
        B, Sq, D = x.shape
        H, Dh = 32, 128
        q = (lambda x, *d: x.permute(*d))((x @ wq).reshape(B, Sq, H, Dh), 0, 2, 1, 3)
        scores = torch.einsum("bhqd,bhkd->bhqk", q, k_cache) * (Dh ** -0.5)
        p = _softmax(scores, axis=-1)
        o = torch.einsum("bhqk,bhkd->bhqd", p, v_cache)
        return (lambda x, *d: x.permute(*d))(o, 0, 2, 1, 3).reshape(B, Sq, H * Dh) @ wo

    x = A_x
    x = x + _A_ref(_layernorm(x, axis=-1), A_k_cache, A_v_cache, A_wq, A_wo)
    x = x + _B_ref(_layernorm(x, axis=-1), B_k_cache, B_v_cache, B_wq, B_wo)
    x = x + _A_ref(_layernorm(x, axis=-1), A_k_cache, A_v_cache, A_wq, A_wo)
    x = x + _B_ref(_layernorm(x, axis=-1), B_k_cache, B_v_cache, B_wq, B_wo)
    return x
```

```asm
; @launch grid=(256,1,1) block=(512,1,1) lds=156672
.amdgcn_target "amdgcn-amd-amdhsa--gfx950"
.text
.globl interleave_layers__gqa_block_cached__mha_block_cached__decode_kernel
.p2align 8
.type interleave_layers__gqa_block_cached__mha_block_cached__decode_kernel,@function
interleave_layers__gqa_block_cached__mha_block_cached__decode_kernel:
    s_cmp_ge_u32 s2, 256
    s_cbranch_scc1 L_end
    s_load_dwordx16 s[16:31], s[0:1], 0
    s_load_dwordx8 s[32:39], s[0:1], 64
    s_load_dwordx2 s[40:41], s[0:1], 96
    s_and_b32 s46, s2, 7
    s_lshl_b32 s46, s46, 2
    s_bfe_u32 s47, s2, 0x20003
    s_or_b32 s46, s46, s47
    s_and_b32 s2, s2, 0xe0
    s_or_b32 s2, s2, s46
    v_lshrrev_b32 v1, 6, v0
    v_and_b32 v2, 63, v0
    v_readfirstlane_b32 s42, v1
    s_mov_b32 s43, 0x05040100
    s_mov_b32 s44, 0x07060302
    s_mov_b32 s72, 0x3fb8aa3b
    s_mov_b32 s73, 0x3db504f3
    s_mov_b32 s49, 400000
    s_lshr_b32 s51, s2, 5
    v_and_b32 v3, 31, v2
    v_lshlrev_b32 v3, 2, v3
    v_mov_b32 v4, 0
    ds_write_b32 v3, v4
    s_waitcnt lgkmcnt(0)
    s_barrier
    s_cmp_ge_u32 s42, 4
    s_cbranch_scc1 L_service
    s_lshl_b32 s46, s2, 18
    s_add_u32 s52, s18, s46
    s_addc_u32 s53, s19, 0
    s_mov_b32 s54, 0x40000
    s_mov_b32 s55, 0x20000
    s_add_u32 s56, s20, s46
    s_addc_u32 s57, s21, 0
    s_mov_b32 s58, 0x40000
    s_mov_b32 s59, 0x20000
    s_add_u32 s76, s18, s46
    s_addc_u32 s77, s19, 0
    s_mov_b32 s78, 0x40000
    s_mov_b32 s79, 0x20000
    s_add_u32 s92, s20, s46
    s_addc_u32 s93, s21, 0
    s_mov_b32 s94, 0x40000
    s_mov_b32 s95, 0x20000
    s_lshl_b32 s46, s2, 20
    s_add_u32 s60, s28, s46
    s_addc_u32 s61, s29, 0
    s_mov_b32 s62, 0x100000
    s_mov_b32 s63, 0x20000
    s_add_u32 s64, s30, s46
    s_addc_u32 s65, s31, 0
    s_mov_b32 s66, 0x100000
    s_mov_b32 s67, 0x20000
    v_lshlrev_b32 v3, 4, v2
    v_add_u32 v4, 4096, v3
    v_mov_b32 v5, 0
    s_lshl_b32 s75, s42, 13
    v_and_b32 v6, 2, v2
    v_cmp_ne_u32 s[68:69], 0, v6
    v_and_b32 v6, 1, v2
    v_cmp_ne_u32 s[70:71], 0, v6
    s_mov_b32 s74, 0
    s_lshl_b32 s46, s51, 21
    s_add_u32 s12, s40, s46
    s_addc_u32 s13, s41, 0
    s_mov_b32 s14, 0x200000
    s_mov_b32 s15, 0x20000
    s_mul_i32 s87, s42, 32768
    s_add_u32 s87, s87, 25600
    v_add_u32 v14, s87, v3
    s_cmp_lg_u32 s42, 3
    s_cbranch_scc1 L_nz_1
    s_lshl_b32 s46, s2, 16
    s_add_u32 s80, s40, s46
    s_addc_u32 s81, s41, 0
    s_mov_b32 s82, 0x10000
    s_mov_b32 s83, 0x20000
    v_mov_b32 v16, 0
    v_mov_b32 v17, 0
    v_mov_b32 v18, 0
    v_mov_b32 v19, 0
    s_mov_b32 s47, 0
    buffer_store_dwordx4 v[16:19], v3, s[80:83], s47 offen sc1
    s_mov_b32 s47, 1024
    buffer_store_dwordx4 v[16:19], v3, s[80:83], s47 offen sc1
    s_mov_b32 s47, 2048
    buffer_store_dwordx4 v[16:19], v3, s[80:83], s47 offen sc1
    s_mov_b32 s47, 3072
    buffer_store_dwordx4 v[16:19], v3, s[80:83], s47 offen sc1
    s_mov_b32 s47, 4096
    buffer_store_dwordx4 v[16:19], v3, s[80:83], s47 offen sc1
    s_mov_b32 s47, 5120
    buffer_store_dwordx4 v[16:19], v3, s[80:83], s47 offen sc1
    s_mov_b32 s47, 6144
    buffer_store_dwordx4 v[16:19], v3, s[80:83], s47 offen sc1
    s_mov_b32 s47, 7168
    buffer_store_dwordx4 v[16:19], v3, s[80:83], s47 offen sc1
    s_mov_b32 s47, 9216
    buffer_store_dwordx4 v[16:19], v3, s[80:83], s47 offen sc1
    s_mov_b32 s47, 10240
    buffer_store_dwordx4 v[16:19], v3, s[80:83], s47 offen sc1
    s_mov_b32 s47, 11264
    buffer_store_dwordx4 v[16:19], v3, s[80:83], s47 offen sc1
    s_mov_b32 s47, 12288
    buffer_store_dwordx4 v[16:19], v3, s[80:83], s47 offen sc1
    s_mov_b32 s47, 13312
    buffer_store_dwordx4 v[16:19], v3, s[80:83], s47 offen sc1
    s_mov_b32 s47, 14336
    buffer_store_dwordx4 v[16:19], v3, s[80:83], s47 offen sc1
    s_mov_b32 s47, 15360
    buffer_store_dwordx4 v[16:19], v3, s[80:83], s47 offen sc1
    s_mov_b32 s47, 16384
    buffer_store_dwordx4 v[16:19], v3, s[80:83], s47 offen sc1
    s_mov_b32 s47, 17408
    buffer_store_dwordx4 v[16:19], v3, s[80:83], s47 offen sc1
    s_waitcnt vmcnt(0)
    s_add_u32 s80, s38, 0
    s_addc_u32 s81, s39, 0
    s_mov_b32 s82, 0x100
    s_mov_b32 s83, 0x20000
    s_lshl_b32 s46, s51, 5
    v_mov_b32 v20, s46
    v_mov_b32 v21, 1
    ds_write_b32 v5, v21 offset:68
    s_mov_b64 exec, 1
    buffer_atomic_add v21, v20, s[80:83], 0 offen offset:4 sc1
    s_mov_b64 exec, -1
    s_nop 3
L_nz_1:
    s_add_u32 s48, s75, 0
    buffer_load_dwordx4 v[88:91], v3, s[52:55], s48 offen offset:0 nt
    buffer_load_dwordx4 v[92:95], v3, s[52:55], s48 offen offset:1024 nt
    buffer_load_dwordx4 v[96:99], v3, s[52:55], s48 offen offset:2048 nt
    buffer_load_dwordx4 v[100:103], v3, s[52:55], s48 offen offset:3072 nt
    buffer_load_dwordx4 v[104:107], v4, s[52:55], s48 offen offset:0 nt
    buffer_load_dwordx4 v[108:111], v4, s[52:55], s48 offen offset:1024 nt
    buffer_load_dwordx4 v[112:115], v4, s[52:55], s48 offen offset:2048 nt
    buffer_load_dwordx4 v[116:119], v4, s[52:55], s48 offen offset:3072 nt
    s_add_u32 s48, s75, 32768
    buffer_load_dwordx4 v[120:123], v3, s[52:55], s48 offen offset:0 nt
    buffer_load_dwordx4 v[124:127], v3, s[52:55], s48 offen offset:1024 nt
    buffer_load_dwordx4 v[128:131], v3, s[52:55], s48 offen offset:2048 nt
    buffer_load_dwordx4 v[132:135], v3, s[52:55], s48 offen offset:3072 nt
    s_waitcnt vmcnt(11)
    s_add_u32 m0, s87, 0
    s_nop 0
    buffer_load_dwordx4 v4, s[52:55], s48 offen offset:0 nt lds
    s_waitcnt vmcnt(11)
    s_add_u32 m0, s87, 0
    s_nop 0
    buffer_load_dwordx4 v4, s[52:55], s48 offen offset:1024 nt lds
    s_waitcnt vmcnt(11)
    s_add_u32 m0, s87, 0
    s_nop 0
    buffer_load_dwordx4 v4, s[52:55], s48 offen offset:2048 nt lds
    s_waitcnt vmcnt(11)
    s_add_u32 m0, s87, 0
    s_nop 0
    buffer_load_dwordx4 v4, s[52:55], s48 offen offset:3072 nt lds
    s_waitcnt vmcnt(11)
    s_add_u32 s48, s75, 65536
    s_add_u32 m0, s87, 4096
    s_nop 0
    buffer_load_dwordx4 v3, s[52:55], s48 offen offset:0 nt lds
    s_waitcnt vmcnt(11)
    s_add_u32 m0, s87, 4096
    s_nop 0
    buffer_load_dwordx4 v3, s[52:55], s48 offen offset:1024 nt lds
    s_waitcnt vmcnt(11)
    s_add_u32 m0, s87, 4096
    s_nop 0
    buffer_load_dwordx4 v3, s[52:55], s48 offen offset:2048 nt lds
    s_waitcnt vmcnt(11)
    s_add_u32 m0, s87, 4096
    s_nop 0
    buffer_load_dwordx4 v3, s[52:55], s48 offen offset:3072 nt lds
    s_waitcnt vmcnt(11)
    s_add_u32 m0, s87, 8192
    s_nop 0
    buffer_load_dwordx4 v4, s[52:55], s48 offen offset:0 nt lds
    s_waitcnt vmcnt(11)
    s_add_u32 m0, s87, 8192
    s_nop 0
    buffer_load_dwordx4 v4, s[52:55], s48 offen offset:1024 nt lds
    s_waitcnt vmcnt(11)
    s_add_u32 m0, s87, 8192
    s_nop 0
    buffer_load_dwordx4 v4, s[52:55], s48 offen offset:2048 nt lds
    s_waitcnt vmcnt(11)
    s_add_u32 m0, s87, 8192
    s_nop 0
    buffer_load_dwordx4 v4, s[52:55], s48 offen offset:3072 nt lds
    s_waitcnt vmcnt(11)
    s_add_u32 s48, s75, 98304
    s_add_u32 m0, s87, 12288
    s_nop 0
    buffer_load_dwordx4 v3, s[52:55], s48 offen offset:0 nt lds
    s_waitcnt vmcnt(11)
    s_add_u32 m0, s87, 12288
    s_nop 0
    buffer_load_dwordx4 v3, s[52:55], s48 offen offset:1024 nt lds
    s_waitcnt vmcnt(11)
    s_add_u32 m0, s87, 12288
    s_nop 0
    buffer_load_dwordx4 v3, s[52:55], s48 offen offset:2048 nt lds
    s_waitcnt vmcnt(11)
    s_add_u32 m0, s87, 12288
    s_nop 0
    buffer_load_dwordx4 v3, s[52:55], s48 offen offset:3072 nt lds
    s_waitcnt vmcnt(11)
    s_add_u32 m0, s87, 16384
    s_nop 0
    buffer_load_dwordx4 v4, s[52:55], s48 offen offset:0 nt lds
    s_waitcnt vmcnt(11)
    s_add_u32 m0, s87, 16384
    s_nop 0
    buffer_load_dwordx4 v4, s[52:55], s48 offen offset:1024 nt lds
    s_waitcnt vmcnt(11)
    s_add_u32 m0, s87, 16384
    s_nop 0
    buffer_load_dwordx4 v4, s[52:55], s48 offen offset:2048 nt lds
    s_waitcnt vmcnt(11)
    s_add_u32 m0, s87, 16384
    s_nop 0
    buffer_load_dwordx4 v4, s[52:55], s48 offen offset:3072 nt lds
    s_waitcnt vmcnt(11)
    s_add_u32 s48, s75, 131072
    s_add_u32 m0, s87, 20480
    s_nop 0
    buffer_load_dwordx4 v3, s[52:55], s48 offen offset:0 nt lds
    s_waitcnt vmcnt(11)
    s_add_u32 m0, s87, 20480
    s_nop 0
    buffer_load_dwordx4 v3, s[52:55], s48 offen offset:1024 nt lds
    s_waitcnt vmcnt(11)
    s_add_u32 m0, s87, 20480
    s_nop 0
    buffer_load_dwordx4 v3, s[52:55], s48 offen offset:2048 nt lds
    s_waitcnt vmcnt(11)
    s_add_u32 m0, s87, 20480
    s_nop 0
    buffer_load_dwordx4 v3, s[52:55], s48 offen offset:3072 nt lds
    s_waitcnt vmcnt(11)
    s_add_u32 m0, s87, 24576
    s_nop 0
    buffer_load_dwordx4 v4, s[52:55], s48 offen offset:0 nt lds
    s_waitcnt vmcnt(11)
    s_add_u32 m0, s87, 24576
    s_nop 0
    buffer_load_dwordx4 v4, s[52:55], s48 offen offset:1024 nt lds
    s_waitcnt vmcnt(11)
    s_add_u32 m0, s87, 24576
    s_nop 0
    buffer_load_dwordx4 v4, s[52:55], s48 offen offset:2048 nt lds
    s_waitcnt vmcnt(11)
    s_add_u32 m0, s87, 24576
    s_nop 0
    buffer_load_dwordx4 v4, s[52:55], s48 offen offset:3072 nt lds
    s_waitcnt vmcnt(11)
    s_add_u32 s48, s75, 163840
    s_add_u32 m0, s87, 28672
    s_nop 0
    buffer_load_dwordx4 v3, s[52:55], s48 offen offset:0 nt lds
    s_waitcnt vmcnt(11)
    s_add_u32 m0, s87, 28672
    s_nop 0
    buffer_load_dwordx4 v3, s[52:55], s48 offen offset:1024 nt lds
    s_waitcnt vmcnt(11)
    s_add_u32 m0, s87, 28672
    s_nop 0
    buffer_load_dwordx4 v3, s[52:55], s48 offen offset:2048 nt lds
    s_waitcnt vmcnt(11)
    s_add_u32 m0, s87, 28672
    s_nop 0
    buffer_load_dwordx4 v3, s[52:55], s48 offen offset:3072 nt lds
    s_waitcnt vmcnt(11)
    buffer_load_dwordx4 v[136:139], v4, s[52:55], s48 offen offset:0 nt
    s_waitcnt vmcnt(11)
    buffer_load_dwordx4 v[140:143], v4, s[52:55], s48 offen offset:1024 nt
    s_waitcnt vmcnt(11)
    buffer_load_dwordx4 v[144:147], v4, s[52:55], s48 offen offset:2048 nt
    s_waitcnt vmcnt(11)
    buffer_load_dwordx4 v[148:151], v4, s[52:55], s48 offen offset:3072 nt
    s_waitcnt vmcnt(11)
    s_add_u32 s48, s75, 196608
    buffer_load_dwordx4 v[152:155], v3, s[52:55], s48 offen offset:0 nt
    s_waitcnt vmcnt(11)
    buffer_load_dwordx4 v[156:159], v3, s[52:55], s48 offen offset:1024 nt
    s_waitcnt vmcnt(11)
    buffer_load_dwordx4 v[160:163], v3, s[52:55], s48 offen offset:2048 nt
    s_waitcnt vmcnt(11)
    buffer_load_dwordx4 v[164:167], v3, s[52:55], s48 offen offset:3072 nt
    s_waitcnt vmcnt(11)
    buffer_load_dwordx4 v[168:171], v4, s[52:55], s48 offen offset:0 nt
    s_waitcnt vmcnt(11)
    buffer_load_dwordx4 v[172:175], v4, s[52:55], s48 offen offset:1024 nt
    s_waitcnt vmcnt(11)
    buffer_load_dwordx4 v[176:179], v4, s[52:55], s48 offen offset:2048 nt
    s_waitcnt vmcnt(11)
    buffer_load_dwordx4 v[180:183], v4, s[52:55], s48 offen offset:3072 nt
    s_waitcnt vmcnt(11)
    s_add_u32 s48, s75, 229376
    buffer_load_dwordx4 v[184:187], v3, s[52:55], s48 offen offset:0 nt
    s_waitcnt vmcnt(11)
    buffer_load_dwordx4 v[188:191], v3, s[52:55], s48 offen offset:1024 nt
    s_waitcnt vmcnt(11)
    buffer_load_dwordx4 v[192:195], v3, s[52:55], s48 offen offset:2048 nt
    s_waitcnt vmcnt(11)
    buffer_load_dwordx4 v[196:199], v3, s[52:55], s48 offen offset:3072 nt
    s_waitcnt vmcnt(11)
    buffer_load_dwordx4 v[200:203], v4, s[52:55], s48 offen offset:0 nt
    s_waitcnt vmcnt(11)
    buffer_load_dwordx4 v[204:207], v4, s[52:55], s48 offen offset:1024 nt
    s_waitcnt vmcnt(11)
    buffer_load_dwordx4 v[208:211], v4, s[52:55], s48 offen offset:2048 nt
    s_waitcnt vmcnt(11)
    buffer_load_dwordx4 v[212:215], v4, s[52:55], s48 offen offset:3072 nt
    s_waitcnt vmcnt(11)
    s_add_u32 s48, s75, 0
    buffer_load_dwordx4 v[216:219], v3, s[56:59], s48 offen offset:0 nt
    s_waitcnt vmcnt(11)
    buffer_load_dwordx4 v[220:223], v3, s[56:59], s48 offen offset:1024 nt
    s_waitcnt vmcnt(11)
    buffer_load_dwordx4 v[224:227], v3, s[56:59], s48 offen offset:2048 nt
    s_waitcnt vmcnt(11)
    buffer_load_dwordx4 v[228:231], v3, s[56:59], s48 offen offset:3072 nt
    s_nop 7
L_stream_loop:
    s_lshl_b32 s50, s74, 1
    s_add_u32 s50, s50, 1
    s_nop 1
L_lw_2:
    ds_read_b32 v8, v5 offset:64
    s_waitcnt lgkmcnt(0)
    v_cmp_gt_u32 vcc, s50, v8
    s_nop 1
    s_cbranch_vccz L_lwd_3
    s_sleep 1
    s_sub_u32 s49, s49, 1
    s_cmp_gt_i32 s49, 0
    s_cbranch_scc1 L_lw_2
L_lwd_3:
    v_and_b32 v6, 15, v2
    v_lshlrev_b32 v6, 4, v6
    ds_read_b128 v[16:19], v6 offset:4608
    ds_read_b128 v[20:23], v6 offset:4864
    ds_read_b128 v[24:27], v6 offset:5120
    ds_read_b128 v[28:31], v6 offset:5376
    s_waitcnt lgkmcnt(0)
    s_waitcnt vmcnt(63)
    v_dot2_f32_bf16 v32, v88, v16, 0
    v_dot2_f32_bf16 v36, v88, v20, 0
    v_dot2_f32_bf16 v40, v88, v24, 0
    v_dot2_f32_bf16 v44, v88, v28, 0
    v_dot2_f32_bf16 v32, v89, v17, v32
    v_dot2_f32_bf16 v36, v89, v21, v36
    v_dot2_f32_bf16 v40, v89, v25, v40
    v_dot2_f32_bf16 v44, v89, v29, v44
    v_dot2_f32_bf16 v32, v90, v18, v32
    v_dot2_f32_bf16 v36, v90, v22, v36
    v_dot2_f32_bf16 v40, v90, v26, v40
    v_dot2_f32_bf16 v44, v90, v30, v44
    v_dot2_f32_bf16 v32, v91, v19, v32
    v_dot2_f32_bf16 v36, v91, v23, v36
    v_dot2_f32_bf16 v40, v91, v27, v40
    v_dot2_f32_bf16 v44, v91, v31, v44
    s_waitcnt vmcnt(11)
    buffer_load_dwordx4 v[88:91], v4, s[56:59], s48 offen offset:0 nt
    s_waitcnt vmcnt(63)
    v_dot2_f32_bf16 v33, v92, v16, 0
    v_dot2_f32_bf16 v37, v92, v20, 0
    v_dot2_f32_bf16 v41, v92, v24, 0
    v_dot2_f32_bf16 v45, v92, v28, 0
    v_dot2_f32_bf16 v33, v93, v17, v33
    v_dot2_f32_bf16 v37, v93, v21, v37
    v_dot2_f32_bf16 v41, v93, v25, v41
    v_dot2_f32_bf16 v45, v93, v29, v45
    v_dot2_f32_bf16 v33, v94, v18, v33
    v_dot2_f32_bf16 v37, v94, v22, v37
    v_dot2_f32_bf16 v41, v94, v26, v41
    v_dot2_f32_bf16 v45, v94, v30, v45
    v_dot2_f32_bf16 v33, v95, v19, v33
    v_dot2_f32_bf16 v37, v95, v23, v37
    v_dot2_f32_bf16 v41, v95, v27, v41
    v_dot2_f32_bf16 v45, v95, v31, v45
    s_waitcnt vmcnt(63)
    v_dot2_f32_bf16 v34, v96, v16, 0
    v_dot2_f32_bf16 v38, v96, v20, 0
    v_dot2_f32_bf16 v42, v96, v24, 0
    v_dot2_f32_bf16 v46, v96, v28, 0
    v_dot2_f32_bf16 v34, v97, v17, v34
    v_dot2_f32_bf16 v38, v97, v21, v38
    v_dot2_f32_bf16 v42, v97, v25, v42
    v_dot2_f32_bf16 v46, v97, v29, v46
    v_dot2_f32_bf16 v34, v98, v18, v34
    v_dot2_f32_bf16 v38, v98, v22, v38
    v_dot2_f32_bf16 v42, v98, v26, v42
    v_dot2_f32_bf16 v46, v98, v30, v46
    v_dot2_f32_bf16 v34, v99, v19, v34
    v_dot2_f32_bf16 v38, v99, v23, v38
    v_dot2_f32_bf16 v42, v99, v27, v42
    v_dot2_f32_bf16 v46, v99, v31, v46
    s_waitcnt vmcnt(11)
    buffer_load_dwordx4 v[92:95], v4, s[56:59], s48 offen offset:1024 nt
    s_waitcnt vmcnt(63)
    v_dot2_f32_bf16 v35, v100, v16, 0
    v_dot2_f32_bf16 v39, v100, v20, 0
    v_dot2_f32_bf16 v43, v100, v24, 0
    v_dot2_f32_bf16 v47, v100, v28, 0
    v_dot2_f32_bf16 v35, v101, v17, v35
    v_dot2_f32_bf16 v39, v101, v21, v39
    v_dot2_f32_bf16 v43, v101, v25, v43
    v_dot2_f32_bf16 v47, v101, v29, v47
    v_dot2_f32_bf16 v35, v102, v18, v35
    v_dot2_f32_bf16 v39, v102, v22, v39
    v_dot2_f32_bf16 v43, v102, v26, v43
    v_dot2_f32_bf16 v47, v102, v30, v47
    v_dot2_f32_bf16 v35, v103, v19, v35
    v_dot2_f32_bf16 v39, v103, v23, v39
    v_dot2_f32_bf16 v43, v103, v27, v43
    v_dot2_f32_bf16 v47, v103, v31, v47
    v_add_f32_dpp v32, v32, v32 row_ror:8 row_mask:0xf bank_mask:0x3
    s_nop 1
    v_add_f32_dpp v32, v40, v40 row_ror:8 row_mask:0xf bank_mask:0xc
    v_add_f32_dpp v33, v33, v33 row_ror:8 row_mask:0xf bank_mask:0x3
    s_nop 1
    v_add_f32_dpp v33, v41, v41 row_ror:8 row_mask:0xf bank_mask:0xc
    v_add_f32_dpp v34, v34, v34 row_ror:8 row_mask:0xf bank_mask:0x3
    s_nop 1
    v_add_f32_dpp v34, v42, v42 row_ror:8 row_mask:0xf bank_mask:0xc
    v_add_f32_dpp v35, v35, v35 row_ror:8 row_mask:0xf bank_mask:0x3
    s_nop 1
    v_add_f32_dpp v35, v43, v43 row_ror:8 row_mask:0xf bank_mask:0xc
    v_add_f32_dpp v36, v36, v36 row_ror:8 row_mask:0xf bank_mask:0x3
    s_nop 1
    v_add_f32_dpp v36, v44, v44 row_ror:8 row_mask:0xf bank_mask:0xc
    v_add_f32_dpp v37, v37, v37 row_ror:8 row_mask:0xf bank_mask:0x3
    s_nop 1
    v_add_f32_dpp v37, v45, v45 row_ror:8 row_mask:0xf bank_mask:0xc
    v_add_f32_dpp v38, v38, v38 row_ror:8 row_mask:0xf bank_mask:0x3
    s_nop 1
    v_add_f32_dpp v38, v46, v46 row_ror:8 row_mask:0xf bank_mask:0xc
    v_add_f32_dpp v39, v39, v39 row_ror:8 row_mask:0xf bank_mask:0x3
    s_nop 1
    v_add_f32_dpp v39, v47, v47 row_ror:8 row_mask:0xf bank_mask:0xc
    v_add_f32_dpp v32, v32, v32 row_shl:4 row_mask:0xf bank_mask:0x5
    s_nop 1
    v_add_f32_dpp v32, v36, v36 row_shr:4 row_mask:0xf bank_mask:0xa
    v_add_f32_dpp v33, v33, v33 row_shl:4 row_mask:0xf bank_mask:0x5
    s_nop 1
    v_add_f32_dpp v33, v37, v37 row_shr:4 row_mask:0xf bank_mask:0xa
    v_add_f32_dpp v34, v34, v34 row_shl:4 row_mask:0xf bank_mask:0x5
    s_nop 1
    v_add_f32_dpp v34, v38, v38 row_shr:4 row_mask:0xf bank_mask:0xa
    v_add_f32_dpp v35, v35, v35 row_shl:4 row_mask:0xf bank_mask:0x5
    s_nop 1
    v_add_f32_dpp v35, v39, v39 row_shr:4 row_mask:0xf bank_mask:0xa
    v_add_f32_dpp v32, v32, v32 quad_perm:[2,3,0,1] row_mask:0xf bank_mask:0xf
    v_add_f32_dpp v34, v34, v34 quad_perm:[2,3,0,1] row_mask:0xf bank_mask:0xf
    v_cndmask_b32 v32, v32, v34, s[68:69]
    v_add_f32_dpp v33, v33, v33 quad_perm:[2,3,0,1] row_mask:0xf bank_mask:0xf
    v_add_f32_dpp v35, v35, v35 quad_perm:[2,3,0,1] row_mask:0xf bank_mask:0xf
    v_cndmask_b32 v33, v33, v35, s[68:69]
    v_add_f32_dpp v32, v32, v32 quad_perm:[1,0,3,2] row_mask:0xf bank_mask:0xf
    s_nop 0
    v_add_f32_dpp v33, v33, v33 quad_perm:[1,0,3,2] row_mask:0xf bank_mask:0xf
    v_cndmask_b32 v48, v32, v33, s[70:71]
    v_cvt_pk_bf16_f32 v48, v48, v48
    v_lshlrev_b32 v48, 16, v48
    v_mul_f32 v48, s73, v48
    v_cvt_pk_bf16_f32 v48, v48, v48
    v_lshlrev_b32 v48, 16, v48
    s_waitcnt vmcnt(63)
    v_dot2_f32_bf16 v32, v104, v16, 0
    v_dot2_f32_bf16 v36, v104, v20, 0
    v_dot2_f32_bf16 v40, v104, v24, 0
    v_dot2_f32_bf16 v44, v104, v28, 0
    v_dot2_f32_bf16 v32, v105, v17, v32
    v_dot2_f32_bf16 v36, v105, v21, v36
    v_dot2_f32_bf16 v40, v105, v25, v40
    v_dot2_f32_bf16 v44, v105, v29, v44
    v_dot2_f32_bf16 v32, v106, v18, v32
    v_dot2_f32_bf16 v36, v106, v22, v36
    v_dot2_f32_bf16 v40, v106, v26, v40
    v_dot2_f32_bf16 v44, v106, v30, v44
    v_dot2_f32_bf16 v32, v107, v19, v32
    v_dot2_f32_bf16 v36, v107, v23, v36
    v_dot2_f32_bf16 v40, v107, v27, v40
    v_dot2_f32_bf16 v44, v107, v31, v44
    s_waitcnt vmcnt(11)
    buffer_load_dwordx4 v[96:99], v4, s[56:59], s48 offen offset:2048 nt
    s_waitcnt vmcnt(63)
    v_dot2_f32_bf16 v33, v108, v16, 0
    v_dot2_f32_bf16 v37, v108, v20, 0
    v_dot2_f32_bf16 v41, v108, v24, 0
    v_dot2_f32_bf16 v45, v108, v28, 0
    v_dot2_f32_bf16 v33, v109, v17, v33
    v_dot2_f32_bf16 v37, v109, v21, v37
    v_dot2_f32_bf16 v41, v109, v25, v41
    v_dot2_f32_bf16 v45, v109, v29, v45
    v_dot2_f32_bf16 v33, v110, v18, v33
    v_dot2_f32_bf16 v37, v110, v22, v37
    v_dot2_f32_bf16 v41, v110, v26, v41
    v_dot2_f32_bf16 v45, v110, v30, v45
    v_dot2_f32_bf16 v33, v111, v19, v33
    v_dot2_f32_bf16 v37, v111, v23, v37
    v_dot2_f32_bf16 v41, v111, v27, v41
    v_dot2_f32_bf16 v45, v111, v31, v45
    s_waitcnt vmcnt(63)
    v_dot2_f32_bf16 v34, v112, v16, 0
    v_dot2_f32_bf16 v38, v112, v20, 0
    v_dot2_f32_bf16 v42, v112, v24, 0
    v_dot2_f32_bf16 v46, v112, v28, 0
    v_dot2_f32_bf16 v34, v113, v17, v34
    v_dot2_f32_bf16 v38, v113, v21, v38
    v_dot2_f32_bf16 v42, v113, v25, v42
    v_dot2_f32_bf16 v46, v113, v29, v46
    v_dot2_f32_bf16 v34, v114, v18, v34
    v_dot2_f32_bf16 v38, v114, v22, v38
    v_dot2_f32_bf16 v42, v114, v26, v42
    v_dot2_f32_bf16 v46, v114, v30, v46
    v_dot2_f32_bf16 v34, v115, v19, v34
    v_dot2_f32_bf16 v38, v115, v23, v38
    v_dot2_f32_bf16 v42, v115, v27, v42
    v_dot2_f32_bf16 v46, v115, v31, v46
    s_waitcnt vmcnt(11)
    buffer_load_dwordx4 v[100:103], v4, s[56:59], s48 offen offset:3072 nt
    s_waitcnt vmcnt(63)
    v_dot2_f32_bf16 v35, v116, v16, 0
    v_dot2_f32_bf16 v39, v116, v20, 0
    v_dot2_f32_bf16 v43, v116, v24, 0
    v_dot2_f32_bf16 v47, v116, v28, 0
    v_dot2_f32_bf16 v35, v117, v17, v35
    v_dot2_f32_bf16 v39, v117, v21, v39
    v_dot2_f32_bf16 v43, v117, v25, v43
    v_dot2_f32_bf16 v47, v117, v29, v47
    v_dot2_f32_bf16 v35, v118, v18, v35
    v_dot2_f32_bf16 v39, v118, v22, v39
    v_dot2_f32_bf16 v43, v118, v26, v43
    v_dot2_f32_bf16 v47, v118, v30, v47
    v_dot2_f32_bf16 v35, v119, v19, v35
    v_dot2_f32_bf16 v39, v119, v23, v39
    v_dot2_f32_bf16 v43, v119, v27, v43
    v_dot2_f32_bf16 v47, v119, v31, v47
    v_add_f32_dpp v32, v32, v32 row_ror:8 row_mask:0xf bank_mask:0x3
    s_nop 1
    v_add_f32_dpp v32, v40, v40 row_ror:8 row_mask:0xf bank_mask:0xc
    v_add_f32_dpp v33, v33, v33 row_ror:8 row_mask:0xf bank_mask:0x3
    s_nop 1
    v_add_f32_dpp v33, v41, v41 row_ror:8 row_mask:0xf bank_mask:0xc
    v_add_f32_dpp v34, v34, v34 row_ror:8 row_mask:0xf bank_mask:0x3
    s_nop 1
    v_add_f32_dpp v34, v42, v42 row_ror:8 row_mask:0xf bank_mask:0xc
    v_add_f32_dpp v35, v35, v35 row_ror:8 row_mask:0xf bank_mask:0x3
    s_nop 1
    v_add_f32_dpp v35, v43, v43 row_ror:8 row_mask:0xf bank_mask:0xc
    v_add_f32_dpp v36, v36, v36 row_ror:8 row_mask:0xf bank_mask:0x3
    s_nop 1
    v_add_f32_dpp v36, v44, v44 row_ror:8 row_mask:0xf bank_mask:0xc
    v_add_f32_dpp v37, v37, v37 row_ror:8 row_mask:0xf bank_mask:0x3
    s_nop 1
    v_add_f32_dpp v37, v45, v45 row_ror:8 row_mask:0xf bank_mask:0xc
    v_add_f32_dpp v38, v38, v38 row_ror:8 row_mask:0xf bank_mask:0x3
    s_nop 1
    v_add_f32_dpp v38, v46, v46 row_ror:8 row_mask:0xf bank_mask:0xc
    v_add_f32_dpp v39, v39, v39 row_ror:8 row_mask:0xf bank_mask:0x3
    s_nop 1
    v_add_f32_dpp v39, v47, v47 row_ror:8 row_mask:0xf bank_mask:0xc
    v_add_f32_dpp v32, v32, v32 row_shl:4 row_mask:0xf bank_mask:0x5
    s_nop 1
    v_add_f32_dpp v32, v36, v36 row_shr:4 row_mask:0xf bank_mask:0xa
    v_add_f32_dpp v33, v33, v33 row_shl:4 row_mask:0xf bank_mask:0x5
    s_nop 1
    v_add_f32_dpp v33, v37, v37 row_shr:4 row_mask:0xf bank_mask:0xa
    v_add_f32_dpp v34, v34, v34 row_shl:4 row_mask:0xf bank_mask:0x5
    s_nop 1
    v_add_f32_dpp v34, v38, v38 row_shr:4 row_mask:0xf bank_mask:0xa
    v_add_f32_dpp v35, v35, v35 row_shl:4 row_mask:0xf bank_mask:0x5
    s_nop 1
    v_add_f32_dpp v35, v39, v39 row_shr:4 row_mask:0xf bank_mask:0xa
    v_add_f32_dpp v32, v32, v32 quad_perm:[2,3,0,1] row_mask:0xf bank_mask:0xf
    v_add_f32_dpp v34, v34, v34 quad_perm:[2,3,0,1] row_mask:0xf bank_mask:0xf
    v_cndmask_b32 v32, v32, v34, s[68:69]
    v_add_f32_dpp v33, v33, v33 quad_perm:[2,3,0,1] row_mask:0xf bank_mask:0xf
    v_add_f32_dpp v35, v35, v35 quad_perm:[2,3,0,1] row_mask:0xf bank_mask:0xf
    v_cndmask_b32 v33, v33, v35, s[68:69]
    v_add_f32_dpp v32, v32, v32 quad_perm:[1,0,3,2] row_mask:0xf bank_mask:0xf
    s_nop 0
    v_add_f32_dpp v33, v33, v33 quad_perm:[1,0,3,2] row_mask:0xf bank_mask:0xf
    v_cndmask_b32 v49, v32, v33, s[70:71]
    v_cvt_pk_bf16_f32 v49, v49, v49
    v_lshlrev_b32 v49, 16, v49
    v_mul_f32 v49, s73, v49
    v_cvt_pk_bf16_f32 v49, v49, v49
    v_lshlrev_b32 v49, 16, v49
    s_waitcnt vmcnt(63)
    v_dot2_f32_bf16 v32, v120, v16, 0
    v_dot2_f32_bf16 v36, v120, v20, 0
    v_dot2_f32_bf16 v40, v120, v24, 0
    v_dot2_f32_bf16 v44, v120, v28, 0
    v_dot2_f32_bf16 v32, v121, v17, v32
    v_dot2_f32_bf16 v36, v121, v21, v36
    v_dot2_f32_bf16 v40, v121, v25, v40
    v_dot2_f32_bf16 v44, v121, v29, v44
    v_dot2_f32_bf16 v32, v122, v18, v32
    v_dot2_f32_bf16 v36, v122, v22, v36
    v_dot2_f32_bf16 v40, v122, v26, v40
    v_dot2_f32_bf16 v44, v122, v30, v44
    v_dot2_f32_bf16 v32, v123, v19, v32
    v_dot2_f32_bf16 v36, v123, v23, v36
    v_dot2_f32_bf16 v40, v123, v27, v40
    v_dot2_f32_bf16 v44, v123, v31, v44
    s_waitcnt vmcnt(11)
    s_add_u32 s48, s75, 32768
    buffer_load_dwordx4 v[104:107], v3, s[56:59], s48 offen offset:0 nt
    s_waitcnt vmcnt(63)
    v_dot2_f32_bf16 v33, v124, v16, 0
    v_dot2_f32_bf16 v37, v124, v20, 0
    v_dot2_f32_bf16 v41, v124, v24, 0
    v_dot2_f32_bf16 v45, v124, v28, 0
    v_dot2_f32_bf16 v33, v125, v17, v33
    v_dot2_f32_bf16 v37, v125, v21, v37
    v_dot2_f32_bf16 v41, v125, v25, v41
    v_dot2_f32_bf16 v45, v125, v29, v45
    v_dot2_f32_bf16 v33, v126, v18, v33
    v_dot2_f32_bf16 v37, v126, v22, v37
    v_dot2_f32_bf16 v41, v126, v26, v41
    v_dot2_f32_bf16 v45, v126, v30, v45
    v_dot2_f32_bf16 v33, v127, v19, v33
    v_dot2_f32_bf16 v37, v127, v23, v37
    v_dot2_f32_bf16 v41, v127, v27, v41
    v_dot2_f32_bf16 v45, v127, v31, v45
    s_waitcnt vmcnt(62)
    v_dot2_f32_bf16 v34, v128, v16, 0
    v_dot2_f32_bf16 v38, v128, v20, 0
    v_dot2_f32_bf16 v42, v128, v24, 0
    v_dot2_f32_bf16 v46, v128, v28, 0
    v_dot2_f32_bf16 v34, v129, v17, v34
    v_dot2_f32_bf16 v38, v129, v21, v38
    v_dot2_f32_bf16 v42, v129, v25, v42
    v_dot2_f32_bf16 v46, v129, v29, v46
    v_dot2_f32_bf16 v34, v130, v18, v34
    v_dot2_f32_bf16 v38, v130, v22, v38
    v_dot2_f32_bf16 v42, v130, v26, v42
    v_dot2_f32_bf16 v46, v130, v30, v46
    v_dot2_f32_bf16 v34, v131, v19, v34
    v_dot2_f32_bf16 v38, v131, v23, v38
    v_dot2_f32_bf16 v42, v131, v27, v42
    v_dot2_f32_bf16 v46, v131, v31, v46
    s_waitcnt vmcnt(11)
    buffer_load_dwordx4 v[108:111], v3, s[56:59], s48 offen offset:1024 nt
    s_waitcnt vmcnt(62)
    v_dot2_f32_bf16 v35, v132, v16, 0
    v_dot2_f32_bf16 v39, v132, v20, 0
    v_dot2_f32_bf16 v43, v132, v24, 0
    v_dot2_f32_bf16 v47, v132, v28, 0
    v_dot2_f32_bf16 v35, v133, v17, v35
    v_dot2_f32_bf16 v39, v133, v21, v39
    v_dot2_f32_bf16 v43, v133, v25, v43
    v_dot2_f32_bf16 v47, v133, v29, v47
    v_dot2_f32_bf16 v35, v134, v18, v35
    v_dot2_f32_bf16 v39, v134, v22, v39
    v_dot2_f32_bf16 v43, v134, v26, v43
    v_dot2_f32_bf16 v47, v134, v30, v47
    v_dot2_f32_bf16 v35, v135, v19, v35
    v_dot2_f32_bf16 v39, v135, v23, v39
    v_dot2_f32_bf16 v43, v135, v27, v43
    v_dot2_f32_bf16 v47, v135, v31, v47
    v_add_f32_dpp v32, v32, v32 row_ror:8 row_mask:0xf bank_mask:0x3
    s_nop 1
    v_add_f32_dpp v32, v40, v40 row_ror:8 row_mask:0xf bank_mask:0xc
    v_add_f32_dpp v33, v33, v33 row_ror:8 row_mask:0xf bank_mask:0x3
    s_nop 1
    v_add_f32_dpp v33, v41, v41 row_ror:8 row_mask:0xf bank_mask:0xc
    v_add_f32_dpp v34, v34, v34 row_ror:8 row_mask:0xf bank_mask:0x3
    s_nop 1
    v_add_f32_dpp v34, v42, v42 row_ror:8 row_mask:0xf bank_mask:0xc
    v_add_f32_dpp v35, v35, v35 row_ror:8 row_mask:0xf bank_mask:0x3
    s_nop 1
    v_add_f32_dpp v35, v43, v43 row_ror:8 row_mask:0xf bank_mask:0xc
    v_add_f32_dpp v36, v36, v36 row_ror:8 row_mask:0xf bank_mask:0x3
    s_nop 1
    v_add_f32_dpp v36, v44, v44 row_ror:8 row_mask:0xf bank_mask:0xc
    v_add_f32_dpp v37, v37, v37 row_ror:8 row_mask:0xf bank_mask:0x3
    s_nop 1
    v_add_f32_dpp v37, v45, v45 row_ror:8 row_mask:0xf bank_mask:0xc
    v_add_f32_dpp v38, v38, v38 row_ror:8 row_mask:0xf bank_mask:0x3
    s_nop 1
    v_add_f32_dpp v38, v46, v46 row_ror:8 row_mask:0xf bank_mask:0xc
    v_add_f32_dpp v39, v39, v39 row_ror:8 row_mask:0xf bank_mask:0x3
    s_nop 1
    v_add_f32_dpp v39, v47, v47 row_ror:8 row_mask:0xf bank_mask:0xc
    v_add_f32_dpp v32, v32, v32 row_shl:4 row_mask:0xf bank_mask:0x5
    s_nop 1
    v_add_f32_dpp v32, v36, v36 row_shr:4 row_mask:0xf bank_mask:0xa
    v_add_f32_dpp v33, v33, v33 row_shl:4 row_mask:0xf bank_mask:0x5
    s_nop 1
    v_add_f32_dpp v33, v37, v37 row_shr:4 row_mask:0xf bank_mask:0xa
    v_add_f32_dpp v34, v34, v34 row_shl:4 row_mask:0xf bank_mask:0x5
    s_nop 1
    v_add_f32_dpp v34, v38, v38 row_shr:4 row_mask:0xf bank_mask:0xa
    v_add_f32_dpp v35, v35, v35 row_shl:4 row_mask:0xf bank_mask:0x5
    s_nop 1
    v_add_f32_dpp v35, v39, v39 row_shr:4 row_mask:0xf bank_mask:0xa
    v_add_f32_dpp v32, v32, v32 quad_perm:[2,3,0,1] row_mask:0xf bank_mask:0xf
    v_add_f32_dpp v34, v34, v34 quad_perm:[2,3,0,1] row_mask:0xf bank_mask:0xf
    v_cndmask_b32 v32, v32, v34, s[68:69]
    v_add_f32_dpp v33, v33, v33 quad_perm:[2,3,0,1] row_mask:0xf bank_mask:0xf
    v_add_f32_dpp v35, v35, v35 quad_perm:[2,3,0,1] row_mask:0xf bank_mask:0xf
    v_cndmask_b32 v33, v33, v35, s[68:69]
    v_add_f32_dpp v32, v32, v32 quad_perm:[1,0,3,2] row_mask:0xf bank_mask:0xf
    s_nop 0
    v_add_f32_dpp v33, v33, v33 quad_perm:[1,0,3,2] row_mask:0xf bank_mask:0xf
    v_cndmask_b32 v50, v32, v33, s[70:71]
    v_cvt_pk_bf16_f32 v50, v50, v50
    v_lshlrev_b32 v50, 16, v50
    v_mul_f32 v50, s73, v50
    v_cvt_pk_bf16_f32 v50, v50, v50
    v_lshlrev_b32 v50, 16, v50
    s_waitcnt vmcnt(58)
    ds_read_b128 v[112:115], v14 offset:0
    ds_read_b128 v[116:119], v14 offset:1024
    ds_read_b128 v[120:123], v14 offset:2048
    ds_read_b128 v[124:127], v14 offset:3072
    s_waitcnt lgkmcnt(0)
    v_dot2_f32_bf16 v32, v112, v16, 0
    v_dot2_f32_bf16 v36, v112, v20, 0
    v_dot2_f32_bf16 v40, v112, v24, 0
    v_dot2_f32_bf16 v44, v112, v28, 0
    v_dot2_f32_bf16 v32, v113, v17, v32
    v_dot2_f32_bf16 v36, v113, v21, v36
    v_dot2_f32_bf16 v40, v113, v25, v40
    v_dot2_f32_bf16 v44, v113, v29, v44
    v_dot2_f32_bf16 v32, v114, v18, v32
    v_dot2_f32_bf16 v36, v114, v22, v36
    v_dot2_f32_bf16 v40, v114, v26, v40
    v_dot2_f32_bf16 v44, v114, v30, v44
    v_dot2_f32_bf16 v32, v115, v19, v32
    v_dot2_f32_bf16 v36, v115, v23, v36
    v_dot2_f32_bf16 v40, v115, v27, v40
    v_dot2_f32_bf16 v44, v115, v31, v44
    s_waitcnt vmcnt(11)
    buffer_load_dwordx4 v[112:115], v3, s[56:59], s48 offen offset:2048 nt
    v_dot2_f32_bf16 v33, v116, v16, 0
    v_dot2_f32_bf16 v37, v116, v20, 0
    v_dot2_f32_bf16 v41, v116, v24, 0
    v_dot2_f32_bf16 v45, v116, v28, 0
    v_dot2_f32_bf16 v33, v117, v17, v33
    v_dot2_f32_bf16 v37, v117, v21, v37
    v_dot2_f32_bf16 v41, v117, v25, v41
    v_dot2_f32_bf16 v45, v117, v29, v45
    v_dot2_f32_bf16 v33, v118, v18, v33
    v_dot2_f32_bf16 v37, v118, v22, v37
    v_dot2_f32_bf16 v41, v118, v26, v41
    v_dot2_f32_bf16 v45, v118, v30, v45
    v_dot2_f32_bf16 v33, v119, v19, v33
    v_dot2_f32_bf16 v37, v119, v23, v37
    v_dot2_f32_bf16 v41, v119, v27, v41
    v_dot2_f32_bf16 v45, v119, v31, v45
    v_dot2_f32_bf16 v34, v120, v16, 0
    v_dot2_f32_bf16 v38, v120, v20, 0
    v_dot2_f32_bf16 v42, v120, v24, 0
    v_dot2_f32_bf16 v46, v120, v28, 0
    v_dot2_f32_bf16 v34, v121, v17, v34
    v_dot2_f32_bf16 v38, v121, v21, v38
    v_dot2_f32_bf16 v42, v121, v25, v42
    v_dot2_f32_bf16 v46, v121, v29, v46
    v_dot2_f32_bf16 v34, v122, v18, v34
    v_dot2_f32_bf16 v38, v122, v22, v38
    v_dot2_f32_bf16 v42, v122, v26, v42
    v_dot2_f32_bf16 v46, v122, v30, v46
    v_dot2_f32_bf16 v34, v123, v19, v34
    v_dot2_f32_bf16 v38, v123, v23, v38
    v_dot2_f32_bf16 v42, v123, v27, v42
    v_dot2_f32_bf16 v46, v123, v31, v46
    s_waitcnt vmcnt(11)
    buffer_load_dwordx4 v[116:119], v3, s[56:59], s48 offen offset:3072 nt
    v_dot2_f32_bf16 v35, v124, v16, 0
    v_dot2_f32_bf16 v39, v124, v20, 0
    v_dot2_f32_bf16 v43, v124, v24, 0
    v_dot2_f32_bf16 v47, v124, v28, 0
    v_dot2_f32_bf16 v35, v125, v17, v35
    v_dot2_f32_bf16 v39, v125, v21, v39
    v_dot2_f32_bf16 v43, v125, v25, v43
    v_dot2_f32_bf16 v47, v125, v29, v47
    v_dot2_f32_bf16 v35, v126, v18, v35
    v_dot2_f32_bf16 v39, v126, v22, v39
    v_dot2_f32_bf16 v43, v126, v26, v43
    v_dot2_f32_bf16 v47, v126, v30, v47
    v_dot2_f32_bf16 v35, v127, v19, v35
    v_dot2_f32_bf16 v39, v127, v23, v39
    v_dot2_f32_bf16 v43, v127, v27, v43
    v_dot2_f32_bf16 v47, v127, v31, v47
    v_add_f32_dpp v32, v32, v32 row_ror:8 row_mask:0xf bank_mask:0x3
    s_nop 1
    v_add_f32_dpp v32, v40, v40 row_ror:8 row_mask:0xf bank_mask:0xc
    v_add_f32_dpp v33, v33, v33 row_ror:8 row_mask:0xf bank_mask:0x3
    s_nop 1
    v_add_f32_dpp v33, v41, v41 row_ror:8 row_mask:0xf bank_mask:0xc
    v_add_f32_dpp v34, v34, v34 row_ror:8 row_mask:0xf bank_mask:0x3
    s_nop 1
    v_add_f32_dpp v34, v42, v42 row_ror:8 row_mask:0xf bank_mask:0xc
    v_add_f32_dpp v35, v35, v35 row_ror:8 row_mask:0xf bank_mask:0x3
    s_nop 1
    v_add_f32_dpp v35, v43, v43 row_ror:8 row_mask:0xf bank_mask:0xc
    v_add_f32_dpp v36, v36, v36 row_ror:8 row_mask:0xf bank_mask:0x3
    s_nop 1
    v_add_f32_dpp v36, v44, v44 row_ror:8 row_mask:0xf bank_mask:0xc
    v_add_f32_dpp v37, v37, v37 row_ror:8 row_mask:0xf bank_mask:0x3
    s_nop 1
    v_add_f32_dpp v37, v45, v45 row_ror:8 row_mask:0xf bank_mask:0xc
    v_add_f32_dpp v38, v38, v38 row_ror:8 row_mask:0xf bank_mask:0x3
    s_nop 1
    v_add_f32_dpp v38, v46, v46 row_ror:8 row_mask:0xf bank_mask:0xc
    v_add_f32_dpp v39, v39, v39 row_ror:8 row_mask:0xf bank_mask:0x3
    s_nop 1
    v_add_f32_dpp v39, v47, v47 row_ror:8 row_mask:0xf bank_mask:0xc
    v_add_f32_dpp v32, v32, v32 row_shl:4 row_mask:0xf bank_mask:0x5
    s_nop 1
    v_add_f32_dpp v32, v36, v36 row_shr:4 row_mask:0xf bank_mask:0xa
    v_add_f32_dpp v33, v33, v33 row_shl:4 row_mask:0xf bank_mask:0x5
    s_nop 1
    v_add_f32_dpp v33, v37, v37 row_shr:4 row_mask:0xf bank_mask:0xa
    v_add_f32_dpp v34, v34, v34 row_shl:4 row_mask:0xf bank_mask:0x5
    s_nop 1
    v_add_f32_dpp v34, v38, v38 row_shr:4 row_mask:0xf bank_mask:0xa
    v_add_f32_dpp v35, v35, v35 row_shl:4 row_mask:0xf bank_mask:0x5
    s_nop 1
    v_add_f32_dpp v35, v39, v39 row_shr:4 row_mask:0xf bank_mask:0xa
    v_add_f32_dpp v32, v32, v32 quad_perm:[2,3,0,1] row_mask:0xf bank_mask:0xf
    v_add_f32_dpp v34, v34, v34 quad_perm:[2,3,0,1] row_mask:0xf bank_mask:0xf
    v_cndmask_b32 v32, v32, v34, s[68:69]
    v_add_f32_dpp v33, v33, v33 quad_perm:[2,3,0,1] row_mask:0xf bank_mask:0xf
    v_add_f32_dpp v35, v35, v35 quad_perm:[2,3,0,1] row_mask:0xf bank_mask:0xf
    v_cndmask_b32 v33, v33, v35, s[68:69]
    v_add_f32_dpp v32, v32, v32 quad_perm:[1,0,3,2] row_mask:0xf bank_mask:0xf
    s_nop 0
    v_add_f32_dpp v33, v33, v33 quad_perm:[1,0,3,2] row_mask:0xf bank_mask:0xf
    v_cndmask_b32 v51, v32, v33, s[70:71]
    v_cvt_pk_bf16_f32 v51, v51, v51
    v_lshlrev_b32 v51, 16, v51
    v_mul_f32 v51, s73, v51
    v_cvt_pk_bf16_f32 v51, v51, v51
    v_lshlrev_b32 v51, 16, v51
    s_waitcnt vmcnt(56)
    ds_read_b128 v[120:123], v14 offset:4096
    ds_read_b128 v[124:127], v14 offset:5120
    ds_read_b128 v[128:131], v14 offset:6144
    ds_read_b128 v[132:135], v14 offset:7168
    s_waitcnt lgkmcnt(0)
    v_dot2_f32_bf16 v32, v120, v16, 0
    v_dot2_f32_bf16 v36, v120, v20, 0
    v_dot2_f32_bf16 v40, v120, v24, 0
    v_dot2_f32_bf16 v44, v120, v28, 0
    v_dot2_f32_bf16 v32, v121, v17, v32
    v_dot2_f32_bf16 v36, v121, v21, v36
    v_dot2_f32_bf16 v40, v121, v25, v40
    v_dot2_f32_bf16 v44, v121, v29, v44
    v_dot2_f32_bf16 v32, v122, v18, v32
    v_dot2_f32_bf16 v36, v122, v22, v36
    v_dot2_f32_bf16 v40, v122, v26, v40
    v_dot2_f32_bf16 v44, v122, v30, v44
    v_dot2_f32_bf16 v32, v123, v19, v32
    v_dot2_f32_bf16 v36, v123, v23, v36
    v_dot2_f32_bf16 v40, v123, v27, v40
    v_dot2_f32_bf16 v44, v123, v31, v44
    s_waitcnt vmcnt(11)
    buffer_load_dwordx4 v[120:123], v4, s[56:59], s48 offen offset:0 nt
    v_dot2_f32_bf16 v33, v124, v16, 0
    v_dot2_f32_bf16 v37, v124, v20, 0
    v_dot2_f32_bf16 v41, v124, v24, 0
    v_dot2_f32_bf16 v45, v124, v28, 0
    v_dot2_f32_bf16 v33, v125, v17, v33
    v_dot2_f32_bf16 v37, v125, v21, v37
    v_dot2_f32_bf16 v41, v125, v25, v41
    v_dot2_f32_bf16 v45, v125, v29, v45
    v_dot2_f32_bf16 v33, v126, v18, v33
    v_dot2_f32_bf16 v37, v126, v22, v37
    v_dot2_f32_bf16 v41, v126, v26, v41
    v_dot2_f32_bf16 v45, v126, v30, v45
    v_dot2_f32_bf16 v33, v127, v19, v33
    v_dot2_f32_bf16 v37, v127, v23, v37
    v_dot2_f32_bf16 v41, v127, v27, v41
    v_dot2_f32_bf16 v45, v127, v31, v45
    v_dot2_f32_bf16 v34, v128, v16, 0
    v_dot2_f32_bf16 v38, v128, v20, 0
    v_dot2_f32_bf16 v42, v128, v24, 0
    v_dot2_f32_bf16 v46, v128, v28, 0
    v_dot2_f32_bf16 v34, v129, v17, v34
    v_dot2_f32_bf16 v38, v129, v21, v38
    v_dot2_f32_bf16 v42, v129, v25, v42
    v_dot2_f32_bf16 v46, v129, v29, v46
    v_dot2_f32_bf16 v34, v130, v18, v34
    v_dot2_f32_bf16 v38, v130, v22, v38
    v_dot2_f32_bf16 v42, v130, v26, v42
    v_dot2_f32_bf16 v46, v130, v30, v46
    v_dot2_f32_bf16 v34, v131, v19, v34
    v_dot2_f32_bf16 v38, v131, v23, v38
    v_dot2_f32_bf16 v42, v131, v27, v42
    v_dot2_f32_bf16 v46, v131, v31, v46
    s_waitcnt vmcnt(11)
    buffer_load_dwordx4 v[124:127], v4, s[56:59], s48 offen offset:1024 nt
    v_dot2_f32_bf16 v35, v132, v16, 0
    v_dot2_f32_bf16 v39, v132, v20, 0
    v_dot2_f32_bf16 v43, v132, v24, 0
    v_dot2_f32_bf16 v47, v132, v28, 0
    v_dot2_f32_bf16 v35, v133, v17, v35
    v_dot2_f32_bf16 v39, v133, v21, v39
    v_dot2_f32_bf16 v43, v133, v25, v43
    v_dot2_f32_bf16 v47, v133, v29, v47
    v_dot2_f32_bf16 v35, v134, v18, v35
    v_dot2_f32_bf16 v39, v134, v22, v39
    v_dot2_f32_bf16 v43, v134, v26, v43
    v_dot2_f32_bf16 v47, v134, v30, v47
    v_dot2_f32_bf16 v35, v135, v19, v35
    v_dot2_f32_bf16 v39, v135, v23, v39
    v_dot2_f32_bf16 v43, v135, v27, v43
    v_dot2_f32_bf16 v47, v135, v31, v47
    v_add_f32_dpp v32, v32, v32 row_ror:8 row_mask:0xf bank_mask:0x3
    s_nop 1
    v_add_f32_dpp v32, v40, v40 row_ror:8 row_mask:0xf bank_mask:0xc
    v_add_f32_dpp v33, v33, v33 row_ror:8 row_mask:0xf bank_mask:0x3
    s_nop 1
    v_add_f32_dpp v33, v41, v41 row_ror:8 row_mask:0xf bank_mask:0xc
    v_add_f32_dpp v34, v34, v34 row_ror:8 row_mask:0xf bank_mask:0x3
    s_nop 1
    v_add_f32_dpp v34, v42, v42 row_ror:8 row_mask:0xf bank_mask:0xc
    v_add_f32_dpp v35, v35, v35 row_ror:8 row_mask:0xf bank_mask:0x3
    s_nop 1
    v_add_f32_dpp v35, v43, v43 row_ror:8 row_mask:0xf bank_mask:0xc
    v_add_f32_dpp v36, v36, v36 row_ror:8 row_mask:0xf bank_mask:0x3
    s_nop 1
    v_add_f32_dpp v36, v44, v44 row_ror:8 row_mask:0xf bank_mask:0xc
    v_add_f32_dpp v37, v37, v37 row_ror:8 row_mask:0xf bank_mask:0x3
    s_nop 1
    v_add_f32_dpp v37, v45, v45 row_ror:8 row_mask:0xf bank_mask:0xc
    v_add_f32_dpp v38, v38, v38 row_ror:8 row_mask:0xf bank_mask:0x3
    s_nop 1
    v_add_f32_dpp v38, v46, v46 row_ror:8 row_mask:0xf bank_mask:0xc
    v_add_f32_dpp v39, v39, v39 row_ror:8 row_mask:0xf bank_mask:0x3
    s_nop 1
    v_add_f32_dpp v39, v47, v47 row_ror:8 row_mask:0xf bank_mask:0xc
    v_add_f32_dpp v32, v32, v32 row_shl:4 row_mask:0xf bank_mask:0x5
    s_nop 1
    v_add_f32_dpp v32, v36, v36 row_shr:4 row_mask:0xf bank_mask:0xa
    v_add_f32_dpp v33, v33, v33 row_shl:4 row_mask:0xf bank_mask:0x5
    s_nop 1
    v_add_f32_dpp v33, v37, v37 row_shr:4 row_mask:0xf bank_mask:0xa
    v_add_f32_dpp v34, v34, v34 row_shl:4 row_mask:0xf bank_mask:0x5
    s_nop 1
    v_add_f32_dpp v34, v38, v38 row_shr:4 row_mask:0xf bank_mask:0xa
    v_add_f32_dpp v35, v35, v35 row_shl:4 row_mask:0xf bank_mask:0x5
    s_nop 1
    v_add_f32_dpp v35, v39, v39 row_shr:4 row_mask:0xf bank_mask:0xa
    v_add_f32_dpp v32, v32, v32 quad_perm:[2,3,0,1] row_mask:0xf bank_mask:0xf
    v_add_f32_dpp v34, v34, v34 quad_perm:[2,3,0,1] row_mask:0xf bank_mask:0xf
    v_cndmask_b32 v32, v32, v34, s[68:69]
    v_add_f32_dpp v33, v33, v33 quad_perm:[2,3,0,1] row_mask:0xf bank_mask:0xf
    v_add_f32_dpp v35, v35, v35 quad_perm:[2,3,0,1] row_mask:0xf bank_mask:0xf
    v_cndmask_b32 v33, v33, v35, s[68:69]
    v_add_f32_dpp v32, v32, v32 quad_perm:[1,0,3,2] row_mask:0xf bank_mask:0xf
    s_nop 0
    v_add_f32_dpp v33, v33, v33 quad_perm:[1,0,3,2] row_mask:0xf bank_mask:0xf
    v_cndmask_b32 v52, v32, v33, s[70:71]
    v_cvt_pk_bf16_f32 v52, v52, v52
    v_lshlrev_b32 v52, 16, v52
    v_mul_f32 v52, s73, v52
    v_cvt_pk_bf16_f32 v52, v52, v52
    v_lshlrev_b32 v52, 16, v52
    s_waitcnt vmcnt(54)
    ds_read_b128 v[128:131], v14 offset:8192
    ds_read_b128 v[132:135], v14 offset:9216
    ds_read_b128 v[232:235], v14 offset:10240
    ds_read_b128 v[236:239], v14 offset:11264
    s_waitcnt lgkmcnt(0)
    v_dot2_f32_bf16 v32, v128, v16, 0
    v_dot2_f32_bf16 v36, v128, v20, 0
    v_dot2_f32_bf16 v40, v128, v24, 0
    v_dot2_f32_bf16 v44, v128, v28, 0
    v_dot2_f32_bf16 v32, v129, v17, v32
    v_dot2_f32_bf16 v36, v129, v21, v36
    v_dot2_f32_bf16 v40, v129, v25, v40
    v_dot2_f32_bf16 v44, v129, v29, v44
    v_dot2_f32_bf16 v32, v130, v18, v32
    v_dot2_f32_bf16 v36, v130, v22, v36
    v_dot2_f32_bf16 v40, v130, v26, v40
    v_dot2_f32_bf16 v44, v130, v30, v44
    v_dot2_f32_bf16 v32, v131, v19, v32
    v_dot2_f32_bf16 v36, v131, v23, v36
    v_dot2_f32_bf16 v40, v131, v27, v40
    v_dot2_f32_bf16 v44, v131, v31, v44
    v_dot2_f32_bf16 v33, v132, v16, 0
    v_dot2_f32_bf16 v37, v132, v20, 0
    v_dot2_f32_bf16 v41, v132, v24, 0
    v_dot2_f32_bf16 v45, v132, v28, 0
    v_dot2_f32_bf16 v33, v133, v17, v33
    v_dot2_f32_bf16 v37, v133, v21, v37
    v_dot2_f32_bf16 v41, v133, v25, v41
    v_dot2_f32_bf16 v45, v133, v29, v45
    v_dot2_f32_bf16 v33, v134, v18, v33
    v_dot2_f32_bf16 v37, v134, v22, v37
    v_dot2_f32_bf16 v41, v134, v26, v41
    v_dot2_f32_bf16 v45, v134, v30, v45
    v_dot2_f32_bf16 v33, v135, v19, v33
    v_dot2_f32_bf16 v37, v135, v23, v37
    v_dot2_f32_bf16 v41, v135, v27, v41
    v_dot2_f32_bf16 v45, v135, v31, v45
    v_dot2_f32_bf16 v34, v232, v16, 0
    v_dot2_f32_bf16 v38, v232, v20, 0
    v_dot2_f32_bf16 v42, v232, v24, 0
    v_dot2_f32_bf16 v46, v232, v28, 0
    v_dot2_f32_bf16 v34, v233, v17, v34
    v_dot2_f32_bf16 v38, v233, v21, v38
    v_dot2_f32_bf16 v42, v233, v25, v42
    v_dot2_f32_bf16 v46, v233, v29, v46
    v_dot2_f32_bf16 v34, v234, v18, v34
    v_dot2_f32_bf16 v38, v234, v22, v38
    v_dot2_f32_bf16 v42, v234, v26, v42
    v_dot2_f32_bf16 v46, v234, v30, v46
    v_dot2_f32_bf16 v34, v235, v19, v34
    v_dot2_f32_bf16 v38, v235, v23, v38
    v_dot2_f32_bf16 v42, v235, v27, v42
    v_dot2_f32_bf16 v46, v235, v31, v46
    s_waitcnt vmcnt(11)
    buffer_load_dwordx4 v[128:131], v4, s[56:59], s48 offen offset:2048 nt
    v_dot2_f32_bf16 v35, v236, v16, 0
    v_dot2_f32_bf16 v39, v236, v20, 0
    v_dot2_f32_bf16 v43, v236, v24, 0
    v_dot2_f32_bf16 v47, v236, v28, 0
    v_dot2_f32_bf16 v35, v237, v17, v35
    v_dot2_f32_bf16 v39, v237, v21, v39
    v_dot2_f32_bf16 v43, v237, v25, v43
    v_dot2_f32_bf16 v47, v237, v29, v47
    v_dot2_f32_bf16 v35, v238, v18, v35
    v_dot2_f32_bf16 v39, v238, v22, v39
    v_dot2_f32_bf16 v43, v238, v26, v43
    v_dot2_f32_bf16 v47, v238, v30, v47
    v_dot2_f32_bf16 v35, v239, v19, v35
    v_dot2_f32_bf16 v39, v239, v23, v39
    v_dot2_f32_bf16 v43, v239, v27, v43
    v_dot2_f32_bf16 v47, v239, v31, v47
    v_add_f32_dpp v32, v32, v32 row_ror:8 row_mask:0xf bank_mask:0x3
    s_nop 1
    v_add_f32_dpp v32, v40, v40 row_ror:8 row_mask:0xf bank_mask:0xc
    v_add_f32_dpp v33, v33, v33 row_ror:8 row_mask:0xf bank_mask:0x3
    s_nop 1
    v_add_f32_dpp v33, v41, v41 row_ror:8 row_mask:0xf bank_mask:0xc
    v_add_f32_dpp v34, v34, v34 row_ror:8 row_mask:0xf bank_mask:0x3
    s_nop 1
    v_add_f32_dpp v34, v42, v42 row_ror:8 row_mask:0xf bank_mask:0xc
    v_add_f32_dpp v35, v35, v35 row_ror:8 row_mask:0xf bank_mask:0x3
    s_nop 1
    v_add_f32_dpp v35, v43, v43 row_ror:8 row_mask:0xf bank_mask:0xc
    v_add_f32_dpp v36, v36, v36 row_ror:8 row_mask:0xf bank_mask:0x3
    s_nop 1
    v_add_f32_dpp v36, v44, v44 row_ror:8 row_mask:0xf bank_mask:0xc
    v_add_f32_dpp v37, v37, v37 row_ror:8 row_mask:0xf bank_mask:0x3
    s_nop 1
    v_add_f32_dpp v37, v45, v45 row_ror:8 row_mask:0xf bank_mask:0xc
    v_add_f32_dpp v38, v38, v38 row_ror:8 row_mask:0xf bank_mask:0x3
    s_nop 1
    v_add_f32_dpp v38, v46, v46 row_ror:8 row_mask:0xf bank_mask:0xc
    v_add_f32_dpp v39, v39, v39 row_ror:8 row_mask:0xf bank_mask:0x3
    s_nop 1
    v_add_f32_dpp v39, v47, v47 row_ror:8 row_mask:0xf bank_mask:0xc
    v_add_f32_dpp v32, v32, v32 row_shl:4 row_mask:0xf bank_mask:0x5
    s_nop 1
    v_add_f32_dpp v32, v36, v36 row_shr:4 row_mask:0xf bank_mask:0xa
    v_add_f32_dpp v33, v33, v33 row_shl:4 row_mask:0xf bank_mask:0x5
    s_nop 1
    v_add_f32_dpp v33, v37, v37 row_shr:4 row_mask:0xf bank_mask:0xa
    v_add_f32_dpp v34, v34, v34 row_shl:4 row_mask:0xf bank_mask:0x5
    s_nop 1
    v_add_f32_dpp v34, v38, v38 row_shr:4 row_mask:0xf bank_mask:0xa
    v_add_f32_dpp v35, v35, v35 row_shl:4 row_mask:0xf bank_mask:0x5
    s_nop 1
    v_add_f32_dpp v35, v39, v39 row_shr:4 row_mask:0xf bank_mask:0xa
    v_add_f32_dpp v32, v32, v32 quad_perm:[2,3,0,1] row_mask:0xf bank_mask:0xf
    v_add_f32_dpp v34, v34, v34 quad_perm:[2,3,0,1] row_mask:0xf bank_mask:0xf
    v_cndmask_b32 v32, v32, v34, s[68:69]
    v_add_f32_dpp v33, v33, v33 quad_perm:[2,3,0,1] row_mask:0xf bank_mask:0xf
    v_add_f32_dpp v35, v35, v35 quad_perm:[2,3,0,1] row_mask:0xf bank_mask:0xf
    v_cndmask_b32 v33, v33, v35, s[68:69]
    v_add_f32_dpp v32, v32, v32 quad_perm:[1,0,3,2] row_mask:0xf bank_mask:0xf
    s_nop 0
    v_add_f32_dpp v33, v33, v33 quad_perm:[1,0,3,2] row_mask:0xf bank_mask:0xf
    v_cndmask_b32 v53, v32, v33, s[70:71]
    v_cvt_pk_bf16_f32 v53, v53, v53
    v_lshlrev_b32 v53, 16, v53
    v_mul_f32 v53, s73, v53
    v_cvt_pk_bf16_f32 v53, v53, v53
    v_lshlrev_b32 v53, 16, v53
    s_waitcnt vmcnt(51)
    ds_read_b128 v[132:135], v14 offset:12288
    ds_read_b128 v[232:235], v14 offset:13312
    ds_read_b128 v[236:239], v14 offset:14336
    ds_read_b128 v[240:243], v14 offset:15360
    s_waitcnt lgkmcnt(0)
    v_dot2_f32_bf16 v32, v132, v16, 0
    v_dot2_f32_bf16 v36, v132, v20, 0
    v_dot2_f32_bf16 v40, v132, v24, 0
    v_dot2_f32_bf16 v44, v132, v28, 0
    v_dot2_f32_bf16 v32, v133, v17, v32
    v_dot2_f32_bf16 v36, v133, v21, v36
    v_dot2_f32_bf16 v40, v133, v25, v40
    v_dot2_f32_bf16 v44, v133, v29, v44
    v_dot2_f32_bf16 v32, v134, v18, v32
    v_dot2_f32_bf16 v36, v134, v22, v36
    v_dot2_f32_bf16 v40, v134, v26, v40
    v_dot2_f32_bf16 v44, v134, v30, v44
    v_dot2_f32_bf16 v32, v135, v19, v32
    v_dot2_f32_bf16 v36, v135, v23, v36
    v_dot2_f32_bf16 v40, v135, v27, v40
    v_dot2_f32_bf16 v44, v135, v31, v44
    v_dot2_f32_bf16 v33, v232, v16, 0
    v_dot2_f32_bf16 v37, v232, v20, 0
    v_dot2_f32_bf16 v41, v232, v24, 0
    v_dot2_f32_bf16 v45, v232, v28, 0
    v_dot2_f32_bf16 v33, v233, v17, v33
    v_dot2_f32_bf16 v37, v233, v21, v37
    v_dot2_f32_bf16 v41, v233, v25, v41
    v_dot2_f32_bf16 v45, v233, v29, v45
    v_dot2_f32_bf16 v33, v234, v18, v33
    v_dot2_f32_bf16 v37, v234, v22, v37
    v_dot2_f32_bf16 v41, v234, v26, v41
    v_dot2_f32_bf16 v45, v234, v30, v45
    v_dot2_f32_bf16 v33, v235, v19, v33
    v_dot2_f32_bf16 v37, v235, v23, v37
    v_dot2_f32_bf16 v41, v235, v27, v41
    v_dot2_f32_bf16 v45, v235, v31, v45
    v_dot2_f32_bf16 v34, v236, v16, 0
    v_dot2_f32_bf16 v38, v236, v20, 0
    v_dot2_f32_bf16 v42, v236, v24, 0
    v_dot2_f32_bf16 v46, v236, v28, 0
    v_dot2_f32_bf16 v34, v237, v17, v34
    v_dot2_f32_bf16 v38, v237, v21, v38
    v_dot2_f32_bf16 v42, v237, v25, v42
    v_dot2_f32_bf16 v46, v237, v29, v46
    v_dot2_f32_bf16 v34, v238, v18, v34
    v_dot2_f32_bf16 v38, v238, v22, v38
    v_dot2_f32_bf16 v42, v238, v26, v42
    v_dot2_f32_bf16 v46, v238, v30, v46
    v_dot2_f32_bf16 v34, v239, v19, v34
    v_dot2_f32_bf16 v38, v239, v23, v38
    v_dot2_f32_bf16 v42, v239, v27, v42
    v_dot2_f32_bf16 v46, v239, v31, v46
    v_dot2_f32_bf16 v35, v240, v16, 0
    v_dot2_f32_bf16 v39, v240, v20, 0
    v_dot2_f32_bf16 v43, v240, v24, 0
    v_dot2_f32_bf16 v47, v240, v28, 0
    v_dot2_f32_bf16 v35, v241, v17, v35
    v_dot2_f32_bf16 v39, v241, v21, v39
    v_dot2_f32_bf16 v43, v241, v25, v43
    v_dot2_f32_bf16 v47, v241, v29, v47
    v_dot2_f32_bf16 v35, v242, v18, v35
    v_dot2_f32_bf16 v39, v242, v22, v39
    v_dot2_f32_bf16 v43, v242, v26, v43
    v_dot2_f32_bf16 v47, v242, v30, v47
    v_dot2_f32_bf16 v35, v243, v19, v35
    v_dot2_f32_bf16 v39, v243, v23, v39
    v_dot2_f32_bf16 v43, v243, v27, v43
    v_dot2_f32_bf16 v47, v243, v31, v47
    v_add_f32_dpp v32, v32, v32 row_ror:8 row_mask:0xf bank_mask:0x3
    s_nop 1
    v_add_f32_dpp v32, v40, v40 row_ror:8 row_mask:0xf bank_mask:0xc
    v_add_f32_dpp v33, v33, v33 row_ror:8 row_mask:0xf bank_mask:0x3
    s_nop 1
    v_add_f32_dpp v33, v41, v41 row_ror:8 row_mask:0xf bank_mask:0xc
    v_add_f32_dpp v34, v34, v34 row_ror:8 row_mask:0xf bank_mask:0x3
    s_nop 1
    v_add_f32_dpp v34, v42, v42 row_ror:8 row_mask:0xf bank_mask:0xc
    v_add_f32_dpp v35, v35, v35 row_ror:8 row_mask:0xf bank_mask:0x3
    s_nop 1
    v_add_f32_dpp v35, v43, v43 row_ror:8 row_mask:0xf bank_mask:0xc
    v_add_f32_dpp v36, v36, v36 row_ror:8 row_mask:0xf bank_mask:0x3
    s_nop 1
    v_add_f32_dpp v36, v44, v44 row_ror:8 row_mask:0xf bank_mask:0xc
    v_add_f32_dpp v37, v37, v37 row_ror:8 row_mask:0xf bank_mask:0x3
    s_nop 1
    v_add_f32_dpp v37, v45, v45 row_ror:8 row_mask:0xf bank_mask:0xc
    v_add_f32_dpp v38, v38, v38 row_ror:8 row_mask:0xf bank_mask:0x3
    s_nop 1
    v_add_f32_dpp v38, v46, v46 row_ror:8 row_mask:0xf bank_mask:0xc
    v_add_f32_dpp v39, v39, v39 row_ror:8 row_mask:0xf bank_mask:0x3
    s_nop 1
    v_add_f32_dpp v39, v47, v47 row_ror:8 row_mask:0xf bank_mask:0xc
    v_add_f32_dpp v32, v32, v32 row_shl:4 row_mask:0xf bank_mask:0x5
    s_nop 1
    v_add_f32_dpp v32, v36, v36 row_shr:4 row_mask:0xf bank_mask:0xa
    v_add_f32_dpp v33, v33, v33 row_shl:4 row_mask:0xf bank_mask:0x5
    s_nop 1
    v_add_f32_dpp v33, v37, v37 row_shr:4 row_mask:0xf bank_mask:0xa
    v_add_f32_dpp v34, v34, v34 row_shl:4 row_mask:0xf bank_mask:0x5
    s_nop 1
    v_add_f32_dpp v34, v38, v38 row_shr:4 row_mask:0xf bank_mask:0xa
    v_add_f32_dpp v35, v35, v35 row_shl:4 row_mask:0xf bank_mask:0x5
    s_nop 1
    v_add_f32_dpp v35, v39, v39 row_shr:4 row_mask:0xf bank_mask:0xa
    v_add_f32_dpp v32, v32, v32 quad_perm:[2,3,0,1] row_mask:0xf bank_mask:0xf
    v_add_f32_dpp v34, v34, v34 quad_perm:[2,3,0,1] row_mask:0xf bank_mask:0xf
    v_cndmask_b32 v32, v32, v34, s[68:69]
    v_add_f32_dpp v33, v33, v33 quad_perm:[2,3,0,1] row_mask:0xf bank_mask:0xf
    v_add_f32_dpp v35, v35, v35 quad_perm:[2,3,0,1] row_mask:0xf bank_mask:0xf
    v_cndmask_b32 v33, v33, v35, s[68:69]
    v_add_f32_dpp v32, v32, v32 quad_perm:[1,0,3,2] row_mask:0xf bank_mask:0xf
    s_nop 0
    v_add_f32_dpp v33, v33, v33 quad_perm:[1,0,3,2] row_mask:0xf bank_mask:0xf
    v_cndmask_b32 v54, v32, v33, s[70:71]
    v_cvt_pk_bf16_f32 v54, v54, v54
    v_lshlrev_b32 v54, 16, v54
    v_mul_f32 v54, s73, v54
    v_cvt_pk_bf16_f32 v54, v54, v54
    v_lshlrev_b32 v54, 16, v54
    s_waitcnt vmcnt(47)
    ds_read_b128 v[132:135], v14 offset:16384
    ds_read_b128 v[232:235], v14 offset:17408
    ds_read_b128 v[236:239], v14 offset:18432
    ds_read_b128 v[240:243], v14 offset:19456
    s_waitcnt lgkmcnt(0)
    v_dot2_f32_bf16 v32, v132, v16, 0
    v_dot2_f32_bf16 v36, v132, v20, 0
    v_dot2_f32_bf16 v40, v132, v24, 0
    v_dot2_f32_bf16 v44, v132, v28, 0
    v_dot2_f32_bf16 v32, v133, v17, v32
    v_dot2_f32_bf16 v36, v133, v21, v36
    v_dot2_f32_bf16 v40, v133, v25, v40
    v_dot2_f32_bf16 v44, v133, v29, v44
    v_dot2_f32_bf16 v32, v134, v18, v32
    v_dot2_f32_bf16 v36, v134, v22, v36
    v_dot2_f32_bf16 v40, v134, v26, v40
    v_dot2_f32_bf16 v44, v134, v30, v44
    v_dot2_f32_bf16 v32, v135, v19, v32
    v_dot2_f32_bf16 v36, v135, v23, v36
    v_dot2_f32_bf16 v40, v135, v27, v40
    v_dot2_f32_bf16 v44, v135, v31, v44
    v_dot2_f32_bf16 v33, v232, v16, 0
    v_dot2_f32_bf16 v37, v232, v20, 0
    v_dot2_f32_bf16 v41, v232, v24, 0
    v_dot2_f32_bf16 v45, v232, v28, 0
    v_dot2_f32_bf16 v33, v233, v17, v33
    v_dot2_f32_bf16 v37, v233, v21, v37
    v_dot2_f32_bf16 v41, v233, v25, v41
    v_dot2_f32_bf16 v45, v233, v29, v45
    v_dot2_f32_bf16 v33, v234, v18, v33
    v_dot2_f32_bf16 v37, v234, v22, v37
    v_dot2_f32_bf16 v41, v234, v26, v41
    v_dot2_f32_bf16 v45, v234, v30, v45
    v_dot2_f32_bf16 v33, v235, v19, v33
    v_dot2_f32_bf16 v37, v235, v23, v37
    v_dot2_f32_bf16 v41, v235, v27, v41
    v_dot2_f32_bf16 v45, v235, v31, v45
    v_dot2_f32_bf16 v34, v236, v16, 0
    v_dot2_f32_bf16 v38, v236, v20, 0
    v_dot2_f32_bf16 v42, v236, v24, 0
    v_dot2_f32_bf16 v46, v236, v28, 0
    v_dot2_f32_bf16 v34, v237, v17, v34
    v_dot2_f32_bf16 v38, v237, v21, v38
    v_dot2_f32_bf16 v42, v237, v25, v42
    v_dot2_f32_bf16 v46, v237, v29, v46
    v_dot2_f32_bf16 v34, v238, v18, v34
    v_dot2_f32_bf16 v38, v238, v22, v38
    v_dot2_f32_bf16 v42, v238, v26, v42
    v_dot2_f32_bf16 v46, v238, v30, v46
    v_dot2_f32_bf16 v34, v239, v19, v34
    v_dot2_f32_bf16 v38, v239, v23, v38
    v_dot2_f32_bf16 v42, v239, v27, v42
    v_dot2_f32_bf16 v46, v239, v31, v46
    v_dot2_f32_bf16 v35, v240, v16, 0
    v_dot2_f32_bf16 v39, v240, v20, 0
    v_dot2_f32_bf16 v43, v240, v24, 0
    v_dot2_f32_bf16 v47, v240, v28, 0
    v_dot2_f32_bf16 v35, v241, v17, v35
    v_dot2_f32_bf16 v39, v241, v21, v39
    v_dot2_f32_bf16 v43, v241, v25, v43
    v_dot2_f32_bf16 v47, v241, v29, v47
    v_dot2_f32_bf16 v35, v242, v18, v35
    v_dot2_f32_bf16 v39, v242, v22, v39
    v_dot2_f32_bf16 v43, v242, v26, v43
    v_dot2_f32_bf16 v47, v242, v30, v47
    v_dot2_f32_bf16 v35, v243, v19, v35
    v_dot2_f32_bf16 v39, v243, v23, v39
    v_dot2_f32_bf16 v43, v243, v27, v43
    v_dot2_f32_bf16 v47, v243, v31, v47
    v_add_f32_dpp v32, v32, v32 row_ror:8 row_mask:0xf bank_mask:0x3
    s_nop 1
    v_add_f32_dpp v32, v40, v40 row_ror:8 row_mask:0xf bank_mask:0xc
    v_add_f32_dpp v33, v33, v33 row_ror:8 row_mask:0xf bank_mask:0x3
    s_nop 1
    v_add_f32_dpp v33, v41, v41 row_ror:8 row_mask:0xf bank_mask:0xc
    v_add_f32_dpp v34, v34, v34 row_ror:8 row_mask:0xf bank_mask:0x3
    s_nop 1
    v_add_f32_dpp v34, v42, v42 row_ror:8 row_mask:0xf bank_mask:0xc
    v_add_f32_dpp v35, v35, v35 row_ror:8 row_mask:0xf bank_mask:0x3
    s_nop 1
    v_add_f32_dpp v35, v43, v43 row_ror:8 row_mask:0xf bank_mask:0xc
    v_add_f32_dpp v36, v36, v36 row_ror:8 row_mask:0xf bank_mask:0x3
    s_nop 1
    v_add_f32_dpp v36, v44, v44 row_ror:8 row_mask:0xf bank_mask:0xc
    v_add_f32_dpp v37, v37, v37 row_ror:8 row_mask:0xf bank_mask:0x3
    s_nop 1
    v_add_f32_dpp v37, v45, v45 row_ror:8 row_mask:0xf bank_mask:0xc
    v_add_f32_dpp v38, v38, v38 row_ror:8 row_mask:0xf bank_mask:0x3
    s_nop 1
    v_add_f32_dpp v38, v46, v46 row_ror:8 row_mask:0xf bank_mask:0xc
    v_add_f32_dpp v39, v39, v39 row_ror:8 row_mask:0xf bank_mask:0x3
    s_nop 1
    v_add_f32_dpp v39, v47, v47 row_ror:8 row_mask:0xf bank_mask:0xc
    v_add_f32_dpp v32, v32, v32 row_shl:4 row_mask:0xf bank_mask:0x5
    s_nop 1
    v_add_f32_dpp v32, v36, v36 row_shr:4 row_mask:0xf bank_mask:0xa
    v_add_f32_dpp v33, v33, v33 row_shl:4 row_mask:0xf bank_mask:0x5
    s_nop 1
    v_add_f32_dpp v33, v37, v37 row_shr:4 row_mask:0xf bank_mask:0xa
    v_add_f32_dpp v34, v34, v34 row_shl:4 row_mask:0xf bank_mask:0x5
    s_nop 1
    v_add_f32_dpp v34, v38, v38 row_shr:4 row_mask:0xf bank_mask:0xa
    v_add_f32_dpp v35, v35, v35 row_shl:4 row_mask:0xf bank_mask:0x5
    s_nop 1
    v_add_f32_dpp v35, v39, v39 row_shr:4 row_mask:0xf bank_mask:0xa
    v_add_f32_dpp v32, v32, v32 quad_perm:[2,3,0,1] row_mask:0xf bank_mask:0xf
    v_add_f32_dpp v34, v34, v34 quad_perm:[2,3,0,1] row_mask:0xf bank_mask:0xf
    v_cndmask_b32 v32, v32, v34, s[68:69]
    v_add_f32_dpp v33, v33, v33 quad_perm:[2,3,0,1] row_mask:0xf bank_mask:0xf
    v_add_f32_dpp v35, v35, v35 quad_perm:[2,3,0,1] row_mask:0xf bank_mask:0xf
    v_cndmask_b32 v33, v33, v35, s[68:69]
    v_add_f32_dpp v32, v32, v32 quad_perm:[1,0,3,2] row_mask:0xf bank_mask:0xf
    s_nop 0
    v_add_f32_dpp v33, v33, v33 quad_perm:[1,0,3,2] row_mask:0xf bank_mask:0xf
    v_cndmask_b32 v55, v32, v33, s[70:71]
    v_cvt_pk_bf16_f32 v55, v55, v55
    v_lshlrev_b32 v55, 16, v55
    v_mul_f32 v55, s73, v55
    v_cvt_pk_bf16_f32 v55, v55, v55
    v_lshlrev_b32 v55, 16, v55
    s_waitcnt vmcnt(43)
    ds_read_b128 v[132:135], v14 offset:20480
    ds_read_b128 v[232:235], v14 offset:21504
    ds_read_b128 v[236:239], v14 offset:22528
    ds_read_b128 v[240:243], v14 offset:23552
    s_waitcnt lgkmcnt(0)
    v_dot2_f32_bf16 v32, v132, v16, 0
    v_dot2_f32_bf16 v36, v132, v20, 0
    v_dot2_f32_bf16 v40, v132, v24, 0
    v_dot2_f32_bf16 v44, v132, v28, 0
    v_dot2_f32_bf16 v32, v133, v17, v32
    v_dot2_f32_bf16 v36, v133, v21, v36
    v_dot2_f32_bf16 v40, v133, v25, v40
    v_dot2_f32_bf16 v44, v133, v29, v44
    v_dot2_f32_bf16 v32, v134, v18, v32
    v_dot2_f32_bf16 v36, v134, v22, v36
    v_dot2_f32_bf16 v40, v134, v26, v40
    v_dot2_f32_bf16 v44, v134, v30, v44
    v_dot2_f32_bf16 v32, v135, v19, v32
    v_dot2_f32_bf16 v36, v135, v23, v36
    v_dot2_f32_bf16 v40, v135, v27, v40
    v_dot2_f32_bf16 v44, v135, v31, v44
    v_dot2_f32_bf16 v33, v232, v16, 0
    v_dot2_f32_bf16 v37, v232, v20, 0
    v_dot2_f32_bf16 v41, v232, v24, 0
    v_dot2_f32_bf16 v45, v232, v28, 0
    v_dot2_f32_bf16 v33, v233, v17, v33
    v_dot2_f32_bf16 v37, v233, v21, v37
    v_dot2_f32_bf16 v41, v233, v25, v41
    v_dot2_f32_bf16 v45, v233, v29, v45
    v_dot2_f32_bf16 v33, v234, v18, v33
    v_dot2_f32_bf16 v37, v234, v22, v37
    v_dot2_f32_bf16 v41, v234, v26, v41
    v_dot2_f32_bf16 v45, v234, v30, v45
    v_dot2_f32_bf16 v33, v235, v19, v33
    v_dot2_f32_bf16 v37, v235, v23, v37
    v_dot2_f32_bf16 v41, v235, v27, v41
    v_dot2_f32_bf16 v45, v235, v31, v45
    v_dot2_f32_bf16 v34, v236, v16, 0
    v_dot2_f32_bf16 v38, v236, v20, 0
    v_dot2_f32_bf16 v42, v236, v24, 0
    v_dot2_f32_bf16 v46, v236, v28, 0
    v_dot2_f32_bf16 v34, v237, v17, v34
    v_dot2_f32_bf16 v38, v237, v21, v38
    v_dot2_f32_bf16 v42, v237, v25, v42
    v_dot2_f32_bf16 v46, v237, v29, v46
    v_dot2_f32_bf16 v34, v238, v18, v34
    v_dot2_f32_bf16 v38, v238, v22, v38
    v_dot2_f32_bf16 v42, v238, v26, v42
    v_dot2_f32_bf16 v46, v238, v30, v46
    v_dot2_f32_bf16 v34, v239, v19, v34
    v_dot2_f32_bf16 v38, v239, v23, v38
    v_dot2_f32_bf16 v42, v239, v27, v42
    v_dot2_f32_bf16 v46, v239, v31, v46
    v_dot2_f32_bf16 v35, v240, v16, 0
    v_dot2_f32_bf16 v39, v240, v20, 0
    v_dot2_f32_bf16 v43, v240, v24, 0
    v_dot2_f32_bf16 v47, v240, v28, 0
    v_dot2_f32_bf16 v35, v241, v17, v35
    v_dot2_f32_bf16 v39, v241, v21, v39
    v_dot2_f32_bf16 v43, v241, v25, v43
    v_dot2_f32_bf16 v47, v241, v29, v47
    v_dot2_f32_bf16 v35, v242, v18, v35
    v_dot2_f32_bf16 v39, v242, v22, v39
    v_dot2_f32_bf16 v43, v242, v26, v43
    v_dot2_f32_bf16 v47, v242, v30, v47
    v_dot2_f32_bf16 v35, v243, v19, v35
    v_dot2_f32_bf16 v39, v243, v23, v39
    v_dot2_f32_bf16 v43, v243, v27, v43
    v_dot2_f32_bf16 v47, v243, v31, v47
    v_add_f32_dpp v32, v32, v32 row_ror:8 row_mask:0xf bank_mask:0x3
    s_nop 1
    v_add_f32_dpp v32, v40, v40 row_ror:8 row_mask:0xf bank_mask:0xc
    v_add_f32_dpp v33, v33, v33 row_ror:8 row_mask:0xf bank_mask:0x3
    s_nop 1
    v_add_f32_dpp v33, v41, v41 row_ror:8 row_mask:0xf bank_mask:0xc
    v_add_f32_dpp v34, v34, v34 row_ror:8 row_mask:0xf bank_mask:0x3
    s_nop 1
    v_add_f32_dpp v34, v42, v42 row_ror:8 row_mask:0xf bank_mask:0xc
    v_add_f32_dpp v35, v35, v35 row_ror:8 row_mask:0xf bank_mask:0x3
    s_nop 1
    v_add_f32_dpp v35, v43, v43 row_ror:8 row_mask:0xf bank_mask:0xc
    v_add_f32_dpp v36, v36, v36 row_ror:8 row_mask:0xf bank_mask:0x3
    s_nop 1
    v_add_f32_dpp v36, v44, v44 row_ror:8 row_mask:0xf bank_mask:0xc
    v_add_f32_dpp v37, v37, v37 row_ror:8 row_mask:0xf bank_mask:0x3
    s_nop 1
    v_add_f32_dpp v37, v45, v45 row_ror:8 row_mask:0xf bank_mask:0xc
    v_add_f32_dpp v38, v38, v38 row_ror:8 row_mask:0xf bank_mask:0x3
    s_nop 1
    v_add_f32_dpp v38, v46, v46 row_ror:8 row_mask:0xf bank_mask:0xc
    v_add_f32_dpp v39, v39, v39 row_ror:8 row_mask:0xf bank_mask:0x3
    s_nop 1
    v_add_f32_dpp v39, v47, v47 row_ror:8 row_mask:0xf bank_mask:0xc
    v_add_f32_dpp v32, v32, v32 row_shl:4 row_mask:0xf bank_mask:0x5
    s_nop 1
    v_add_f32_dpp v32, v36, v36 row_shr:4 row_mask:0xf bank_mask:0xa
    v_add_f32_dpp v33, v33, v33 row_shl:4 row_mask:0xf bank_mask:0x5
    s_nop 1
    v_add_f32_dpp v33, v37, v37 row_shr:4 row_mask:0xf bank_mask:0xa
    v_add_f32_dpp v34, v34, v34 row_shl:4 row_mask:0xf bank_mask:0x5
    s_nop 1
    v_add_f32_dpp v34, v38, v38 row_shr:4 row_mask:0xf bank_mask:0xa
    v_add_f32_dpp v35, v35, v35 row_shl:4 row_mask:0xf bank_mask:0x5
    s_nop 1
    v_add_f32_dpp v35, v39, v39 row_shr:4 row_mask:0xf bank_mask:0xa
    v_add_f32_dpp v32, v32, v32 quad_perm:[2,3,0,1] row_mask:0xf bank_mask:0xf
    v_add_f32_dpp v34, v34, v34 quad_perm:[2,3,0,1] row_mask:0xf bank_mask:0xf
    v_cndmask_b32 v32, v32, v34, s[68:69]
    v_add_f32_dpp v33, v33, v33 quad_perm:[2,3,0,1] row_mask:0xf bank_mask:0xf
    v_add_f32_dpp v35, v35, v35 quad_perm:[2,3,0,1] row_mask:0xf bank_mask:0xf
    v_cndmask_b32 v33, v33, v35, s[68:69]
    v_add_f32_dpp v32, v32, v32 quad_perm:[1,0,3,2] row_mask:0xf bank_mask:0xf
    s_nop 0
    v_add_f32_dpp v33, v33, v33 quad_perm:[1,0,3,2] row_mask:0xf bank_mask:0xf
    v_cndmask_b32 v56, v32, v33, s[70:71]
    v_cvt_pk_bf16_f32 v56, v56, v56
    v_lshlrev_b32 v56, 16, v56
    v_mul_f32 v56, s73, v56
    v_cvt_pk_bf16_f32 v56, v56, v56
    v_lshlrev_b32 v56, 16, v56
    s_waitcnt vmcnt(39)
    ds_read_b128 v[132:135], v14 offset:24576
    ds_read_b128 v[232:235], v14 offset:25600
    ds_read_b128 v[236:239], v14 offset:26624
    ds_read_b128 v[240:243], v14 offset:27648
    s_waitcnt lgkmcnt(0)
    v_dot2_f32_bf16 v32, v132, v16, 0
    v_dot2_f32_bf16 v36, v132, v20, 0
    v_dot2_f32_bf16 v40, v132, v24, 0
    v_dot2_f32_bf16 v44, v132, v28, 0
    v_dot2_f32_bf16 v32, v133, v17, v32
    v_dot2_f32_bf16 v36, v133, v21, v36
    v_dot2_f32_bf16 v40, v133, v25, v40
    v_dot2_f32_bf16 v44, v133, v29, v44
    v_dot2_f32_bf16 v32, v134, v18, v32
    v_dot2_f32_bf16 v36, v134, v22, v36
    v_dot2_f32_bf16 v40, v134, v26, v40
    v_dot2_f32_bf16 v44, v134, v30, v44
    v_dot2_f32_bf16 v32, v135, v19, v32
    v_dot2_f32_bf16 v36, v135, v23, v36
    v_dot2_f32_bf16 v40, v135, v27, v40
    v_dot2_f32_bf16 v44, v135, v31, v44
    v_dot2_f32_bf16 v33, v232, v16, 0
    v_dot2_f32_bf16 v37, v232, v20, 0
    v_dot2_f32_bf16 v41, v232, v24, 0
    v_dot2_f32_bf16 v45, v232, v28, 0
    v_dot2_f32_bf16 v33, v233, v17, v33
    v_dot2_f32_bf16 v37, v233, v21, v37
    v_dot2_f32_bf16 v41, v233, v25, v41
    v_dot2_f32_bf16 v45, v233, v29, v45
    v_dot2_f32_bf16 v33, v234, v18, v33
    v_dot2_f32_bf16 v37, v234, v22, v37
    v_dot2_f32_bf16 v41, v234, v26, v41
    v_dot2_f32_bf16 v45, v234, v30, v45
    v_dot2_f32_bf16 v33, v235, v19, v33
    v_dot2_f32_bf16 v37, v235, v23, v37
    v_dot2_f32_bf16 v41, v235, v27, v41
    v_dot2_f32_bf16 v45, v235, v31, v45
    v_dot2_f32_bf16 v34, v236, v16, 0
    v_dot2_f32_bf16 v38, v236, v20, 0
    v_dot2_f32_bf16 v42, v236, v24, 0
    v_dot2_f32_bf16 v46, v236, v28, 0
    v_dot2_f32_bf16 v34, v237, v17, v34
    v_dot2_f32_bf16 v38, v237, v21, v38
    v_dot2_f32_bf16 v42, v237, v25, v42
    v_dot2_f32_bf16 v46, v237, v29, v46
    v_dot2_f32_bf16 v34, v238, v18, v34
    v_dot2_f32_bf16 v38, v238, v22, v38
    v_dot2_f32_bf16 v42, v238, v26, v42
    v_dot2_f32_bf16 v46, v238, v30, v46
    v_dot2_f32_bf16 v34, v239, v19, v34
    v_dot2_f32_bf16 v38, v239, v23, v38
    v_dot2_f32_bf16 v42, v239, v27, v42
    v_dot2_f32_bf16 v46, v239, v31, v46
    v_dot2_f32_bf16 v35, v240, v16, 0
    v_dot2_f32_bf16 v39, v240, v20, 0
    v_dot2_f32_bf16 v43, v240, v24, 0
    v_dot2_f32_bf16 v47, v240, v28, 0
    v_dot2_f32_bf16 v35, v241, v17, v35
    v_dot2_f32_bf16 v39, v241, v21, v39
    v_dot2_f32_bf16 v43, v241, v25, v43
    v_dot2_f32_bf16 v47, v241, v29, v47
    v_dot2_f32_bf16 v35, v242, v18, v35
    v_dot2_f32_bf16 v39, v242, v22, v39
    v_dot2_f32_bf16 v43, v242, v26, v43
    v_dot2_f32_bf16 v47, v242, v30, v47
    v_dot2_f32_bf16 v35, v243, v19, v35
    v_dot2_f32_bf16 v39, v243, v23, v39
    v_dot2_f32_bf16 v43, v243, v27, v43
    v_dot2_f32_bf16 v47, v243, v31, v47
    v_add_f32_dpp v32, v32, v32 row_ror:8 row_mask:0xf bank_mask:0x3
    s_nop 1
    v_add_f32_dpp v32, v40, v40 row_ror:8 row_mask:0xf bank_mask:0xc
    v_add_f32_dpp v33, v33, v33 row_ror:8 row_mask:0xf bank_mask:0x3
    s_nop 1
    v_add_f32_dpp v33, v41, v41 row_ror:8 row_mask:0xf bank_mask:0xc
    v_add_f32_dpp v34, v34, v34 row_ror:8 row_mask:0xf bank_mask:0x3
    s_nop 1
    v_add_f32_dpp v34, v42, v42 row_ror:8 row_mask:0xf bank_mask:0xc
    v_add_f32_dpp v35, v35, v35 row_ror:8 row_mask:0xf bank_mask:0x3
    s_nop 1
    v_add_f32_dpp v35, v43, v43 row_ror:8 row_mask:0xf bank_mask:0xc
    v_add_f32_dpp v36, v36, v36 row_ror:8 row_mask:0xf bank_mask:0x3
    s_nop 1
    v_add_f32_dpp v36, v44, v44 row_ror:8 row_mask:0xf bank_mask:0xc
    v_add_f32_dpp v37, v37, v37 row_ror:8 row_mask:0xf bank_mask:0x3
    s_nop 1
    v_add_f32_dpp v37, v45, v45 row_ror:8 row_mask:0xf bank_mask:0xc
    v_add_f32_dpp v38, v38, v38 row_ror:8 row_mask:0xf bank_mask:0x3
    s_nop 1
    v_add_f32_dpp v38, v46, v46 row_ror:8 row_mask:0xf bank_mask:0xc
    v_add_f32_dpp v39, v39, v39 row_ror:8 row_mask:0xf bank_mask:0x3
    s_nop 1
    v_add_f32_dpp v39, v47, v47 row_ror:8 row_mask:0xf bank_mask:0xc
    v_add_f32_dpp v32, v32, v32 row_shl:4 row_mask:0xf bank_mask:0x5
    s_nop 1
    v_add_f32_dpp v32, v36, v36 row_shr:4 row_mask:0xf bank_mask:0xa
    v_add_f32_dpp v33, v33, v33 row_shl:4 row_mask:0xf bank_mask:0x5
    s_nop 1
    v_add_f32_dpp v33, v37, v37 row_shr:4 row_mask:0xf bank_mask:0xa
    v_add_f32_dpp v34, v34, v34 row_shl:4 row_mask:0xf bank_mask:0x5
    s_nop 1
    v_add_f32_dpp v34, v38, v38 row_shr:4 row_mask:0xf bank_mask:0xa
    v_add_f32_dpp v35, v35, v35 row_shl:4 row_mask:0xf bank_mask:0x5
    s_nop 1
    v_add_f32_dpp v35, v39, v39 row_shr:4 row_mask:0xf bank_mask:0xa
    v_add_f32_dpp v32, v32, v32 quad_perm:[2,3,0,1] row_mask:0xf bank_mask:0xf
    v_add_f32_dpp v34, v34, v34 quad_perm:[2,3,0,1] row_mask:0xf bank_mask:0xf
    v_cndmask_b32 v32, v32, v34, s[68:69]
    v_add_f32_dpp v33, v33, v33 quad_perm:[2,3,0,1] row_mask:0xf bank_mask:0xf
    v_add_f32_dpp v35, v35, v35 quad_perm:[2,3,0,1] row_mask:0xf bank_mask:0xf
    v_cndmask_b32 v33, v33, v35, s[68:69]
    v_add_f32_dpp v32, v32, v32 quad_perm:[1,0,3,2] row_mask:0xf bank_mask:0xf
    s_nop 0
    v_add_f32_dpp v33, v33, v33 quad_perm:[1,0,3,2] row_mask:0xf bank_mask:0xf
    v_cndmask_b32 v57, v32, v33, s[70:71]
    v_cvt_pk_bf16_f32 v57, v57, v57
    v_lshlrev_b32 v57, 16, v57
    v_mul_f32 v57, s73, v57
    v_cvt_pk_bf16_f32 v57, v57, v57
    v_lshlrev_b32 v57, 16, v57
    s_waitcnt vmcnt(35)
    ds_read_b128 v[132:135], v14 offset:28672
    ds_read_b128 v[232:235], v14 offset:29696
    ds_read_b128 v[236:239], v14 offset:30720
    ds_read_b128 v[240:243], v14 offset:31744
    s_waitcnt lgkmcnt(0)
    v_dot2_f32_bf16 v32, v132, v16, 0
    v_dot2_f32_bf16 v36, v132, v20, 0
    v_dot2_f32_bf16 v40, v132, v24, 0
    v_dot2_f32_bf16 v44, v132, v28, 0
    v_dot2_f32_bf16 v32, v133, v17, v32
    v_dot2_f32_bf16 v36, v133, v21, v36
    v_dot2_f32_bf16 v40, v133, v25, v40
    v_dot2_f32_bf16 v44, v133, v29, v44
    v_dot2_f32_bf16 v32, v134, v18, v32
    v_dot2_f32_bf16 v36, v134, v22, v36
    v_dot2_f32_bf16 v40, v134, v26, v40
    v_dot2_f32_bf16 v44, v134, v30, v44
    v_dot2_f32_bf16 v32, v135, v19, v32
    v_dot2_f32_bf16 v36, v135, v23, v36
    v_dot2_f32_bf16 v40, v135, v27, v40
    v_dot2_f32_bf16 v44, v135, v31, v44
    s_waitcnt vmcnt(11)
    buffer_load_dwordx4 v[132:135], v4, s[56:59], s48 offen offset:3072 nt
    v_dot2_f32_bf16 v33, v232, v16, 0
    v_dot2_f32_bf16 v37, v232, v20, 0
    v_dot2_f32_bf16 v41, v232, v24, 0
    v_dot2_f32_bf16 v45, v232, v28, 0
    v_dot2_f32_bf16 v33, v233, v17, v33
    v_dot2_f32_bf16 v37, v233, v21, v37
    v_dot2_f32_bf16 v41, v233, v25, v41
    v_dot2_f32_bf16 v45, v233, v29, v45
    v_dot2_f32_bf16 v33, v234, v18, v33
    v_dot2_f32_bf16 v37, v234, v22, v37
    v_dot2_f32_bf16 v41, v234, v26, v41
    v_dot2_f32_bf16 v45, v234, v30, v45
    v_dot2_f32_bf16 v33, v235, v19, v33
    v_dot2_f32_bf16 v37, v235, v23, v37
    v_dot2_f32_bf16 v41, v235, v27, v41
    v_dot2_f32_bf16 v45, v235, v31, v45
    v_dot2_f32_bf16 v34, v236, v16, 0
    v_dot2_f32_bf16 v38, v236, v20, 0
    v_dot2_f32_bf16 v42, v236, v24, 0
    v_dot2_f32_bf16 v46, v236, v28, 0
    v_dot2_f32_bf16 v34, v237, v17, v34
    v_dot2_f32_bf16 v38, v237, v21, v38
    v_dot2_f32_bf16 v42, v237, v25, v42
    v_dot2_f32_bf16 v46, v237, v29, v46
    v_dot2_f32_bf16 v34, v238, v18, v34
    v_dot2_f32_bf16 v38, v238, v22, v38
    v_dot2_f32_bf16 v42, v238, v26, v42
    v_dot2_f32_bf16 v46, v238, v30, v46
    v_dot2_f32_bf16 v34, v239, v19, v34
    v_dot2_f32_bf16 v38, v239, v23, v38
    v_dot2_f32_bf16 v42, v239, v27, v42
    v_dot2_f32_bf16 v46, v239, v31, v46
    s_waitcnt vmcnt(11)
    s_add_u32 s48, s75, 65536
    buffer_load_dwordx4 v[232:235], v3, s[56:59], s48 offen offset:0 nt
    v_dot2_f32_bf16 v35, v240, v16, 0
    v_dot2_f32_bf16 v39, v240, v20, 0
    v_dot2_f32_bf16 v43, v240, v24, 0
    v_dot2_f32_bf16 v47, v240, v28, 0
    v_dot2_f32_bf16 v35, v241, v17, v35
    v_dot2_f32_bf16 v39, v241, v21, v39
    v_dot2_f32_bf16 v43, v241, v25, v43
    v_dot2_f32_bf16 v47, v241, v29, v47
    v_dot2_f32_bf16 v35, v242, v18, v35
    v_dot2_f32_bf16 v39, v242, v22, v39
    v_dot2_f32_bf16 v43, v242, v26, v43
    v_dot2_f32_bf16 v47, v242, v30, v47
    v_dot2_f32_bf16 v35, v243, v19, v35
    v_dot2_f32_bf16 v39, v243, v23, v39
    v_dot2_f32_bf16 v43, v243, v27, v43
    v_dot2_f32_bf16 v47, v243, v31, v47
    v_add_f32_dpp v32, v32, v32 row_ror:8 row_mask:0xf bank_mask:0x3
    s_nop 1
    v_add_f32_dpp v32, v40, v40 row_ror:8 row_mask:0xf bank_mask:0xc
    v_add_f32_dpp v33, v33, v33 row_ror:8 row_mask:0xf bank_mask:0x3
    s_nop 1
    v_add_f32_dpp v33, v41, v41 row_ror:8 row_mask:0xf bank_mask:0xc
    v_add_f32_dpp v34, v34, v34 row_ror:8 row_mask:0xf bank_mask:0x3
    s_nop 1
    v_add_f32_dpp v34, v42, v42 row_ror:8 row_mask:0xf bank_mask:0xc
    v_add_f32_dpp v35, v35, v35 row_ror:8 row_mask:0xf bank_mask:0x3
    s_nop 1
    v_add_f32_dpp v35, v43, v43 row_ror:8 row_mask:0xf bank_mask:0xc
    v_add_f32_dpp v36, v36, v36 row_ror:8 row_mask:0xf bank_mask:0x3
    s_nop 1
    v_add_f32_dpp v36, v44, v44 row_ror:8 row_mask:0xf bank_mask:0xc
    v_add_f32_dpp v37, v37, v37 row_ror:8 row_mask:0xf bank_mask:0x3
    s_nop 1
    v_add_f32_dpp v37, v45, v45 row_ror:8 row_mask:0xf bank_mask:0xc
    v_add_f32_dpp v38, v38, v38 row_ror:8 row_mask:0xf bank_mask:0x3
    s_nop 1
    v_add_f32_dpp v38, v46, v46 row_ror:8 row_mask:0xf bank_mask:0xc
    v_add_f32_dpp v39, v39, v39 row_ror:8 row_mask:0xf bank_mask:0x3
    s_nop 1
    v_add_f32_dpp v39, v47, v47 row_ror:8 row_mask:0xf bank_mask:0xc
    v_add_f32_dpp v32, v32, v32 row_shl:4 row_mask:0xf bank_mask:0x5
    s_nop 1
    v_add_f32_dpp v32, v36, v36 row_shr:4 row_mask:0xf bank_mask:0xa
    v_add_f32_dpp v33, v33, v33 row_shl:4 row_mask:0xf bank_mask:0x5
    s_nop 1
    v_add_f32_dpp v33, v37, v37 row_shr:4 row_mask:0xf bank_mask:0xa
    v_add_f32_dpp v34, v34, v34 row_shl:4 row_mask:0xf bank_mask:0x5
    s_nop 1
    v_add_f32_dpp v34, v38, v38 row_shr:4 row_mask:0xf bank_mask:0xa
    v_add_f32_dpp v35, v35, v35 row_shl:4 row_mask:0xf bank_mask:0x5
    s_nop 1
    v_add_f32_dpp v35, v39, v39 row_shr:4 row_mask:0xf bank_mask:0xa
    v_add_f32_dpp v32, v32, v32 quad_perm:[2,3,0,1] row_mask:0xf bank_mask:0xf
    v_add_f32_dpp v34, v34, v34 quad_perm:[2,3,0,1] row_mask:0xf bank_mask:0xf
    v_cndmask_b32 v32, v32, v34, s[68:69]
    v_add_f32_dpp v33, v33, v33 quad_perm:[2,3,0,1] row_mask:0xf bank_mask:0xf
    v_add_f32_dpp v35, v35, v35 quad_perm:[2,3,0,1] row_mask:0xf bank_mask:0xf
    v_cndmask_b32 v33, v33, v35, s[68:69]
    v_add_f32_dpp v32, v32, v32 quad_perm:[1,0,3,2] row_mask:0xf bank_mask:0xf
    s_nop 0
    v_add_f32_dpp v33, v33, v33 quad_perm:[1,0,3,2] row_mask:0xf bank_mask:0xf
    v_cndmask_b32 v58, v32, v33, s[70:71]
    v_cvt_pk_bf16_f32 v58, v58, v58
    v_lshlrev_b32 v58, 16, v58
    v_mul_f32 v58, s73, v58
    v_cvt_pk_bf16_f32 v58, v58, v58
    v_lshlrev_b32 v58, 16, v58
    s_waitcnt vmcnt(36)
    v_dot2_f32_bf16 v32, v136, v16, 0
    v_dot2_f32_bf16 v36, v136, v20, 0
    v_dot2_f32_bf16 v40, v136, v24, 0
    v_dot2_f32_bf16 v44, v136, v28, 0
    v_dot2_f32_bf16 v32, v137, v17, v32
    v_dot2_f32_bf16 v36, v137, v21, v36
    v_dot2_f32_bf16 v40, v137, v25, v40
    v_dot2_f32_bf16 v44, v137, v29, v44
    v_dot2_f32_bf16 v32, v138, v18, v32
    v_dot2_f32_bf16 v36, v138, v22, v36
    v_dot2_f32_bf16 v40, v138, v26, v40
    v_dot2_f32_bf16 v44, v138, v30, v44
    v_dot2_f32_bf16 v32, v139, v19, v32
    v_dot2_f32_bf16 v36, v139, v23, v36
    v_dot2_f32_bf16 v40, v139, v27, v40
    v_dot2_f32_bf16 v44, v139, v31, v44
    s_waitcnt vmcnt(11)
    buffer_load_dwordx4 v[136:139], v3, s[56:59], s48 offen offset:1024 nt
    s_waitcnt vmcnt(36)
    v_dot2_f32_bf16 v33, v140, v16, 0
    v_dot2_f32_bf16 v37, v140, v20, 0
    v_dot2_f32_bf16 v41, v140, v24, 0
    v_dot2_f32_bf16 v45, v140, v28, 0
    v_dot2_f32_bf16 v33, v141, v17, v33
    v_dot2_f32_bf16 v37, v141, v21, v37
    v_dot2_f32_bf16 v41, v141, v25, v41
    v_dot2_f32_bf16 v45, v141, v29, v45
    v_dot2_f32_bf16 v33, v142, v18, v33
    v_dot2_f32_bf16 v37, v142, v22, v37
    v_dot2_f32_bf16 v41, v142, v26, v41
    v_dot2_f32_bf16 v45, v142, v30, v45
    v_dot2_f32_bf16 v33, v143, v19, v33
    v_dot2_f32_bf16 v37, v143, v23, v37
    v_dot2_f32_bf16 v41, v143, v27, v41
    v_dot2_f32_bf16 v45, v143, v31, v45
    s_waitcnt vmcnt(35)
    v_dot2_f32_bf16 v34, v144, v16, 0
    v_dot2_f32_bf16 v38, v144, v20, 0
    v_dot2_f32_bf16 v42, v144, v24, 0
    v_dot2_f32_bf16 v46, v144, v28, 0
    v_dot2_f32_bf16 v34, v145, v17, v34
    v_dot2_f32_bf16 v38, v145, v21, v38
    v_dot2_f32_bf16 v42, v145, v25, v42
    v_dot2_f32_bf16 v46, v145, v29, v46
    v_dot2_f32_bf16 v34, v146, v18, v34
    v_dot2_f32_bf16 v38, v146, v22, v38
    v_dot2_f32_bf16 v42, v146, v26, v42
    v_dot2_f32_bf16 v46, v146, v30, v46
    v_dot2_f32_bf16 v34, v147, v19, v34
    v_dot2_f32_bf16 v38, v147, v23, v38
    v_dot2_f32_bf16 v42, v147, v27, v42
    v_dot2_f32_bf16 v46, v147, v31, v46
    s_waitcnt vmcnt(11)
    buffer_load_dwordx4 v[140:143], v3, s[56:59], s48 offen offset:2048 nt
    s_waitcnt vmcnt(35)
    v_dot2_f32_bf16 v35, v148, v16, 0
    v_dot2_f32_bf16 v39, v148, v20, 0
    v_dot2_f32_bf16 v43, v148, v24, 0
    v_dot2_f32_bf16 v47, v148, v28, 0
    v_dot2_f32_bf16 v35, v149, v17, v35
    v_dot2_f32_bf16 v39, v149, v21, v39
    v_dot2_f32_bf16 v43, v149, v25, v43
    v_dot2_f32_bf16 v47, v149, v29, v47
    v_dot2_f32_bf16 v35, v150, v18, v35
    v_dot2_f32_bf16 v39, v150, v22, v39
    v_dot2_f32_bf16 v43, v150, v26, v43
    v_dot2_f32_bf16 v47, v150, v30, v47
    v_dot2_f32_bf16 v35, v151, v19, v35
    v_dot2_f32_bf16 v39, v151, v23, v39
    v_dot2_f32_bf16 v43, v151, v27, v43
    v_dot2_f32_bf16 v47, v151, v31, v47
    v_add_f32_dpp v32, v32, v32 row_ror:8 row_mask:0xf bank_mask:0x3
    s_nop 1
    v_add_f32_dpp v32, v40, v40 row_ror:8 row_mask:0xf bank_mask:0xc
    v_add_f32_dpp v33, v33, v33 row_ror:8 row_mask:0xf bank_mask:0x3
    s_nop 1
    v_add_f32_dpp v33, v41, v41 row_ror:8 row_mask:0xf bank_mask:0xc
    v_add_f32_dpp v34, v34, v34 row_ror:8 row_mask:0xf bank_mask:0x3
    s_nop 1
    v_add_f32_dpp v34, v42, v42 row_ror:8 row_mask:0xf bank_mask:0xc
    v_add_f32_dpp v35, v35, v35 row_ror:8 row_mask:0xf bank_mask:0x3
    s_nop 1
    v_add_f32_dpp v35, v43, v43 row_ror:8 row_mask:0xf bank_mask:0xc
    v_add_f32_dpp v36, v36, v36 row_ror:8 row_mask:0xf bank_mask:0x3
    s_nop 1
    v_add_f32_dpp v36, v44, v44 row_ror:8 row_mask:0xf bank_mask:0xc
    v_add_f32_dpp v37, v37, v37 row_ror:8 row_mask:0xf bank_mask:0x3
    s_nop 1
    v_add_f32_dpp v37, v45, v45 row_ror:8 row_mask:0xf bank_mask:0xc
    v_add_f32_dpp v38, v38, v38 row_ror:8 row_mask:0xf bank_mask:0x3
    s_nop 1
    v_add_f32_dpp v38, v46, v46 row_ror:8 row_mask:0xf bank_mask:0xc
    v_add_f32_dpp v39, v39, v39 row_ror:8 row_mask:0xf bank_mask:0x3
    s_nop 1
    v_add_f32_dpp v39, v47, v47 row_ror:8 row_mask:0xf bank_mask:0xc
    v_add_f32_dpp v32, v32, v32 row_shl:4 row_mask:0xf bank_mask:0x5
    s_nop 1
    v_add_f32_dpp v32, v36, v36 row_shr:4 row_mask:0xf bank_mask:0xa
    v_add_f32_dpp v33, v33, v33 row_shl:4 row_mask:0xf bank_mask:0x5
    s_nop 1
    v_add_f32_dpp v33, v37, v37 row_shr:4 row_mask:0xf bank_mask:0xa
    v_add_f32_dpp v34, v34, v34 row_shl:4 row_mask:0xf bank_mask:0x5
    s_nop 1
    v_add_f32_dpp v34, v38, v38 row_shr:4 row_mask:0xf bank_mask:0xa
    v_add_f32_dpp v35, v35, v35 row_shl:4 row_mask:0xf bank_mask:0x5
    s_nop 1
    v_add_f32_dpp v35, v39, v39 row_shr:4 row_mask:0xf bank_mask:0xa
    v_add_f32_dpp v32, v32, v32 quad_perm:[2,3,0,1] row_mask:0xf bank_mask:0xf
    v_add_f32_dpp v34, v34, v34 quad_perm:[2,3,0,1] row_mask:0xf bank_mask:0xf
    v_cndmask_b32 v32, v32, v34, s[68:69]
    v_add_f32_dpp v33, v33, v33 quad_perm:[2,3,0,1] row_mask:0xf bank_mask:0xf
    v_add_f32_dpp v35, v35, v35 quad_perm:[2,3,0,1] row_mask:0xf bank_mask:0xf
    v_cndmask_b32 v33, v33, v35, s[68:69]
    v_add_f32_dpp v32, v32, v32 quad_perm:[1,0,3,2] row_mask:0xf bank_mask:0xf
    s_nop 0
    v_add_f32_dpp v33, v33, v33 quad_perm:[1,0,3,2] row_mask:0xf bank_mask:0xf
    v_cndmask_b32 v59, v32, v33, s[70:71]
    v_cvt_pk_bf16_f32 v59, v59, v59
    v_lshlrev_b32 v59, 16, v59
    v_mul_f32 v59, s73, v59
    v_cvt_pk_bf16_f32 v59, v59, v59
    v_lshlrev_b32 v59, 16, v59
    s_waitcnt vmcnt(34)
    v_dot2_f32_bf16 v32, v152, v16, 0
    v_dot2_f32_bf16 v36, v152, v20, 0
    v_dot2_f32_bf16 v40, v152, v24, 0
    v_dot2_f32_bf16 v44, v152, v28, 0
    v_dot2_f32_bf16 v32, v153, v17, v32
    v_dot2_f32_bf16 v36, v153, v21, v36
    v_dot2_f32_bf16 v40, v153, v25, v40
    v_dot2_f32_bf16 v44, v153, v29, v44
    v_dot2_f32_bf16 v32, v154, v18, v32
    v_dot2_f32_bf16 v36, v154, v22, v36
    v_dot2_f32_bf16 v40, v154, v26, v40
    v_dot2_f32_bf16 v44, v154, v30, v44
    v_dot2_f32_bf16 v32, v155, v19, v32
    v_dot2_f32_bf16 v36, v155, v23, v36
    v_dot2_f32_bf16 v40, v155, v27, v40
    v_dot2_f32_bf16 v44, v155, v31, v44
    s_waitcnt vmcnt(11)
    buffer_load_dwordx4 v[144:147], v3, s[56:59], s48 offen offset:3072 nt
    s_waitcnt vmcnt(34)
    v_dot2_f32_bf16 v33, v156, v16, 0
    v_dot2_f32_bf16 v37, v156, v20, 0
    v_dot2_f32_bf16 v41, v156, v24, 0
    v_dot2_f32_bf16 v45, v156, v28, 0
    v_dot2_f32_bf16 v33, v157, v17, v33
    v_dot2_f32_bf16 v37, v157, v21, v37
    v_dot2_f32_bf16 v41, v157, v25, v41
    v_dot2_f32_bf16 v45, v157, v29, v45
    v_dot2_f32_bf16 v33, v158, v18, v33
    v_dot2_f32_bf16 v37, v158, v22, v37
    v_dot2_f32_bf16 v41, v158, v26, v41
    v_dot2_f32_bf16 v45, v158, v30, v45
    v_dot2_f32_bf16 v33, v159, v19, v33
    v_dot2_f32_bf16 v37, v159, v23, v37
    v_dot2_f32_bf16 v41, v159, v27, v41
    v_dot2_f32_bf16 v45, v159, v31, v45
    s_waitcnt vmcnt(33)
    v_dot2_f32_bf16 v34, v160, v16, 0
    v_dot2_f32_bf16 v38, v160, v20, 0
    v_dot2_f32_bf16 v42, v160, v24, 0
    v_dot2_f32_bf16 v46, v160, v28, 0
    v_dot2_f32_bf16 v34, v161, v17, v34
    v_dot2_f32_bf16 v38, v161, v21, v38
    v_dot2_f32_bf16 v42, v161, v25, v42
    v_dot2_f32_bf16 v46, v161, v29, v46
    v_dot2_f32_bf16 v34, v162, v18, v34
    v_dot2_f32_bf16 v38, v162, v22, v38
    v_dot2_f32_bf16 v42, v162, v26, v42
    v_dot2_f32_bf16 v46, v162, v30, v46
    v_dot2_f32_bf16 v34, v163, v19, v34
    v_dot2_f32_bf16 v38, v163, v23, v38
    v_dot2_f32_bf16 v42, v163, v27, v42
    v_dot2_f32_bf16 v46, v163, v31, v46
    s_waitcnt vmcnt(11)
    buffer_load_dwordx4 v[148:151], v4, s[56:59], s48 offen offset:0 nt
    s_waitcnt vmcnt(33)
    v_dot2_f32_bf16 v35, v164, v16, 0
    v_dot2_f32_bf16 v39, v164, v20, 0
    v_dot2_f32_bf16 v43, v164, v24, 0
    v_dot2_f32_bf16 v47, v164, v28, 0
    v_dot2_f32_bf16 v35, v165, v17, v35
    v_dot2_f32_bf16 v39, v165, v21, v39
    v_dot2_f32_bf16 v43, v165, v25, v43
    v_dot2_f32_bf16 v47, v165, v29, v47
    v_dot2_f32_bf16 v35, v166, v18, v35
    v_dot2_f32_bf16 v39, v166, v22, v39
    v_dot2_f32_bf16 v43, v166, v26, v43
    v_dot2_f32_bf16 v47, v166, v30, v47
    v_dot2_f32_bf16 v35, v167, v19, v35
    v_dot2_f32_bf16 v39, v167, v23, v39
    v_dot2_f32_bf16 v43, v167, v27, v43
    v_dot2_f32_bf16 v47, v167, v31, v47
    v_add_f32_dpp v32, v32, v32 row_ror:8 row_mask:0xf bank_mask:0x3
    s_nop 1
    v_add_f32_dpp v32, v40, v40 row_ror:8 row_mask:0xf bank_mask:0xc
    v_add_f32_dpp v33, v33, v33 row_ror:8 row_mask:0xf bank_mask:0x3
    s_nop 1
    v_add_f32_dpp v33, v41, v41 row_ror:8 row_mask:0xf bank_mask:0xc
    v_add_f32_dpp v34, v34, v34 row_ror:8 row_mask:0xf bank_mask:0x3
    s_nop 1
    v_add_f32_dpp v34, v42, v42 row_ror:8 row_mask:0xf bank_mask:0xc
    v_add_f32_dpp v35, v35, v35 row_ror:8 row_mask:0xf bank_mask:0x3
    s_nop 1
    v_add_f32_dpp v35, v43, v43 row_ror:8 row_mask:0xf bank_mask:0xc
    v_add_f32_dpp v36, v36, v36 row_ror:8 row_mask:0xf bank_mask:0x3
    s_nop 1
    v_add_f32_dpp v36, v44, v44 row_ror:8 row_mask:0xf bank_mask:0xc
    v_add_f32_dpp v37, v37, v37 row_ror:8 row_mask:0xf bank_mask:0x3
    s_nop 1
    v_add_f32_dpp v37, v45, v45 row_ror:8 row_mask:0xf bank_mask:0xc
    v_add_f32_dpp v38, v38, v38 row_ror:8 row_mask:0xf bank_mask:0x3
    s_nop 1
    v_add_f32_dpp v38, v46, v46 row_ror:8 row_mask:0xf bank_mask:0xc
    v_add_f32_dpp v39, v39, v39 row_ror:8 row_mask:0xf bank_mask:0x3
    s_nop 1
    v_add_f32_dpp v39, v47, v47 row_ror:8 row_mask:0xf bank_mask:0xc
    v_add_f32_dpp v32, v32, v32 row_shl:4 row_mask:0xf bank_mask:0x5
    s_nop 1
    v_add_f32_dpp v32, v36, v36 row_shr:4 row_mask:0xf bank_mask:0xa
    v_add_f32_dpp v33, v33, v33 row_shl:4 row_mask:0xf bank_mask:0x5
    s_nop 1
    v_add_f32_dpp v33, v37, v37 row_shr:4 row_mask:0xf bank_mask:0xa
    v_add_f32_dpp v34, v34, v34 row_shl:4 row_mask:0xf bank_mask:0x5
    s_nop 1
    v_add_f32_dpp v34, v38, v38 row_shr:4 row_mask:0xf bank_mask:0xa
    v_add_f32_dpp v35, v35, v35 row_shl:4 row_mask:0xf bank_mask:0x5
    s_nop 1
    v_add_f32_dpp v35, v39, v39 row_shr:4 row_mask:0xf bank_mask:0xa
    v_add_f32_dpp v32, v32, v32 quad_perm:[2,3,0,1] row_mask:0xf bank_mask:0xf
    v_add_f32_dpp v34, v34, v34 quad_perm:[2,3,0,1] row_mask:0xf bank_mask:0xf
    v_cndmask_b32 v32, v32, v34, s[68:69]
    v_add_f32_dpp v33, v33, v33 quad_perm:[2,3,0,1] row_mask:0xf bank_mask:0xf
    v_add_f32_dpp v35, v35, v35 quad_perm:[2,3,0,1] row_mask:0xf bank_mask:0xf
    v_cndmask_b32 v33, v33, v35, s[68:69]
    v_add_f32_dpp v32, v32, v32 quad_perm:[1,0,3,2] row_mask:0xf bank_mask:0xf
    s_nop 0
    v_add_f32_dpp v33, v33, v33 quad_perm:[1,0,3,2] row_mask:0xf bank_mask:0xf
    v_cndmask_b32 v60, v32, v33, s[70:71]
    v_cvt_pk_bf16_f32 v60, v60, v60
    v_lshlrev_b32 v60, 16, v60
    v_mul_f32 v60, s73, v60
    v_cvt_pk_bf16_f32 v60, v60, v60
    v_lshlrev_b32 v60, 16, v60
    s_waitcnt vmcnt(32)
    v_dot2_f32_bf16 v32, v168, v16, 0
    v_dot2_f32_bf16 v36, v168, v20, 0
    v_dot2_f32_bf16 v40, v168, v24, 0
    v_dot2_f32_bf16 v44, v168, v28, 0
    v_dot2_f32_bf16 v32, v169, v17, v32
    v_dot2_f32_bf16 v36, v169, v21, v36
    v_dot2_f32_bf16 v40, v169, v25, v40
    v_dot2_f32_bf16 v44, v169, v29, v44
    v_dot2_f32_bf16 v32, v170, v18, v32
    v_dot2_f32_bf16 v36, v170, v22, v36
    v_dot2_f32_bf16 v40, v170, v26, v40
    v_dot2_f32_bf16 v44, v170, v30, v44
    v_dot2_f32_bf16 v32, v171, v19, v32
    v_dot2_f32_bf16 v36, v171, v23, v36
    v_dot2_f32_bf16 v40, v171, v27, v40
    v_dot2_f32_bf16 v44, v171, v31, v44
    s_waitcnt vmcnt(11)
    buffer_load_dwordx4 v[152:155], v4, s[56:59], s48 offen offset:1024 nt
    s_waitcnt vmcnt(32)
    v_dot2_f32_bf16 v33, v172, v16, 0
    v_dot2_f32_bf16 v37, v172, v20, 0
    v_dot2_f32_bf16 v41, v172, v24, 0
    v_dot2_f32_bf16 v45, v172, v28, 0
    v_dot2_f32_bf16 v33, v173, v17, v33
    v_dot2_f32_bf16 v37, v173, v21, v37
    v_dot2_f32_bf16 v41, v173, v25, v41
    v_dot2_f32_bf16 v45, v173, v29, v45
    v_dot2_f32_bf16 v33, v174, v18, v33
    v_dot2_f32_bf16 v37, v174, v22, v37
    v_dot2_f32_bf16 v41, v174, v26, v41
    v_dot2_f32_bf16 v45, v174, v30, v45
    v_dot2_f32_bf16 v33, v175, v19, v33
    v_dot2_f32_bf16 v37, v175, v23, v37
    v_dot2_f32_bf16 v41, v175, v27, v41
    v_dot2_f32_bf16 v45, v175, v31, v45
    s_waitcnt vmcnt(31)
    v_dot2_f32_bf16 v34, v176, v16, 0
    v_dot2_f32_bf16 v38, v176, v20, 0
    v_dot2_f32_bf16 v42, v176, v24, 0
    v_dot2_f32_bf16 v46, v176, v28, 0
    v_dot2_f32_bf16 v34, v177, v17, v34
    v_dot2_f32_bf16 v38, v177, v21, v38
    v_dot2_f32_bf16 v42, v177, v25, v42
    v_dot2_f32_bf16 v46, v177, v29, v46
    v_dot2_f32_bf16 v34, v178, v18, v34
    v_dot2_f32_bf16 v38, v178, v22, v38
    v_dot2_f32_bf16 v42, v178, v26, v42
    v_dot2_f32_bf16 v46, v178, v30, v46
    v_dot2_f32_bf16 v34, v179, v19, v34
    v_dot2_f32_bf16 v38, v179, v23, v38
    v_dot2_f32_bf16 v42, v179, v27, v42
    v_dot2_f32_bf16 v46, v179, v31, v46
    s_waitcnt vmcnt(11)
    buffer_load_dwordx4 v[156:159], v4, s[56:59], s48 offen offset:2048 nt
    s_waitcnt vmcnt(31)
    v_dot2_f32_bf16 v35, v180, v16, 0
    v_dot2_f32_bf16 v39, v180, v20, 0
    v_dot2_f32_bf16 v43, v180, v24, 0
    v_dot2_f32_bf16 v47, v180, v28, 0
    v_dot2_f32_bf16 v35, v181, v17, v35
    v_dot2_f32_bf16 v39, v181, v21, v39
    v_dot2_f32_bf16 v43, v181, v25, v43
    v_dot2_f32_bf16 v47, v181, v29, v47
    v_dot2_f32_bf16 v35, v182, v18, v35
    v_dot2_f32_bf16 v39, v182, v22, v39
    v_dot2_f32_bf16 v43, v182, v26, v43
    v_dot2_f32_bf16 v47, v182, v30, v47
    v_dot2_f32_bf16 v35, v183, v19, v35
    v_dot2_f32_bf16 v39, v183, v23, v39
    v_dot2_f32_bf16 v43, v183, v27, v43
    v_dot2_f32_bf16 v47, v183, v31, v47
    v_add_f32_dpp v32, v32, v32 row_ror:8 row_mask:0xf bank_mask:0x3
    s_nop 1
    v_add_f32_dpp v32, v40, v40 row_ror:8 row_mask:0xf bank_mask:0xc
    v_add_f32_dpp v33, v33, v33 row_ror:8 row_mask:0xf bank_mask:0x3
    s_nop 1
    v_add_f32_dpp v33, v41, v41 row_ror:8 row_mask:0xf bank_mask:0xc
    v_add_f32_dpp v34, v34, v34 row_ror:8 row_mask:0xf bank_mask:0x3
    s_nop 1
    v_add_f32_dpp v34, v42, v42 row_ror:8 row_mask:0xf bank_mask:0xc
    v_add_f32_dpp v35, v35, v35 row_ror:8 row_mask:0xf bank_mask:0x3
    s_nop 1
    v_add_f32_dpp v35, v43, v43 row_ror:8 row_mask:0xf bank_mask:0xc
    v_add_f32_dpp v36, v36, v36 row_ror:8 row_mask:0xf bank_mask:0x3
    s_nop 1
    v_add_f32_dpp v36, v44, v44 row_ror:8 row_mask:0xf bank_mask:0xc
    v_add_f32_dpp v37, v37, v37 row_ror:8 row_mask:0xf bank_mask:0x3
    s_nop 1
    v_add_f32_dpp v37, v45, v45 row_ror:8 row_mask:0xf bank_mask:0xc
    v_add_f32_dpp v38, v38, v38 row_ror:8 row_mask:0xf bank_mask:0x3
    s_nop 1
    v_add_f32_dpp v38, v46, v46 row_ror:8 row_mask:0xf bank_mask:0xc
    v_add_f32_dpp v39, v39, v39 row_ror:8 row_mask:0xf bank_mask:0x3
    s_nop 1
    v_add_f32_dpp v39, v47, v47 row_ror:8 row_mask:0xf bank_mask:0xc
    v_add_f32_dpp v32, v32, v32 row_shl:4 row_mask:0xf bank_mask:0x5
    s_nop 1
    v_add_f32_dpp v32, v36, v36 row_shr:4 row_mask:0xf bank_mask:0xa
    v_add_f32_dpp v33, v33, v33 row_shl:4 row_mask:0xf bank_mask:0x5
    s_nop 1
    v_add_f32_dpp v33, v37, v37 row_shr:4 row_mask:0xf bank_mask:0xa
    v_add_f32_dpp v34, v34, v34 row_shl:4 row_mask:0xf bank_mask:0x5
    s_nop 1
    v_add_f32_dpp v34, v38, v38 row_shr:4 row_mask:0xf bank_mask:0xa
    v_add_f32_dpp v35, v35, v35 row_shl:4 row_mask:0xf bank_mask:0x5
    s_nop 1
    v_add_f32_dpp v35, v39, v39 row_shr:4 row_mask:0xf bank_mask:0xa
    v_add_f32_dpp v32, v32, v32 quad_perm:[2,3,0,1] row_mask:0xf bank_mask:0xf
    v_add_f32_dpp v34, v34, v34 quad_perm:[2,3,0,1] row_mask:0xf bank_mask:0xf
    v_cndmask_b32 v32, v32, v34, s[68:69]
    v_add_f32_dpp v33, v33, v33 quad_perm:[2,3,0,1] row_mask:0xf bank_mask:0xf
    v_add_f32_dpp v35, v35, v35 quad_perm:[2,3,0,1] row_mask:0xf bank_mask:0xf
    v_cndmask_b32 v33, v33, v35, s[68:69]
    v_add_f32_dpp v32, v32, v32 quad_perm:[1,0,3,2] row_mask:0xf bank_mask:0xf
    s_nop 0
    v_add_f32_dpp v33, v33, v33 quad_perm:[1,0,3,2] row_mask:0xf bank_mask:0xf
    v_cndmask_b32 v61, v32, v33, s[70:71]
    v_cvt_pk_bf16_f32 v61, v61, v61
    v_lshlrev_b32 v61, 16, v61
    v_mul_f32 v61, s73, v61
    v_cvt_pk_bf16_f32 v61, v61, v61
    v_lshlrev_b32 v61, 16, v61
    s_waitcnt vmcnt(30)
    v_dot2_f32_bf16 v32, v184, v16, 0
    v_dot2_f32_bf16 v36, v184, v20, 0
    v_dot2_f32_bf16 v40, v184, v24, 0
    v_dot2_f32_bf16 v44, v184, v28, 0
    v_dot2_f32_bf16 v32, v185, v17, v32
    v_dot2_f32_bf16 v36, v185, v21, v36
    v_dot2_f32_bf16 v40, v185, v25, v40
    v_dot2_f32_bf16 v44, v185, v29, v44
    v_dot2_f32_bf16 v32, v186, v18, v32
    v_dot2_f32_bf16 v36, v186, v22, v36
    v_dot2_f32_bf16 v40, v186, v26, v40
    v_dot2_f32_bf16 v44, v186, v30, v44
    v_dot2_f32_bf16 v32, v187, v19, v32
    v_dot2_f32_bf16 v36, v187, v23, v36
    v_dot2_f32_bf16 v40, v187, v27, v40
    v_dot2_f32_bf16 v44, v187, v31, v44
    s_waitcnt vmcnt(11)
    buffer_load_dwordx4 v[160:163], v4, s[56:59], s48 offen offset:3072 nt
    s_waitcnt vmcnt(30)
    v_dot2_f32_bf16 v33, v188, v16, 0
    v_dot2_f32_bf16 v37, v188, v20, 0
    v_dot2_f32_bf16 v41, v188, v24, 0
    v_dot2_f32_bf16 v45, v188, v28, 0
    v_dot2_f32_bf16 v33, v189, v17, v33
    v_dot2_f32_bf16 v37, v189, v21, v37
    v_dot2_f32_bf16 v41, v189, v25, v41
    v_dot2_f32_bf16 v45, v189, v29, v45
    v_dot2_f32_bf16 v33, v190, v18, v33
    v_dot2_f32_bf16 v37, v190, v22, v37
    v_dot2_f32_bf16 v41, v190, v26, v41
    v_dot2_f32_bf16 v45, v190, v30, v45
    v_dot2_f32_bf16 v33, v191, v19, v33
    v_dot2_f32_bf16 v37, v191, v23, v37
    v_dot2_f32_bf16 v41, v191, v27, v41
    v_dot2_f32_bf16 v45, v191, v31, v45
    s_waitcnt vmcnt(29)
    v_dot2_f32_bf16 v34, v192, v16, 0
    v_dot2_f32_bf16 v38, v192, v20, 0
    v_dot2_f32_bf16 v42, v192, v24, 0
    v_dot2_f32_bf16 v46, v192, v28, 0
    v_dot2_f32_bf16 v34, v193, v17, v34
    v_dot2_f32_bf16 v38, v193, v21, v38
    v_dot2_f32_bf16 v42, v193, v25, v42
    v_dot2_f32_bf16 v46, v193, v29, v46
    v_dot2_f32_bf16 v34, v194, v18, v34
    v_dot2_f32_bf16 v38, v194, v22, v38
    v_dot2_f32_bf16 v42, v194, v26, v42
    v_dot2_f32_bf16 v46, v194, v30, v46
    v_dot2_f32_bf16 v34, v195, v19, v34
    v_dot2_f32_bf16 v38, v195, v23, v38
    v_dot2_f32_bf16 v42, v195, v27, v42
    v_dot2_f32_bf16 v46, v195, v31, v46
    s_waitcnt vmcnt(11)
    s_add_u32 s48, s75, 98304
    buffer_load_dwordx4 v[164:167], v3, s[56:59], s48 offen offset:0 nt
    s_waitcnt vmcnt(29)
    v_dot2_f32_bf16 v35, v196, v16, 0
    v_dot2_f32_bf16 v39, v196, v20, 0
    v_dot2_f32_bf16 v43, v196, v24, 0
    v_dot2_f32_bf16 v47, v196, v28, 0
    v_dot2_f32_bf16 v35, v197, v17, v35
    v_dot2_f32_bf16 v39, v197, v21, v39
    v_dot2_f32_bf16 v43, v197, v25, v43
    v_dot2_f32_bf16 v47, v197, v29, v47
    v_dot2_f32_bf16 v35, v198, v18, v35
    v_dot2_f32_bf16 v39, v198, v22, v39
    v_dot2_f32_bf16 v43, v198, v26, v43
    v_dot2_f32_bf16 v47, v198, v30, v47
    v_dot2_f32_bf16 v35, v199, v19, v35
    v_dot2_f32_bf16 v39, v199, v23, v39
    v_dot2_f32_bf16 v43, v199, v27, v43
    v_dot2_f32_bf16 v47, v199, v31, v47
    v_add_f32_dpp v32, v32, v32 row_ror:8 row_mask:0xf bank_mask:0x3
    s_nop 1
    v_add_f32_dpp v32, v40, v40 row_ror:8 row_mask:0xf bank_mask:0xc
    v_add_f32_dpp v33, v33, v33 row_ror:8 row_mask:0xf bank_mask:0x3
    s_nop 1
    v_add_f32_dpp v33, v41, v41 row_ror:8 row_mask:0xf bank_mask:0xc
    v_add_f32_dpp v34, v34, v34 row_ror:8 row_mask:0xf bank_mask:0x3
    s_nop 1
    v_add_f32_dpp v34, v42, v42 row_ror:8 row_mask:0xf bank_mask:0xc
    v_add_f32_dpp v35, v35, v35 row_ror:8 row_mask:0xf bank_mask:0x3
    s_nop 1
    v_add_f32_dpp v35, v43, v43 row_ror:8 row_mask:0xf bank_mask:0xc
    v_add_f32_dpp v36, v36, v36 row_ror:8 row_mask:0xf bank_mask:0x3
    s_nop 1
    v_add_f32_dpp v36, v44, v44 row_ror:8 row_mask:0xf bank_mask:0xc
    v_add_f32_dpp v37, v37, v37 row_ror:8 row_mask:0xf bank_mask:0x3
    s_nop 1
    v_add_f32_dpp v37, v45, v45 row_ror:8 row_mask:0xf bank_mask:0xc
    v_add_f32_dpp v38, v38, v38 row_ror:8 row_mask:0xf bank_mask:0x3
    s_nop 1
    v_add_f32_dpp v38, v46, v46 row_ror:8 row_mask:0xf bank_mask:0xc
    v_add_f32_dpp v39, v39, v39 row_ror:8 row_mask:0xf bank_mask:0x3
    s_nop 1
    v_add_f32_dpp v39, v47, v47 row_ror:8 row_mask:0xf bank_mask:0xc
    v_add_f32_dpp v32, v32, v32 row_shl:4 row_mask:0xf bank_mask:0x5
    s_nop 1
    v_add_f32_dpp v32, v36, v36 row_shr:4 row_mask:0xf bank_mask:0xa
    v_add_f32_dpp v33, v33, v33 row_shl:4 row_mask:0xf bank_mask:0x5
    s_nop 1
    v_add_f32_dpp v33, v37, v37 row_shr:4 row_mask:0xf bank_mask:0xa
    v_add_f32_dpp v34, v34, v34 row_shl:4 row_mask:0xf bank_mask:0x5
    s_nop 1
    v_add_f32_dpp v34, v38, v38 row_shr:4 row_mask:0xf bank_mask:0xa
    v_add_f32_dpp v35, v35, v35 row_shl:4 row_mask:0xf bank_mask:0x5
    s_nop 1
    v_add_f32_dpp v35, v39, v39 row_shr:4 row_mask:0xf bank_mask:0xa
    v_add_f32_dpp v32, v32, v32 quad_perm:[2,3,0,1] row_mask:0xf bank_mask:0xf
    v_add_f32_dpp v34, v34, v34 quad_perm:[2,3,0,1] row_mask:0xf bank_mask:0xf
    v_cndmask_b32 v32, v32, v34, s[68:69]
    v_add_f32_dpp v33, v33, v33 quad_perm:[2,3,0,1] row_mask:0xf bank_mask:0xf
    v_add_f32_dpp v35, v35, v35 quad_perm:[2,3,0,1] row_mask:0xf bank_mask:0xf
    v_cndmask_b32 v33, v33, v35, s[68:69]
    v_add_f32_dpp v32, v32, v32 quad_perm:[1,0,3,2] row_mask:0xf bank_mask:0xf
    s_nop 0
    v_add_f32_dpp v33, v33, v33 quad_perm:[1,0,3,2] row_mask:0xf bank_mask:0xf
    v_cndmask_b32 v62, v32, v33, s[70:71]
    v_cvt_pk_bf16_f32 v62, v62, v62
    v_lshlrev_b32 v62, 16, v62
    v_mul_f32 v62, s73, v62
    v_cvt_pk_bf16_f32 v62, v62, v62
    v_lshlrev_b32 v62, 16, v62
    s_waitcnt vmcnt(28)
    v_dot2_f32_bf16 v32, v200, v16, 0
    v_dot2_f32_bf16 v36, v200, v20, 0
    v_dot2_f32_bf16 v40, v200, v24, 0
    v_dot2_f32_bf16 v44, v200, v28, 0
    v_dot2_f32_bf16 v32, v201, v17, v32
    v_dot2_f32_bf16 v36, v201, v21, v36
    v_dot2_f32_bf16 v40, v201, v25, v40
    v_dot2_f32_bf16 v44, v201, v29, v44
    v_dot2_f32_bf16 v32, v202, v18, v32
    v_dot2_f32_bf16 v36, v202, v22, v36
    v_dot2_f32_bf16 v40, v202, v26, v40
    v_dot2_f32_bf16 v44, v202, v30, v44
    v_dot2_f32_bf16 v32, v203, v19, v32
    v_dot2_f32_bf16 v36, v203, v23, v36
    v_dot2_f32_bf16 v40, v203, v27, v40
    v_dot2_f32_bf16 v44, v203, v31, v44
    s_waitcnt vmcnt(11)
    buffer_load_dwordx4 v[168:171], v3, s[56:59], s48 offen offset:1024 nt
    s_waitcnt vmcnt(28)
    v_dot2_f32_bf16 v33, v204, v16, 0
    v_dot2_f32_bf16 v37, v204, v20, 0
    v_dot2_f32_bf16 v41, v204, v24, 0
    v_dot2_f32_bf16 v45, v204, v28, 0
    v_dot2_f32_bf16 v33, v205, v17, v33
    v_dot2_f32_bf16 v37, v205, v21, v37
    v_dot2_f32_bf16 v41, v205, v25, v41
    v_dot2_f32_bf16 v45, v205, v29, v45
    v_dot2_f32_bf16 v33, v206, v18, v33
    v_dot2_f32_bf16 v37, v206, v22, v37
    v_dot2_f32_bf16 v41, v206, v26, v41
    v_dot2_f32_bf16 v45, v206, v30, v45
    v_dot2_f32_bf16 v33, v207, v19, v33
    v_dot2_f32_bf16 v37, v207, v23, v37
    v_dot2_f32_bf16 v41, v207, v27, v41
    v_dot2_f32_bf16 v45, v207, v31, v45
    s_waitcnt vmcnt(27)
    v_dot2_f32_bf16 v34, v208, v16, 0
    v_dot2_f32_bf16 v38, v208, v20, 0
    v_dot2_f32_bf16 v42, v208, v24, 0
    v_dot2_f32_bf16 v46, v208, v28, 0
    v_dot2_f32_bf16 v34, v209, v17, v34
    v_dot2_f32_bf16 v38, v209, v21, v38
    v_dot2_f32_bf16 v42, v209, v25, v42
    v_dot2_f32_bf16 v46, v209, v29, v46
    v_dot2_f32_bf16 v34, v210, v18, v34
    v_dot2_f32_bf16 v38, v210, v22, v38
    v_dot2_f32_bf16 v42, v210, v26, v42
    v_dot2_f32_bf16 v46, v210, v30, v46
    v_dot2_f32_bf16 v34, v211, v19, v34
    v_dot2_f32_bf16 v38, v211, v23, v38
    v_dot2_f32_bf16 v42, v211, v27, v42
    v_dot2_f32_bf16 v46, v211, v31, v46
    s_waitcnt vmcnt(11)
    buffer_load_dwordx4 v[172:175], v3, s[56:59], s48 offen offset:2048 nt
    s_waitcnt vmcnt(27)
    v_dot2_f32_bf16 v35, v212, v16, 0
    v_dot2_f32_bf16 v39, v212, v20, 0
    v_dot2_f32_bf16 v43, v212, v24, 0
    v_dot2_f32_bf16 v47, v212, v28, 0
    v_dot2_f32_bf16 v35, v213, v17, v35
    v_dot2_f32_bf16 v39, v213, v21, v39
    v_dot2_f32_bf16 v43, v213, v25, v43
    v_dot2_f32_bf16 v47, v213, v29, v47
    v_dot2_f32_bf16 v35, v214, v18, v35
    v_dot2_f32_bf16 v39, v214, v22, v39
    v_dot2_f32_bf16 v43, v214, v26, v43
    v_dot2_f32_bf16 v47, v214, v30, v47
    v_dot2_f32_bf16 v35, v215, v19, v35
    v_dot2_f32_bf16 v39, v215, v23, v39
    v_dot2_f32_bf16 v43, v215, v27, v43
    v_dot2_f32_bf16 v47, v215, v31, v47
    v_add_f32_dpp v32, v32, v32 row_ror:8 row_mask:0xf bank_mask:0x3
    s_nop 1
    v_add_f32_dpp v32, v40, v40 row_ror:8 row_mask:0xf bank_mask:0xc
    v_add_f32_dpp v33, v33, v33 row_ror:8 row_mask:0xf bank_mask:0x3
    s_nop 1
    v_add_f32_dpp v33, v41, v41 row_ror:8 row_mask:0xf bank_mask:0xc
    v_add_f32_dpp v34, v34, v34 row_ror:8 row_mask:0xf bank_mask:0x3
    s_nop 1
    v_add_f32_dpp v34, v42, v42 row_ror:8 row_mask:0xf bank_mask:0xc
    v_add_f32_dpp v35, v35, v35 row_ror:8 row_mask:0xf bank_mask:0x3
    s_nop 1
    v_add_f32_dpp v35, v43, v43 row_ror:8 row_mask:0xf bank_mask:0xc
    v_add_f32_dpp v36, v36, v36 row_ror:8 row_mask:0xf bank_mask:0x3
    s_nop 1
    v_add_f32_dpp v36, v44, v44 row_ror:8 row_mask:0xf bank_mask:0xc
    v_add_f32_dpp v37, v37, v37 row_ror:8 row_mask:0xf bank_mask:0x3
    s_nop 1
    v_add_f32_dpp v37, v45, v45 row_ror:8 row_mask:0xf bank_mask:0xc
    v_add_f32_dpp v38, v38, v38 row_ror:8 row_mask:0xf bank_mask:0x3
    s_nop 1
    v_add_f32_dpp v38, v46, v46 row_ror:8 row_mask:0xf bank_mask:0xc
    v_add_f32_dpp v39, v39, v39 row_ror:8 row_mask:0xf bank_mask:0x3
    s_nop 1
    v_add_f32_dpp v39, v47, v47 row_ror:8 row_mask:0xf bank_mask:0xc
    v_add_f32_dpp v32, v32, v32 row_shl:4 row_mask:0xf bank_mask:0x5
    s_nop 1
    v_add_f32_dpp v32, v36, v36 row_shr:4 row_mask:0xf bank_mask:0xa
    v_add_f32_dpp v33, v33, v33 row_shl:4 row_mask:0xf bank_mask:0x5
    s_nop 1
    v_add_f32_dpp v33, v37, v37 row_shr:4 row_mask:0xf bank_mask:0xa
    v_add_f32_dpp v34, v34, v34 row_shl:4 row_mask:0xf bank_mask:0x5
    s_nop 1
    v_add_f32_dpp v34, v38, v38 row_shr:4 row_mask:0xf bank_mask:0xa
    v_add_f32_dpp v35, v35, v35 row_shl:4 row_mask:0xf bank_mask:0x5
    s_nop 1
    v_add_f32_dpp v35, v39, v39 row_shr:4 row_mask:0xf bank_mask:0xa
    v_add_f32_dpp v32, v32, v32 quad_perm:[2,3,0,1] row_mask:0xf bank_mask:0xf
    v_add_f32_dpp v34, v34, v34 quad_perm:[2,3,0,1] row_mask:0xf bank_mask:0xf
    v_cndmask_b32 v32, v32, v34, s[68:69]
    v_add_f32_dpp v33, v33, v33 quad_perm:[2,3,0,1] row_mask:0xf bank_mask:0xf
    v_add_f32_dpp v35, v35, v35 quad_perm:[2,3,0,1] row_mask:0xf bank_mask:0xf
    v_cndmask_b32 v33, v33, v35, s[68:69]
    v_add_f32_dpp v32, v32, v32 quad_perm:[1,0,3,2] row_mask:0xf bank_mask:0xf
    s_nop 0
    v_add_f32_dpp v33, v33, v33 quad_perm:[1,0,3,2] row_mask:0xf bank_mask:0xf
    v_cndmask_b32 v63, v32, v33, s[70:71]
    v_cvt_pk_bf16_f32 v63, v63, v63
    v_lshlrev_b32 v63, 16, v63
    v_mul_f32 v63, s73, v63
    v_cvt_pk_bf16_f32 v63, v63, v63
    v_lshlrev_b32 v63, 16, v63
    buffer_load_dwordx4 v[176:179], v3, s[56:59], s48 offen offset:3072 nt
    buffer_load_dwordx4 v[180:183], v4, s[56:59], s48 offen offset:0 nt
    buffer_load_dwordx4 v[184:187], v4, s[56:59], s48 offen offset:1024 nt
    buffer_load_dwordx4 v[188:191], v4, s[56:59], s48 offen offset:2048 nt
    buffer_load_dwordx4 v[192:195], v4, s[56:59], s48 offen offset:3072 nt
    s_add_u32 s48, s75, 131072
    buffer_load_dwordx4 v[196:199], v3, s[56:59], s48 offen offset:0 nt
    buffer_load_dwordx4 v[200:203], v3, s[56:59], s48 offen offset:1024 nt
    buffer_load_dwordx4 v[204:207], v3, s[56:59], s48 offen offset:2048 nt
    buffer_load_dwordx4 v[208:211], v3, s[56:59], s48 offen offset:3072 nt
    buffer_load_dwordx4 v[212:215], v4, s[56:59], s48 offen offset:0 nt
    buffer_load_dwordx4 v[236:239], v4, s[56:59], s48 offen offset:1024 nt
    buffer_load_dwordx4 v[240:243], v4, s[56:59], s48 offen offset:2048 nt
    v_max_f32 v64, v48, v49
    v_max_f32 v64, v64, v50
    v_max_f32 v64, v64, v51
    v_max_f32 v64, v64, v52
    v_max_f32 v64, v64, v53
    v_max_f32 v64, v64, v54
    v_max_f32 v64, v64, v55
    v_max_f32 v64, v64, v56
    v_max_f32 v64, v64, v57
    v_max_f32 v64, v64, v58
    v_max_f32 v64, v64, v59
    v_max_f32 v64, v64, v60
    v_max_f32 v64, v64, v61
    v_max_f32 v64, v64, v62
    v_max_f32 v64, v64, v63
    s_nop 1
    v_max_f32_dpp v64, v64, v64 quad_perm:[1,0,3,2] row_mask:0xf bank_mask:0xf
    s_nop 1
    v_max_f32_dpp v64, v64, v64 quad_perm:[2,3,0,1] row_mask:0xf bank_mask:0xf
    v_mov_b32 v66, v64
    s_nop 1
    v_permlane16_swap_b32 v64, v66
    v_max_f32 v64, v64, v66
    v_mov_b32 v66, v64
    s_nop 1
    v_permlane32_swap_b32 v64, v66
    v_max_f32 v64, v64, v66
    v_mov_b32 v65, 0
    v_sub_f32 v66, v48, v64
    v_mul_f32 v66, s72, v66
    v_exp_f32 v66, v66
    s_nop 0
    v_add_f32 v65, v65, v66
    v_sub_f32 v66, v49, v64
    v_mul_f32 v66, s72, v66
    v_exp_f32 v66, v66
    s_nop 0
    v_add_f32 v65, v65, v66
    v_sub_f32 v66, v50, v64
    v_mul_f32 v66, s72, v66
    v_exp_f32 v66, v66
    s_nop 0
    v_add_f32 v65, v65, v66
    v_sub_f32 v66, v51, v64
    v_mul_f32 v66, s72, v66
    v_exp_f32 v66, v66
    s_nop 0
    v_add_f32 v65, v65, v66
    v_sub_f32 v66, v52, v64
    v_mul_f32 v66, s72, v66
    v_exp_f32 v66, v66
    s_nop 0
    v_add_f32 v65, v65, v66
    v_sub_f32 v66, v53, v64
    v_mul_f32 v66, s72, v66
    v_exp_f32 v66, v66
    s_nop 0
    v_add_f32 v65, v65, v66
    v_sub_f32 v66, v54, v64
    v_mul_f32 v66, s72, v66
    v_exp_f32 v66, v66
    s_nop 0
    v_add_f32 v65, v65, v66
    v_sub_f32 v66, v55, v64
    v_mul_f32 v66, s72, v66
    v_exp_f32 v66, v66
    s_nop 0
    v_add_f32 v65, v65, v66
    v_sub_f32 v66, v56, v64
    v_mul_f32 v66, s72, v66
    v_exp_f32 v66, v66
    s_nop 0
    v_add_f32 v65, v65, v66
    v_sub_f32 v66, v57, v64
    v_mul_f32 v66, s72, v66
    v_exp_f32 v66, v66
    s_nop 0
    v_add_f32 v65, v65, v66
    v_sub_f32 v66, v58, v64
    v_mul_f32 v66, s72, v66
    v_exp_f32 v66, v66
    s_nop 0
    v_add_f32 v65, v65, v66
    v_sub_f32 v66, v59, v64
    v_mul_f32 v66, s72, v66
    v_exp_f32 v66, v66
    s_nop 0
    v_add_f32 v65, v65, v66
    v_sub_f32 v66, v60, v64
    v_mul_f32 v66, s72, v66
    v_exp_f32 v66, v66
    s_nop 0
    v_add_f32 v65, v65, v66
    v_sub_f32 v66, v61, v64
    v_mul_f32 v66, s72, v66
    v_exp_f32 v66, v66
    s_nop 0
    v_add_f32 v65, v65, v66
    v_sub_f32 v66, v62, v64
    v_mul_f32 v66, s72, v66
    v_exp_f32 v66, v66
    s_nop 0
    v_add_f32 v65, v65, v66
    v_sub_f32 v66, v63, v64
    v_mul_f32 v66, s72, v66
    v_exp_f32 v66, v66
    s_nop 0
    v_add_f32 v65, v65, v66
    s_nop 1
    v_add_f32_dpp v65, v65, v65 quad_perm:[1,0,3,2] row_mask:0xf bank_mask:0xf
    s_nop 1
    v_add_f32_dpp v65, v65, v65 quad_perm:[2,3,0,1] row_mask:0xf bank_mask:0xf
    v_mov_b32 v66, v65
    s_nop 1
    v_permlane16_swap_b32 v65, v66
    v_add_f32 v65, v65, v66
    v_mov_b32 v66, v65
    s_nop 1
    v_permlane32_swap_b32 v65, v66
    v_add_f32 v65, v65, v66
    v_bfe_u32 v67, v2, 2, 2
    v_lshlrev_b32 v67, 3, v67
    s_lshl_b32 s46, s42, 5
    v_add_u32 v66, s46, v67
    ds_write_b64 v66, v[64:65] offset:128
    s_lshl_b32 s46, s42, 2
    v_mov_b32 v66, s46
    s_waitcnt lgkmcnt(0)
    v_mov_b32 v68, s50
    ds_write_b32 v66, v68 offset:48
    s_nop 1
L_lw_4:
    ds_read_b128 v[8:11], v5 offset:48
    s_waitcnt lgkmcnt(0)
    v_min_u32 v8, v8, v9
    v_min3_u32 v8, v8, v10, v11
    v_cmp_gt_u32 vcc, s50, v8
    s_nop 1
    s_cbranch_vccz L_lwd_5
    s_sleep 1
    s_sub_u32 s49, s49, 1
    s_cmp_gt_i32 s49, 0
    s_cbranch_scc1 L_lw_4
L_lwd_5:
    ds_read_b64 v[32:33], v67 offset:128
    ds_read_b64 v[34:35], v67 offset:160
    ds_read_b64 v[36:37], v67 offset:192
    ds_read_b64 v[38:39], v67 offset:224
    s_waitcnt lgkmcnt(0)
    v_max_f32 v64, v32, v34
    v_max_f32 v64, v64, v36
    v_max_f32 v64, v64, v38
    v_mov_b32 v65, 0
    v_sub_f32 v66, v32, v64
    v_mul_f32 v66, s72, v66
    v_exp_f32 v66, v66
    s_nop 0
    v_fma_f32 v65, v66, v33, v65
    v_sub_f32 v66, v34, v64
    v_mul_f32 v66, s72, v66
    v_exp_f32 v66, v66
    s_nop 0
    v_fma_f32 v65, v66, v35, v65
    v_sub_f32 v66, v36, v64
    v_mul_f32 v66, s72, v66
    v_exp_f32 v66, v66
    s_nop 0
    v_fma_f32 v65, v66, v37, v65
    v_sub_f32 v66, v38, v64
    v_mul_f32 v66, s72, v66
    v_exp_f32 v66, v66
    s_nop 0
    v_fma_f32 v65, v66, v39, v65
    ds_write_b64 v67, v[64:65] offset:256
    v_lshrrev_b32 v68, 4, v2
    v_lshlrev_b32 v68, 4, v68
    v_bfe_u32 v66, v2, 2, 2
    v_lshl_add_u32 v68, v66, 6, v68
    v_and_b32 v66, 3, v2
    v_lshl_add_u32 v68, v66, 1, v68
    s_lshl_b32 s46, s42, 11
    v_add_u32 v68, s46, v68
    v_sub_f32 v66, v48, v64
    v_mul_f32 v66, s72, v66
    v_exp_f32 v66, v66
    s_nop 0
    v_cvt_pk_bf16_f32 v66, v66, v66
    ds_write_b16 v68, v66 offset:9216
    v_sub_f32 v66, v49, v64
    v_mul_f32 v66, s72, v66
    v_exp_f32 v66, v66
    s_nop 0
    v_cvt_pk_bf16_f32 v66, v66, v66
    ds_write_b16 v68, v66 offset:9224
    v_sub_f32 v66, v50, v64
    v_mul_f32 v66, s72, v66
    v_exp_f32 v66, v66
    s_nop 0
    v_cvt_pk_bf16_f32 v66, v66, v66
    ds_write_b16 v68, v66 offset:9472
    v_sub_f32 v66, v51, v64
    v_mul_f32 v66, s72, v66
    v_exp_f32 v66, v66
    s_nop 0
    v_cvt_pk_bf16_f32 v66, v66, v66
    ds_write_b16 v68, v66 offset:9480
    v_sub_f32 v66, v52, v64
    v_mul_f32 v66, s72, v66
    v_exp_f32 v66, v66
    s_nop 0
    v_cvt_pk_bf16_f32 v66, v66, v66
    ds_write_b16 v68, v66 offset:9728
    v_sub_f32 v66, v53, v64
    v_mul_f32 v66, s72, v66
    v_exp_f32 v66, v66
    s_nop 0
    v_cvt_pk_bf16_f32 v66, v66, v66
    ds_write_b16 v68, v66 offset:9736
    v_sub_f32 v66, v54, v64
    v_mul_f32 v66, s72, v66
    v_exp_f32 v66, v66
    s_nop 0
    v_cvt_pk_bf16_f32 v66, v66, v66
    ds_write_b16 v68, v66 offset:9984
    v_sub_f32 v66, v55, v64
    v_mul_f32 v66, s72, v66
    v_exp_f32 v66, v66
    s_nop 0
    v_cvt_pk_bf16_f32 v66, v66, v66
    ds_write_b16 v68, v66 offset:9992
    v_sub_f32 v66, v56, v64
    v_mul_f32 v66, s72, v66
    v_exp_f32 v66, v66
    s_nop 0
    v_cvt_pk_bf16_f32 v66, v66, v66
    ds_write_b16 v68, v66 offset:10240
    v_sub_f32 v66, v57, v64
    v_mul_f32 v66, s72, v66
    v_exp_f32 v66, v66
    s_nop 0
    v_cvt_pk_bf16_f32 v66, v66, v66
    ds_write_b16 v68, v66 offset:10248
    v_sub_f32 v66, v58, v64
    v_mul_f32 v66, s72, v66
    v_exp_f32 v66, v66
    s_nop 0
    v_cvt_pk_bf16_f32 v66, v66, v66
    ds_write_b16 v68, v66 offset:10496
    v_sub_f32 v66, v59, v64
    v_mul_f32 v66, s72, v66
    v_exp_f32 v66, v66
    s_nop 0
    v_cvt_pk_bf16_f32 v66, v66, v66
    ds_write_b16 v68, v66 offset:10504
    v_sub_f32 v66, v60, v64
    v_mul_f32 v66, s72, v66
    v_exp_f32 v66, v66
    s_nop 0
    v_cvt_pk_bf16_f32 v66, v66, v66
    ds_write_b16 v68, v66 offset:10752
    v_sub_f32 v66, v61, v64
    v_mul_f32 v66, s72, v66
    v_exp_f32 v66, v66
    s_nop 0
    v_cvt_pk_bf16_f32 v66, v66, v66
    ds_write_b16 v68, v66 offset:10760
    v_sub_f32 v66, v62, v64
    v_mul_f32 v66, s72, v66
    v_exp_f32 v66, v66
    s_nop 0
    v_cvt_pk_bf16_f32 v66, v66, v66
    ds_write_b16 v68, v66 offset:11008
    v_sub_f32 v66, v63, v64
    v_mul_f32 v66, s72, v66
    v_exp_f32 v66, v66
    s_nop 0
    v_cvt_pk_bf16_f32 v66, v66, v66
    ds_write_b16 v68, v66 offset:11016
    v_lshrrev_b32 v7, 4, v2
    v_lshlrev_b32 v7, 4, v7
    v_and_b32 v66, 3, v2
    v_lshl_add_u32 v7, v66, 6, v7
    v_add_u32 v7, s46, v7
    s_waitcnt lgkmcnt(0)
    v_mov_b32 v16, 0
    v_mov_b32 v17, 0
    v_mov_b32 v18, 0
    v_mov_b32 v19, 0
    v_mov_b32 v20, 0
    v_mov_b32 v21, 0
    v_mov_b32 v22, 0
    v_mov_b32 v23, 0
    v_mov_b32 v24, 0
    v_mov_b32 v25, 0
    v_mov_b32 v26, 0
    v_mov_b32 v27, 0
    v_mov_b32 v28, 0
    v_mov_b32 v29, 0
    v_mov_b32 v30, 0
    v_mov_b32 v31, 0
    v_mov_b32 v32, 0
    v_mov_b32 v33, 0
    v_mov_b32 v34, 0
    v_mov_b32 v35, 0
    v_mov_b32 v36, 0
    v_mov_b32 v37, 0
    v_mov_b32 v38, 0
    v_mov_b32 v39, 0
    v_mov_b32 v40, 0
    v_mov_b32 v41, 0
    v_mov_b32 v42, 0
    v_mov_b32 v43, 0
    v_mov_b32 v44, 0
    v_mov_b32 v45, 0
    v_mov_b32 v46, 0
    v_mov_b32 v47, 0
    ds_read_b128 v[80:83], v7 offset:9216
    s_waitcnt vmcnt(11)
    buffer_load_dwordx4 v[244:247], v4, s[56:59], s48 offen offset:3072 nt
    s_waitcnt vmcnt(39)
    s_waitcnt vmcnt(38)
    v_perm_b32 v48, v220, v216, s43
    v_perm_b32 v52, v220, v216, s44
    v_perm_b32 v56, v221, v217, s43
    v_perm_b32 v60, v221, v217, s44
    v_perm_b32 v64, v222, v218, s43
    v_perm_b32 v68, v222, v218, s44
    v_perm_b32 v72, v223, v219, s43
    v_perm_b32 v76, v223, v219, s44
    s_waitcnt vmcnt(11)
    s_add_u32 s48, s75, 163840
    buffer_load_dwordx4 v[216:219], v3, s[56:59], s48 offen offset:0 nt
    s_waitcnt vmcnt(38)
    s_waitcnt vmcnt(37)
    v_perm_b32 v49, v228, v224, s43
    v_perm_b32 v53, v228, v224, s44
    v_perm_b32 v57, v229, v225, s43
    v_perm_b32 v61, v229, v225, s44
    v_perm_b32 v65, v230, v226, s43
    v_perm_b32 v69, v230, v226, s44
    v_perm_b32 v73, v231, v227, s43
    v_perm_b32 v77, v231, v227, s44
    s_waitcnt vmcnt(11)
    buffer_load_dwordx4 v[220:223], v3, s[56:59], s48 offen offset:1024 nt
    s_waitcnt vmcnt(37)
    s_waitcnt vmcnt(36)
    v_perm_b32 v50, v92, v88, s43
    v_perm_b32 v54, v92, v88, s44
    v_perm_b32 v58, v93, v89, s43
    v_perm_b32 v62, v93, v89, s44
    v_perm_b32 v66, v94, v90, s43
    v_perm_b32 v70, v94, v90, s44
    v_perm_b32 v74, v95, v91, s43
    v_perm_b32 v78, v95, v91, s44
    s_waitcnt vmcnt(11)
    buffer_load_dwordx4 v[224:227], v3, s[56:59], s48 offen offset:2048 nt
    s_waitcnt vmcnt(36)
    s_waitcnt vmcnt(35)
    v_perm_b32 v51, v100, v96, s43
    v_perm_b32 v55, v100, v96, s44
    v_perm_b32 v59, v101, v97, s43
    v_perm_b32 v63, v101, v97, s44
    v_perm_b32 v67, v102, v98, s43
    v_perm_b32 v71, v102, v98, s44
    v_perm_b32 v75, v103, v99, s43
    v_perm_b32 v79, v103, v99, s44
    s_waitcnt lgkmcnt(0)
    v_mfma_f32_16x16x32_bf16 v[16:19], v[48:51], v[80:83], v[16:19]
    v_mfma_f32_16x16x32_bf16 v[20:23], v[52:55], v[80:83], v[20:23]
    v_mfma_f32_16x16x32_bf16 v[24:27], v[56:59], v[80:83], v[24:27]
    v_mfma_f32_16x16x32_bf16 v[28:31], v[60:63], v[80:83], v[28:31]
    v_mfma_f32_16x16x32_bf16 v[32:35], v[64:67], v[80:83], v[32:35]
    v_mfma_f32_16x16x32_bf16 v[36:39], v[68:71], v[80:83], v[36:39]
    v_mfma_f32_16x16x32_bf16 v[40:43], v[72:75], v[80:83], v[40:43]
    v_mfma_f32_16x16x32_bf16 v[44:47], v[76:79], v[80:83], v[44:47]
    ds_read_b128 v[84:87], v7 offset:9472
    s_waitcnt vmcnt(11)
    buffer_load_dwordx4 v[228:231], v3, s[56:59], s48 offen offset:3072 nt
    s_waitcnt vmcnt(35)
    s_waitcnt vmcnt(34)
    v_perm_b32 v48, v108, v104, s43
    v_perm_b32 v52, v108, v104, s44
    v_perm_b32 v56, v109, v105, s43
    v_perm_b32 v60, v109, v105, s44
    v_perm_b32 v64, v110, v106, s43
    v_perm_b32 v68, v110, v106, s44
    v_perm_b32 v72, v111, v107, s43
    v_perm_b32 v76, v111, v107, s44
    s_waitcnt vmcnt(33)
    s_waitcnt vmcnt(32)
    v_perm_b32 v49, v116, v112, s43
    v_perm_b32 v53, v116, v112, s44
    v_perm_b32 v57, v117, v113, s43
    v_perm_b32 v61, v117, v113, s44
    v_perm_b32 v65, v118, v114, s43
    v_perm_b32 v69, v118, v114, s44
    v_perm_b32 v73, v119, v115, s43
    v_perm_b32 v77, v119, v115, s44
    s_waitcnt vmcnt(31)
    s_waitcnt vmcnt(30)
    v_perm_b32 v50, v124, v120, s43
    v_perm_b32 v54, v124, v120, s44
    v_perm_b32 v58, v125, v121, s43
    v_perm_b32 v62, v125, v121, s44
    v_perm_b32 v66, v126, v122, s43
    v_perm_b32 v70, v126, v122, s44
    v_perm_b32 v74, v127, v123, s43
    v_perm_b32 v78, v127, v123, s44
    s_waitcnt vmcnt(29)
    s_waitcnt vmcnt(28)
    v_perm_b32 v51, v132, v128, s43
    v_perm_b32 v55, v132, v128, s44
    v_perm_b32 v59, v133, v129, s43
    v_perm_b32 v63, v133, v129, s44
    v_perm_b32 v67, v134, v130, s43
    v_perm_b32 v71, v134, v130, s44
    v_perm_b32 v75, v135, v131, s43
    v_perm_b32 v79, v135, v131, s44
    s_waitcnt lgkmcnt(0)
    v_mfma_f32_16x16x32_bf16 v[16:19], v[48:51], v[84:87], v[16:19]
    v_mfma_f32_16x16x32_bf16 v[20:23], v[52:55], v[84:87], v[20:23]
    v_mfma_f32_16x16x32_bf16 v[24:27], v[56:59], v[84:87], v[24:27]
    v_mfma_f32_16x16x32_bf16 v[28:31], v[60:63], v[84:87], v[28:31]
    v_mfma_f32_16x16x32_bf16 v[32:35], v[64:67], v[84:87], v[32:35]
    v_mfma_f32_16x16x32_bf16 v[36:39], v[68:71], v[84:87], v[36:39]
    v_mfma_f32_16x16x32_bf16 v[40:43], v[72:75], v[84:87], v[40:43]
    v_mfma_f32_16x16x32_bf16 v[44:47], v[76:79], v[84:87], v[44:47]
    ds_read_b128 v[80:83], v7 offset:9728
    s_waitcnt vmcnt(27)
    s_waitcnt vmcnt(26)
    v_perm_b32 v48, v136, v232, s43
    v_perm_b32 v52, v136, v232, s44
    v_perm_b32 v56, v137, v233, s43
    v_perm_b32 v60, v137, v233, s44
    v_perm_b32 v64, v138, v234, s43
    v_perm_b32 v68, v138, v234, s44
    v_perm_b32 v72, v139, v235, s43
    v_perm_b32 v76, v139, v235, s44
    s_waitcnt vmcnt(11)
    buffer_load_dwordx4 v[136:139], v4, s[56:59], s48 offen offset:0 nt
    s_waitcnt vmcnt(26)
    s_waitcnt vmcnt(25)
    v_perm_b32 v49, v144, v140, s43
    v_perm_b32 v53, v144, v140, s44
    v_perm_b32 v57, v145, v141, s43
    v_perm_b32 v61, v145, v141, s44
    v_perm_b32 v65, v146, v142, s43
    v_perm_b32 v69, v146, v142, s44
    v_perm_b32 v73, v147, v143, s43
    v_perm_b32 v77, v147, v143, s44
    s_waitcnt vmcnt(11)
    buffer_load_dwordx4 v[140:143], v4, s[56:59], s48 offen offset:1024 nt
    s_waitcnt vmcnt(25)
    s_waitcnt vmcnt(24)
    v_perm_b32 v50, v152, v148, s43
    v_perm_b32 v54, v152, v148, s44
    v_perm_b32 v58, v153, v149, s43
    v_perm_b32 v62, v153, v149, s44
    v_perm_b32 v66, v154, v150, s43
    v_perm_b32 v70, v154, v150, s44
    v_perm_b32 v74, v155, v151, s43
    v_perm_b32 v78, v155, v151, s44
    s_waitcnt vmcnt(11)
    buffer_load_dwordx4 v[144:147], v4, s[56:59], s48 offen offset:2048 nt
    s_waitcnt vmcnt(24)
    s_waitcnt vmcnt(23)
    v_perm_b32 v51, v160, v156, s43
    v_perm_b32 v55, v160, v156, s44
    v_perm_b32 v59, v161, v157, s43
    v_perm_b32 v63, v161, v157, s44
    v_perm_b32 v67, v162, v158, s43
    v_perm_b32 v71, v162, v158, s44
    v_perm_b32 v75, v163, v159, s43
    v_perm_b32 v79, v163, v159, s44
    s_waitcnt lgkmcnt(0)
    v_mfma_f32_16x16x32_bf16 v[16:19], v[48:51], v[80:83], v[16:19]
    v_mfma_f32_16x16x32_bf16 v[20:23], v[52:55], v[80:83], v[20:23]
    v_mfma_f32_16x16x32_bf16 v[24:27], v[56:59], v[80:83], v[24:27]
    v_mfma_f32_16x16x32_bf16 v[28:31], v[60:63], v[80:83], v[28:31]
    v_mfma_f32_16x16x32_bf16 v[32:35], v[64:67], v[80:83], v[32:35]
    v_mfma_f32_16x16x32_bf16 v[36:39], v[68:71], v[80:83], v[36:39]
    v_mfma_f32_16x16x32_bf16 v[40:43], v[72:75], v[80:83], v[40:43]
    v_mfma_f32_16x16x32_bf16 v[44:47], v[76:79], v[80:83], v[44:47]
    ds_read_b128 v[84:87], v7 offset:9984
    s_waitcnt vmcnt(11)
    buffer_load_dwordx4 v[148:151], v4, s[56:59], s48 offen offset:3072 nt
    s_waitcnt vmcnt(23)
    s_waitcnt vmcnt(22)
    v_perm_b32 v48, v168, v164, s43
    v_perm_b32 v52, v168, v164, s44
    v_perm_b32 v56, v169, v165, s43
    v_perm_b32 v60, v169, v165, s44
    v_perm_b32 v64, v170, v166, s43
    v_perm_b32 v68, v170, v166, s44
    v_perm_b32 v72, v171, v167, s43
    v_perm_b32 v76, v171, v167, s44
    s_waitcnt vmcnt(11)
    s_add_u32 s48, s75, 196608
    buffer_load_dwordx4 v[152:155], v3, s[56:59], s48 offen offset:0 nt
    s_waitcnt vmcnt(22)
    s_waitcnt vmcnt(21)
    v_perm_b32 v49, v176, v172, s43
    v_perm_b32 v53, v176, v172, s44
    v_perm_b32 v57, v177, v173, s43
    v_perm_b32 v61, v177, v173, s44
    v_perm_b32 v65, v178, v174, s43
    v_perm_b32 v69, v178, v174, s44
    v_perm_b32 v73, v179, v175, s43
    v_perm_b32 v77, v179, v175, s44
    s_waitcnt vmcnt(11)
    buffer_load_dwordx4 v[156:159], v3, s[56:59], s48 offen offset:1024 nt
    s_waitcnt vmcnt(21)
    s_waitcnt vmcnt(20)
    v_perm_b32 v50, v184, v180, s43
    v_perm_b32 v54, v184, v180, s44
    v_perm_b32 v58, v185, v181, s43
    v_perm_b32 v62, v185, v181, s44
    v_perm_b32 v66, v186, v182, s43
    v_perm_b32 v70, v186, v182, s44
    v_perm_b32 v74, v187, v183, s43
    v_perm_b32 v78, v187, v183, s44
    s_waitcnt vmcnt(11)
    buffer_load_dwordx4 v[160:163], v3, s[56:59], s48 offen offset:2048 nt
    s_waitcnt vmcnt(20)
    s_waitcnt vmcnt(19)
    v_perm_b32 v51, v192, v188, s43
    v_perm_b32 v55, v192, v188, s44
    v_perm_b32 v59, v193, v189, s43
    v_perm_b32 v63, v193, v189, s44
    v_perm_b32 v67, v194, v190, s43
    v_perm_b32 v71, v194, v190, s44
    v_perm_b32 v75, v195, v191, s43
    v_perm_b32 v79, v195, v191, s44
    s_waitcnt lgkmcnt(0)
    v_mfma_f32_16x16x32_bf16 v[16:19], v[48:51], v[84:87], v[16:19]
    v_mfma_f32_16x16x32_bf16 v[20:23], v[52:55], v[84:87], v[20:23]
    v_mfma_f32_16x16x32_bf16 v[24:27], v[56:59], v[84:87], v[24:27]
    v_mfma_f32_16x16x32_bf16 v[28:31], v[60:63], v[84:87], v[28:31]
    v_mfma_f32_16x16x32_bf16 v[32:35], v[64:67], v[84:87], v[32:35]
    v_mfma_f32_16x16x32_bf16 v[36:39], v[68:71], v[84:87], v[36:39]
    v_mfma_f32_16x16x32_bf16 v[40:43], v[72:75], v[84:87], v[40:43]
    v_mfma_f32_16x16x32_bf16 v[44:47], v[76:79], v[84:87], v[44:47]
    ds_read_b128 v[80:83], v7 offset:10240
    s_waitcnt vmcnt(11)
    buffer_load_dwordx4 v[164:167], v3, s[56:59], s48 offen offset:3072 nt
    s_waitcnt vmcnt(19)
    s_waitcnt vmcnt(18)
    v_perm_b32 v48, v200, v196, s43
    v_perm_b32 v52, v200, v196, s44
    v_perm_b32 v56, v201, v197, s43
    v_perm_b32 v60, v201, v197, s44
    v_perm_b32 v64, v202, v198, s43
    v_perm_b32 v68, v202, v198, s44
    v_perm_b32 v72, v203, v199, s43
    v_perm_b32 v76, v203, v199, s44
    s_waitcnt vmcnt(11)
    buffer_load_dwordx4 v[168:171], v4, s[56:59], s48 offen offset:0 nt
    s_waitcnt vmcnt(18)
    s_waitcnt vmcnt(17)
    v_perm_b32 v49, v208, v204, s43
    v_perm_b32 v53, v208, v204, s44
    v_perm_b32 v57, v209, v205, s43
    v_perm_b32 v61, v209, v205, s44
    v_perm_b32 v65, v210, v206, s43
    v_perm_b32 v69, v210, v206, s44
    v_perm_b32 v73, v211, v207, s43
    v_perm_b32 v77, v211, v207, s44
    s_waitcnt vmcnt(11)
    buffer_load_dwordx4 v[172:175], v4, s[56:59], s48 offen offset:1024 nt
    s_waitcnt vmcnt(17)
    s_waitcnt vmcnt(16)
    v_perm_b32 v50, v236, v212, s43
    v_perm_b32 v54, v236, v212, s44
    v_perm_b32 v58, v237, v213, s43
    v_perm_b32 v62, v237, v213, s44
    v_perm_b32 v66, v238, v214, s43
    v_perm_b32 v70, v238, v214, s44
    v_perm_b32 v74, v239, v215, s43
    v_perm_b32 v78, v239, v215, s44
    s_waitcnt vmcnt(11)
    buffer_load_dwordx4 v[176:179], v4, s[56:59], s48 offen offset:2048 nt
    s_waitcnt vmcnt(16)
    s_waitcnt vmcnt(15)
    v_perm_b32 v51, v244, v240, s43
    v_perm_b32 v55, v244, v240, s44
    v_perm_b32 v59, v245, v241, s43
    v_perm_b32 v63, v245, v241, s44
    v_perm_b32 v67, v246, v242, s43
    v_perm_b32 v71, v246, v242, s44
    v_perm_b32 v75, v247, v243, s43
    v_perm_b32 v79, v247, v243, s44
    s_waitcnt lgkmcnt(0)
    v_mfma_f32_16x16x32_bf16 v[16:19], v[48:51], v[80:83], v[16:19]
    v_mfma_f32_16x16x32_bf16 v[20:23], v[52:55], v[80:83], v[20:23]
    v_mfma_f32_16x16x32_bf16 v[24:27], v[56:59], v[80:83], v[24:27]
    v_mfma_f32_16x16x32_bf16 v[28:31], v[60:63], v[80:83], v[28:31]
    v_mfma_f32_16x16x32_bf16 v[32:35], v[64:67], v[80:83], v[32:35]
    v_mfma_f32_16x16x32_bf16 v[36:39], v[68:71], v[80:83], v[36:39]
    v_mfma_f32_16x16x32_bf16 v[40:43], v[72:75], v[80:83], v[40:43]
    v_mfma_f32_16x16x32_bf16 v[44:47], v[76:79], v[80:83], v[44:47]
    ds_read_b128 v[84:87], v7 offset:10496
    s_waitcnt vmcnt(11)
    buffer_load_dwordx4 v[180:183], v4, s[56:59], s48 offen offset:3072 nt
    s_waitcnt vmcnt(15)
    s_waitcnt vmcnt(14)
    v_perm_b32 v48, v220, v216, s43
    v_perm_b32 v52, v220, v216, s44
    v_perm_b32 v56, v221, v217, s43
    v_perm_b32 v60, v221, v217, s44
    v_perm_b32 v64, v222, v218, s43
    v_perm_b32 v68, v222, v218, s44
    v_perm_b32 v72, v223, v219, s43
    v_perm_b32 v76, v223, v219, s44
    s_waitcnt vmcnt(11)
    s_add_u32 s48, s75, 229376
    buffer_load_dwordx4 v[184:187], v3, s[56:59], s48 offen offset:0 nt
    s_waitcnt vmcnt(14)
    s_waitcnt vmcnt(13)
    v_perm_b32 v49, v228, v224, s43
    v_perm_b32 v53, v228, v224, s44
    v_perm_b32 v57, v229, v225, s43
    v_perm_b32 v61, v229, v225, s44
    v_perm_b32 v65, v230, v226, s43
    v_perm_b32 v69, v230, v226, s44
    v_perm_b32 v73, v231, v227, s43
    v_perm_b32 v77, v231, v227, s44
    buffer_load_dwordx4 v[188:191], v3, s[56:59], s48 offen offset:1024 nt
    s_waitcnt vmcnt(13)
    s_waitcnt vmcnt(12)
    v_perm_b32 v50, v140, v136, s43
    v_perm_b32 v54, v140, v136, s44
    v_perm_b32 v58, v141, v137, s43
    v_perm_b32 v62, v141, v137, s44
    v_perm_b32 v66, v142, v138, s43
    v_perm_b32 v70, v142, v138, s44
    v_perm_b32 v74, v143, v139, s43
    v_perm_b32 v78, v143, v139, s44
    buffer_load_dwordx4 v[136:139], v3, s[56:59], s48 offen offset:2048 nt
    buffer_load_dwordx4 v[140:143], v3, s[56:59], s48 offen offset:3072 nt
    s_waitcnt vmcnt(13)
    s_waitcnt vmcnt(12)
    v_perm_b32 v51, v148, v144, s43
    v_perm_b32 v55, v148, v144, s44
    v_perm_b32 v59, v149, v145, s43
    v_perm_b32 v63, v149, v145, s44
    v_perm_b32 v67, v150, v146, s43
    v_perm_b32 v71, v150, v146, s44
    v_perm_b32 v75, v151, v147, s43
    v_perm_b32 v79, v151, v147, s44
    s_waitcnt lgkmcnt(0)
    v_mfma_f32_16x16x32_bf16 v[16:19], v[48:51], v[84:87], v[16:19]
    v_mfma_f32_16x16x32_bf16 v[20:23], v[52:55], v[84:87], v[20:23]
    v_mfma_f32_16x16x32_bf16 v[24:27], v[56:59], v[84:87], v[24:27]
    v_mfma_f32_16x16x32_bf16 v[28:31], v[60:63], v[84:87], v[28:31]
    v_mfma_f32_16x16x32_bf16 v[32:35], v[64:67], v[84:87], v[32:35]
    v_mfma_f32_16x16x32_bf16 v[36:39], v[68:71], v[84:87], v[36:39]
    v_mfma_f32_16x16x32_bf16 v[40:43], v[72:75], v[84:87], v[40:43]
    v_mfma_f32_16x16x32_bf16 v[44:47], v[76:79], v[84:87], v[44:47]
    buffer_load_dwordx4 v[144:147], v4, s[56:59], s48 offen offset:0 nt
    ds_read_b128 v[80:83], v7 offset:10752
    buffer_load_dwordx4 v[148:151], v4, s[56:59], s48 offen offset:1024 nt
    s_waitcnt vmcnt(13)
    s_waitcnt vmcnt(12)
    v_perm_b32 v48, v156, v152, s43
    v_perm_b32 v52, v156, v152, s44
    v_perm_b32 v56, v157, v153, s43
    v_perm_b32 v60, v157, v153, s44
    v_perm_b32 v64, v158, v154, s43
    v_perm_b32 v68, v158, v154, s44
    v_perm_b32 v72, v159, v155, s43
    v_perm_b32 v76, v159, v155, s44
    buffer_load_dwordx4 v[152:155], v4, s[56:59], s48 offen offset:2048 nt
    buffer_load_dwordx4 v[156:159], v4, s[56:59], s48 offen offset:3072 nt
    s_waitcnt vmcnt(13)
    s_waitcnt vmcnt(12)
    v_perm_b32 v49, v164, v160, s43
    v_perm_b32 v53, v164, v160, s44
    v_perm_b32 v57, v165, v161, s43
    v_perm_b32 v61, v165, v161, s44
    v_perm_b32 v65, v166, v162, s43
    v_perm_b32 v69, v166, v162, s44
    v_perm_b32 v73, v167, v163, s43
    v_perm_b32 v77, v167, v163, s44
    s_add_u32 s48, s75, 0
    buffer_load_dwordx4 v[88:91], v3, s[60:63], s48 offen offset:0 nt
    buffer_load_dwordx4 v[92:95], v3, s[60:63], s48 offen offset:1024 nt
    s_waitcnt vmcnt(13)
    s_waitcnt vmcnt(12)
    v_perm_b32 v50, v172, v168, s43
    v_perm_b32 v54, v172, v168, s44
    v_perm_b32 v58, v173, v169, s43
    v_perm_b32 v62, v173, v169, s44
    v_perm_b32 v66, v174, v170, s43
    v_perm_b32 v70, v174, v170, s44
    v_perm_b32 v74, v175, v171, s43
    v_perm_b32 v78, v175, v171, s44
    buffer_load_dwordx4 v[96:99], v3, s[60:63], s48 offen offset:2048 nt
    buffer_load_dwordx4 v[100:103], v3, s[60:63], s48 offen offset:3072 nt
    s_waitcnt vmcnt(13)
    s_waitcnt vmcnt(12)
    v_perm_b32 v51, v180, v176, s43
    v_perm_b32 v55, v180, v176, s44
    v_perm_b32 v59, v181, v177, s43
    v_perm_b32 v63, v181, v177, s44
    v_perm_b32 v67, v182, v178, s43
    v_perm_b32 v71, v182, v178, s44
    v_perm_b32 v75, v183, v179, s43
    v_perm_b32 v79, v183, v179, s44
    s_waitcnt lgkmcnt(0)
    v_mfma_f32_16x16x32_bf16 v[16:19], v[48:51], v[80:83], v[16:19]
    v_mfma_f32_16x16x32_bf16 v[20:23], v[52:55], v[80:83], v[20:23]
    v_mfma_f32_16x16x32_bf16 v[24:27], v[56:59], v[80:83], v[24:27]
    v_mfma_f32_16x16x32_bf16 v[28:31], v[60:63], v[80:83], v[28:31]
    v_mfma_f32_16x16x32_bf16 v[32:35], v[64:67], v[80:83], v[32:35]
    v_mfma_f32_16x16x32_bf16 v[36:39], v[68:71], v[80:83], v[36:39]
    v_mfma_f32_16x16x32_bf16 v[40:43], v[72:75], v[80:83], v[40:43]
    v_mfma_f32_16x16x32_bf16 v[44:47], v[76:79], v[80:83], v[44:47]
    buffer_load_dwordx4 v[104:107], v4, s[60:63], s48 offen offset:0 nt
    ds_read_b128 v[84:87], v7 offset:11008
    buffer_load_dwordx4 v[108:111], v4, s[60:63], s48 offen offset:1024 nt
    s_waitcnt vmcnt(13)
    s_waitcnt vmcnt(12)
    v_perm_b32 v48, v188, v184, s43
    v_perm_b32 v52, v188, v184, s44
    v_perm_b32 v56, v189, v185, s43
    v_perm_b32 v60, v189, v185, s44
    v_perm_b32 v64, v190, v186, s43
    v_perm_b32 v68, v190, v186, s44
    v_perm_b32 v72, v191, v187, s43
    v_perm_b32 v76, v191, v187, s44
    buffer_load_dwordx4 v[112:115], v4, s[60:63], s48 offen offset:2048 nt
    buffer_load_dwordx4 v[116:119], v4, s[60:63], s48 offen offset:3072 nt
    s_waitcnt vmcnt(13)
    s_waitcnt vmcnt(12)
    v_perm_b32 v49, v140, v136, s43
    v_perm_b32 v53, v140, v136, s44
    v_perm_b32 v57, v141, v137, s43
    v_perm_b32 v61, v141, v137, s44
    v_perm_b32 v65, v142, v138, s43
    v_perm_b32 v69, v142, v138, s44
    v_perm_b32 v73, v143, v139, s43
    v_perm_b32 v77, v143, v139, s44
    s_add_u32 s48, s75, 32768
    buffer_load_dwordx4 v[120:123], v3, s[60:63], s48 offen offset:0 nt
    buffer_load_dwordx4 v[124:127], v3, s[60:63], s48 offen offset:1024 nt
    s_waitcnt vmcnt(13)
    s_waitcnt vmcnt(12)
    v_perm_b32 v50, v148, v144, s43
    v_perm_b32 v54, v148, v144, s44
    v_perm_b32 v58, v149, v145, s43
    v_perm_b32 v62, v149, v145, s44
    v_perm_b32 v66, v150, v146, s43
    v_perm_b32 v70, v150, v146, s44
    v_perm_b32 v74, v151, v147, s43
    v_perm_b32 v78, v151, v147, s44
    buffer_load_dwordx4 v[128:131], v3, s[60:63], s48 offen offset:2048 nt
    buffer_load_dwordx4 v[132:135], v3, s[60:63], s48 offen offset:3072 nt
    s_waitcnt vmcnt(13)
    s_waitcnt vmcnt(12)
    v_perm_b32 v51, v156, v152, s43
    v_perm_b32 v55, v156, v152, s44
    v_perm_b32 v59, v157, v153, s43
    v_perm_b32 v63, v157, v153, s44
    v_perm_b32 v67, v158, v154, s43
    v_perm_b32 v71, v158, v154, s44
    v_perm_b32 v75, v159, v155, s43
    v_perm_b32 v79, v159, v155, s44
    s_waitcnt lgkmcnt(0)
    v_mfma_f32_16x16x32_bf16 v[16:19], v[48:51], v[84:87], v[16:19]
    v_mfma_f32_16x16x32_bf16 v[20:23], v[52:55], v[84:87], v[20:23]
    v_mfma_f32_16x16x32_bf16 v[24:27], v[56:59], v[84:87], v[24:27]
    v_mfma_f32_16x16x32_bf16 v[28:31], v[60:63], v[84:87], v[28:31]
    v_mfma_f32_16x16x32_bf16 v[32:35], v[64:67], v[84:87], v[32:35]
    v_mfma_f32_16x16x32_bf16 v[36:39], v[68:71], v[84:87], v[36:39]
    v_mfma_f32_16x16x32_bf16 v[40:43], v[72:75], v[84:87], v[40:43]
    v_mfma_f32_16x16x32_bf16 v[44:47], v[76:79], v[84:87], v[44:47]
    v_and_b32 v13, 15, v2
    v_cmp_gt_u32 vcc, 4, v13
    v_lshlrev_b32 v12, 9, v13
    v_lshrrev_b32 v13, 4, v2
    v_lshl_add_u32 v12, v13, 7, v12
    s_lshl_b32 s46, s42, 11
    v_add_u32 v12, s46, v12
    s_mov_b64 s[90:91], vcc
    s_mov_b64 exec, s[90:91]
    ds_write_b32 v12, v16 offset:17408
    ds_write_b32 v12, v17 offset:17440
    ds_write_b32 v12, v18 offset:17472
    ds_write_b32 v12, v19 offset:17504
    ds_write_b32 v12, v20 offset:17412
    ds_write_b32 v12, v21 offset:17444
    ds_write_b32 v12, v22 offset:17476
    ds_write_b32 v12, v23 offset:17508
    ds_write_b32 v12, v24 offset:17416
    ds_write_b32 v12, v25 offset:17448
    ds_write_b32 v12, v26 offset:17480
    ds_write_b32 v12, v27 offset:17512
    ds_write_b32 v12, v28 offset:17420
    ds_write_b32 v12, v29 offset:17452
    ds_write_b32 v12, v30 offset:17484
    ds_write_b32 v12, v31 offset:17516
    ds_write_b32 v12, v32 offset:17424
    ds_write_b32 v12, v33 offset:17456
    ds_write_b32 v12, v34 offset:17488
    ds_write_b32 v12, v35 offset:17520
    ds_write_b32 v12, v36 offset:17428
    ds_write_b32 v12, v37 offset:17460
    ds_write_b32 v12, v38 offset:17492
    ds_write_b32 v12, v39 offset:17524
    ds_write_b32 v12, v40 offset:17432
    ds_write_b32 v12, v41 offset:17464
    ds_write_b32 v12, v42 offset:17496
    ds_write_b32 v12, v43 offset:17528
    ds_write_b32 v12, v44 offset:17436
    ds_write_b32 v12, v45 offset:17468
    ds_write_b32 v12, v46 offset:17500
    ds_write_b32 v12, v47 offset:17532
    s_mov_b64 exec, -1
    s_lshl_b32 s46, s42, 2
    v_mov_b32 v13, s46
    s_waitcnt lgkmcnt(0)
    v_mov_b32 v12, s50
    ds_write_b32 v13, v12 offset:32
    s_waitcnt vmcnt(11)
    s_add_u32 m0, s87, 0
    s_nop 0
    buffer_load_dwordx4 v4, s[60:63], s48 offen offset:0 nt lds
    s_waitcnt vmcnt(11)
    s_add_u32 m0, s87, 0
    s_nop 0
    buffer_load_dwordx4 v4, s[60:63], s48 offen offset:1024 nt lds
    s_waitcnt vmcnt(11)
    s_add_u32 m0, s87, 0
    s_nop 0
    buffer_load_dwordx4 v4, s[60:63], s48 offen offset:2048 nt lds
    s_waitcnt vmcnt(11)
    s_add_u32 m0, s87, 0
    s_nop 0
    buffer_load_dwordx4 v4, s[60:63], s48 offen offset:3072 nt lds
    s_waitcnt vmcnt(11)
    s_add_u32 s48, s75, 65536
    s_add_u32 m0, s87, 4096
    s_nop 0
    buffer_load_dwordx4 v3, s[60:63], s48 offen offset:0 nt lds
    s_waitcnt vmcnt(11)
    s_add_u32 m0, s87, 4096
    s_nop 0
    buffer_load_dwordx4 v3, s[60:63], s48 offen offset:1024 nt lds
    s_waitcnt vmcnt(11)
    s_add_u32 m0, s87, 4096
    s_nop 0
    buffer_load_dwordx4 v3, s[60:63], s48 offen offset:2048 nt lds
    s_waitcnt vmcnt(11)
    s_add_u32 m0, s87, 4096
    s_nop 0
    buffer_load_dwordx4 v3, s[60:63], s48 offen offset:3072 nt lds
    s_waitcnt vmcnt(11)
    s_add_u32 m0, s87, 8192
    s_nop 0
    buffer_load_dwordx4 v4, s[60:63], s48 offen offset:0 nt lds
    s_waitcnt vmcnt(11)
    s_add_u32 m0, s87, 8192
    s_nop 0
    buffer_load_dwordx4 v4, s[60:63], s48 offen offset:1024 nt lds
    s_waitcnt vmcnt(11)
    s_add_u32 m0, s87, 8192
    s_nop 0
    buffer_load_dwordx4 v4, s[60:63], s48 offen offset:2048 nt lds
    s_waitcnt vmcnt(11)
    s_add_u32 m0, s87, 8192
    s_nop 0
    buffer_load_dwordx4 v4, s[60:63], s48 offen offset:3072 nt lds
    s_waitcnt vmcnt(11)
    s_add_u32 s48, s75, 98304
    s_add_u32 m0, s87, 12288
    s_nop 0
    buffer_load_dwordx4 v3, s[60:63], s48 offen offset:0 nt lds
    s_waitcnt vmcnt(11)
    s_add_u32 m0, s87, 12288
    s_nop 0
    buffer_load_dwordx4 v3, s[60:63], s48 offen offset:1024 nt lds
    s_waitcnt vmcnt(11)
    s_add_u32 m0, s87, 12288
    s_nop 0
    buffer_load_dwordx4 v3, s[60:63], s48 offen offset:2048 nt lds
    s_waitcnt vmcnt(11)
    s_add_u32 m0, s87, 12288
    s_nop 0
    buffer_load_dwordx4 v3, s[60:63], s48 offen offset:3072 nt lds
    s_waitcnt vmcnt(11)
    s_add_u32 m0, s87, 16384
    s_nop 0
    buffer_load_dwordx4 v4, s[60:63], s48 offen offset:0 nt lds
    s_waitcnt vmcnt(11)
    s_add_u32 m0, s87, 16384
    s_nop 0
    buffer_load_dwordx4 v4, s[60:63], s48 offen offset:1024 nt lds
    s_waitcnt vmcnt(11)
    s_add_u32 m0, s87, 16384
    s_nop 0
    buffer_load_dwordx4 v4, s[60:63], s48 offen offset:2048 nt lds
    s_waitcnt vmcnt(11)
    s_add_u32 m0, s87, 16384
    s_nop 0
    buffer_load_dwordx4 v4, s[60:63], s48 offen offset:3072 nt lds
    s_waitcnt vmcnt(11)
    s_add_u32 s48, s75, 131072
    s_add_u32 m0, s87, 20480
    s_nop 0
    buffer_load_dwordx4 v3, s[60:63], s48 offen offset:0 nt lds
    s_waitcnt vmcnt(11)
    s_add_u32 m0, s87, 20480
    s_nop 0
    buffer_load_dwordx4 v3, s[60:63], s48 offen offset:1024 nt lds
    s_waitcnt vmcnt(11)
    s_add_u32 m0, s87, 20480
    s_nop 0
    buffer_load_dwordx4 v3, s[60:63], s48 offen offset:2048 nt lds
    s_waitcnt vmcnt(11)
    s_add_u32 m0, s87, 20480
    s_nop 0
    buffer_load_dwordx4 v3, s[60:63], s48 offen offset:3072 nt lds
    s_waitcnt vmcnt(11)
    s_add_u32 m0, s87, 24576
    s_nop 0
    buffer_load_dwordx4 v4, s[60:63], s48 offen offset:0 nt lds
    s_waitcnt vmcnt(11)
    s_add_u32 m0, s87, 24576
    s_nop 0
    buffer_load_dwordx4 v4, s[60:63], s48 offen offset:1024 nt lds
    s_waitcnt vmcnt(11)
    s_add_u32 m0, s87, 24576
    s_nop 0
    buffer_load_dwordx4 v4, s[60:63], s48 offen offset:2048 nt lds
    s_waitcnt vmcnt(11)
    s_add_u32 m0, s87, 24576
    s_nop 0
    buffer_load_dwordx4 v4, s[60:63], s48 offen offset:3072 nt lds
    s_waitcnt vmcnt(11)
    s_add_u32 s48, s75, 163840
    s_add_u32 m0, s87, 28672
    s_nop 0
    buffer_load_dwordx4 v3, s[60:63], s48 offen offset:0 nt lds
    s_waitcnt vmcnt(11)
    s_add_u32 m0, s87, 28672
    s_nop 0
    buffer_load_dwordx4 v3, s[60:63], s48 offen offset:1024 nt lds
    s_waitcnt vmcnt(11)
    s_add_u32 m0, s87, 28672
    s_nop 0
    buffer_load_dwordx4 v3, s[60:63], s48 offen offset:2048 nt lds
    s_waitcnt vmcnt(11)
    s_add_u32 m0, s87, 28672
    s_nop 0
    buffer_load_dwordx4 v3, s[60:63], s48 offen offset:3072 nt lds
    s_waitcnt vmcnt(11)
    buffer_load_dwordx4 v[136:139], v4, s[60:63], s48 offen offset:0 nt
    s_waitcnt vmcnt(11)
    buffer_load_dwordx4 v[140:143], v4, s[60:63], s48 offen offset:1024 nt
    s_waitcnt vmcnt(11)
    buffer_load_dwordx4 v[144:147], v4, s[60:63], s48 offen offset:2048 nt
    s_waitcnt vmcnt(11)
    buffer_load_dwordx4 v[148:151], v4, s[60:63], s48 offen offset:3072 nt
    s_waitcnt vmcnt(11)
    s_add_u32 s48, s75, 196608
    buffer_load_dwordx4 v[152:155], v3, s[60:63], s48 offen offset:0 nt
    s_waitcnt vmcnt(11)
    buffer_load_dwordx4 v[156:159], v3, s[60:63], s48 offen offset:1024 nt
    s_waitcnt vmcnt(11)
    buffer_load_dwordx4 v[160:163], v3, s[60:63], s48 offen offset:2048 nt
    s_waitcnt vmcnt(11)
    buffer_load_dwordx4 v[164:167], v3, s[60:63], s48 offen offset:3072 nt
    s_waitcnt vmcnt(11)
    buffer_load_dwordx4 v[168:171], v4, s[60:63], s48 offen offset:0 nt
    s_waitcnt vmcnt(11)
    buffer_load_dwordx4 v[172:175], v4, s[60:63], s48 offen offset:1024 nt
    s_waitcnt vmcnt(11)
    buffer_load_dwordx4 v[176:179], v4, s[60:63], s48 offen offset:2048 nt
    s_waitcnt vmcnt(11)
    buffer_load_dwordx4 v[180:183], v4, s[60:63], s48 offen offset:3072 nt
    s_waitcnt vmcnt(11)
    s_add_u32 s48, s75, 229376
    buffer_load_dwordx4 v[184:187], v3, s[60:63], s48 offen offset:0 nt
    s_waitcnt vmcnt(11)
    buffer_load_dwordx4 v[188:191], v3, s[60:63], s48 offen offset:1024 nt
    s_waitcnt vmcnt(11)
    buffer_load_dwordx4 v[192:195], v3, s[60:63], s48 offen offset:2048 nt
    s_waitcnt vmcnt(11)
    buffer_load_dwordx4 v[196:199], v3, s[60:63], s48 offen offset:3072 nt
    s_waitcnt vmcnt(11)
    buffer_load_dwordx4 v[200:203], v4, s[60:63], s48 offen offset:0 nt
    s_waitcnt vmcnt(11)
    buffer_load_dwordx4 v[204:207], v4, s[60:63], s48 offen offset:1024 nt
    s_waitcnt vmcnt(11)
    buffer_load_dwordx4 v[208:211], v4, s[60:63], s48 offen offset:2048 nt
    s_waitcnt vmcnt(11)
    buffer_load_dwordx4 v[212:215], v4, s[60:63], s48 offen offset:3072 nt
    s_waitcnt vmcnt(11)
    s_add_u32 s48, s75, 262144
    buffer_load_dwordx4 v[216:219], v3, s[60:63], s48 offen offset:0 nt
    s_waitcnt vmcnt(11)
    buffer_load_dwordx4 v[220:223], v3, s[60:63], s48 offen offset:1024 nt
    s_waitcnt vmcnt(11)
    buffer_load_dwordx4 v[224:227], v3, s[60:63], s48 offen offset:2048 nt
    s_waitcnt vmcnt(11)
    buffer_load_dwordx4 v[228:231], v3, s[60:63], s48 offen offset:3072 nt
    s_cmp_eq_u32 s74, 1
    s_cselect_b32 s78, 0, s78
    s_cselect_b32 s94, 0, s94
    s_lshl_b32 s50, s74, 1
    s_add_u32 s50, s50, 2
    s_nop 1
L_lw_6:
    ds_read_b32 v8, v5 offset:64
    s_waitcnt lgkmcnt(0)
    v_cmp_gt_u32 vcc, s50, v8
    s_nop 1
    s_cbranch_vccz L_lwd_7
    s_sleep 1
    s_sub_u32 s49, s49, 1
    s_cmp_gt_i32 s49, 0
    s_cbranch_scc1 L_lw_6
L_lwd_7:
    v_and_b32 v6, 15, v2
    v_lshlrev_b32 v6, 4, v6
    ds_read_b128 v[16:19], v6 offset:4608
    s_waitcnt lgkmcnt(0)
    s_waitcnt vmcnt(63)
    v_dot2_f32_bf16 v32, v88, v16, 0
    v_dot2_f32_bf16 v32, v89, v17, v32
    v_dot2_f32_bf16 v32, v90, v18, v32
    v_dot2_f32_bf16 v32, v91, v19, v32
    s_waitcnt vmcnt(11)
    buffer_load_dwordx4 v[88:91], v4, s[60:63], s48 offen offset:0 nt
    s_waitcnt vmcnt(63)
    v_dot2_f32_bf16 v33, v92, v16, 0
    v_dot2_f32_bf16 v33, v93, v17, v33
    v_dot2_f32_bf16 v33, v94, v18, v33
    v_dot2_f32_bf16 v33, v95, v19, v33
    s_waitcnt vmcnt(63)
    v_dot2_f32_bf16 v34, v96, v16, 0
    v_dot2_f32_bf16 v34, v97, v17, v34
    v_dot2_f32_bf16 v34, v98, v18, v34
    v_dot2_f32_bf16 v34, v99, v19, v34
    s_waitcnt vmcnt(11)
    buffer_load_dwordx4 v[92:95], v4, s[60:63], s48 offen offset:1024 nt
    s_waitcnt vmcnt(63)
    v_dot2_f32_bf16 v35, v100, v16, 0
    v_dot2_f32_bf16 v35, v101, v17, v35
    v_dot2_f32_bf16 v35, v102, v18, v35
    v_dot2_f32_bf16 v35, v103, v19, v35
    s_waitcnt vmcnt(63)
    v_dot2_f32_bf16 v36, v104, v16, 0
    v_dot2_f32_bf16 v36, v105, v17, v36
    v_dot2_f32_bf16 v36, v106, v18, v36
    v_dot2_f32_bf16 v36, v107, v19, v36
    s_waitcnt vmcnt(11)
    buffer_load_dwordx4 v[96:99], v4, s[60:63], s48 offen offset:2048 nt
    s_waitcnt vmcnt(63)
    v_dot2_f32_bf16 v37, v108, v16, 0
    v_dot2_f32_bf16 v37, v109, v17, v37
    v_dot2_f32_bf16 v37, v110, v18, v37
    v_dot2_f32_bf16 v37, v111, v19, v37
    s_waitcnt vmcnt(63)
    v_dot2_f32_bf16 v38, v112, v16, 0
    v_dot2_f32_bf16 v38, v113, v17, v38
    v_dot2_f32_bf16 v38, v114, v18, v38
    v_dot2_f32_bf16 v38, v115, v19, v38
    s_waitcnt vmcnt(11)
    buffer_load_dwordx4 v[100:103], v4, s[60:63], s48 offen offset:3072 nt
    s_waitcnt vmcnt(63)
    v_dot2_f32_bf16 v39, v116, v16, 0
    v_dot2_f32_bf16 v39, v117, v17, v39
    v_dot2_f32_bf16 v39, v118, v18, v39
    v_dot2_f32_bf16 v39, v119, v19, v39
    s_waitcnt vmcnt(63)
    v_dot2_f32_bf16 v40, v120, v16, 0
    v_dot2_f32_bf16 v40, v121, v17, v40
    v_dot2_f32_bf16 v40, v122, v18, v40
    v_dot2_f32_bf16 v40, v123, v19, v40
    s_waitcnt vmcnt(11)
    s_add_u32 s48, s75, 294912
    buffer_load_dwordx4 v[104:107], v3, s[60:63], s48 offen offset:0 nt
    s_waitcnt vmcnt(63)
    v_dot2_f32_bf16 v41, v124, v16, 0
    v_dot2_f32_bf16 v41, v125, v17, v41
    v_dot2_f32_bf16 v41, v126, v18, v41
    v_dot2_f32_bf16 v41, v127, v19, v41
    s_waitcnt vmcnt(62)
    v_dot2_f32_bf16 v42, v128, v16, 0
    v_dot2_f32_bf16 v42, v129, v17, v42
    v_dot2_f32_bf16 v42, v130, v18, v42
    v_dot2_f32_bf16 v42, v131, v19, v42
    s_waitcnt vmcnt(11)
    buffer_load_dwordx4 v[108:111], v3, s[60:63], s48 offen offset:1024 nt
    s_waitcnt vmcnt(62)
    v_dot2_f32_bf16 v43, v132, v16, 0
    v_dot2_f32_bf16 v43, v133, v17, v43
    v_dot2_f32_bf16 v43, v134, v18, v43
    v_dot2_f32_bf16 v43, v135, v19, v43
    s_waitcnt vmcnt(58)
    ds_read_b128 v[112:115], v14 offset:0
    ds_read_b128 v[116:119], v14 offset:1024
    ds_read_b128 v[120:123], v14 offset:2048
    ds_read_b128 v[124:127], v14 offset:3072
    s_waitcnt lgkmcnt(0)
    v_dot2_f32_bf16 v44, v112, v16, 0
    v_dot2_f32_bf16 v44, v113, v17, v44
    v_dot2_f32_bf16 v44, v114, v18, v44
    v_dot2_f32_bf16 v44, v115, v19, v44
    s_waitcnt vmcnt(11)
    buffer_load_dwordx4 v[112:115], v3, s[60:63], s48 offen offset:2048 nt
    v_dot2_f32_bf16 v45, v116, v16, 0
    v_dot2_f32_bf16 v45, v117, v17, v45
    v_dot2_f32_bf16 v45, v118, v18, v45
    v_dot2_f32_bf16 v45, v119, v19, v45
    v_dot2_f32_bf16 v46, v120, v16, 0
    v_dot2_f32_bf16 v46, v121, v17, v46
    v_dot2_f32_bf16 v46, v122, v18, v46
    v_dot2_f32_bf16 v46, v123, v19, v46
    s_waitcnt vmcnt(11)
    buffer_load_dwordx4 v[116:119], v3, s[60:63], s48 offen offset:3072 nt
    v_dot2_f32_bf16 v47, v124, v16, 0
    v_dot2_f32_bf16 v47, v125, v17, v47
    v_dot2_f32_bf16 v47, v126, v18, v47
    v_dot2_f32_bf16 v47, v127, v19, v47
    v_add_f32_dpp v32, v32, v32 row_ror:8 row_mask:0xf bank_mask:0x3
    s_nop 1
    v_add_f32_dpp v32, v40, v40 row_ror:8 row_mask:0xf bank_mask:0xc
    v_add_f32_dpp v33, v33, v33 row_ror:8 row_mask:0xf bank_mask:0x3
    s_nop 1
    v_add_f32_dpp v33, v41, v41 row_ror:8 row_mask:0xf bank_mask:0xc
    v_add_f32_dpp v34, v34, v34 row_ror:8 row_mask:0xf bank_mask:0x3
    s_nop 1
    v_add_f32_dpp v34, v42, v42 row_ror:8 row_mask:0xf bank_mask:0xc
    v_add_f32_dpp v35, v35, v35 row_ror:8 row_mask:0xf bank_mask:0x3
    s_nop 1
    v_add_f32_dpp v35, v43, v43 row_ror:8 row_mask:0xf bank_mask:0xc
    v_add_f32_dpp v36, v36, v36 row_ror:8 row_mask:0xf bank_mask:0x3
    s_nop 1
    v_add_f32_dpp v36, v44, v44 row_ror:8 row_mask:0xf bank_mask:0xc
    v_add_f32_dpp v37, v37, v37 row_ror:8 row_mask:0xf bank_mask:0x3
    s_nop 1
    v_add_f32_dpp v37, v45, v45 row_ror:8 row_mask:0xf bank_mask:0xc
    v_add_f32_dpp v38, v38, v38 row_ror:8 row_mask:0xf bank_mask:0x3
    s_nop 1
    v_add_f32_dpp v38, v46, v46 row_ror:8 row_mask:0xf bank_mask:0xc
    v_add_f32_dpp v39, v39, v39 row_ror:8 row_mask:0xf bank_mask:0x3
    s_nop 1
    v_add_f32_dpp v39, v47, v47 row_ror:8 row_mask:0xf bank_mask:0xc
    v_add_f32_dpp v32, v32, v32 row_shl:4 row_mask:0xf bank_mask:0x5
    s_nop 1
    v_add_f32_dpp v32, v36, v36 row_shr:4 row_mask:0xf bank_mask:0xa
    v_add_f32_dpp v33, v33, v33 row_shl:4 row_mask:0xf bank_mask:0x5
    s_nop 1
    v_add_f32_dpp v33, v37, v37 row_shr:4 row_mask:0xf bank_mask:0xa
    v_add_f32_dpp v34, v34, v34 row_shl:4 row_mask:0xf bank_mask:0x5
    s_nop 1
    v_add_f32_dpp v34, v38, v38 row_shr:4 row_mask:0xf bank_mask:0xa
    v_add_f32_dpp v35, v35, v35 row_shl:4 row_mask:0xf bank_mask:0x5
    s_nop 1
    v_add_f32_dpp v35, v39, v39 row_shr:4 row_mask:0xf bank_mask:0xa
    v_add_f32_dpp v32, v32, v32 quad_perm:[2,3,0,1] row_mask:0xf bank_mask:0xf
    v_add_f32_dpp v34, v34, v34 quad_perm:[2,3,0,1] row_mask:0xf bank_mask:0xf
    v_cndmask_b32 v32, v32, v34, s[68:69]
    v_add_f32_dpp v33, v33, v33 quad_perm:[2,3,0,1] row_mask:0xf bank_mask:0xf
    v_add_f32_dpp v35, v35, v35 quad_perm:[2,3,0,1] row_mask:0xf bank_mask:0xf
    v_cndmask_b32 v33, v33, v35, s[68:69]
    v_add_f32_dpp v32, v32, v32 quad_perm:[1,0,3,2] row_mask:0xf bank_mask:0xf
    s_nop 0
    v_add_f32_dpp v33, v33, v33 quad_perm:[1,0,3,2] row_mask:0xf bank_mask:0xf
    v_cndmask_b32 v48, v32, v33, s[70:71]
    v_cvt_pk_bf16_f32 v48, v48, v48
    v_lshlrev_b32 v48, 16, v48
    v_mul_f32 v48, s73, v48
    v_cvt_pk_bf16_f32 v48, v48, v48
    v_lshlrev_b32 v48, 16, v48
    s_waitcnt vmcnt(56)
    ds_read_b128 v[120:123], v14 offset:4096
    ds_read_b128 v[124:127], v14 offset:5120
    ds_read_b128 v[128:131], v14 offset:6144
    ds_read_b128 v[132:135], v14 offset:7168
    s_waitcnt lgkmcnt(0)
    v_dot2_f32_bf16 v32, v120, v16, 0
    v_dot2_f32_bf16 v32, v121, v17, v32
    v_dot2_f32_bf16 v32, v122, v18, v32
    v_dot2_f32_bf16 v32, v123, v19, v32
    s_waitcnt vmcnt(11)
    buffer_load_dwordx4 v[120:123], v4, s[60:63], s48 offen offset:0 nt
    v_dot2_f32_bf16 v33, v124, v16, 0
    v_dot2_f32_bf16 v33, v125, v17, v33
    v_dot2_f32_bf16 v33, v126, v18, v33
    v_dot2_f32_bf16 v33, v127, v19, v33
    v_dot2_f32_bf16 v34, v128, v16, 0
    v_dot2_f32_bf16 v34, v129, v17, v34
    v_dot2_f32_bf16 v34, v130, v18, v34
    v_dot2_f32_bf16 v34, v131, v19, v34
    s_waitcnt vmcnt(11)
    buffer_load_dwordx4 v[124:127], v4, s[60:63], s48 offen offset:1024 nt
    v_dot2_f32_bf16 v35, v132, v16, 0
    v_dot2_f32_bf16 v35, v133, v17, v35
    v_dot2_f32_bf16 v35, v134, v18, v35
    v_dot2_f32_bf16 v35, v135, v19, v35
    s_waitcnt vmcnt(54)
    ds_read_b128 v[128:131], v14 offset:8192
    ds_read_b128 v[132:135], v14 offset:9216
    ds_read_b128 v[232:235], v14 offset:10240
    ds_read_b128 v[236:239], v14 offset:11264
    s_waitcnt lgkmcnt(0)
    v_dot2_f32_bf16 v36, v128, v16, 0
    v_dot2_f32_bf16 v36, v129, v17, v36
    v_dot2_f32_bf16 v36, v130, v18, v36
    v_dot2_f32_bf16 v36, v131, v19, v36
    v_dot2_f32_bf16 v37, v132, v16, 0
    v_dot2_f32_bf16 v37, v133, v17, v37
    v_dot2_f32_bf16 v37, v134, v18, v37
    v_dot2_f32_bf16 v37, v135, v19, v37
    v_dot2_f32_bf16 v38, v232, v16, 0
    v_dot2_f32_bf16 v38, v233, v17, v38
    v_dot2_f32_bf16 v38, v234, v18, v38
    v_dot2_f32_bf16 v38, v235, v19, v38
    s_waitcnt vmcnt(11)
    buffer_load_dwordx4 v[128:131], v4, s[60:63], s48 offen offset:2048 nt
    v_dot2_f32_bf16 v39, v236, v16, 0
    v_dot2_f32_bf16 v39, v237, v17, v39
    v_dot2_f32_bf16 v39, v238, v18, v39
    v_dot2_f32_bf16 v39, v239, v19, v39
    s_waitcnt vmcnt(51)
    ds_read_b128 v[132:135], v14 offset:12288
    ds_read_b128 v[232:235], v14 offset:13312
    ds_read_b128 v[236:239], v14 offset:14336
    ds_read_b128 v[240:243], v14 offset:15360
    s_waitcnt lgkmcnt(0)
    v_dot2_f32_bf16 v40, v132, v16, 0
    v_dot2_f32_bf16 v40, v133, v17, v40
    v_dot2_f32_bf16 v40, v134, v18, v40
    v_dot2_f32_bf16 v40, v135, v19, v40
    v_dot2_f32_bf16 v41, v232, v16, 0
    v_dot2_f32_bf16 v41, v233, v17, v41
    v_dot2_f32_bf16 v41, v234, v18, v41
    v_dot2_f32_bf16 v41, v235, v19, v41
    v_dot2_f32_bf16 v42, v236, v16, 0
    v_dot2_f32_bf16 v42, v237, v17, v42
    v_dot2_f32_bf16 v42, v238, v18, v42
    v_dot2_f32_bf16 v42, v239, v19, v42
    v_dot2_f32_bf16 v43, v240, v16, 0
    v_dot2_f32_bf16 v43, v241, v17, v43
    v_dot2_f32_bf16 v43, v242, v18, v43
    v_dot2_f32_bf16 v43, v243, v19, v43
    s_waitcnt vmcnt(47)
    ds_read_b128 v[132:135], v14 offset:16384
    ds_read_b128 v[232:235], v14 offset:17408
    ds_read_b128 v[236:239], v14 offset:18432
    ds_read_b128 v[240:243], v14 offset:19456
    s_waitcnt lgkmcnt(0)
    v_dot2_f32_bf16 v44, v132, v16, 0
    v_dot2_f32_bf16 v44, v133, v17, v44
    v_dot2_f32_bf16 v44, v134, v18, v44
    v_dot2_f32_bf16 v44, v135, v19, v44
    v_dot2_f32_bf16 v45, v232, v16, 0
    v_dot2_f32_bf16 v45, v233, v17, v45
    v_dot2_f32_bf16 v45, v234, v18, v45
    v_dot2_f32_bf16 v45, v235, v19, v45
    v_dot2_f32_bf16 v46, v236, v16, 0
    v_dot2_f32_bf16 v46, v237, v17, v46
    v_dot2_f32_bf16 v46, v238, v18, v46
    v_dot2_f32_bf16 v46, v239, v19, v46
    v_dot2_f32_bf16 v47, v240, v16, 0
    v_dot2_f32_bf16 v47, v241, v17, v47
    v_dot2_f32_bf16 v47, v242, v18, v47
    v_dot2_f32_bf16 v47, v243, v19, v47
    v_add_f32_dpp v32, v32, v32 row_ror:8 row_mask:0xf bank_mask:0x3
    s_nop 1
    v_add_f32_dpp v32, v40, v40 row_ror:8 row_mask:0xf bank_mask:0xc
    v_add_f32_dpp v33, v33, v33 row_ror:8 row_mask:0xf bank_mask:0x3
    s_nop 1
    v_add_f32_dpp v33, v41, v41 row_ror:8 row_mask:0xf bank_mask:0xc
    v_add_f32_dpp v34, v34, v34 row_ror:8 row_mask:0xf bank_mask:0x3
    s_nop 1
    v_add_f32_dpp v34, v42, v42 row_ror:8 row_mask:0xf bank_mask:0xc
    v_add_f32_dpp v35, v35, v35 row_ror:8 row_mask:0xf bank_mask:0x3
    s_nop 1
    v_add_f32_dpp v35, v43, v43 row_ror:8 row_mask:0xf bank_mask:0xc
    v_add_f32_dpp v36, v36, v36 row_ror:8 row_mask:0xf bank_mask:0x3
    s_nop 1
    v_add_f32_dpp v36, v44, v44 row_ror:8 row_mask:0xf bank_mask:0xc
    v_add_f32_dpp v37, v37, v37 row_ror:8 row_mask:0xf bank_mask:0x3
    s_nop 1
    v_add_f32_dpp v37, v45, v45 row_ror:8 row_mask:0xf bank_mask:0xc
    v_add_f32_dpp v38, v38, v38 row_ror:8 row_mask:0xf bank_mask:0x3
    s_nop 1
    v_add_f32_dpp v38, v46, v46 row_ror:8 row_mask:0xf bank_mask:0xc
    v_add_f32_dpp v39, v39, v39 row_ror:8 row_mask:0xf bank_mask:0x3
    s_nop 1
    v_add_f32_dpp v39, v47, v47 row_ror:8 row_mask:0xf bank_mask:0xc
    v_add_f32_dpp v32, v32, v32 row_shl:4 row_mask:0xf bank_mask:0x5
    s_nop 1
    v_add_f32_dpp v32, v36, v36 row_shr:4 row_mask:0xf bank_mask:0xa
    v_add_f32_dpp v33, v33, v33 row_shl:4 row_mask:0xf bank_mask:0x5
    s_nop 1
    v_add_f32_dpp v33, v37, v37 row_shr:4 row_mask:0xf bank_mask:0xa
    v_add_f32_dpp v34, v34, v34 row_shl:4 row_mask:0xf bank_mask:0x5
    s_nop 1
    v_add_f32_dpp v34, v38, v38 row_shr:4 row_mask:0xf bank_mask:0xa
    v_add_f32_dpp v35, v35, v35 row_shl:4 row_mask:0xf bank_mask:0x5
    s_nop 1
    v_add_f32_dpp v35, v39, v39 row_shr:4 row_mask:0xf bank_mask:0xa
    v_add_f32_dpp v32, v32, v32 quad_perm:[2,3,0,1] row_mask:0xf bank_mask:0xf
    v_add_f32_dpp v34, v34, v34 quad_perm:[2,3,0,1] row_mask:0xf bank_mask:0xf
    v_cndmask_b32 v32, v32, v34, s[68:69]
    v_add_f32_dpp v33, v33, v33 quad_perm:[2,3,0,1] row_mask:0xf bank_mask:0xf
    v_add_f32_dpp v35, v35, v35 quad_perm:[2,3,0,1] row_mask:0xf bank_mask:0xf
    v_cndmask_b32 v33, v33, v35, s[68:69]
    v_add_f32_dpp v32, v32, v32 quad_perm:[1,0,3,2] row_mask:0xf bank_mask:0xf
    s_nop 0
    v_add_f32_dpp v33, v33, v33 quad_perm:[1,0,3,2] row_mask:0xf bank_mask:0xf
    v_cndmask_b32 v49, v32, v33, s[70:71]
    v_cvt_pk_bf16_f32 v49, v49, v49
    v_lshlrev_b32 v49, 16, v49
    v_mul_f32 v49, s73, v49
    v_cvt_pk_bf16_f32 v49, v49, v49
    v_lshlrev_b32 v49, 16, v49
    s_waitcnt vmcnt(43)
    ds_read_b128 v[132:135], v14 offset:20480
    ds_read_b128 v[232:235], v14 offset:21504
    ds_read_b128 v[236:239], v14 offset:22528
    ds_read_b128 v[240:243], v14 offset:23552
    s_waitcnt lgkmcnt(0)
    v_dot2_f32_bf16 v32, v132, v16, 0
    v_dot2_f32_bf16 v32, v133, v17, v32
    v_dot2_f32_bf16 v32, v134, v18, v32
    v_dot2_f32_bf16 v32, v135, v19, v32
    v_dot2_f32_bf16 v33, v232, v16, 0
    v_dot2_f32_bf16 v33, v233, v17, v33
    v_dot2_f32_bf16 v33, v234, v18, v33
    v_dot2_f32_bf16 v33, v235, v19, v33
    v_dot2_f32_bf16 v34, v236, v16, 0
    v_dot2_f32_bf16 v34, v237, v17, v34
    v_dot2_f32_bf16 v34, v238, v18, v34
    v_dot2_f32_bf16 v34, v239, v19, v34
    v_dot2_f32_bf16 v35, v240, v16, 0
    v_dot2_f32_bf16 v35, v241, v17, v35
    v_dot2_f32_bf16 v35, v242, v18, v35
    v_dot2_f32_bf16 v35, v243, v19, v35
    s_waitcnt vmcnt(39)
    ds_read_b128 v[132:135], v14 offset:24576
    ds_read_b128 v[232:235], v14 offset:25600
    ds_read_b128 v[236:239], v14 offset:26624
    ds_read_b128 v[240:243], v14 offset:27648
    s_waitcnt lgkmcnt(0)
    v_dot2_f32_bf16 v36, v132, v16, 0
    v_dot2_f32_bf16 v36, v133, v17, v36
    v_dot2_f32_bf16 v36, v134, v18, v36
    v_dot2_f32_bf16 v36, v135, v19, v36
    v_dot2_f32_bf16 v37, v232, v16, 0
    v_dot2_f32_bf16 v37, v233, v17, v37
    v_dot2_f32_bf16 v37, v234, v18, v37
    v_dot2_f32_bf16 v37, v235, v19, v37
    v_dot2_f32_bf16 v38, v236, v16, 0
    v_dot2_f32_bf16 v38, v237, v17, v38
    v_dot2_f32_bf16 v38, v238, v18, v38
    v_dot2_f32_bf16 v38, v239, v19, v38
    v_dot2_f32_bf16 v39, v240, v16, 0
    v_dot2_f32_bf16 v39, v241, v17, v39
    v_dot2_f32_bf16 v39, v242, v18, v39
    v_dot2_f32_bf16 v39, v243, v19, v39
    s_waitcnt vmcnt(35)
    ds_read_b128 v[132:135], v14 offset:28672
    ds_read_b128 v[232:235], v14 offset:29696
    ds_read_b128 v[236:239], v14 offset:30720
    ds_read_b128 v[240:243], v14 offset:31744
    s_waitcnt lgkmcnt(0)
    v_dot2_f32_bf16 v40, v132, v16, 0
    v_dot2_f32_bf16 v40, v133, v17, v40
    v_dot2_f32_bf16 v40, v134, v18, v40
    v_dot2_f32_bf16 v40, v135, v19, v40
    s_waitcnt vmcnt(11)
    buffer_load_dwordx4 v[132:135], v4, s[60:63], s48 offen offset:3072 nt
    v_dot2_f32_bf16 v41, v232, v16, 0
    v_dot2_f32_bf16 v41, v233, v17, v41
    v_dot2_f32_bf16 v41, v234, v18, v41
    v_dot2_f32_bf16 v41, v235, v19, v41
    v_dot2_f32_bf16 v42, v236, v16, 0
    v_dot2_f32_bf16 v42, v237, v17, v42
    v_dot2_f32_bf16 v42, v238, v18, v42
    v_dot2_f32_bf16 v42, v239, v19, v42
    s_waitcnt vmcnt(11)
    s_add_u32 s48, s75, 327680
    buffer_load_dwordx4 v[232:235], v3, s[60:63], s48 offen offset:0 nt
    v_dot2_f32_bf16 v43, v240, v16, 0
    v_dot2_f32_bf16 v43, v241, v17, v43
    v_dot2_f32_bf16 v43, v242, v18, v43
    v_dot2_f32_bf16 v43, v243, v19, v43
    s_waitcnt vmcnt(36)
    v_dot2_f32_bf16 v44, v136, v16, 0
    v_dot2_f32_bf16 v44, v137, v17, v44
    v_dot2_f32_bf16 v44, v138, v18, v44
    v_dot2_f32_bf16 v44, v139, v19, v44
    s_waitcnt vmcnt(11)
    buffer_load_dwordx4 v[136:139], v3, s[60:63], s48 offen offset:1024 nt
    s_waitcnt vmcnt(36)
    v_dot2_f32_bf16 v45, v140, v16, 0
    v_dot2_f32_bf16 v45, v141, v17, v45
    v_dot2_f32_bf16 v45, v142, v18, v45
    v_dot2_f32_bf16 v45, v143, v19, v45
    s_waitcnt vmcnt(35)
    v_dot2_f32_bf16 v46, v144, v16, 0
    v_dot2_f32_bf16 v46, v145, v17, v46
    v_dot2_f32_bf16 v46, v146, v18, v46
    v_dot2_f32_bf16 v46, v147, v19, v46
    s_waitcnt vmcnt(11)
    buffer_load_dwordx4 v[140:143], v3, s[60:63], s48 offen offset:2048 nt
    s_waitcnt vmcnt(35)
    v_dot2_f32_bf16 v47, v148, v16, 0
    v_dot2_f32_bf16 v47, v149, v17, v47
    v_dot2_f32_bf16 v47, v150, v18, v47
    v_dot2_f32_bf16 v47, v151, v19, v47
    v_add_f32_dpp v32, v32, v32 row_ror:8 row_mask:0xf bank_mask:0x3
    s_nop 1
    v_add_f32_dpp v32, v40, v40 row_ror:8 row_mask:0xf bank_mask:0xc
    v_add_f32_dpp v33, v33, v33 row_ror:8 row_mask:0xf bank_mask:0x3
    s_nop 1
    v_add_f32_dpp v33, v41, v41 row_ror:8 row_mask:0xf bank_mask:0xc
    v_add_f32_dpp v34, v34, v34 row_ror:8 row_mask:0xf bank_mask:0x3
    s_nop 1
    v_add_f32_dpp v34, v42, v42 row_ror:8 row_mask:0xf bank_mask:0xc
    v_add_f32_dpp v35, v35, v35 row_ror:8 row_mask:0xf bank_mask:0x3
    s_nop 1
    v_add_f32_dpp v35, v43, v43 row_ror:8 row_mask:0xf bank_mask:0xc
    v_add_f32_dpp v36, v36, v36 row_ror:8 row_mask:0xf bank_mask:0x3
    s_nop 1
    v_add_f32_dpp v36, v44, v44 row_ror:8 row_mask:0xf bank_mask:0xc
    v_add_f32_dpp v37, v37, v37 row_ror:8 row_mask:0xf bank_mask:0x3
    s_nop 1
    v_add_f32_dpp v37, v45, v45 row_ror:8 row_mask:0xf bank_mask:0xc
    v_add_f32_dpp v38, v38, v38 row_ror:8 row_mask:0xf bank_mask:0x3
    s_nop 1
    v_add_f32_dpp v38, v46, v46 row_ror:8 row_mask:0xf bank_mask:0xc
    v_add_f32_dpp v39, v39, v39 row_ror:8 row_mask:0xf bank_mask:0x3
    s_nop 1
    v_add_f32_dpp v39, v47, v47 row_ror:8 row_mask:0xf bank_mask:0xc
    v_add_f32_dpp v32, v32, v32 row_shl:4 row_mask:0xf bank_mask:0x5
    s_nop 1
    v_add_f32_dpp v32, v36, v36 row_shr:4 row_mask:0xf bank_mask:0xa
    v_add_f32_dpp v33, v33, v33 row_shl:4 row_mask:0xf bank_mask:0x5
    s_nop 1
    v_add_f32_dpp v33, v37, v37 row_shr:4 row_mask:0xf bank_mask:0xa
    v_add_f32_dpp v34, v34, v34 row_shl:4 row_mask:0xf bank_mask:0x5
    s_nop 1
    v_add_f32_dpp v34, v38, v38 row_shr:4 row_mask:0xf bank_mask:0xa
    v_add_f32_dpp v35, v35, v35 row_shl:4 row_mask:0xf bank_mask:0x5
    s_nop 1
    v_add_f32_dpp v35, v39, v39 row_shr:4 row_mask:0xf bank_mask:0xa
    v_add_f32_dpp v32, v32, v32 quad_perm:[2,3,0,1] row_mask:0xf bank_mask:0xf
    v_add_f32_dpp v34, v34, v34 quad_perm:[2,3,0,1] row_mask:0xf bank_mask:0xf
    v_cndmask_b32 v32, v32, v34, s[68:69]
    v_add_f32_dpp v33, v33, v33 quad_perm:[2,3,0,1] row_mask:0xf bank_mask:0xf
    v_add_f32_dpp v35, v35, v35 quad_perm:[2,3,0,1] row_mask:0xf bank_mask:0xf
    v_cndmask_b32 v33, v33, v35, s[68:69]
    v_add_f32_dpp v32, v32, v32 quad_perm:[1,0,3,2] row_mask:0xf bank_mask:0xf
    s_nop 0
    v_add_f32_dpp v33, v33, v33 quad_perm:[1,0,3,2] row_mask:0xf bank_mask:0xf
    v_cndmask_b32 v50, v32, v33, s[70:71]
    v_cvt_pk_bf16_f32 v50, v50, v50
    v_lshlrev_b32 v50, 16, v50
    v_mul_f32 v50, s73, v50
    v_cvt_pk_bf16_f32 v50, v50, v50
    v_lshlrev_b32 v50, 16, v50
    s_waitcnt vmcnt(34)
    v_dot2_f32_bf16 v32, v152, v16, 0
    v_dot2_f32_bf16 v32, v153, v17, v32
    v_dot2_f32_bf16 v32, v154, v18, v32
    v_dot2_f32_bf16 v32, v155, v19, v32
    s_waitcnt vmcnt(11)
    buffer_load_dwordx4 v[144:147], v3, s[60:63], s48 offen offset:3072 nt
    s_waitcnt vmcnt(34)
    v_dot2_f32_bf16 v33, v156, v16, 0
    v_dot2_f32_bf16 v33, v157, v17, v33
    v_dot2_f32_bf16 v33, v158, v18, v33
    v_dot2_f32_bf16 v33, v159, v19, v33
    s_waitcnt vmcnt(33)
    v_dot2_f32_bf16 v34, v160, v16, 0
    v_dot2_f32_bf16 v34, v161, v17, v34
    v_dot2_f32_bf16 v34, v162, v18, v34
    v_dot2_f32_bf16 v34, v163, v19, v34
    s_waitcnt vmcnt(11)
    buffer_load_dwordx4 v[148:151], v4, s[60:63], s48 offen offset:0 nt
    s_waitcnt vmcnt(33)
    v_dot2_f32_bf16 v35, v164, v16, 0
    v_dot2_f32_bf16 v35, v165, v17, v35
    v_dot2_f32_bf16 v35, v166, v18, v35
    v_dot2_f32_bf16 v35, v167, v19, v35
    s_waitcnt vmcnt(32)
    v_dot2_f32_bf16 v36, v168, v16, 0
    v_dot2_f32_bf16 v36, v169, v17, v36
    v_dot2_f32_bf16 v36, v170, v18, v36
    v_dot2_f32_bf16 v36, v171, v19, v36
    s_waitcnt vmcnt(11)
    buffer_load_dwordx4 v[152:155], v4, s[60:63], s48 offen offset:1024 nt
    s_waitcnt vmcnt(32)
    v_dot2_f32_bf16 v37, v172, v16, 0
    v_dot2_f32_bf16 v37, v173, v17, v37
    v_dot2_f32_bf16 v37, v174, v18, v37
    v_dot2_f32_bf16 v37, v175, v19, v37
    s_waitcnt vmcnt(31)
    v_dot2_f32_bf16 v38, v176, v16, 0
    v_dot2_f32_bf16 v38, v177, v17, v38
    v_dot2_f32_bf16 v38, v178, v18, v38
    v_dot2_f32_bf16 v38, v179, v19, v38
    s_waitcnt vmcnt(11)
    buffer_load_dwordx4 v[156:159], v4, s[60:63], s48 offen offset:2048 nt
    s_waitcnt vmcnt(31)
    v_dot2_f32_bf16 v39, v180, v16, 0
    v_dot2_f32_bf16 v39, v181, v17, v39
    v_dot2_f32_bf16 v39, v182, v18, v39
    v_dot2_f32_bf16 v39, v183, v19, v39
    s_waitcnt vmcnt(30)
    v_dot2_f32_bf16 v40, v184, v16, 0
    v_dot2_f32_bf16 v40, v185, v17, v40
    v_dot2_f32_bf16 v40, v186, v18, v40
    v_dot2_f32_bf16 v40, v187, v19, v40
    s_waitcnt vmcnt(11)
    buffer_load_dwordx4 v[160:163], v4, s[60:63], s48 offen offset:3072 nt
    s_waitcnt vmcnt(30)
    v_dot2_f32_bf16 v41, v188, v16, 0
    v_dot2_f32_bf16 v41, v189, v17, v41
    v_dot2_f32_bf16 v41, v190, v18, v41
    v_dot2_f32_bf16 v41, v191, v19, v41
    s_waitcnt vmcnt(29)
    v_dot2_f32_bf16 v42, v192, v16, 0
    v_dot2_f32_bf16 v42, v193, v17, v42
    v_dot2_f32_bf16 v42, v194, v18, v42
    v_dot2_f32_bf16 v42, v195, v19, v42
    s_waitcnt vmcnt(11)
    s_add_u32 s48, s75, 360448
    buffer_load_dwordx4 v[164:167], v3, s[60:63], s48 offen offset:0 nt
    s_waitcnt vmcnt(29)
    v_dot2_f32_bf16 v43, v196, v16, 0
    v_dot2_f32_bf16 v43, v197, v17, v43
    v_dot2_f32_bf16 v43, v198, v18, v43
    v_dot2_f32_bf16 v43, v199, v19, v43
    s_waitcnt vmcnt(28)
    v_dot2_f32_bf16 v44, v200, v16, 0
    v_dot2_f32_bf16 v44, v201, v17, v44
    v_dot2_f32_bf16 v44, v202, v18, v44
    v_dot2_f32_bf16 v44, v203, v19, v44
    s_waitcnt vmcnt(11)
    buffer_load_dwordx4 v[168:171], v3, s[60:63], s48 offen offset:1024 nt
    s_waitcnt vmcnt(28)
    v_dot2_f32_bf16 v45, v204, v16, 0
    v_dot2_f32_bf16 v45, v205, v17, v45
    v_dot2_f32_bf16 v45, v206, v18, v45
    v_dot2_f32_bf16 v45, v207, v19, v45
    s_waitcnt vmcnt(27)
    v_dot2_f32_bf16 v46, v208, v16, 0
    v_dot2_f32_bf16 v46, v209, v17, v46
    v_dot2_f32_bf16 v46, v210, v18, v46
    v_dot2_f32_bf16 v46, v211, v19, v46
    s_waitcnt vmcnt(11)
    buffer_load_dwordx4 v[172:175], v3, s[60:63], s48 offen offset:2048 nt
    s_waitcnt vmcnt(27)
    v_dot2_f32_bf16 v47, v212, v16, 0
    v_dot2_f32_bf16 v47, v213, v17, v47
    v_dot2_f32_bf16 v47, v214, v18, v47
    v_dot2_f32_bf16 v47, v215, v19, v47
    v_add_f32_dpp v32, v32, v32 row_ror:8 row_mask:0xf bank_mask:0x3
    s_nop 1
    v_add_f32_dpp v32, v40, v40 row_ror:8 row_mask:0xf bank_mask:0xc
    v_add_f32_dpp v33, v33, v33 row_ror:8 row_mask:0xf bank_mask:0x3
    s_nop 1
    v_add_f32_dpp v33, v41, v41 row_ror:8 row_mask:0xf bank_mask:0xc
    v_add_f32_dpp v34, v34, v34 row_ror:8 row_mask:0xf bank_mask:0x3
    s_nop 1
    v_add_f32_dpp v34, v42, v42 row_ror:8 row_mask:0xf bank_mask:0xc
    v_add_f32_dpp v35, v35, v35 row_ror:8 row_mask:0xf bank_mask:0x3
    s_nop 1
    v_add_f32_dpp v35, v43, v43 row_ror:8 row_mask:0xf bank_mask:0xc
    v_add_f32_dpp v36, v36, v36 row_ror:8 row_mask:0xf bank_mask:0x3
    s_nop 1
    v_add_f32_dpp v36, v44, v44 row_ror:8 row_mask:0xf bank_mask:0xc
    v_add_f32_dpp v37, v37, v37 row_ror:8 row_mask:0xf bank_mask:0x3
    s_nop 1
    v_add_f32_dpp v37, v45, v45 row_ror:8 row_mask:0xf bank_mask:0xc
    v_add_f32_dpp v38, v38, v38 row_ror:8 row_mask:0xf bank_mask:0x3
    s_nop 1
    v_add_f32_dpp v38, v46, v46 row_ror:8 row_mask:0xf bank_mask:0xc
    v_add_f32_dpp v39, v39, v39 row_ror:8 row_mask:0xf bank_mask:0x3
    s_nop 1
    v_add_f32_dpp v39, v47, v47 row_ror:8 row_mask:0xf bank_mask:0xc
    v_add_f32_dpp v32, v32, v32 row_shl:4 row_mask:0xf bank_mask:0x5
    s_nop 1
    v_add_f32_dpp v32, v36, v36 row_shr:4 row_mask:0xf bank_mask:0xa
    v_add_f32_dpp v33, v33, v33 row_shl:4 row_mask:0xf bank_mask:0x5
    s_nop 1
    v_add_f32_dpp v33, v37, v37 row_shr:4 row_mask:0xf bank_mask:0xa
    v_add_f32_dpp v34, v34, v34 row_shl:4 row_mask:0xf bank_mask:0x5
    s_nop 1
    v_add_f32_dpp v34, v38, v38 row_shr:4 row_mask:0xf bank_mask:0xa
    v_add_f32_dpp v35, v35, v35 row_shl:4 row_mask:0xf bank_mask:0x5
    s_nop 1
    v_add_f32_dpp v35, v39, v39 row_shr:4 row_mask:0xf bank_mask:0xa
    v_add_f32_dpp v32, v32, v32 quad_perm:[2,3,0,1] row_mask:0xf bank_mask:0xf
    v_add_f32_dpp v34, v34, v34 quad_perm:[2,3,0,1] row_mask:0xf bank_mask:0xf
    v_cndmask_b32 v32, v32, v34, s[68:69]
    v_add_f32_dpp v33, v33, v33 quad_perm:[2,3,0,1] row_mask:0xf bank_mask:0xf
    v_add_f32_dpp v35, v35, v35 quad_perm:[2,3,0,1] row_mask:0xf bank_mask:0xf
    v_cndmask_b32 v33, v33, v35, s[68:69]
    v_add_f32_dpp v32, v32, v32 quad_perm:[1,0,3,2] row_mask:0xf bank_mask:0xf
    s_nop 0
    v_add_f32_dpp v33, v33, v33 quad_perm:[1,0,3,2] row_mask:0xf bank_mask:0xf
    v_cndmask_b32 v51, v32, v33, s[70:71]
    v_cvt_pk_bf16_f32 v51, v51, v51
    v_lshlrev_b32 v51, 16, v51
    v_mul_f32 v51, s73, v51
    v_cvt_pk_bf16_f32 v51, v51, v51
    v_lshlrev_b32 v51, 16, v51
    s_waitcnt vmcnt(26)
    v_dot2_f32_bf16 v32, v216, v16, 0
    v_dot2_f32_bf16 v32, v217, v17, v32
    v_dot2_f32_bf16 v32, v218, v18, v32
    v_dot2_f32_bf16 v32, v219, v19, v32
    s_waitcnt vmcnt(11)
    buffer_load_dwordx4 v[176:179], v3, s[60:63], s48 offen offset:3072 nt
    s_waitcnt vmcnt(26)
    v_dot2_f32_bf16 v33, v220, v16, 0
    v_dot2_f32_bf16 v33, v221, v17, v33
    v_dot2_f32_bf16 v33, v222, v18, v33
    v_dot2_f32_bf16 v33, v223, v19, v33
    s_waitcnt vmcnt(25)
    v_dot2_f32_bf16 v34, v224, v16, 0
    v_dot2_f32_bf16 v34, v225, v17, v34
    v_dot2_f32_bf16 v34, v226, v18, v34
    v_dot2_f32_bf16 v34, v227, v19, v34
    s_waitcnt vmcnt(11)
    buffer_load_dwordx4 v[180:183], v4, s[60:63], s48 offen offset:0 nt
    s_waitcnt vmcnt(25)
    v_dot2_f32_bf16 v35, v228, v16, 0
    v_dot2_f32_bf16 v35, v229, v17, v35
    v_dot2_f32_bf16 v35, v230, v18, v35
    v_dot2_f32_bf16 v35, v231, v19, v35
    s_waitcnt vmcnt(24)
    v_dot2_f32_bf16 v36, v88, v16, 0
    v_dot2_f32_bf16 v36, v89, v17, v36
    v_dot2_f32_bf16 v36, v90, v18, v36
    v_dot2_f32_bf16 v36, v91, v19, v36
    s_waitcnt vmcnt(11)
    buffer_load_dwordx4 v[88:91], v4, s[60:63], s48 offen offset:1024 nt
    s_waitcnt vmcnt(24)
    v_dot2_f32_bf16 v37, v92, v16, 0
    v_dot2_f32_bf16 v37, v93, v17, v37
    v_dot2_f32_bf16 v37, v94, v18, v37
    v_dot2_f32_bf16 v37, v95, v19, v37
    s_waitcnt vmcnt(23)
    v_dot2_f32_bf16 v38, v96, v16, 0
    v_dot2_f32_bf16 v38, v97, v17, v38
    v_dot2_f32_bf16 v38, v98, v18, v38
    v_dot2_f32_bf16 v38, v99, v19, v38
    s_waitcnt vmcnt(11)
    buffer_load_dwordx4 v[92:95], v4, s[60:63], s48 offen offset:2048 nt
    s_waitcnt vmcnt(23)
    v_dot2_f32_bf16 v39, v100, v16, 0
    v_dot2_f32_bf16 v39, v101, v17, v39
    v_dot2_f32_bf16 v39, v102, v18, v39
    v_dot2_f32_bf16 v39, v103, v19, v39
    s_waitcnt vmcnt(22)
    v_dot2_f32_bf16 v40, v104, v16, 0
    v_dot2_f32_bf16 v40, v105, v17, v40
    v_dot2_f32_bf16 v40, v106, v18, v40
    v_dot2_f32_bf16 v40, v107, v19, v40
    s_waitcnt vmcnt(11)
    buffer_load_dwordx4 v[96:99], v4, s[60:63], s48 offen offset:3072 nt
    s_waitcnt vmcnt(22)
    v_dot2_f32_bf16 v41, v108, v16, 0
    v_dot2_f32_bf16 v41, v109, v17, v41
    v_dot2_f32_bf16 v41, v110, v18, v41
    v_dot2_f32_bf16 v41, v111, v19, v41
    s_waitcnt vmcnt(21)
    v_dot2_f32_bf16 v42, v112, v16, 0
    v_dot2_f32_bf16 v42, v113, v17, v42
    v_dot2_f32_bf16 v42, v114, v18, v42
    v_dot2_f32_bf16 v42, v115, v19, v42
    s_waitcnt vmcnt(11)
    s_add_u32 s48, s75, 393216
    buffer_load_dwordx4 v[100:103], v3, s[60:63], s48 offen offset:0 nt
    s_waitcnt vmcnt(21)
    v_dot2_f32_bf16 v43, v116, v16, 0
    v_dot2_f32_bf16 v43, v117, v17, v43
    v_dot2_f32_bf16 v43, v118, v18, v43
    v_dot2_f32_bf16 v43, v119, v19, v43
    s_waitcnt vmcnt(20)
    v_dot2_f32_bf16 v44, v120, v16, 0
    v_dot2_f32_bf16 v44, v121, v17, v44
    v_dot2_f32_bf16 v44, v122, v18, v44
    v_dot2_f32_bf16 v44, v123, v19, v44
    s_waitcnt vmcnt(11)
    buffer_load_dwordx4 v[104:107], v3, s[60:63], s48 offen offset:1024 nt
    s_waitcnt vmcnt(20)
    v_dot2_f32_bf16 v45, v124, v16, 0
    v_dot2_f32_bf16 v45, v125, v17, v45
    v_dot2_f32_bf16 v45, v126, v18, v45
    v_dot2_f32_bf16 v45, v127, v19, v45
    s_waitcnt vmcnt(19)
    v_dot2_f32_bf16 v46, v128, v16, 0
    v_dot2_f32_bf16 v46, v129, v17, v46
    v_dot2_f32_bf16 v46, v130, v18, v46
    v_dot2_f32_bf16 v46, v131, v19, v46
    s_waitcnt vmcnt(11)
    buffer_load_dwordx4 v[108:111], v3, s[60:63], s48 offen offset:2048 nt
    s_waitcnt vmcnt(19)
    v_dot2_f32_bf16 v47, v132, v16, 0
    v_dot2_f32_bf16 v47, v133, v17, v47
    v_dot2_f32_bf16 v47, v134, v18, v47
    v_dot2_f32_bf16 v47, v135, v19, v47
    v_add_f32_dpp v32, v32, v32 row_ror:8 row_mask:0xf bank_mask:0x3
    s_nop 1
    v_add_f32_dpp v32, v40, v40 row_ror:8 row_mask:0xf bank_mask:0xc
    v_add_f32_dpp v33, v33, v33 row_ror:8 row_mask:0xf bank_mask:0x3
    s_nop 1
    v_add_f32_dpp v33, v41, v41 row_ror:8 row_mask:0xf bank_mask:0xc
    v_add_f32_dpp v34, v34, v34 row_ror:8 row_mask:0xf bank_mask:0x3
    s_nop 1
    v_add_f32_dpp v34, v42, v42 row_ror:8 row_mask:0xf bank_mask:0xc
    v_add_f32_dpp v35, v35, v35 row_ror:8 row_mask:0xf bank_mask:0x3
    s_nop 1
    v_add_f32_dpp v35, v43, v43 row_ror:8 row_mask:0xf bank_mask:0xc
    v_add_f32_dpp v36, v36, v36 row_ror:8 row_mask:0xf bank_mask:0x3
    s_nop 1
    v_add_f32_dpp v36, v44, v44 row_ror:8 row_mask:0xf bank_mask:0xc
    v_add_f32_dpp v37, v37, v37 row_ror:8 row_mask:0xf bank_mask:0x3
    s_nop 1
    v_add_f32_dpp v37, v45, v45 row_ror:8 row_mask:0xf bank_mask:0xc
    v_add_f32_dpp v38, v38, v38 row_ror:8 row_mask:0xf bank_mask:0x3
    s_nop 1
    v_add_f32_dpp v38, v46, v46 row_ror:8 row_mask:0xf bank_mask:0xc
    v_add_f32_dpp v39, v39, v39 row_ror:8 row_mask:0xf bank_mask:0x3
    s_nop 1
    v_add_f32_dpp v39, v47, v47 row_ror:8 row_mask:0xf bank_mask:0xc
    v_add_f32_dpp v32, v32, v32 row_shl:4 row_mask:0xf bank_mask:0x5
    s_nop 1
    v_add_f32_dpp v32, v36, v36 row_shr:4 row_mask:0xf bank_mask:0xa
    v_add_f32_dpp v33, v33, v33 row_shl:4 row_mask:0xf bank_mask:0x5
    s_nop 1
    v_add_f32_dpp v33, v37, v37 row_shr:4 row_mask:0xf bank_mask:0xa
    v_add_f32_dpp v34, v34, v34 row_shl:4 row_mask:0xf bank_mask:0x5
    s_nop 1
    v_add_f32_dpp v34, v38, v38 row_shr:4 row_mask:0xf bank_mask:0xa
    v_add_f32_dpp v35, v35, v35 row_shl:4 row_mask:0xf bank_mask:0x5
    s_nop 1
    v_add_f32_dpp v35, v39, v39 row_shr:4 row_mask:0xf bank_mask:0xa
    v_add_f32_dpp v32, v32, v32 quad_perm:[2,3,0,1] row_mask:0xf bank_mask:0xf
    v_add_f32_dpp v34, v34, v34 quad_perm:[2,3,0,1] row_mask:0xf bank_mask:0xf
    v_cndmask_b32 v32, v32, v34, s[68:69]
    v_add_f32_dpp v33, v33, v33 quad_perm:[2,3,0,1] row_mask:0xf bank_mask:0xf
    v_add_f32_dpp v35, v35, v35 quad_perm:[2,3,0,1] row_mask:0xf bank_mask:0xf
    v_cndmask_b32 v33, v33, v35, s[68:69]
    v_add_f32_dpp v32, v32, v32 quad_perm:[1,0,3,2] row_mask:0xf bank_mask:0xf
    s_nop 0
    v_add_f32_dpp v33, v33, v33 quad_perm:[1,0,3,2] row_mask:0xf bank_mask:0xf
    v_cndmask_b32 v52, v32, v33, s[70:71]
    v_cvt_pk_bf16_f32 v52, v52, v52
    v_lshlrev_b32 v52, 16, v52
    v_mul_f32 v52, s73, v52
    v_cvt_pk_bf16_f32 v52, v52, v52
    v_lshlrev_b32 v52, 16, v52
    s_waitcnt vmcnt(18)
    v_dot2_f32_bf16 v32, v232, v16, 0
    v_dot2_f32_bf16 v32, v233, v17, v32
    v_dot2_f32_bf16 v32, v234, v18, v32
    v_dot2_f32_bf16 v32, v235, v19, v32
    s_waitcnt vmcnt(11)
    buffer_load_dwordx4 v[112:115], v3, s[60:63], s48 offen offset:3072 nt
    s_waitcnt vmcnt(18)
    v_dot2_f32_bf16 v33, v136, v16, 0
    v_dot2_f32_bf16 v33, v137, v17, v33
    v_dot2_f32_bf16 v33, v138, v18, v33
    v_dot2_f32_bf16 v33, v139, v19, v33
    s_waitcnt vmcnt(17)
    v_dot2_f32_bf16 v34, v140, v16, 0
    v_dot2_f32_bf16 v34, v141, v17, v34
    v_dot2_f32_bf16 v34, v142, v18, v34
    v_dot2_f32_bf16 v34, v143, v19, v34
    s_waitcnt vmcnt(11)
    buffer_load_dwordx4 v[116:119], v4, s[60:63], s48 offen offset:0 nt
    s_waitcnt vmcnt(17)
    v_dot2_f32_bf16 v35, v144, v16, 0
    v_dot2_f32_bf16 v35, v145, v17, v35
    v_dot2_f32_bf16 v35, v146, v18, v35
    v_dot2_f32_bf16 v35, v147, v19, v35
    s_waitcnt vmcnt(16)
    v_dot2_f32_bf16 v36, v148, v16, 0
    v_dot2_f32_bf16 v36, v149, v17, v36
    v_dot2_f32_bf16 v36, v150, v18, v36
    v_dot2_f32_bf16 v36, v151, v19, v36
    s_waitcnt vmcnt(11)
    buffer_load_dwordx4 v[120:123], v4, s[60:63], s48 offen offset:1024 nt
    s_waitcnt vmcnt(16)
    v_dot2_f32_bf16 v37, v152, v16, 0
    v_dot2_f32_bf16 v37, v153, v17, v37
    v_dot2_f32_bf16 v37, v154, v18, v37
    v_dot2_f32_bf16 v37, v155, v19, v37
    s_waitcnt vmcnt(15)
    v_dot2_f32_bf16 v38, v156, v16, 0
    v_dot2_f32_bf16 v38, v157, v17, v38
    v_dot2_f32_bf16 v38, v158, v18, v38
    v_dot2_f32_bf16 v38, v159, v19, v38
    s_waitcnt vmcnt(11)
    buffer_load_dwordx4 v[124:127], v4, s[60:63], s48 offen offset:2048 nt
    s_waitcnt vmcnt(15)
    v_dot2_f32_bf16 v39, v160, v16, 0
    v_dot2_f32_bf16 v39, v161, v17, v39
    v_dot2_f32_bf16 v39, v162, v18, v39
    v_dot2_f32_bf16 v39, v163, v19, v39
    s_waitcnt vmcnt(14)
    v_dot2_f32_bf16 v40, v164, v16, 0
    v_dot2_f32_bf16 v40, v165, v17, v40
    v_dot2_f32_bf16 v40, v166, v18, v40
    v_dot2_f32_bf16 v40, v167, v19, v40
    s_waitcnt vmcnt(11)
    buffer_load_dwordx4 v[128:131], v4, s[60:63], s48 offen offset:3072 nt
    s_waitcnt vmcnt(14)
    v_dot2_f32_bf16 v41, v168, v16, 0
    v_dot2_f32_bf16 v41, v169, v17, v41
    v_dot2_f32_bf16 v41, v170, v18, v41
    v_dot2_f32_bf16 v41, v171, v19, v41
    s_waitcnt vmcnt(13)
    v_dot2_f32_bf16 v42, v172, v16, 0
    v_dot2_f32_bf16 v42, v173, v17, v42
    v_dot2_f32_bf16 v42, v174, v18, v42
    v_dot2_f32_bf16 v42, v175, v19, v42
    s_waitcnt vmcnt(11)
    s_add_u32 s48, s75, 425984
    buffer_load_dwordx4 v[132:135], v3, s[60:63], s48 offen offset:0 nt
    s_waitcnt vmcnt(13)
    v_dot2_f32_bf16 v43, v176, v16, 0
    v_dot2_f32_bf16 v43, v177, v17, v43
    v_dot2_f32_bf16 v43, v178, v18, v43
    v_dot2_f32_bf16 v43, v179, v19, v43
    s_waitcnt vmcnt(12)
    v_dot2_f32_bf16 v44, v180, v16, 0
    v_dot2_f32_bf16 v44, v181, v17, v44
    v_dot2_f32_bf16 v44, v182, v18, v44
    v_dot2_f32_bf16 v44, v183, v19, v44
    buffer_load_dwordx4 v[136:139], v3, s[60:63], s48 offen offset:1024 nt
    s_waitcnt vmcnt(12)
    v_dot2_f32_bf16 v45, v88, v16, 0
    v_dot2_f32_bf16 v45, v89, v17, v45
    v_dot2_f32_bf16 v45, v90, v18, v45
    v_dot2_f32_bf16 v45, v91, v19, v45
    buffer_load_dwordx4 v[88:91], v3, s[60:63], s48 offen offset:2048 nt
    s_waitcnt vmcnt(12)
    v_dot2_f32_bf16 v46, v92, v16, 0
    v_dot2_f32_bf16 v46, v93, v17, v46
    v_dot2_f32_bf16 v46, v94, v18, v46
    v_dot2_f32_bf16 v46, v95, v19, v46
    buffer_load_dwordx4 v[92:95], v3, s[60:63], s48 offen offset:3072 nt
    s_waitcnt vmcnt(12)
    v_dot2_f32_bf16 v47, v96, v16, 0
    v_dot2_f32_bf16 v47, v97, v17, v47
    v_dot2_f32_bf16 v47, v98, v18, v47
    v_dot2_f32_bf16 v47, v99, v19, v47
    v_add_f32_dpp v32, v32, v32 row_ror:8 row_mask:0xf bank_mask:0x3
    s_nop 1
    v_add_f32_dpp v32, v40, v40 row_ror:8 row_mask:0xf bank_mask:0xc
    v_add_f32_dpp v33, v33, v33 row_ror:8 row_mask:0xf bank_mask:0x3
    s_nop 1
    v_add_f32_dpp v33, v41, v41 row_ror:8 row_mask:0xf bank_mask:0xc
    v_add_f32_dpp v34, v34, v34 row_ror:8 row_mask:0xf bank_mask:0x3
    s_nop 1
    v_add_f32_dpp v34, v42, v42 row_ror:8 row_mask:0xf bank_mask:0xc
    v_add_f32_dpp v35, v35, v35 row_ror:8 row_mask:0xf bank_mask:0x3
    s_nop 1
    v_add_f32_dpp v35, v43, v43 row_ror:8 row_mask:0xf bank_mask:0xc
    v_add_f32_dpp v36, v36, v36 row_ror:8 row_mask:0xf bank_mask:0x3
    s_nop 1
    v_add_f32_dpp v36, v44, v44 row_ror:8 row_mask:0xf bank_mask:0xc
    v_add_f32_dpp v37, v37, v37 row_ror:8 row_mask:0xf bank_mask:0x3
    s_nop 1
    v_add_f32_dpp v37, v45, v45 row_ror:8 row_mask:0xf bank_mask:0xc
    v_add_f32_dpp v38, v38, v38 row_ror:8 row_mask:0xf bank_mask:0x3
    s_nop 1
    v_add_f32_dpp v38, v46, v46 row_ror:8 row_mask:0xf bank_mask:0xc
    v_add_f32_dpp v39, v39, v39 row_ror:8 row_mask:0xf bank_mask:0x3
    s_nop 1
    v_add_f32_dpp v39, v47, v47 row_ror:8 row_mask:0xf bank_mask:0xc
    v_add_f32_dpp v32, v32, v32 row_shl:4 row_mask:0xf bank_mask:0x5
    s_nop 1
    v_add_f32_dpp v32, v36, v36 row_shr:4 row_mask:0xf bank_mask:0xa
    v_add_f32_dpp v33, v33, v33 row_shl:4 row_mask:0xf bank_mask:0x5
    s_nop 1
    v_add_f32_dpp v33, v37, v37 row_shr:4 row_mask:0xf bank_mask:0xa
    v_add_f32_dpp v34, v34, v34 row_shl:4 row_mask:0xf bank_mask:0x5
    s_nop 1
    v_add_f32_dpp v34, v38, v38 row_shr:4 row_mask:0xf bank_mask:0xa
    v_add_f32_dpp v35, v35, v35 row_shl:4 row_mask:0xf bank_mask:0x5
    s_nop 1
    v_add_f32_dpp v35, v39, v39 row_shr:4 row_mask:0xf bank_mask:0xa
    v_add_f32_dpp v32, v32, v32 quad_perm:[2,3,0,1] row_mask:0xf bank_mask:0xf
    v_add_f32_dpp v34, v34, v34 quad_perm:[2,3,0,1] row_mask:0xf bank_mask:0xf
    v_cndmask_b32 v32, v32, v34, s[68:69]
    v_add_f32_dpp v33, v33, v33 quad_perm:[2,3,0,1] row_mask:0xf bank_mask:0xf
    v_add_f32_dpp v35, v35, v35 quad_perm:[2,3,0,1] row_mask:0xf bank_mask:0xf
    v_cndmask_b32 v33, v33, v35, s[68:69]
    v_add_f32_dpp v32, v32, v32 quad_perm:[1,0,3,2] row_mask:0xf bank_mask:0xf
    s_nop 0
    v_add_f32_dpp v33, v33, v33 quad_perm:[1,0,3,2] row_mask:0xf bank_mask:0xf
    v_cndmask_b32 v53, v32, v33, s[70:71]
    v_cvt_pk_bf16_f32 v53, v53, v53
    v_lshlrev_b32 v53, 16, v53
    v_mul_f32 v53, s73, v53
    v_cvt_pk_bf16_f32 v53, v53, v53
    v_lshlrev_b32 v53, 16, v53
    buffer_load_dwordx4 v[96:99], v4, s[60:63], s48 offen offset:0 nt
    s_waitcnt vmcnt(12)
    v_dot2_f32_bf16 v32, v100, v16, 0
    v_dot2_f32_bf16 v32, v101, v17, v32
    v_dot2_f32_bf16 v32, v102, v18, v32
    v_dot2_f32_bf16 v32, v103, v19, v32
    buffer_load_dwordx4 v[100:103], v4, s[60:63], s48 offen offset:1024 nt
    s_waitcnt vmcnt(12)
    v_dot2_f32_bf16 v33, v104, v16, 0
    v_dot2_f32_bf16 v33, v105, v17, v33
    v_dot2_f32_bf16 v33, v106, v18, v33
    v_dot2_f32_bf16 v33, v107, v19, v33
    buffer_load_dwordx4 v[104:107], v4, s[60:63], s48 offen offset:2048 nt
    s_waitcnt vmcnt(12)
    v_dot2_f32_bf16 v34, v108, v16, 0
    v_dot2_f32_bf16 v34, v109, v17, v34
    v_dot2_f32_bf16 v34, v110, v18, v34
    v_dot2_f32_bf16 v34, v111, v19, v34
    buffer_load_dwordx4 v[108:111], v4, s[60:63], s48 offen offset:3072 nt
    s_waitcnt vmcnt(12)
    v_dot2_f32_bf16 v35, v112, v16, 0
    v_dot2_f32_bf16 v35, v113, v17, v35
    v_dot2_f32_bf16 v35, v114, v18, v35
    v_dot2_f32_bf16 v35, v115, v19, v35
    s_add_u32 s48, s75, 458752
    buffer_load_dwordx4 v[112:115], v3, s[60:63], s48 offen offset:0 nt
    s_waitcnt vmcnt(12)
    v_dot2_f32_bf16 v36, v116, v16, 0
    v_dot2_f32_bf16 v36, v117, v17, v36
    v_dot2_f32_bf16 v36, v118, v18, v36
    v_dot2_f32_bf16 v36, v119, v19, v36
    buffer_load_dwordx4 v[116:119], v3, s[60:63], s48 offen offset:1024 nt
    s_waitcnt vmcnt(12)
    v_dot2_f32_bf16 v37, v120, v16, 0
    v_dot2_f32_bf16 v37, v121, v17, v37
    v_dot2_f32_bf16 v37, v122, v18, v37
    v_dot2_f32_bf16 v37, v123, v19, v37
    buffer_load_dwordx4 v[120:123], v3, s[60:63], s48 offen offset:2048 nt
    s_waitcnt vmcnt(12)
    v_dot2_f32_bf16 v38, v124, v16, 0
    v_dot2_f32_bf16 v38, v125, v17, v38
    v_dot2_f32_bf16 v38, v126, v18, v38
    v_dot2_f32_bf16 v38, v127, v19, v38
    buffer_load_dwordx4 v[124:127], v3, s[60:63], s48 offen offset:3072 nt
    s_waitcnt vmcnt(12)
    v_dot2_f32_bf16 v39, v128, v16, 0
    v_dot2_f32_bf16 v39, v129, v17, v39
    v_dot2_f32_bf16 v39, v130, v18, v39
    v_dot2_f32_bf16 v39, v131, v19, v39
    buffer_load_dwordx4 v[128:131], v4, s[60:63], s48 offen offset:0 nt
    s_waitcnt vmcnt(12)
    v_dot2_f32_bf16 v40, v132, v16, 0
    v_dot2_f32_bf16 v40, v133, v17, v40
    v_dot2_f32_bf16 v40, v134, v18, v40
    v_dot2_f32_bf16 v40, v135, v19, v40
    buffer_load_dwordx4 v[132:135], v4, s[60:63], s48 offen offset:1024 nt
    s_waitcnt vmcnt(12)
    v_dot2_f32_bf16 v41, v136, v16, 0
    v_dot2_f32_bf16 v41, v137, v17, v41
    v_dot2_f32_bf16 v41, v138, v18, v41
    v_dot2_f32_bf16 v41, v139, v19, v41
    buffer_load_dwordx4 v[136:139], v4, s[60:63], s48 offen offset:2048 nt
    s_waitcnt vmcnt(12)
    v_dot2_f32_bf16 v42, v88, v16, 0
    v_dot2_f32_bf16 v42, v89, v17, v42
    v_dot2_f32_bf16 v42, v90, v18, v42
    v_dot2_f32_bf16 v42, v91, v19, v42
    buffer_load_dwordx4 v[88:91], v4, s[60:63], s48 offen offset:3072 nt
    s_waitcnt vmcnt(12)
    v_dot2_f32_bf16 v43, v92, v16, 0
    v_dot2_f32_bf16 v43, v93, v17, v43
    v_dot2_f32_bf16 v43, v94, v18, v43
    v_dot2_f32_bf16 v43, v95, v19, v43
    s_add_u32 s48, s75, 491520
    buffer_load_dwordx4 v[92:95], v3, s[60:63], s48 offen offset:0 nt
    s_waitcnt vmcnt(12)
    v_dot2_f32_bf16 v44, v96, v16, 0
    v_dot2_f32_bf16 v44, v97, v17, v44
    v_dot2_f32_bf16 v44, v98, v18, v44
    v_dot2_f32_bf16 v44, v99, v19, v44
    buffer_load_dwordx4 v[96:99], v3, s[60:63], s48 offen offset:1024 nt
    s_waitcnt vmcnt(12)
    v_dot2_f32_bf16 v45, v100, v16, 0
    v_dot2_f32_bf16 v45, v101, v17, v45
    v_dot2_f32_bf16 v45, v102, v18, v45
    v_dot2_f32_bf16 v45, v103, v19, v45
    buffer_load_dwordx4 v[100:103], v3, s[60:63], s48 offen offset:2048 nt
    s_waitcnt vmcnt(12)
    v_dot2_f32_bf16 v46, v104, v16, 0
    v_dot2_f32_bf16 v46, v105, v17, v46
    v_dot2_f32_bf16 v46, v106, v18, v46
    v_dot2_f32_bf16 v46, v107, v19, v46
    buffer_load_dwordx4 v[104:107], v3, s[60:63], s48 offen offset:3072 nt
    s_waitcnt vmcnt(12)
    v_dot2_f32_bf16 v47, v108, v16, 0
    v_dot2_f32_bf16 v47, v109, v17, v47
    v_dot2_f32_bf16 v47, v110, v18, v47
    v_dot2_f32_bf16 v47, v111, v19, v47
    v_add_f32_dpp v32, v32, v32 row_ror:8 row_mask:0xf bank_mask:0x3
    s_nop 1
    v_add_f32_dpp v32, v40, v40 row_ror:8 row_mask:0xf bank_mask:0xc
    v_add_f32_dpp v33, v33, v33 row_ror:8 row_mask:0xf bank_mask:0x3
    s_nop 1
    v_add_f32_dpp v33, v41, v41 row_ror:8 row_mask:0xf bank_mask:0xc
    v_add_f32_dpp v34, v34, v34 row_ror:8 row_mask:0xf bank_mask:0x3
    s_nop 1
    v_add_f32_dpp v34, v42, v42 row_ror:8 row_mask:0xf bank_mask:0xc
    v_add_f32_dpp v35, v35, v35 row_ror:8 row_mask:0xf bank_mask:0x3
    s_nop 1
    v_add_f32_dpp v35, v43, v43 row_ror:8 row_mask:0xf bank_mask:0xc
    v_add_f32_dpp v36, v36, v36 row_ror:8 row_mask:0xf bank_mask:0x3
    s_nop 1
    v_add_f32_dpp v36, v44, v44 row_ror:8 row_mask:0xf bank_mask:0xc
    v_add_f32_dpp v37, v37, v37 row_ror:8 row_mask:0xf bank_mask:0x3
    s_nop 1
    v_add_f32_dpp v37, v45, v45 row_ror:8 row_mask:0xf bank_mask:0xc
    v_add_f32_dpp v38, v38, v38 row_ror:8 row_mask:0xf bank_mask:0x3
    s_nop 1
    v_add_f32_dpp v38, v46, v46 row_ror:8 row_mask:0xf bank_mask:0xc
    v_add_f32_dpp v39, v39, v39 row_ror:8 row_mask:0xf bank_mask:0x3
    s_nop 1
    v_add_f32_dpp v39, v47, v47 row_ror:8 row_mask:0xf bank_mask:0xc
    v_add_f32_dpp v32, v32, v32 row_shl:4 row_mask:0xf bank_mask:0x5
    s_nop 1
    v_add_f32_dpp v32, v36, v36 row_shr:4 row_mask:0xf bank_mask:0xa
    v_add_f32_dpp v33, v33, v33 row_shl:4 row_mask:0xf bank_mask:0x5
    s_nop 1
    v_add_f32_dpp v33, v37, v37 row_shr:4 row_mask:0xf bank_mask:0xa
    v_add_f32_dpp v34, v34, v34 row_shl:4 row_mask:0xf bank_mask:0x5
    s_nop 1
    v_add_f32_dpp v34, v38, v38 row_shr:4 row_mask:0xf bank_mask:0xa
    v_add_f32_dpp v35, v35, v35 row_shl:4 row_mask:0xf bank_mask:0x5
    s_nop 1
    v_add_f32_dpp v35, v39, v39 row_shr:4 row_mask:0xf bank_mask:0xa
    v_add_f32_dpp v32, v32, v32 quad_perm:[2,3,0,1] row_mask:0xf bank_mask:0xf
    v_add_f32_dpp v34, v34, v34 quad_perm:[2,3,0,1] row_mask:0xf bank_mask:0xf
    v_cndmask_b32 v32, v32, v34, s[68:69]
    v_add_f32_dpp v33, v33, v33 quad_perm:[2,3,0,1] row_mask:0xf bank_mask:0xf
    v_add_f32_dpp v35, v35, v35 quad_perm:[2,3,0,1] row_mask:0xf bank_mask:0xf
    v_cndmask_b32 v33, v33, v35, s[68:69]
    v_add_f32_dpp v32, v32, v32 quad_perm:[1,0,3,2] row_mask:0xf bank_mask:0xf
    s_nop 0
    v_add_f32_dpp v33, v33, v33 quad_perm:[1,0,3,2] row_mask:0xf bank_mask:0xf
    v_cndmask_b32 v54, v32, v33, s[70:71]
    v_cvt_pk_bf16_f32 v54, v54, v54
    v_lshlrev_b32 v54, 16, v54
    v_mul_f32 v54, s73, v54
    v_cvt_pk_bf16_f32 v54, v54, v54
    v_lshlrev_b32 v54, 16, v54
    buffer_load_dwordx4 v[108:111], v4, s[60:63], s48 offen offset:0 nt
    s_waitcnt vmcnt(12)
    v_dot2_f32_bf16 v32, v112, v16, 0
    v_dot2_f32_bf16 v32, v113, v17, v32
    v_dot2_f32_bf16 v32, v114, v18, v32
    v_dot2_f32_bf16 v32, v115, v19, v32
    buffer_load_dwordx4 v[112:115], v4, s[60:63], s48 offen offset:1024 nt
    s_waitcnt vmcnt(12)
    v_dot2_f32_bf16 v33, v116, v16, 0
    v_dot2_f32_bf16 v33, v117, v17, v33
    v_dot2_f32_bf16 v33, v118, v18, v33
    v_dot2_f32_bf16 v33, v119, v19, v33
    buffer_load_dwordx4 v[116:119], v4, s[60:63], s48 offen offset:2048 nt
    s_waitcnt vmcnt(12)
    v_dot2_f32_bf16 v34, v120, v16, 0
    v_dot2_f32_bf16 v34, v121, v17, v34
    v_dot2_f32_bf16 v34, v122, v18, v34
    v_dot2_f32_bf16 v34, v123, v19, v34
    buffer_load_dwordx4 v[120:123], v4, s[60:63], s48 offen offset:3072 nt
    s_waitcnt vmcnt(12)
    v_dot2_f32_bf16 v35, v124, v16, 0
    v_dot2_f32_bf16 v35, v125, v17, v35
    v_dot2_f32_bf16 v35, v126, v18, v35
    v_dot2_f32_bf16 v35, v127, v19, v35
    s_add_u32 s48, s75, 524288
    buffer_load_dwordx4 v[124:127], v3, s[60:63], s48 offen offset:0 nt
    s_waitcnt vmcnt(12)
    v_dot2_f32_bf16 v36, v128, v16, 0
    v_dot2_f32_bf16 v36, v129, v17, v36
    v_dot2_f32_bf16 v36, v130, v18, v36
    v_dot2_f32_bf16 v36, v131, v19, v36
    buffer_load_dwordx4 v[128:131], v3, s[60:63], s48 offen offset:1024 nt
    s_waitcnt vmcnt(12)
    v_dot2_f32_bf16 v37, v132, v16, 0
    v_dot2_f32_bf16 v37, v133, v17, v37
    v_dot2_f32_bf16 v37, v134, v18, v37
    v_dot2_f32_bf16 v37, v135, v19, v37
    buffer_load_dwordx4 v[132:135], v3, s[60:63], s48 offen offset:2048 nt
    s_waitcnt vmcnt(12)
    v_dot2_f32_bf16 v38, v136, v16, 0
    v_dot2_f32_bf16 v38, v137, v17, v38
    v_dot2_f32_bf16 v38, v138, v18, v38
    v_dot2_f32_bf16 v38, v139, v19, v38
    buffer_load_dwordx4 v[136:139], v3, s[60:63], s48 offen offset:3072 nt
    s_waitcnt vmcnt(12)
    v_dot2_f32_bf16 v39, v88, v16, 0
    v_dot2_f32_bf16 v39, v89, v17, v39
    v_dot2_f32_bf16 v39, v90, v18, v39
    v_dot2_f32_bf16 v39, v91, v19, v39
    buffer_load_dwordx4 v[88:91], v4, s[60:63], s48 offen offset:0 nt
    s_waitcnt vmcnt(12)
    v_dot2_f32_bf16 v40, v92, v16, 0
    v_dot2_f32_bf16 v40, v93, v17, v40
    v_dot2_f32_bf16 v40, v94, v18, v40
    v_dot2_f32_bf16 v40, v95, v19, v40
    buffer_load_dwordx4 v[92:95], v4, s[60:63], s48 offen offset:1024 nt
    s_waitcnt vmcnt(12)
    v_dot2_f32_bf16 v41, v96, v16, 0
    v_dot2_f32_bf16 v41, v97, v17, v41
    v_dot2_f32_bf16 v41, v98, v18, v41
    v_dot2_f32_bf16 v41, v99, v19, v41
    buffer_load_dwordx4 v[96:99], v4, s[60:63], s48 offen offset:2048 nt
    s_waitcnt vmcnt(12)
    v_dot2_f32_bf16 v42, v100, v16, 0
    v_dot2_f32_bf16 v42, v101, v17, v42
    v_dot2_f32_bf16 v42, v102, v18, v42
    v_dot2_f32_bf16 v42, v103, v19, v42
    buffer_load_dwordx4 v[100:103], v4, s[60:63], s48 offen offset:3072 nt
    s_waitcnt vmcnt(12)
    v_dot2_f32_bf16 v43, v104, v16, 0
    v_dot2_f32_bf16 v43, v105, v17, v43
    v_dot2_f32_bf16 v43, v106, v18, v43
    v_dot2_f32_bf16 v43, v107, v19, v43
    s_add_u32 s48, s75, 557056
    buffer_load_dwordx4 v[104:107], v3, s[60:63], s48 offen offset:0 nt
    s_waitcnt vmcnt(12)
    v_dot2_f32_bf16 v44, v108, v16, 0
    v_dot2_f32_bf16 v44, v109, v17, v44
    v_dot2_f32_bf16 v44, v110, v18, v44
    v_dot2_f32_bf16 v44, v111, v19, v44
    buffer_load_dwordx4 v[108:111], v3, s[60:63], s48 offen offset:1024 nt
    s_waitcnt vmcnt(12)
    v_dot2_f32_bf16 v45, v112, v16, 0
    v_dot2_f32_bf16 v45, v113, v17, v45
    v_dot2_f32_bf16 v45, v114, v18, v45
    v_dot2_f32_bf16 v45, v115, v19, v45
    buffer_load_dwordx4 v[112:115], v3, s[60:63], s48 offen offset:2048 nt
    s_waitcnt vmcnt(12)
    v_dot2_f32_bf16 v46, v116, v16, 0
    v_dot2_f32_bf16 v46, v117, v17, v46
    v_dot2_f32_bf16 v46, v118, v18, v46
    v_dot2_f32_bf16 v46, v119, v19, v46
    buffer_load_dwordx4 v[116:119], v3, s[60:63], s48 offen offset:3072 nt
    s_waitcnt vmcnt(12)
    v_dot2_f32_bf16 v47, v120, v16, 0
    v_dot2_f32_bf16 v47, v121, v17, v47
    v_dot2_f32_bf16 v47, v122, v18, v47
    v_dot2_f32_bf16 v47, v123, v19, v47
    v_add_f32_dpp v32, v32, v32 row_ror:8 row_mask:0xf bank_mask:0x3
    s_nop 1
    v_add_f32_dpp v32, v40, v40 row_ror:8 row_mask:0xf bank_mask:0xc
    v_add_f32_dpp v33, v33, v33 row_ror:8 row_mask:0xf bank_mask:0x3
    s_nop 1
    v_add_f32_dpp v33, v41, v41 row_ror:8 row_mask:0xf bank_mask:0xc
    v_add_f32_dpp v34, v34, v34 row_ror:8 row_mask:0xf bank_mask:0x3
    s_nop 1
    v_add_f32_dpp v34, v42, v42 row_ror:8 row_mask:0xf bank_mask:0xc
    v_add_f32_dpp v35, v35, v35 row_ror:8 row_mask:0xf bank_mask:0x3
    s_nop 1
    v_add_f32_dpp v35, v43, v43 row_ror:8 row_mask:0xf bank_mask:0xc
    v_add_f32_dpp v36, v36, v36 row_ror:8 row_mask:0xf bank_mask:0x3
    s_nop 1
    v_add_f32_dpp v36, v44, v44 row_ror:8 row_mask:0xf bank_mask:0xc
    v_add_f32_dpp v37, v37, v37 row_ror:8 row_mask:0xf bank_mask:0x3
    s_nop 1
    v_add_f32_dpp v37, v45, v45 row_ror:8 row_mask:0xf bank_mask:0xc
    v_add_f32_dpp v38, v38, v38 row_ror:8 row_mask:0xf bank_mask:0x3
    s_nop 1
    v_add_f32_dpp v38, v46, v46 row_ror:8 row_mask:0xf bank_mask:0xc
    v_add_f32_dpp v39, v39, v39 row_ror:8 row_mask:0xf bank_mask:0x3
    s_nop 1
    v_add_f32_dpp v39, v47, v47 row_ror:8 row_mask:0xf bank_mask:0xc
    v_add_f32_dpp v32, v32, v32 row_shl:4 row_mask:0xf bank_mask:0x5
    s_nop 1
    v_add_f32_dpp v32, v36, v36 row_shr:4 row_mask:0xf bank_mask:0xa
    v_add_f32_dpp v33, v33, v33 row_shl:4 row_mask:0xf bank_mask:0x5
    s_nop 1
    v_add_f32_dpp v33, v37, v37 row_shr:4 row_mask:0xf bank_mask:0xa
    v_add_f32_dpp v34, v34, v34 row_shl:4 row_mask:0xf bank_mask:0x5
    s_nop 1
    v_add_f32_dpp v34, v38, v38 row_shr:4 row_mask:0xf bank_mask:0xa
    v_add_f32_dpp v35, v35, v35 row_shl:4 row_mask:0xf bank_mask:0x5
    s_nop 1
    v_add_f32_dpp v35, v39, v39 row_shr:4 row_mask:0xf bank_mask:0xa
    v_add_f32_dpp v32, v32, v32 quad_perm:[2,3,0,1] row_mask:0xf bank_mask:0xf
    v_add_f32_dpp v34, v34, v34 quad_perm:[2,3,0,1] row_mask:0xf bank_mask:0xf
    v_cndmask_b32 v32, v32, v34, s[68:69]
    v_add_f32_dpp v33, v33, v33 quad_perm:[2,3,0,1] row_mask:0xf bank_mask:0xf
    v_add_f32_dpp v35, v35, v35 quad_perm:[2,3,0,1] row_mask:0xf bank_mask:0xf
    v_cndmask_b32 v33, v33, v35, s[68:69]
    v_add_f32_dpp v32, v32, v32 quad_perm:[1,0,3,2] row_mask:0xf bank_mask:0xf
    s_nop 0
    v_add_f32_dpp v33, v33, v33 quad_perm:[1,0,3,2] row_mask:0xf bank_mask:0xf
    v_cndmask_b32 v55, v32, v33, s[70:71]
    v_cvt_pk_bf16_f32 v55, v55, v55
    v_lshlrev_b32 v55, 16, v55
    v_mul_f32 v55, s73, v55
    v_cvt_pk_bf16_f32 v55, v55, v55
    v_lshlrev_b32 v55, 16, v55
    buffer_load_dwordx4 v[120:123], v4, s[60:63], s48 offen offset:0 nt
    s_waitcnt vmcnt(12)
    v_dot2_f32_bf16 v32, v124, v16, 0
    v_dot2_f32_bf16 v32, v125, v17, v32
    v_dot2_f32_bf16 v32, v126, v18, v32
    v_dot2_f32_bf16 v32, v127, v19, v32
    buffer_load_dwordx4 v[124:127], v4, s[60:63], s48 offen offset:1024 nt
    s_waitcnt vmcnt(12)
    v_dot2_f32_bf16 v33, v128, v16, 0
    v_dot2_f32_bf16 v33, v129, v17, v33
    v_dot2_f32_bf16 v33, v130, v18, v33
    v_dot2_f32_bf16 v33, v131, v19, v33
    buffer_load_dwordx4 v[128:131], v4, s[60:63], s48 offen offset:2048 nt
    s_waitcnt vmcnt(12)
    v_dot2_f32_bf16 v34, v132, v16, 0
    v_dot2_f32_bf16 v34, v133, v17, v34
    v_dot2_f32_bf16 v34, v134, v18, v34
    v_dot2_f32_bf16 v34, v135, v19, v34
    buffer_load_dwordx4 v[132:135], v4, s[60:63], s48 offen offset:3072 nt
    s_waitcnt vmcnt(12)
    v_dot2_f32_bf16 v35, v136, v16, 0
    v_dot2_f32_bf16 v35, v137, v17, v35
    v_dot2_f32_bf16 v35, v138, v18, v35
    v_dot2_f32_bf16 v35, v139, v19, v35
    s_add_u32 s48, s75, 589824
    buffer_load_dwordx4 v[136:139], v3, s[60:63], s48 offen offset:0 nt
    s_waitcnt vmcnt(12)
    v_dot2_f32_bf16 v36, v88, v16, 0
    v_dot2_f32_bf16 v36, v89, v17, v36
    v_dot2_f32_bf16 v36, v90, v18, v36
    v_dot2_f32_bf16 v36, v91, v19, v36
    buffer_load_dwordx4 v[88:91], v3, s[60:63], s48 offen offset:1024 nt
    s_waitcnt vmcnt(12)
    v_dot2_f32_bf16 v37, v92, v16, 0
    v_dot2_f32_bf16 v37, v93, v17, v37
    v_dot2_f32_bf16 v37, v94, v18, v37
    v_dot2_f32_bf16 v37, v95, v19, v37
    buffer_load_dwordx4 v[92:95], v3, s[60:63], s48 offen offset:2048 nt
    s_waitcnt vmcnt(12)
    v_dot2_f32_bf16 v38, v96, v16, 0
    v_dot2_f32_bf16 v38, v97, v17, v38
    v_dot2_f32_bf16 v38, v98, v18, v38
    v_dot2_f32_bf16 v38, v99, v19, v38
    buffer_load_dwordx4 v[96:99], v3, s[60:63], s48 offen offset:3072 nt
    s_waitcnt vmcnt(12)
    v_dot2_f32_bf16 v39, v100, v16, 0
    v_dot2_f32_bf16 v39, v101, v17, v39
    v_dot2_f32_bf16 v39, v102, v18, v39
    v_dot2_f32_bf16 v39, v103, v19, v39
    buffer_load_dwordx4 v[100:103], v4, s[60:63], s48 offen offset:0 nt
    s_waitcnt vmcnt(12)
    v_dot2_f32_bf16 v40, v104, v16, 0
    v_dot2_f32_bf16 v40, v105, v17, v40
    v_dot2_f32_bf16 v40, v106, v18, v40
    v_dot2_f32_bf16 v40, v107, v19, v40
    buffer_load_dwordx4 v[104:107], v4, s[60:63], s48 offen offset:1024 nt
    s_waitcnt vmcnt(12)
    v_dot2_f32_bf16 v41, v108, v16, 0
    v_dot2_f32_bf16 v41, v109, v17, v41
    v_dot2_f32_bf16 v41, v110, v18, v41
    v_dot2_f32_bf16 v41, v111, v19, v41
    buffer_load_dwordx4 v[108:111], v4, s[60:63], s48 offen offset:2048 nt
    s_waitcnt vmcnt(12)
    v_dot2_f32_bf16 v42, v112, v16, 0
    v_dot2_f32_bf16 v42, v113, v17, v42
    v_dot2_f32_bf16 v42, v114, v18, v42
    v_dot2_f32_bf16 v42, v115, v19, v42
    buffer_load_dwordx4 v[112:115], v4, s[60:63], s48 offen offset:3072 nt
    s_waitcnt vmcnt(12)
    v_dot2_f32_bf16 v43, v116, v16, 0
    v_dot2_f32_bf16 v43, v117, v17, v43
    v_dot2_f32_bf16 v43, v118, v18, v43
    v_dot2_f32_bf16 v43, v119, v19, v43
    s_add_u32 s48, s75, 622592
    buffer_load_dwordx4 v[116:119], v3, s[60:63], s48 offen offset:0 nt
    s_waitcnt vmcnt(12)
    v_dot2_f32_bf16 v44, v120, v16, 0
    v_dot2_f32_bf16 v44, v121, v17, v44
    v_dot2_f32_bf16 v44, v122, v18, v44
    v_dot2_f32_bf16 v44, v123, v19, v44
    buffer_load_dwordx4 v[120:123], v3, s[60:63], s48 offen offset:1024 nt
    s_waitcnt vmcnt(12)
    v_dot2_f32_bf16 v45, v124, v16, 0
    v_dot2_f32_bf16 v45, v125, v17, v45
    v_dot2_f32_bf16 v45, v126, v18, v45
    v_dot2_f32_bf16 v45, v127, v19, v45
    buffer_load_dwordx4 v[124:127], v3, s[60:63], s48 offen offset:2048 nt
    s_waitcnt vmcnt(12)
    v_dot2_f32_bf16 v46, v128, v16, 0
    v_dot2_f32_bf16 v46, v129, v17, v46
    v_dot2_f32_bf16 v46, v130, v18, v46
    v_dot2_f32_bf16 v46, v131, v19, v46
    buffer_load_dwordx4 v[128:131], v3, s[60:63], s48 offen offset:3072 nt
    s_waitcnt vmcnt(12)
    v_dot2_f32_bf16 v47, v132, v16, 0
    v_dot2_f32_bf16 v47, v133, v17, v47
    v_dot2_f32_bf16 v47, v134, v18, v47
    v_dot2_f32_bf16 v47, v135, v19, v47
    v_add_f32_dpp v32, v32, v32 row_ror:8 row_mask:0xf bank_mask:0x3
    s_nop 1
    v_add_f32_dpp v32, v40, v40 row_ror:8 row_mask:0xf bank_mask:0xc
    v_add_f32_dpp v33, v33, v33 row_ror:8 row_mask:0xf bank_mask:0x3
    s_nop 1
    v_add_f32_dpp v33, v41, v41 row_ror:8 row_mask:0xf bank_mask:0xc
    v_add_f32_dpp v34, v34, v34 row_ror:8 row_mask:0xf bank_mask:0x3
    s_nop 1
    v_add_f32_dpp v34, v42, v42 row_ror:8 row_mask:0xf bank_mask:0xc
    v_add_f32_dpp v35, v35, v35 row_ror:8 row_mask:0xf bank_mask:0x3
    s_nop 1
    v_add_f32_dpp v35, v43, v43 row_ror:8 row_mask:0xf bank_mask:0xc
    v_add_f32_dpp v36, v36, v36 row_ror:8 row_mask:0xf bank_mask:0x3
    s_nop 1
    v_add_f32_dpp v36, v44, v44 row_ror:8 row_mask:0xf bank_mask:0xc
    v_add_f32_dpp v37, v37, v37 row_ror:8 row_mask:0xf bank_mask:0x3
    s_nop 1
    v_add_f32_dpp v37, v45, v45 row_ror:8 row_mask:0xf bank_mask:0xc
    v_add_f32_dpp v38, v38, v38 row_ror:8 row_mask:0xf bank_mask:0x3
    s_nop 1
    v_add_f32_dpp v38, v46, v46 row_ror:8 row_mask:0xf bank_mask:0xc
    v_add_f32_dpp v39, v39, v39 row_ror:8 row_mask:0xf bank_mask:0x3
    s_nop 1
    v_add_f32_dpp v39, v47, v47 row_ror:8 row_mask:0xf bank_mask:0xc
    v_add_f32_dpp v32, v32, v32 row_shl:4 row_mask:0xf bank_mask:0x5
    s_nop 1
    v_add_f32_dpp v32, v36, v36 row_shr:4 row_mask:0xf bank_mask:0xa
    v_add_f32_dpp v33, v33, v33 row_shl:4 row_mask:0xf bank_mask:0x5
    s_nop 1
    v_add_f32_dpp v33, v37, v37 row_shr:4 row_mask:0xf bank_mask:0xa
    v_add_f32_dpp v34, v34, v34 row_shl:4 row_mask:0xf bank_mask:0x5
    s_nop 1
    v_add_f32_dpp v34, v38, v38 row_shr:4 row_mask:0xf bank_mask:0xa
    v_add_f32_dpp v35, v35, v35 row_shl:4 row_mask:0xf bank_mask:0x5
    s_nop 1
    v_add_f32_dpp v35, v39, v39 row_shr:4 row_mask:0xf bank_mask:0xa
    v_add_f32_dpp v32, v32, v32 quad_perm:[2,3,0,1] row_mask:0xf bank_mask:0xf
    v_add_f32_dpp v34, v34, v34 quad_perm:[2,3,0,1] row_mask:0xf bank_mask:0xf
    v_cndmask_b32 v32, v32, v34, s[68:69]
    v_add_f32_dpp v33, v33, v33 quad_perm:[2,3,0,1] row_mask:0xf bank_mask:0xf
    v_add_f32_dpp v35, v35, v35 quad_perm:[2,3,0,1] row_mask:0xf bank_mask:0xf
    v_cndmask_b32 v33, v33, v35, s[68:69]
    v_add_f32_dpp v32, v32, v32 quad_perm:[1,0,3,2] row_mask:0xf bank_mask:0xf
    s_nop 0
    v_add_f32_dpp v33, v33, v33 quad_perm:[1,0,3,2] row_mask:0xf bank_mask:0xf
    v_cndmask_b32 v56, v32, v33, s[70:71]
    v_cvt_pk_bf16_f32 v56, v56, v56
    v_lshlrev_b32 v56, 16, v56
    v_mul_f32 v56, s73, v56
    v_cvt_pk_bf16_f32 v56, v56, v56
    v_lshlrev_b32 v56, 16, v56
    buffer_load_dwordx4 v[132:135], v4, s[60:63], s48 offen offset:0 nt
    s_waitcnt vmcnt(12)
    v_dot2_f32_bf16 v32, v136, v16, 0
    v_dot2_f32_bf16 v32, v137, v17, v32
    v_dot2_f32_bf16 v32, v138, v18, v32
    v_dot2_f32_bf16 v32, v139, v19, v32
    buffer_load_dwordx4 v[136:139], v4, s[60:63], s48 offen offset:1024 nt
    s_waitcnt vmcnt(12)
    v_dot2_f32_bf16 v33, v88, v16, 0
    v_dot2_f32_bf16 v33, v89, v17, v33
    v_dot2_f32_bf16 v33, v90, v18, v33
    v_dot2_f32_bf16 v33, v91, v19, v33
    buffer_load_dwordx4 v[88:91], v4, s[60:63], s48 offen offset:2048 nt
    s_waitcnt vmcnt(12)
    v_dot2_f32_bf16 v34, v92, v16, 0
    v_dot2_f32_bf16 v34, v93, v17, v34
    v_dot2_f32_bf16 v34, v94, v18, v34
    v_dot2_f32_bf16 v34, v95, v19, v34
    buffer_load_dwordx4 v[92:95], v4, s[60:63], s48 offen offset:3072 nt
    s_waitcnt vmcnt(12)
    v_dot2_f32_bf16 v35, v96, v16, 0
    v_dot2_f32_bf16 v35, v97, v17, v35
    v_dot2_f32_bf16 v35, v98, v18, v35
    v_dot2_f32_bf16 v35, v99, v19, v35
    s_add_u32 s48, s75, 655360
    buffer_load_dwordx4 v[96:99], v3, s[60:63], s48 offen offset:0 nt
    s_waitcnt vmcnt(12)
    v_dot2_f32_bf16 v36, v100, v16, 0
    v_dot2_f32_bf16 v36, v101, v17, v36
    v_dot2_f32_bf16 v36, v102, v18, v36
    v_dot2_f32_bf16 v36, v103, v19, v36
    buffer_load_dwordx4 v[100:103], v3, s[60:63], s48 offen offset:1024 nt
    s_waitcnt vmcnt(12)
    v_dot2_f32_bf16 v37, v104, v16, 0
    v_dot2_f32_bf16 v37, v105, v17, v37
    v_dot2_f32_bf16 v37, v106, v18, v37
    v_dot2_f32_bf16 v37, v107, v19, v37
    buffer_load_dwordx4 v[104:107], v3, s[60:63], s48 offen offset:2048 nt
    s_waitcnt vmcnt(12)
    v_dot2_f32_bf16 v38, v108, v16, 0
    v_dot2_f32_bf16 v38, v109, v17, v38
    v_dot2_f32_bf16 v38, v110, v18, v38
    v_dot2_f32_bf16 v38, v111, v19, v38
    buffer_load_dwordx4 v[108:111], v3, s[60:63], s48 offen offset:3072 nt
    s_waitcnt vmcnt(12)
    v_dot2_f32_bf16 v39, v112, v16, 0
    v_dot2_f32_bf16 v39, v113, v17, v39
    v_dot2_f32_bf16 v39, v114, v18, v39
    v_dot2_f32_bf16 v39, v115, v19, v39
    buffer_load_dwordx4 v[112:115], v4, s[60:63], s48 offen offset:0 nt
    s_waitcnt vmcnt(12)
    v_dot2_f32_bf16 v40, v116, v16, 0
    v_dot2_f32_bf16 v40, v117, v17, v40
    v_dot2_f32_bf16 v40, v118, v18, v40
    v_dot2_f32_bf16 v40, v119, v19, v40
    buffer_load_dwordx4 v[116:119], v4, s[60:63], s48 offen offset:1024 nt
    s_waitcnt vmcnt(12)
    v_dot2_f32_bf16 v41, v120, v16, 0
    v_dot2_f32_bf16 v41, v121, v17, v41
    v_dot2_f32_bf16 v41, v122, v18, v41
    v_dot2_f32_bf16 v41, v123, v19, v41
    buffer_load_dwordx4 v[120:123], v4, s[60:63], s48 offen offset:2048 nt
    s_waitcnt vmcnt(12)
    v_dot2_f32_bf16 v42, v124, v16, 0
    v_dot2_f32_bf16 v42, v125, v17, v42
    v_dot2_f32_bf16 v42, v126, v18, v42
    v_dot2_f32_bf16 v42, v127, v19, v42
    buffer_load_dwordx4 v[124:127], v4, s[60:63], s48 offen offset:3072 nt
    s_waitcnt vmcnt(12)
    v_dot2_f32_bf16 v43, v128, v16, 0
    v_dot2_f32_bf16 v43, v129, v17, v43
    v_dot2_f32_bf16 v43, v130, v18, v43
    v_dot2_f32_bf16 v43, v131, v19, v43
    s_add_u32 s48, s75, 688128
    buffer_load_dwordx4 v[128:131], v3, s[60:63], s48 offen offset:0 nt
    s_waitcnt vmcnt(12)
    v_dot2_f32_bf16 v44, v132, v16, 0
    v_dot2_f32_bf16 v44, v133, v17, v44
    v_dot2_f32_bf16 v44, v134, v18, v44
    v_dot2_f32_bf16 v44, v135, v19, v44
    buffer_load_dwordx4 v[132:135], v3, s[60:63], s48 offen offset:1024 nt
    s_waitcnt vmcnt(12)
    v_dot2_f32_bf16 v45, v136, v16, 0
    v_dot2_f32_bf16 v45, v137, v17, v45
    v_dot2_f32_bf16 v45, v138, v18, v45
    v_dot2_f32_bf16 v45, v139, v19, v45
    buffer_load_dwordx4 v[136:139], v3, s[60:63], s48 offen offset:2048 nt
    s_waitcnt vmcnt(12)
    v_dot2_f32_bf16 v46, v88, v16, 0
    v_dot2_f32_bf16 v46, v89, v17, v46
    v_dot2_f32_bf16 v46, v90, v18, v46
    v_dot2_f32_bf16 v46, v91, v19, v46
    buffer_load_dwordx4 v[88:91], v3, s[60:63], s48 offen offset:3072 nt
    s_waitcnt vmcnt(12)
    v_dot2_f32_bf16 v47, v92, v16, 0
    v_dot2_f32_bf16 v47, v93, v17, v47
    v_dot2_f32_bf16 v47, v94, v18, v47
    v_dot2_f32_bf16 v47, v95, v19, v47
    v_add_f32_dpp v32, v32, v32 row_ror:8 row_mask:0xf bank_mask:0x3
    s_nop 1
    v_add_f32_dpp v32, v40, v40 row_ror:8 row_mask:0xf bank_mask:0xc
    v_add_f32_dpp v33, v33, v33 row_ror:8 row_mask:0xf bank_mask:0x3
    s_nop 1
    v_add_f32_dpp v33, v41, v41 row_ror:8 row_mask:0xf bank_mask:0xc
    v_add_f32_dpp v34, v34, v34 row_ror:8 row_mask:0xf bank_mask:0x3
    s_nop 1
    v_add_f32_dpp v34, v42, v42 row_ror:8 row_mask:0xf bank_mask:0xc
    v_add_f32_dpp v35, v35, v35 row_ror:8 row_mask:0xf bank_mask:0x3
    s_nop 1
    v_add_f32_dpp v35, v43, v43 row_ror:8 row_mask:0xf bank_mask:0xc
    v_add_f32_dpp v36, v36, v36 row_ror:8 row_mask:0xf bank_mask:0x3
    s_nop 1
    v_add_f32_dpp v36, v44, v44 row_ror:8 row_mask:0xf bank_mask:0xc
    v_add_f32_dpp v37, v37, v37 row_ror:8 row_mask:0xf bank_mask:0x3
    s_nop 1
    v_add_f32_dpp v37, v45, v45 row_ror:8 row_mask:0xf bank_mask:0xc
    v_add_f32_dpp v38, v38, v38 row_ror:8 row_mask:0xf bank_mask:0x3
    s_nop 1
    v_add_f32_dpp v38, v46, v46 row_ror:8 row_mask:0xf bank_mask:0xc
    v_add_f32_dpp v39, v39, v39 row_ror:8 row_mask:0xf bank_mask:0x3
    s_nop 1
    v_add_f32_dpp v39, v47, v47 row_ror:8 row_mask:0xf bank_mask:0xc
    v_add_f32_dpp v32, v32, v32 row_shl:4 row_mask:0xf bank_mask:0x5
    s_nop 1
    v_add_f32_dpp v32, v36, v36 row_shr:4 row_mask:0xf bank_mask:0xa
    v_add_f32_dpp v33, v33, v33 row_shl:4 row_mask:0xf bank_mask:0x5
    s_nop 1
    v_add_f32_dpp v33, v37, v37 row_shr:4 row_mask:0xf bank_mask:0xa
    v_add_f32_dpp v34, v34, v34 row_shl:4 row_mask:0xf bank_mask:0x5
    s_nop 1
    v_add_f32_dpp v34, v38, v38 row_shr:4 row_mask:0xf bank_mask:0xa
    v_add_f32_dpp v35, v35, v35 row_shl:4 row_mask:0xf bank_mask:0x5
    s_nop 1
    v_add_f32_dpp v35, v39, v39 row_shr:4 row_mask:0xf bank_mask:0xa
    v_add_f32_dpp v32, v32, v32 quad_perm:[2,3,0,1] row_mask:0xf bank_mask:0xf
    v_add_f32_dpp v34, v34, v34 quad_perm:[2,3,0,1] row_mask:0xf bank_mask:0xf
    v_cndmask_b32 v32, v32, v34, s[68:69]
    v_add_f32_dpp v33, v33, v33 quad_perm:[2,3,0,1] row_mask:0xf bank_mask:0xf
    v_add_f32_dpp v35, v35, v35 quad_perm:[2,3,0,1] row_mask:0xf bank_mask:0xf
    v_cndmask_b32 v33, v33, v35, s[68:69]
    v_add_f32_dpp v32, v32, v32 quad_perm:[1,0,3,2] row_mask:0xf bank_mask:0xf
    s_nop 0
    v_add_f32_dpp v33, v33, v33 quad_perm:[1,0,3,2] row_mask:0xf bank_mask:0xf
    v_cndmask_b32 v57, v32, v33, s[70:71]
    v_cvt_pk_bf16_f32 v57, v57, v57
    v_lshlrev_b32 v57, 16, v57
    v_mul_f32 v57, s73, v57
    v_cvt_pk_bf16_f32 v57, v57, v57
    v_lshlrev_b32 v57, 16, v57
    buffer_load_dwordx4 v[92:95], v4, s[60:63], s48 offen offset:0 nt
    s_waitcnt vmcnt(12)
    v_dot2_f32_bf16 v32, v96, v16, 0
    v_dot2_f32_bf16 v32, v97, v17, v32
    v_dot2_f32_bf16 v32, v98, v18, v32
    v_dot2_f32_bf16 v32, v99, v19, v32
    buffer_load_dwordx4 v[96:99], v4, s[60:63], s48 offen offset:1024 nt
    s_waitcnt vmcnt(12)
    v_dot2_f32_bf16 v33, v100, v16, 0
    v_dot2_f32_bf16 v33, v101, v17, v33
    v_dot2_f32_bf16 v33, v102, v18, v33
    v_dot2_f32_bf16 v33, v103, v19, v33
    buffer_load_dwordx4 v[100:103], v4, s[60:63], s48 offen offset:2048 nt
    s_waitcnt vmcnt(12)
    v_dot2_f32_bf16 v34, v104, v16, 0
    v_dot2_f32_bf16 v34, v105, v17, v34
    v_dot2_f32_bf16 v34, v106, v18, v34
    v_dot2_f32_bf16 v34, v107, v19, v34
    buffer_load_dwordx4 v[104:107], v4, s[60:63], s48 offen offset:3072 nt
    s_waitcnt vmcnt(12)
    v_dot2_f32_bf16 v35, v108, v16, 0
    v_dot2_f32_bf16 v35, v109, v17, v35
    v_dot2_f32_bf16 v35, v110, v18, v35
    v_dot2_f32_bf16 v35, v111, v19, v35
    s_add_u32 s48, s75, 720896
    buffer_load_dwordx4 v[108:111], v3, s[60:63], s48 offen offset:0 nt
    s_waitcnt vmcnt(12)
    v_dot2_f32_bf16 v36, v112, v16, 0
    v_dot2_f32_bf16 v36, v113, v17, v36
    v_dot2_f32_bf16 v36, v114, v18, v36
    v_dot2_f32_bf16 v36, v115, v19, v36
    buffer_load_dwordx4 v[112:115], v3, s[60:63], s48 offen offset:1024 nt
    s_waitcnt vmcnt(12)
    v_dot2_f32_bf16 v37, v116, v16, 0
    v_dot2_f32_bf16 v37, v117, v17, v37
    v_dot2_f32_bf16 v37, v118, v18, v37
    v_dot2_f32_bf16 v37, v119, v19, v37
    buffer_load_dwordx4 v[116:119], v3, s[60:63], s48 offen offset:2048 nt
    s_waitcnt vmcnt(12)
    v_dot2_f32_bf16 v38, v120, v16, 0
    v_dot2_f32_bf16 v38, v121, v17, v38
    v_dot2_f32_bf16 v38, v122, v18, v38
    v_dot2_f32_bf16 v38, v123, v19, v38
    buffer_load_dwordx4 v[120:123], v3, s[60:63], s48 offen offset:3072 nt
    s_waitcnt vmcnt(12)
    v_dot2_f32_bf16 v39, v124, v16, 0
    v_dot2_f32_bf16 v39, v125, v17, v39
    v_dot2_f32_bf16 v39, v126, v18, v39
    v_dot2_f32_bf16 v39, v127, v19, v39
    buffer_load_dwordx4 v[124:127], v4, s[60:63], s48 offen offset:0 nt
    s_waitcnt vmcnt(12)
    v_dot2_f32_bf16 v40, v128, v16, 0
    v_dot2_f32_bf16 v40, v129, v17, v40
    v_dot2_f32_bf16 v40, v130, v18, v40
    v_dot2_f32_bf16 v40, v131, v19, v40
    buffer_load_dwordx4 v[128:131], v4, s[60:63], s48 offen offset:1024 nt
    s_waitcnt vmcnt(12)
    v_dot2_f32_bf16 v41, v132, v16, 0
    v_dot2_f32_bf16 v41, v133, v17, v41
    v_dot2_f32_bf16 v41, v134, v18, v41
    v_dot2_f32_bf16 v41, v135, v19, v41
    buffer_load_dwordx4 v[132:135], v4, s[60:63], s48 offen offset:2048 nt
    s_waitcnt vmcnt(12)
    v_dot2_f32_bf16 v42, v136, v16, 0
    v_dot2_f32_bf16 v42, v137, v17, v42
    v_dot2_f32_bf16 v42, v138, v18, v42
    v_dot2_f32_bf16 v42, v139, v19, v42
    buffer_load_dwordx4 v[136:139], v4, s[60:63], s48 offen offset:3072 nt
    s_waitcnt vmcnt(12)
    v_dot2_f32_bf16 v43, v88, v16, 0
    v_dot2_f32_bf16 v43, v89, v17, v43
    v_dot2_f32_bf16 v43, v90, v18, v43
    v_dot2_f32_bf16 v43, v91, v19, v43
    s_add_u32 s48, s75, 753664
    buffer_load_dwordx4 v[88:91], v3, s[60:63], s48 offen offset:0 nt
    s_waitcnt vmcnt(12)
    v_dot2_f32_bf16 v44, v92, v16, 0
    v_dot2_f32_bf16 v44, v93, v17, v44
    v_dot2_f32_bf16 v44, v94, v18, v44
    v_dot2_f32_bf16 v44, v95, v19, v44
    buffer_load_dwordx4 v[92:95], v3, s[60:63], s48 offen offset:1024 nt
    s_waitcnt vmcnt(12)
    v_dot2_f32_bf16 v45, v96, v16, 0
    v_dot2_f32_bf16 v45, v97, v17, v45
    v_dot2_f32_bf16 v45, v98, v18, v45
    v_dot2_f32_bf16 v45, v99, v19, v45
    buffer_load_dwordx4 v[96:99], v3, s[60:63], s48 offen offset:2048 nt
    s_waitcnt vmcnt(12)
    v_dot2_f32_bf16 v46, v100, v16, 0
    v_dot2_f32_bf16 v46, v101, v17, v46
    v_dot2_f32_bf16 v46, v102, v18, v46
    v_dot2_f32_bf16 v46, v103, v19, v46
    buffer_load_dwordx4 v[100:103], v3, s[60:63], s48 offen offset:3072 nt
    s_waitcnt vmcnt(12)
    v_dot2_f32_bf16 v47, v104, v16, 0
    v_dot2_f32_bf16 v47, v105, v17, v47
    v_dot2_f32_bf16 v47, v106, v18, v47
    v_dot2_f32_bf16 v47, v107, v19, v47
    v_add_f32_dpp v32, v32, v32 row_ror:8 row_mask:0xf bank_mask:0x3
    s_nop 1
    v_add_f32_dpp v32, v40, v40 row_ror:8 row_mask:0xf bank_mask:0xc
    v_add_f32_dpp v33, v33, v33 row_ror:8 row_mask:0xf bank_mask:0x3
    s_nop 1
    v_add_f32_dpp v33, v41, v41 row_ror:8 row_mask:0xf bank_mask:0xc
    v_add_f32_dpp v34, v34, v34 row_ror:8 row_mask:0xf bank_mask:0x3
    s_nop 1
    v_add_f32_dpp v34, v42, v42 row_ror:8 row_mask:0xf bank_mask:0xc
    v_add_f32_dpp v35, v35, v35 row_ror:8 row_mask:0xf bank_mask:0x3
    s_nop 1
    v_add_f32_dpp v35, v43, v43 row_ror:8 row_mask:0xf bank_mask:0xc
    v_add_f32_dpp v36, v36, v36 row_ror:8 row_mask:0xf bank_mask:0x3
    s_nop 1
    v_add_f32_dpp v36, v44, v44 row_ror:8 row_mask:0xf bank_mask:0xc
    v_add_f32_dpp v37, v37, v37 row_ror:8 row_mask:0xf bank_mask:0x3
    s_nop 1
    v_add_f32_dpp v37, v45, v45 row_ror:8 row_mask:0xf bank_mask:0xc
    v_add_f32_dpp v38, v38, v38 row_ror:8 row_mask:0xf bank_mask:0x3
    s_nop 1
    v_add_f32_dpp v38, v46, v46 row_ror:8 row_mask:0xf bank_mask:0xc
    v_add_f32_dpp v39, v39, v39 row_ror:8 row_mask:0xf bank_mask:0x3
    s_nop 1
    v_add_f32_dpp v39, v47, v47 row_ror:8 row_mask:0xf bank_mask:0xc
    v_add_f32_dpp v32, v32, v32 row_shl:4 row_mask:0xf bank_mask:0x5
    s_nop 1
    v_add_f32_dpp v32, v36, v36 row_shr:4 row_mask:0xf bank_mask:0xa
    v_add_f32_dpp v33, v33, v33 row_shl:4 row_mask:0xf bank_mask:0x5
    s_nop 1
    v_add_f32_dpp v33, v37, v37 row_shr:4 row_mask:0xf bank_mask:0xa
    v_add_f32_dpp v34, v34, v34 row_shl:4 row_mask:0xf bank_mask:0x5
    s_nop 1
    v_add_f32_dpp v34, v38, v38 row_shr:4 row_mask:0xf bank_mask:0xa
    v_add_f32_dpp v35, v35, v35 row_shl:4 row_mask:0xf bank_mask:0x5
    s_nop 1
    v_add_f32_dpp v35, v39, v39 row_shr:4 row_mask:0xf bank_mask:0xa
    v_add_f32_dpp v32, v32, v32 quad_perm:[2,3,0,1] row_mask:0xf bank_mask:0xf
    v_add_f32_dpp v34, v34, v34 quad_perm:[2,3,0,1] row_mask:0xf bank_mask:0xf
    v_cndmask_b32 v32, v32, v34, s[68:69]
    v_add_f32_dpp v33, v33, v33 quad_perm:[2,3,0,1] row_mask:0xf bank_mask:0xf
    v_add_f32_dpp v35, v35, v35 quad_perm:[2,3,0,1] row_mask:0xf bank_mask:0xf
    v_cndmask_b32 v33, v33, v35, s[68:69]
    v_add_f32_dpp v32, v32, v32 quad_perm:[1,0,3,2] row_mask:0xf bank_mask:0xf
    s_nop 0
    v_add_f32_dpp v33, v33, v33 quad_perm:[1,0,3,2] row_mask:0xf bank_mask:0xf
    v_cndmask_b32 v58, v32, v33, s[70:71]
    v_cvt_pk_bf16_f32 v58, v58, v58
    v_lshlrev_b32 v58, 16, v58
    v_mul_f32 v58, s73, v58
    v_cvt_pk_bf16_f32 v58, v58, v58
    v_lshlrev_b32 v58, 16, v58
    buffer_load_dwordx4 v[104:107], v4, s[60:63], s48 offen offset:0 nt
    s_waitcnt vmcnt(12)
    v_dot2_f32_bf16 v32, v108, v16, 0
    v_dot2_f32_bf16 v32, v109, v17, v32
    v_dot2_f32_bf16 v32, v110, v18, v32
    v_dot2_f32_bf16 v32, v111, v19, v32
    buffer_load_dwordx4 v[108:111], v4, s[60:63], s48 offen offset:1024 nt
    s_waitcnt vmcnt(12)
    v_dot2_f32_bf16 v33, v112, v16, 0
    v_dot2_f32_bf16 v33, v113, v17, v33
    v_dot2_f32_bf16 v33, v114, v18, v33
    v_dot2_f32_bf16 v33, v115, v19, v33
    buffer_load_dwordx4 v[112:115], v4, s[60:63], s48 offen offset:2048 nt
    s_waitcnt vmcnt(12)
    v_dot2_f32_bf16 v34, v116, v16, 0
    v_dot2_f32_bf16 v34, v117, v17, v34
    v_dot2_f32_bf16 v34, v118, v18, v34
    v_dot2_f32_bf16 v34, v119, v19, v34
    buffer_load_dwordx4 v[116:119], v4, s[60:63], s48 offen offset:3072 nt
    s_waitcnt vmcnt(12)
    v_dot2_f32_bf16 v35, v120, v16, 0
    v_dot2_f32_bf16 v35, v121, v17, v35
    v_dot2_f32_bf16 v35, v122, v18, v35
    v_dot2_f32_bf16 v35, v123, v19, v35
    s_add_u32 s48, s75, 786432
    buffer_load_dwordx4 v[120:123], v3, s[60:63], s48 offen offset:0 nt
    s_waitcnt vmcnt(12)
    v_dot2_f32_bf16 v36, v124, v16, 0
    v_dot2_f32_bf16 v36, v125, v17, v36
    v_dot2_f32_bf16 v36, v126, v18, v36
    v_dot2_f32_bf16 v36, v127, v19, v36
    buffer_load_dwordx4 v[124:127], v3, s[60:63], s48 offen offset:1024 nt
    s_waitcnt vmcnt(12)
    v_dot2_f32_bf16 v37, v128, v16, 0
    v_dot2_f32_bf16 v37, v129, v17, v37
    v_dot2_f32_bf16 v37, v130, v18, v37
    v_dot2_f32_bf16 v37, v131, v19, v37
    buffer_load_dwordx4 v[128:131], v3, s[60:63], s48 offen offset:2048 nt
    s_waitcnt vmcnt(12)
    v_dot2_f32_bf16 v38, v132, v16, 0
    v_dot2_f32_bf16 v38, v133, v17, v38
    v_dot2_f32_bf16 v38, v134, v18, v38
    v_dot2_f32_bf16 v38, v135, v19, v38
    buffer_load_dwordx4 v[132:135], v3, s[60:63], s48 offen offset:3072 nt
    s_waitcnt vmcnt(12)
    v_dot2_f32_bf16 v39, v136, v16, 0
    v_dot2_f32_bf16 v39, v137, v17, v39
    v_dot2_f32_bf16 v39, v138, v18, v39
    v_dot2_f32_bf16 v39, v139, v19, v39
    buffer_load_dwordx4 v[136:139], v4, s[60:63], s48 offen offset:0 nt
    s_waitcnt vmcnt(12)
    v_dot2_f32_bf16 v40, v88, v16, 0
    v_dot2_f32_bf16 v40, v89, v17, v40
    v_dot2_f32_bf16 v40, v90, v18, v40
    v_dot2_f32_bf16 v40, v91, v19, v40
    buffer_load_dwordx4 v[88:91], v4, s[60:63], s48 offen offset:1024 nt
    s_waitcnt vmcnt(12)
    v_dot2_f32_bf16 v41, v92, v16, 0
    v_dot2_f32_bf16 v41, v93, v17, v41
    v_dot2_f32_bf16 v41, v94, v18, v41
    v_dot2_f32_bf16 v41, v95, v19, v41
    buffer_load_dwordx4 v[92:95], v4, s[60:63], s48 offen offset:2048 nt
    s_waitcnt vmcnt(12)
    v_dot2_f32_bf16 v42, v96, v16, 0
    v_dot2_f32_bf16 v42, v97, v17, v42
    v_dot2_f32_bf16 v42, v98, v18, v42
    v_dot2_f32_bf16 v42, v99, v19, v42
    buffer_load_dwordx4 v[96:99], v4, s[60:63], s48 offen offset:3072 nt
    s_waitcnt vmcnt(12)
    v_dot2_f32_bf16 v43, v100, v16, 0
    v_dot2_f32_bf16 v43, v101, v17, v43
    v_dot2_f32_bf16 v43, v102, v18, v43
    v_dot2_f32_bf16 v43, v103, v19, v43
    s_add_u32 s48, s75, 819200
    buffer_load_dwordx4 v[100:103], v3, s[60:63], s48 offen offset:0 nt
    s_waitcnt vmcnt(12)
    v_dot2_f32_bf16 v44, v104, v16, 0
    v_dot2_f32_bf16 v44, v105, v17, v44
    v_dot2_f32_bf16 v44, v106, v18, v44
    v_dot2_f32_bf16 v44, v107, v19, v44
    buffer_load_dwordx4 v[104:107], v3, s[60:63], s48 offen offset:1024 nt
    s_waitcnt vmcnt(12)
    v_dot2_f32_bf16 v45, v108, v16, 0
    v_dot2_f32_bf16 v45, v109, v17, v45
    v_dot2_f32_bf16 v45, v110, v18, v45
    v_dot2_f32_bf16 v45, v111, v19, v45
    buffer_load_dwordx4 v[108:111], v3, s[60:63], s48 offen offset:2048 nt
    s_waitcnt vmcnt(12)
    v_dot2_f32_bf16 v46, v112, v16, 0
    v_dot2_f32_bf16 v46, v113, v17, v46
    v_dot2_f32_bf16 v46, v114, v18, v46
    v_dot2_f32_bf16 v46, v115, v19, v46
    buffer_load_dwordx4 v[112:115], v3, s[60:63], s48 offen offset:3072 nt
    s_waitcnt vmcnt(12)
    v_dot2_f32_bf16 v47, v116, v16, 0
    v_dot2_f32_bf16 v47, v117, v17, v47
    v_dot2_f32_bf16 v47, v118, v18, v47
    v_dot2_f32_bf16 v47, v119, v19, v47
    v_add_f32_dpp v32, v32, v32 row_ror:8 row_mask:0xf bank_mask:0x3
    s_nop 1
    v_add_f32_dpp v32, v40, v40 row_ror:8 row_mask:0xf bank_mask:0xc
    v_add_f32_dpp v33, v33, v33 row_ror:8 row_mask:0xf bank_mask:0x3
    s_nop 1
    v_add_f32_dpp v33, v41, v41 row_ror:8 row_mask:0xf bank_mask:0xc
    v_add_f32_dpp v34, v34, v34 row_ror:8 row_mask:0xf bank_mask:0x3
    s_nop 1
    v_add_f32_dpp v34, v42, v42 row_ror:8 row_mask:0xf bank_mask:0xc
    v_add_f32_dpp v35, v35, v35 row_ror:8 row_mask:0xf bank_mask:0x3
    s_nop 1
    v_add_f32_dpp v35, v43, v43 row_ror:8 row_mask:0xf bank_mask:0xc
    v_add_f32_dpp v36, v36, v36 row_ror:8 row_mask:0xf bank_mask:0x3
    s_nop 1
    v_add_f32_dpp v36, v44, v44 row_ror:8 row_mask:0xf bank_mask:0xc
    v_add_f32_dpp v37, v37, v37 row_ror:8 row_mask:0xf bank_mask:0x3
    s_nop 1
    v_add_f32_dpp v37, v45, v45 row_ror:8 row_mask:0xf bank_mask:0xc
    v_add_f32_dpp v38, v38, v38 row_ror:8 row_mask:0xf bank_mask:0x3
    s_nop 1
    v_add_f32_dpp v38, v46, v46 row_ror:8 row_mask:0xf bank_mask:0xc
    v_add_f32_dpp v39, v39, v39 row_ror:8 row_mask:0xf bank_mask:0x3
    s_nop 1
    v_add_f32_dpp v39, v47, v47 row_ror:8 row_mask:0xf bank_mask:0xc
    v_add_f32_dpp v32, v32, v32 row_shl:4 row_mask:0xf bank_mask:0x5
    s_nop 1
    v_add_f32_dpp v32, v36, v36 row_shr:4 row_mask:0xf bank_mask:0xa
    v_add_f32_dpp v33, v33, v33 row_shl:4 row_mask:0xf bank_mask:0x5
    s_nop 1
    v_add_f32_dpp v33, v37, v37 row_shr:4 row_mask:0xf bank_mask:0xa
    v_add_f32_dpp v34, v34, v34 row_shl:4 row_mask:0xf bank_mask:0x5
    s_nop 1
    v_add_f32_dpp v34, v38, v38 row_shr:4 row_mask:0xf bank_mask:0xa
    v_add_f32_dpp v35, v35, v35 row_shl:4 row_mask:0xf bank_mask:0x5
    s_nop 1
    v_add_f32_dpp v35, v39, v39 row_shr:4 row_mask:0xf bank_mask:0xa
    v_add_f32_dpp v32, v32, v32 quad_perm:[2,3,0,1] row_mask:0xf bank_mask:0xf
    v_add_f32_dpp v34, v34, v34 quad_perm:[2,3,0,1] row_mask:0xf bank_mask:0xf
    v_cndmask_b32 v32, v32, v34, s[68:69]
    v_add_f32_dpp v33, v33, v33 quad_perm:[2,3,0,1] row_mask:0xf bank_mask:0xf
    v_add_f32_dpp v35, v35, v35 quad_perm:[2,3,0,1] row_mask:0xf bank_mask:0xf
    v_cndmask_b32 v33, v33, v35, s[68:69]
    v_add_f32_dpp v32, v32, v32 quad_perm:[1,0,3,2] row_mask:0xf bank_mask:0xf
    s_nop 0
    v_add_f32_dpp v33, v33, v33 quad_perm:[1,0,3,2] row_mask:0xf bank_mask:0xf
    v_cndmask_b32 v59, v32, v33, s[70:71]
    v_cvt_pk_bf16_f32 v59, v59, v59
    v_lshlrev_b32 v59, 16, v59
    v_mul_f32 v59, s73, v59
    v_cvt_pk_bf16_f32 v59, v59, v59
    v_lshlrev_b32 v59, 16, v59
    buffer_load_dwordx4 v[116:119], v4, s[60:63], s48 offen offset:0 nt
    s_waitcnt vmcnt(12)
    v_dot2_f32_bf16 v32, v120, v16, 0
    v_dot2_f32_bf16 v32, v121, v17, v32
    v_dot2_f32_bf16 v32, v122, v18, v32
    v_dot2_f32_bf16 v32, v123, v19, v32
    buffer_load_dwordx4 v[120:123], v4, s[60:63], s48 offen offset:1024 nt
    s_waitcnt vmcnt(12)
    v_dot2_f32_bf16 v33, v124, v16, 0
    v_dot2_f32_bf16 v33, v125, v17, v33
    v_dot2_f32_bf16 v33, v126, v18, v33
    v_dot2_f32_bf16 v33, v127, v19, v33
    buffer_load_dwordx4 v[124:127], v4, s[60:63], s48 offen offset:2048 nt
    s_waitcnt vmcnt(12)
    v_dot2_f32_bf16 v34, v128, v16, 0
    v_dot2_f32_bf16 v34, v129, v17, v34
    v_dot2_f32_bf16 v34, v130, v18, v34
    v_dot2_f32_bf16 v34, v131, v19, v34
    buffer_load_dwordx4 v[128:131], v4, s[60:63], s48 offen offset:3072 nt
    s_waitcnt vmcnt(12)
    v_dot2_f32_bf16 v35, v132, v16, 0
    v_dot2_f32_bf16 v35, v133, v17, v35
    v_dot2_f32_bf16 v35, v134, v18, v35
    v_dot2_f32_bf16 v35, v135, v19, v35
    s_add_u32 s48, s75, 851968
    buffer_load_dwordx4 v[132:135], v3, s[60:63], s48 offen offset:0 nt
    s_waitcnt vmcnt(12)
    v_dot2_f32_bf16 v36, v136, v16, 0
    v_dot2_f32_bf16 v36, v137, v17, v36
    v_dot2_f32_bf16 v36, v138, v18, v36
    v_dot2_f32_bf16 v36, v139, v19, v36
    buffer_load_dwordx4 v[136:139], v3, s[60:63], s48 offen offset:1024 nt
    s_waitcnt vmcnt(12)
    v_dot2_f32_bf16 v37, v88, v16, 0
    v_dot2_f32_bf16 v37, v89, v17, v37
    v_dot2_f32_bf16 v37, v90, v18, v37
    v_dot2_f32_bf16 v37, v91, v19, v37
    buffer_load_dwordx4 v[88:91], v3, s[60:63], s48 offen offset:2048 nt
    s_waitcnt vmcnt(12)
    v_dot2_f32_bf16 v38, v92, v16, 0
    v_dot2_f32_bf16 v38, v93, v17, v38
    v_dot2_f32_bf16 v38, v94, v18, v38
    v_dot2_f32_bf16 v38, v95, v19, v38
    buffer_load_dwordx4 v[92:95], v3, s[60:63], s48 offen offset:3072 nt
    s_waitcnt vmcnt(12)
    v_dot2_f32_bf16 v39, v96, v16, 0
    v_dot2_f32_bf16 v39, v97, v17, v39
    v_dot2_f32_bf16 v39, v98, v18, v39
    v_dot2_f32_bf16 v39, v99, v19, v39
    buffer_load_dwordx4 v[96:99], v4, s[60:63], s48 offen offset:0 nt
    s_waitcnt vmcnt(12)
    v_dot2_f32_bf16 v40, v100, v16, 0
    v_dot2_f32_bf16 v40, v101, v17, v40
    v_dot2_f32_bf16 v40, v102, v18, v40
    v_dot2_f32_bf16 v40, v103, v19, v40
    buffer_load_dwordx4 v[100:103], v4, s[60:63], s48 offen offset:1024 nt
    s_waitcnt vmcnt(12)
    v_dot2_f32_bf16 v41, v104, v16, 0
    v_dot2_f32_bf16 v41, v105, v17, v41
    v_dot2_f32_bf16 v41, v106, v18, v41
    v_dot2_f32_bf16 v41, v107, v19, v41
    buffer_load_dwordx4 v[104:107], v4, s[60:63], s48 offen offset:2048 nt
    s_waitcnt vmcnt(12)
    v_dot2_f32_bf16 v42, v108, v16, 0
    v_dot2_f32_bf16 v42, v109, v17, v42
    v_dot2_f32_bf16 v42, v110, v18, v42
    v_dot2_f32_bf16 v42, v111, v19, v42
    buffer_load_dwordx4 v[108:111], v4, s[60:63], s48 offen offset:3072 nt
    s_waitcnt vmcnt(12)
    v_dot2_f32_bf16 v43, v112, v16, 0
    v_dot2_f32_bf16 v43, v113, v17, v43
    v_dot2_f32_bf16 v43, v114, v18, v43
    v_dot2_f32_bf16 v43, v115, v19, v43
    s_add_u32 s48, s75, 884736
    buffer_load_dwordx4 v[112:115], v3, s[60:63], s48 offen offset:0 nt
    s_waitcnt vmcnt(12)
    v_dot2_f32_bf16 v44, v116, v16, 0
    v_dot2_f32_bf16 v44, v117, v17, v44
    v_dot2_f32_bf16 v44, v118, v18, v44
    v_dot2_f32_bf16 v44, v119, v19, v44
    buffer_load_dwordx4 v[116:119], v3, s[60:63], s48 offen offset:1024 nt
    s_waitcnt vmcnt(12)
    v_dot2_f32_bf16 v45, v120, v16, 0
    v_dot2_f32_bf16 v45, v121, v17, v45
    v_dot2_f32_bf16 v45, v122, v18, v45
    v_dot2_f32_bf16 v45, v123, v19, v45
    buffer_load_dwordx4 v[120:123], v3, s[60:63], s48 offen offset:2048 nt
    s_waitcnt vmcnt(12)
    v_dot2_f32_bf16 v46, v124, v16, 0
    v_dot2_f32_bf16 v46, v125, v17, v46
    v_dot2_f32_bf16 v46, v126, v18, v46
    v_dot2_f32_bf16 v46, v127, v19, v46
    buffer_load_dwordx4 v[124:127], v3, s[60:63], s48 offen offset:3072 nt
    s_waitcnt vmcnt(12)
    v_dot2_f32_bf16 v47, v128, v16, 0
    v_dot2_f32_bf16 v47, v129, v17, v47
    v_dot2_f32_bf16 v47, v130, v18, v47
    v_dot2_f32_bf16 v47, v131, v19, v47
    v_add_f32_dpp v32, v32, v32 row_ror:8 row_mask:0xf bank_mask:0x3
    s_nop 1
    v_add_f32_dpp v32, v40, v40 row_ror:8 row_mask:0xf bank_mask:0xc
    v_add_f32_dpp v33, v33, v33 row_ror:8 row_mask:0xf bank_mask:0x3
    s_nop 1
    v_add_f32_dpp v33, v41, v41 row_ror:8 row_mask:0xf bank_mask:0xc
    v_add_f32_dpp v34, v34, v34 row_ror:8 row_mask:0xf bank_mask:0x3
    s_nop 1
    v_add_f32_dpp v34, v42, v42 row_ror:8 row_mask:0xf bank_mask:0xc
    v_add_f32_dpp v35, v35, v35 row_ror:8 row_mask:0xf bank_mask:0x3
    s_nop 1
    v_add_f32_dpp v35, v43, v43 row_ror:8 row_mask:0xf bank_mask:0xc
    v_add_f32_dpp v36, v36, v36 row_ror:8 row_mask:0xf bank_mask:0x3
    s_nop 1
    v_add_f32_dpp v36, v44, v44 row_ror:8 row_mask:0xf bank_mask:0xc
    v_add_f32_dpp v37, v37, v37 row_ror:8 row_mask:0xf bank_mask:0x3
    s_nop 1
    v_add_f32_dpp v37, v45, v45 row_ror:8 row_mask:0xf bank_mask:0xc
    v_add_f32_dpp v38, v38, v38 row_ror:8 row_mask:0xf bank_mask:0x3
    s_nop 1
    v_add_f32_dpp v38, v46, v46 row_ror:8 row_mask:0xf bank_mask:0xc
    v_add_f32_dpp v39, v39, v39 row_ror:8 row_mask:0xf bank_mask:0x3
    s_nop 1
    v_add_f32_dpp v39, v47, v47 row_ror:8 row_mask:0xf bank_mask:0xc
    v_add_f32_dpp v32, v32, v32 row_shl:4 row_mask:0xf bank_mask:0x5
    s_nop 1
    v_add_f32_dpp v32, v36, v36 row_shr:4 row_mask:0xf bank_mask:0xa
    v_add_f32_dpp v33, v33, v33 row_shl:4 row_mask:0xf bank_mask:0x5
    s_nop 1
    v_add_f32_dpp v33, v37, v37 row_shr:4 row_mask:0xf bank_mask:0xa
    v_add_f32_dpp v34, v34, v34 row_shl:4 row_mask:0xf bank_mask:0x5
    s_nop 1
    v_add_f32_dpp v34, v38, v38 row_shr:4 row_mask:0xf bank_mask:0xa
    v_add_f32_dpp v35, v35, v35 row_shl:4 row_mask:0xf bank_mask:0x5
    s_nop 1
    v_add_f32_dpp v35, v39, v39 row_shr:4 row_mask:0xf bank_mask:0xa
    v_add_f32_dpp v32, v32, v32 quad_perm:[2,3,0,1] row_mask:0xf bank_mask:0xf
    v_add_f32_dpp v34, v34, v34 quad_perm:[2,3,0,1] row_mask:0xf bank_mask:0xf
    v_cndmask_b32 v32, v32, v34, s[68:69]
    v_add_f32_dpp v33, v33, v33 quad_perm:[2,3,0,1] row_mask:0xf bank_mask:0xf
    v_add_f32_dpp v35, v35, v35 quad_perm:[2,3,0,1] row_mask:0xf bank_mask:0xf
    v_cndmask_b32 v33, v33, v35, s[68:69]
    v_add_f32_dpp v32, v32, v32 quad_perm:[1,0,3,2] row_mask:0xf bank_mask:0xf
    s_nop 0
    v_add_f32_dpp v33, v33, v33 quad_perm:[1,0,3,2] row_mask:0xf bank_mask:0xf
    v_cndmask_b32 v60, v32, v33, s[70:71]
    v_cvt_pk_bf16_f32 v60, v60, v60
    v_lshlrev_b32 v60, 16, v60
    v_mul_f32 v60, s73, v60
    v_cvt_pk_bf16_f32 v60, v60, v60
    v_lshlrev_b32 v60, 16, v60
    buffer_load_dwordx4 v[128:131], v4, s[60:63], s48 offen offset:0 nt
    s_waitcnt vmcnt(12)
    v_dot2_f32_bf16 v32, v132, v16, 0
    v_dot2_f32_bf16 v32, v133, v17, v32
    v_dot2_f32_bf16 v32, v134, v18, v32
    v_dot2_f32_bf16 v32, v135, v19, v32
    buffer_load_dwordx4 v[132:135], v4, s[60:63], s48 offen offset:1024 nt
    s_waitcnt vmcnt(12)
    v_dot2_f32_bf16 v33, v136, v16, 0
    v_dot2_f32_bf16 v33, v137, v17, v33
    v_dot2_f32_bf16 v33, v138, v18, v33
    v_dot2_f32_bf16 v33, v139, v19, v33
    buffer_load_dwordx4 v[136:139], v4, s[60:63], s48 offen offset:2048 nt
    s_waitcnt vmcnt(12)
    v_dot2_f32_bf16 v34, v88, v16, 0
    v_dot2_f32_bf16 v34, v89, v17, v34
    v_dot2_f32_bf16 v34, v90, v18, v34
    v_dot2_f32_bf16 v34, v91, v19, v34
    buffer_load_dwordx4 v[88:91], v4, s[60:63], s48 offen offset:3072 nt
    s_waitcnt vmcnt(12)
    v_dot2_f32_bf16 v35, v92, v16, 0
    v_dot2_f32_bf16 v35, v93, v17, v35
    v_dot2_f32_bf16 v35, v94, v18, v35
    v_dot2_f32_bf16 v35, v95, v19, v35
    s_add_u32 s48, s75, 917504
    buffer_load_dwordx4 v[92:95], v3, s[60:63], s48 offen offset:0 nt
    s_waitcnt vmcnt(12)
    v_dot2_f32_bf16 v36, v96, v16, 0
    v_dot2_f32_bf16 v36, v97, v17, v36
    v_dot2_f32_bf16 v36, v98, v18, v36
    v_dot2_f32_bf16 v36, v99, v19, v36
    buffer_load_dwordx4 v[96:99], v3, s[60:63], s48 offen offset:1024 nt
    s_waitcnt vmcnt(12)
    v_dot2_f32_bf16 v37, v100, v16, 0
    v_dot2_f32_bf16 v37, v101, v17, v37
    v_dot2_f32_bf16 v37, v102, v18, v37
    v_dot2_f32_bf16 v37, v103, v19, v37
    buffer_load_dwordx4 v[100:103], v3, s[60:63], s48 offen offset:2048 nt
    s_waitcnt vmcnt(12)
    v_dot2_f32_bf16 v38, v104, v16, 0
    v_dot2_f32_bf16 v38, v105, v17, v38
    v_dot2_f32_bf16 v38, v106, v18, v38
    v_dot2_f32_bf16 v38, v107, v19, v38
    buffer_load_dwordx4 v[104:107], v3, s[60:63], s48 offen offset:3072 nt
    s_waitcnt vmcnt(12)
    v_dot2_f32_bf16 v39, v108, v16, 0
    v_dot2_f32_bf16 v39, v109, v17, v39
    v_dot2_f32_bf16 v39, v110, v18, v39
    v_dot2_f32_bf16 v39, v111, v19, v39
    buffer_load_dwordx4 v[108:111], v4, s[60:63], s48 offen offset:0 nt
    s_waitcnt vmcnt(12)
    v_dot2_f32_bf16 v40, v112, v16, 0
    v_dot2_f32_bf16 v40, v113, v17, v40
    v_dot2_f32_bf16 v40, v114, v18, v40
    v_dot2_f32_bf16 v40, v115, v19, v40
    buffer_load_dwordx4 v[112:115], v4, s[60:63], s48 offen offset:1024 nt
    s_waitcnt vmcnt(12)
    v_dot2_f32_bf16 v41, v116, v16, 0
    v_dot2_f32_bf16 v41, v117, v17, v41
    v_dot2_f32_bf16 v41, v118, v18, v41
    v_dot2_f32_bf16 v41, v119, v19, v41
    buffer_load_dwordx4 v[116:119], v4, s[60:63], s48 offen offset:2048 nt
    s_waitcnt vmcnt(12)
    v_dot2_f32_bf16 v42, v120, v16, 0
    v_dot2_f32_bf16 v42, v121, v17, v42
    v_dot2_f32_bf16 v42, v122, v18, v42
    v_dot2_f32_bf16 v42, v123, v19, v42
    buffer_load_dwordx4 v[120:123], v4, s[60:63], s48 offen offset:3072 nt
    s_waitcnt vmcnt(12)
    v_dot2_f32_bf16 v43, v124, v16, 0
    v_dot2_f32_bf16 v43, v125, v17, v43
    v_dot2_f32_bf16 v43, v126, v18, v43
    v_dot2_f32_bf16 v43, v127, v19, v43
    s_add_u32 s48, s75, 950272
    buffer_load_dwordx4 v[124:127], v3, s[60:63], s48 offen offset:0 nt
    s_waitcnt vmcnt(12)
    v_dot2_f32_bf16 v44, v128, v16, 0
    v_dot2_f32_bf16 v44, v129, v17, v44
    v_dot2_f32_bf16 v44, v130, v18, v44
    v_dot2_f32_bf16 v44, v131, v19, v44
    buffer_load_dwordx4 v[128:131], v3, s[60:63], s48 offen offset:1024 nt
    s_waitcnt vmcnt(12)
    v_dot2_f32_bf16 v45, v132, v16, 0
    v_dot2_f32_bf16 v45, v133, v17, v45
    v_dot2_f32_bf16 v45, v134, v18, v45
    v_dot2_f32_bf16 v45, v135, v19, v45
    buffer_load_dwordx4 v[132:135], v3, s[60:63], s48 offen offset:2048 nt
    s_waitcnt vmcnt(12)
    v_dot2_f32_bf16 v46, v136, v16, 0
    v_dot2_f32_bf16 v46, v137, v17, v46
    v_dot2_f32_bf16 v46, v138, v18, v46
    v_dot2_f32_bf16 v46, v139, v19, v46
    buffer_load_dwordx4 v[136:139], v3, s[60:63], s48 offen offset:3072 nt
    s_waitcnt vmcnt(12)
    v_dot2_f32_bf16 v47, v88, v16, 0
    v_dot2_f32_bf16 v47, v89, v17, v47
    v_dot2_f32_bf16 v47, v90, v18, v47
    v_dot2_f32_bf16 v47, v91, v19, v47
    v_add_f32_dpp v32, v32, v32 row_ror:8 row_mask:0xf bank_mask:0x3
    s_nop 1
    v_add_f32_dpp v32, v40, v40 row_ror:8 row_mask:0xf bank_mask:0xc
    v_add_f32_dpp v33, v33, v33 row_ror:8 row_mask:0xf bank_mask:0x3
    s_nop 1
    v_add_f32_dpp v33, v41, v41 row_ror:8 row_mask:0xf bank_mask:0xc
    v_add_f32_dpp v34, v34, v34 row_ror:8 row_mask:0xf bank_mask:0x3
    s_nop 1
    v_add_f32_dpp v34, v42, v42 row_ror:8 row_mask:0xf bank_mask:0xc
    v_add_f32_dpp v35, v35, v35 row_ror:8 row_mask:0xf bank_mask:0x3
    s_nop 1
    v_add_f32_dpp v35, v43, v43 row_ror:8 row_mask:0xf bank_mask:0xc
    v_add_f32_dpp v36, v36, v36 row_ror:8 row_mask:0xf bank_mask:0x3
    s_nop 1
    v_add_f32_dpp v36, v44, v44 row_ror:8 row_mask:0xf bank_mask:0xc
    v_add_f32_dpp v37, v37, v37 row_ror:8 row_mask:0xf bank_mask:0x3
    s_nop 1
    v_add_f32_dpp v37, v45, v45 row_ror:8 row_mask:0xf bank_mask:0xc
    v_add_f32_dpp v38, v38, v38 row_ror:8 row_mask:0xf bank_mask:0x3
    s_nop 1
    v_add_f32_dpp v38, v46, v46 row_ror:8 row_mask:0xf bank_mask:0xc
    v_add_f32_dpp v39, v39, v39 row_ror:8 row_mask:0xf bank_mask:0x3
    s_nop 1
    v_add_f32_dpp v39, v47, v47 row_ror:8 row_mask:0xf bank_mask:0xc
    v_add_f32_dpp v32, v32, v32 row_shl:4 row_mask:0xf bank_mask:0x5
    s_nop 1
    v_add_f32_dpp v32, v36, v36 row_shr:4 row_mask:0xf bank_mask:0xa
    v_add_f32_dpp v33, v33, v33 row_shl:4 row_mask:0xf bank_mask:0x5
    s_nop 1
    v_add_f32_dpp v33, v37, v37 row_shr:4 row_mask:0xf bank_mask:0xa
    v_add_f32_dpp v34, v34, v34 row_shl:4 row_mask:0xf bank_mask:0x5
    s_nop 1
    v_add_f32_dpp v34, v38, v38 row_shr:4 row_mask:0xf bank_mask:0xa
    v_add_f32_dpp v35, v35, v35 row_shl:4 row_mask:0xf bank_mask:0x5
    s_nop 1
    v_add_f32_dpp v35, v39, v39 row_shr:4 row_mask:0xf bank_mask:0xa
    v_add_f32_dpp v32, v32, v32 quad_perm:[2,3,0,1] row_mask:0xf bank_mask:0xf
    v_add_f32_dpp v34, v34, v34 quad_perm:[2,3,0,1] row_mask:0xf bank_mask:0xf
    v_cndmask_b32 v32, v32, v34, s[68:69]
    v_add_f32_dpp v33, v33, v33 quad_perm:[2,3,0,1] row_mask:0xf bank_mask:0xf
    v_add_f32_dpp v35, v35, v35 quad_perm:[2,3,0,1] row_mask:0xf bank_mask:0xf
    v_cndmask_b32 v33, v33, v35, s[68:69]
    v_add_f32_dpp v32, v32, v32 quad_perm:[1,0,3,2] row_mask:0xf bank_mask:0xf
    s_nop 0
    v_add_f32_dpp v33, v33, v33 quad_perm:[1,0,3,2] row_mask:0xf bank_mask:0xf
    v_cndmask_b32 v61, v32, v33, s[70:71]
    v_cvt_pk_bf16_f32 v61, v61, v61
    v_lshlrev_b32 v61, 16, v61
    v_mul_f32 v61, s73, v61
    v_cvt_pk_bf16_f32 v61, v61, v61
    v_lshlrev_b32 v61, 16, v61
    buffer_load_dwordx4 v[88:91], v4, s[60:63], s48 offen offset:0 nt
    s_waitcnt vmcnt(12)
    v_dot2_f32_bf16 v32, v92, v16, 0
    v_dot2_f32_bf16 v32, v93, v17, v32
    v_dot2_f32_bf16 v32, v94, v18, v32
    v_dot2_f32_bf16 v32, v95, v19, v32
    buffer_load_dwordx4 v[92:95], v4, s[60:63], s48 offen offset:1024 nt
    s_waitcnt vmcnt(12)
    v_dot2_f32_bf16 v33, v96, v16, 0
    v_dot2_f32_bf16 v33, v97, v17, v33
    v_dot2_f32_bf16 v33, v98, v18, v33
    v_dot2_f32_bf16 v33, v99, v19, v33
    buffer_load_dwordx4 v[96:99], v4, s[60:63], s48 offen offset:2048 nt
    s_waitcnt vmcnt(12)
    v_dot2_f32_bf16 v34, v100, v16, 0
    v_dot2_f32_bf16 v34, v101, v17, v34
    v_dot2_f32_bf16 v34, v102, v18, v34
    v_dot2_f32_bf16 v34, v103, v19, v34
    buffer_load_dwordx4 v[100:103], v4, s[60:63], s48 offen offset:3072 nt
    s_waitcnt vmcnt(12)
    v_dot2_f32_bf16 v35, v104, v16, 0
    v_dot2_f32_bf16 v35, v105, v17, v35
    v_dot2_f32_bf16 v35, v106, v18, v35
    v_dot2_f32_bf16 v35, v107, v19, v35
    s_add_u32 s48, s75, 983040
    buffer_load_dwordx4 v[104:107], v3, s[60:63], s48 offen offset:0 nt
    s_waitcnt vmcnt(12)
    v_dot2_f32_bf16 v36, v108, v16, 0
    v_dot2_f32_bf16 v36, v109, v17, v36
    v_dot2_f32_bf16 v36, v110, v18, v36
    v_dot2_f32_bf16 v36, v111, v19, v36
    buffer_load_dwordx4 v[108:111], v3, s[60:63], s48 offen offset:1024 nt
    s_waitcnt vmcnt(12)
    v_dot2_f32_bf16 v37, v112, v16, 0
    v_dot2_f32_bf16 v37, v113, v17, v37
    v_dot2_f32_bf16 v37, v114, v18, v37
    v_dot2_f32_bf16 v37, v115, v19, v37
    buffer_load_dwordx4 v[112:115], v3, s[60:63], s48 offen offset:2048 nt
    s_waitcnt vmcnt(12)
    v_dot2_f32_bf16 v38, v116, v16, 0
    v_dot2_f32_bf16 v38, v117, v17, v38
    v_dot2_f32_bf16 v38, v118, v18, v38
    v_dot2_f32_bf16 v38, v119, v19, v38
    buffer_load_dwordx4 v[116:119], v3, s[60:63], s48 offen offset:3072 nt
    s_waitcnt vmcnt(12)
    v_dot2_f32_bf16 v39, v120, v16, 0
    v_dot2_f32_bf16 v39, v121, v17, v39
    v_dot2_f32_bf16 v39, v122, v18, v39
    v_dot2_f32_bf16 v39, v123, v19, v39
    buffer_load_dwordx4 v[120:123], v4, s[60:63], s48 offen offset:0 nt
    s_waitcnt vmcnt(12)
    v_dot2_f32_bf16 v40, v124, v16, 0
    v_dot2_f32_bf16 v40, v125, v17, v40
    v_dot2_f32_bf16 v40, v126, v18, v40
    v_dot2_f32_bf16 v40, v127, v19, v40
    buffer_load_dwordx4 v[124:127], v4, s[60:63], s48 offen offset:1024 nt
    s_waitcnt vmcnt(12)
    v_dot2_f32_bf16 v41, v128, v16, 0
    v_dot2_f32_bf16 v41, v129, v17, v41
    v_dot2_f32_bf16 v41, v130, v18, v41
    v_dot2_f32_bf16 v41, v131, v19, v41
    buffer_load_dwordx4 v[128:131], v4, s[60:63], s48 offen offset:2048 nt
    s_waitcnt vmcnt(12)
    v_dot2_f32_bf16 v42, v132, v16, 0
    v_dot2_f32_bf16 v42, v133, v17, v42
    v_dot2_f32_bf16 v42, v134, v18, v42
    v_dot2_f32_bf16 v42, v135, v19, v42
    buffer_load_dwordx4 v[132:135], v4, s[60:63], s48 offen offset:3072 nt
    s_waitcnt vmcnt(12)
    v_dot2_f32_bf16 v43, v136, v16, 0
    v_dot2_f32_bf16 v43, v137, v17, v43
    v_dot2_f32_bf16 v43, v138, v18, v43
    v_dot2_f32_bf16 v43, v139, v19, v43
    s_add_u32 s48, s75, 1015808
    buffer_load_dwordx4 v[136:139], v3, s[60:63], s48 offen offset:0 nt
    s_waitcnt vmcnt(12)
    v_dot2_f32_bf16 v44, v88, v16, 0
    v_dot2_f32_bf16 v44, v89, v17, v44
    v_dot2_f32_bf16 v44, v90, v18, v44
    v_dot2_f32_bf16 v44, v91, v19, v44
    buffer_load_dwordx4 v[88:91], v3, s[60:63], s48 offen offset:1024 nt
    s_waitcnt vmcnt(12)
    v_dot2_f32_bf16 v45, v92, v16, 0
    v_dot2_f32_bf16 v45, v93, v17, v45
    v_dot2_f32_bf16 v45, v94, v18, v45
    v_dot2_f32_bf16 v45, v95, v19, v45
    buffer_load_dwordx4 v[92:95], v3, s[60:63], s48 offen offset:2048 nt
    s_waitcnt vmcnt(12)
    v_dot2_f32_bf16 v46, v96, v16, 0
    v_dot2_f32_bf16 v46, v97, v17, v46
    v_dot2_f32_bf16 v46, v98, v18, v46
    v_dot2_f32_bf16 v46, v99, v19, v46
    buffer_load_dwordx4 v[96:99], v3, s[60:63], s48 offen offset:3072 nt
    s_waitcnt vmcnt(12)
    v_dot2_f32_bf16 v47, v100, v16, 0
    v_dot2_f32_bf16 v47, v101, v17, v47
    v_dot2_f32_bf16 v47, v102, v18, v47
    v_dot2_f32_bf16 v47, v103, v19, v47
    v_add_f32_dpp v32, v32, v32 row_ror:8 row_mask:0xf bank_mask:0x3
    s_nop 1
    v_add_f32_dpp v32, v40, v40 row_ror:8 row_mask:0xf bank_mask:0xc
    v_add_f32_dpp v33, v33, v33 row_ror:8 row_mask:0xf bank_mask:0x3
    s_nop 1
    v_add_f32_dpp v33, v41, v41 row_ror:8 row_mask:0xf bank_mask:0xc
    v_add_f32_dpp v34, v34, v34 row_ror:8 row_mask:0xf bank_mask:0x3
    s_nop 1
    v_add_f32_dpp v34, v42, v42 row_ror:8 row_mask:0xf bank_mask:0xc
    v_add_f32_dpp v35, v35, v35 row_ror:8 row_mask:0xf bank_mask:0x3
    s_nop 1
    v_add_f32_dpp v35, v43, v43 row_ror:8 row_mask:0xf bank_mask:0xc
    v_add_f32_dpp v36, v36, v36 row_ror:8 row_mask:0xf bank_mask:0x3
    s_nop 1
    v_add_f32_dpp v36, v44, v44 row_ror:8 row_mask:0xf bank_mask:0xc
    v_add_f32_dpp v37, v37, v37 row_ror:8 row_mask:0xf bank_mask:0x3
    s_nop 1
    v_add_f32_dpp v37, v45, v45 row_ror:8 row_mask:0xf bank_mask:0xc
    v_add_f32_dpp v38, v38, v38 row_ror:8 row_mask:0xf bank_mask:0x3
    s_nop 1
    v_add_f32_dpp v38, v46, v46 row_ror:8 row_mask:0xf bank_mask:0xc
    v_add_f32_dpp v39, v39, v39 row_ror:8 row_mask:0xf bank_mask:0x3
    s_nop 1
    v_add_f32_dpp v39, v47, v47 row_ror:8 row_mask:0xf bank_mask:0xc
    v_add_f32_dpp v32, v32, v32 row_shl:4 row_mask:0xf bank_mask:0x5
    s_nop 1
    v_add_f32_dpp v32, v36, v36 row_shr:4 row_mask:0xf bank_mask:0xa
    v_add_f32_dpp v33, v33, v33 row_shl:4 row_mask:0xf bank_mask:0x5
    s_nop 1
    v_add_f32_dpp v33, v37, v37 row_shr:4 row_mask:0xf bank_mask:0xa
    v_add_f32_dpp v34, v34, v34 row_shl:4 row_mask:0xf bank_mask:0x5
    s_nop 1
    v_add_f32_dpp v34, v38, v38 row_shr:4 row_mask:0xf bank_mask:0xa
    v_add_f32_dpp v35, v35, v35 row_shl:4 row_mask:0xf bank_mask:0x5
    s_nop 1
    v_add_f32_dpp v35, v39, v39 row_shr:4 row_mask:0xf bank_mask:0xa
    v_add_f32_dpp v32, v32, v32 quad_perm:[2,3,0,1] row_mask:0xf bank_mask:0xf
    v_add_f32_dpp v34, v34, v34 quad_perm:[2,3,0,1] row_mask:0xf bank_mask:0xf
    v_cndmask_b32 v32, v32, v34, s[68:69]
    v_add_f32_dpp v33, v33, v33 quad_perm:[2,3,0,1] row_mask:0xf bank_mask:0xf
    v_add_f32_dpp v35, v35, v35 quad_perm:[2,3,0,1] row_mask:0xf bank_mask:0xf
    v_cndmask_b32 v33, v33, v35, s[68:69]
    v_add_f32_dpp v32, v32, v32 quad_perm:[1,0,3,2] row_mask:0xf bank_mask:0xf
    s_nop 0
    v_add_f32_dpp v33, v33, v33 quad_perm:[1,0,3,2] row_mask:0xf bank_mask:0xf
    v_cndmask_b32 v62, v32, v33, s[70:71]
    v_cvt_pk_bf16_f32 v62, v62, v62
    v_lshlrev_b32 v62, 16, v62
    v_mul_f32 v62, s73, v62
    v_cvt_pk_bf16_f32 v62, v62, v62
    v_lshlrev_b32 v62, 16, v62
    buffer_load_dwordx4 v[100:103], v4, s[60:63], s48 offen offset:0 nt
    s_waitcnt vmcnt(12)
    v_dot2_f32_bf16 v32, v104, v16, 0
    v_dot2_f32_bf16 v32, v105, v17, v32
    v_dot2_f32_bf16 v32, v106, v18, v32
    v_dot2_f32_bf16 v32, v107, v19, v32
    buffer_load_dwordx4 v[104:107], v4, s[60:63], s48 offen offset:1024 nt
    s_waitcnt vmcnt(12)
    v_dot2_f32_bf16 v33, v108, v16, 0
    v_dot2_f32_bf16 v33, v109, v17, v33
    v_dot2_f32_bf16 v33, v110, v18, v33
    v_dot2_f32_bf16 v33, v111, v19, v33
    buffer_load_dwordx4 v[108:111], v4, s[60:63], s48 offen offset:2048 nt
    s_waitcnt vmcnt(12)
    v_dot2_f32_bf16 v34, v112, v16, 0
    v_dot2_f32_bf16 v34, v113, v17, v34
    v_dot2_f32_bf16 v34, v114, v18, v34
    v_dot2_f32_bf16 v34, v115, v19, v34
    buffer_load_dwordx4 v[112:115], v4, s[60:63], s48 offen offset:3072 nt
    s_waitcnt vmcnt(12)
    v_dot2_f32_bf16 v35, v116, v16, 0
    v_dot2_f32_bf16 v35, v117, v17, v35
    v_dot2_f32_bf16 v35, v118, v18, v35
    v_dot2_f32_bf16 v35, v119, v19, v35
    s_add_u32 s48, s75, 0
    buffer_load_dwordx4 v[116:119], v3, s[64:67], s48 offen offset:0 nt
    s_waitcnt vmcnt(12)
    v_dot2_f32_bf16 v36, v120, v16, 0
    v_dot2_f32_bf16 v36, v121, v17, v36
    v_dot2_f32_bf16 v36, v122, v18, v36
    v_dot2_f32_bf16 v36, v123, v19, v36
    buffer_load_dwordx4 v[120:123], v3, s[64:67], s48 offen offset:1024 nt
    s_waitcnt vmcnt(12)
    v_dot2_f32_bf16 v37, v124, v16, 0
    v_dot2_f32_bf16 v37, v125, v17, v37
    v_dot2_f32_bf16 v37, v126, v18, v37
    v_dot2_f32_bf16 v37, v127, v19, v37
    buffer_load_dwordx4 v[124:127], v3, s[64:67], s48 offen offset:2048 nt
    s_waitcnt vmcnt(12)
    v_dot2_f32_bf16 v38, v128, v16, 0
    v_dot2_f32_bf16 v38, v129, v17, v38
    v_dot2_f32_bf16 v38, v130, v18, v38
    v_dot2_f32_bf16 v38, v131, v19, v38
    buffer_load_dwordx4 v[128:131], v3, s[64:67], s48 offen offset:3072 nt
    s_waitcnt vmcnt(12)
    v_dot2_f32_bf16 v39, v132, v16, 0
    v_dot2_f32_bf16 v39, v133, v17, v39
    v_dot2_f32_bf16 v39, v134, v18, v39
    v_dot2_f32_bf16 v39, v135, v19, v39
    buffer_load_dwordx4 v[132:135], v4, s[64:67], s48 offen offset:0 nt
    s_waitcnt vmcnt(12)
    v_dot2_f32_bf16 v40, v136, v16, 0
    v_dot2_f32_bf16 v40, v137, v17, v40
    v_dot2_f32_bf16 v40, v138, v18, v40
    v_dot2_f32_bf16 v40, v139, v19, v40
    buffer_load_dwordx4 v[136:139], v4, s[64:67], s48 offen offset:1024 nt
    s_waitcnt vmcnt(12)
    v_dot2_f32_bf16 v41, v88, v16, 0
    v_dot2_f32_bf16 v41, v89, v17, v41
    v_dot2_f32_bf16 v41, v90, v18, v41
    v_dot2_f32_bf16 v41, v91, v19, v41
    buffer_load_dwordx4 v[88:91], v4, s[64:67], s48 offen offset:2048 nt
    s_waitcnt vmcnt(12)
    v_dot2_f32_bf16 v42, v92, v16, 0
    v_dot2_f32_bf16 v42, v93, v17, v42
    v_dot2_f32_bf16 v42, v94, v18, v42
    v_dot2_f32_bf16 v42, v95, v19, v42
    buffer_load_dwordx4 v[92:95], v4, s[64:67], s48 offen offset:3072 nt
    s_waitcnt vmcnt(12)
    v_dot2_f32_bf16 v43, v96, v16, 0
    v_dot2_f32_bf16 v43, v97, v17, v43
    v_dot2_f32_bf16 v43, v98, v18, v43
    v_dot2_f32_bf16 v43, v99, v19, v43
    s_add_u32 s48, s75, 32768
    buffer_load_dwordx4 v[96:99], v3, s[64:67], s48 offen offset:0 nt
    s_waitcnt vmcnt(12)
    v_dot2_f32_bf16 v44, v100, v16, 0
    v_dot2_f32_bf16 v44, v101, v17, v44
    v_dot2_f32_bf16 v44, v102, v18, v44
    v_dot2_f32_bf16 v44, v103, v19, v44
    buffer_load_dwordx4 v[100:103], v3, s[64:67], s48 offen offset:1024 nt
    s_waitcnt vmcnt(12)
    v_dot2_f32_bf16 v45, v104, v16, 0
    v_dot2_f32_bf16 v45, v105, v17, v45
    v_dot2_f32_bf16 v45, v106, v18, v45
    v_dot2_f32_bf16 v45, v107, v19, v45
    buffer_load_dwordx4 v[104:107], v3, s[64:67], s48 offen offset:2048 nt
    s_waitcnt vmcnt(12)
    v_dot2_f32_bf16 v46, v108, v16, 0
    v_dot2_f32_bf16 v46, v109, v17, v46
    v_dot2_f32_bf16 v46, v110, v18, v46
    v_dot2_f32_bf16 v46, v111, v19, v46
    buffer_load_dwordx4 v[108:111], v3, s[64:67], s48 offen offset:3072 nt
    s_waitcnt vmcnt(12)
    v_dot2_f32_bf16 v47, v112, v16, 0
    v_dot2_f32_bf16 v47, v113, v17, v47
    v_dot2_f32_bf16 v47, v114, v18, v47
    v_dot2_f32_bf16 v47, v115, v19, v47
    v_add_f32_dpp v32, v32, v32 row_ror:8 row_mask:0xf bank_mask:0x3
    s_nop 1
    v_add_f32_dpp v32, v40, v40 row_ror:8 row_mask:0xf bank_mask:0xc
    v_add_f32_dpp v33, v33, v33 row_ror:8 row_mask:0xf bank_mask:0x3
    s_nop 1
    v_add_f32_dpp v33, v41, v41 row_ror:8 row_mask:0xf bank_mask:0xc
    v_add_f32_dpp v34, v34, v34 row_ror:8 row_mask:0xf bank_mask:0x3
    s_nop 1
    v_add_f32_dpp v34, v42, v42 row_ror:8 row_mask:0xf bank_mask:0xc
    v_add_f32_dpp v35, v35, v35 row_ror:8 row_mask:0xf bank_mask:0x3
    s_nop 1
    v_add_f32_dpp v35, v43, v43 row_ror:8 row_mask:0xf bank_mask:0xc
    v_add_f32_dpp v36, v36, v36 row_ror:8 row_mask:0xf bank_mask:0x3
    s_nop 1
    v_add_f32_dpp v36, v44, v44 row_ror:8 row_mask:0xf bank_mask:0xc
    v_add_f32_dpp v37, v37, v37 row_ror:8 row_mask:0xf bank_mask:0x3
    s_nop 1
    v_add_f32_dpp v37, v45, v45 row_ror:8 row_mask:0xf bank_mask:0xc
    v_add_f32_dpp v38, v38, v38 row_ror:8 row_mask:0xf bank_mask:0x3
    s_nop 1
    v_add_f32_dpp v38, v46, v46 row_ror:8 row_mask:0xf bank_mask:0xc
    v_add_f32_dpp v39, v39, v39 row_ror:8 row_mask:0xf bank_mask:0x3
    s_nop 1
    v_add_f32_dpp v39, v47, v47 row_ror:8 row_mask:0xf bank_mask:0xc
    v_add_f32_dpp v32, v32, v32 row_shl:4 row_mask:0xf bank_mask:0x5
    s_nop 1
    v_add_f32_dpp v32, v36, v36 row_shr:4 row_mask:0xf bank_mask:0xa
    v_add_f32_dpp v33, v33, v33 row_shl:4 row_mask:0xf bank_mask:0x5
    s_nop 1
    v_add_f32_dpp v33, v37, v37 row_shr:4 row_mask:0xf bank_mask:0xa
    v_add_f32_dpp v34, v34, v34 row_shl:4 row_mask:0xf bank_mask:0x5
    s_nop 1
    v_add_f32_dpp v34, v38, v38 row_shr:4 row_mask:0xf bank_mask:0xa
    v_add_f32_dpp v35, v35, v35 row_shl:4 row_mask:0xf bank_mask:0x5
    s_nop 1
    v_add_f32_dpp v35, v39, v39 row_shr:4 row_mask:0xf bank_mask:0xa
    v_add_f32_dpp v32, v32, v32 quad_perm:[2,3,0,1] row_mask:0xf bank_mask:0xf
    v_add_f32_dpp v34, v34, v34 quad_perm:[2,3,0,1] row_mask:0xf bank_mask:0xf
    v_cndmask_b32 v32, v32, v34, s[68:69]
    v_add_f32_dpp v33, v33, v33 quad_perm:[2,3,0,1] row_mask:0xf bank_mask:0xf
    v_add_f32_dpp v35, v35, v35 quad_perm:[2,3,0,1] row_mask:0xf bank_mask:0xf
    v_cndmask_b32 v33, v33, v35, s[68:69]
    v_add_f32_dpp v32, v32, v32 quad_perm:[1,0,3,2] row_mask:0xf bank_mask:0xf
    s_nop 0
    v_add_f32_dpp v33, v33, v33 quad_perm:[1,0,3,2] row_mask:0xf bank_mask:0xf
    v_cndmask_b32 v63, v32, v33, s[70:71]
    v_cvt_pk_bf16_f32 v63, v63, v63
    v_lshlrev_b32 v63, 16, v63
    v_mul_f32 v63, s73, v63
    v_cvt_pk_bf16_f32 v63, v63, v63
    v_lshlrev_b32 v63, 16, v63
    buffer_load_dwordx4 v[112:115], v4, s[64:67], s48 offen offset:0 nt
    buffer_load_dwordx4 v[140:143], v4, s[64:67], s48 offen offset:1024 nt
    buffer_load_dwordx4 v[144:147], v4, s[64:67], s48 offen offset:2048 nt
    buffer_load_dwordx4 v[148:151], v4, s[64:67], s48 offen offset:3072 nt
    s_add_u32 s48, s75, 65536
    buffer_load_dwordx4 v[152:155], v3, s[64:67], s48 offen offset:0 nt
    buffer_load_dwordx4 v[156:159], v3, s[64:67], s48 offen offset:1024 nt
    buffer_load_dwordx4 v[160:163], v3, s[64:67], s48 offen offset:2048 nt
    buffer_load_dwordx4 v[164:167], v3, s[64:67], s48 offen offset:3072 nt
    buffer_load_dwordx4 v[168:171], v4, s[64:67], s48 offen offset:0 nt
    buffer_load_dwordx4 v[172:175], v4, s[64:67], s48 offen offset:1024 nt
    buffer_load_dwordx4 v[176:179], v4, s[64:67], s48 offen offset:2048 nt
    buffer_load_dwordx4 v[180:183], v4, s[64:67], s48 offen offset:3072 nt
    v_max_f32 v64, v48, v49
    v_max_f32 v64, v64, v50
    v_max_f32 v64, v64, v51
    v_max_f32 v64, v64, v52
    v_max_f32 v64, v64, v53
    v_max_f32 v64, v64, v54
    v_max_f32 v64, v64, v55
    v_max_f32 v64, v64, v56
    v_max_f32 v64, v64, v57
    v_max_f32 v64, v64, v58
    v_max_f32 v64, v64, v59
    v_max_f32 v64, v64, v60
    v_max_f32 v64, v64, v61
    v_max_f32 v64, v64, v62
    v_max_f32 v64, v64, v63
    s_nop 1
    v_max_f32_dpp v64, v64, v64 quad_perm:[1,0,3,2] row_mask:0xf bank_mask:0xf
    s_nop 1
    v_max_f32_dpp v64, v64, v64 quad_perm:[2,3,0,1] row_mask:0xf bank_mask:0xf
    s_nop 1
    v_max_f32_dpp v64, v64, v64 row_half_mirror row_mask:0xf bank_mask:0xf
    s_nop 1
    v_max_f32_dpp v64, v64, v64 row_mirror row_mask:0xf bank_mask:0xf
    v_mov_b32 v66, v64
    s_nop 1
    v_permlane16_swap_b32 v64, v66
    v_max_f32 v64, v64, v66
    v_mov_b32 v66, v64
    s_nop 1
    v_permlane32_swap_b32 v64, v66
    v_max_f32 v64, v64, v66
    v_mov_b32 v65, 0
    v_sub_f32 v66, v48, v64
    v_mul_f32 v66, s72, v66
    v_exp_f32 v66, v66
    s_nop 0
    v_add_f32 v65, v65, v66
    v_sub_f32 v66, v49, v64
    v_mul_f32 v66, s72, v66
    v_exp_f32 v66, v66
    s_nop 0
    v_add_f32 v65, v65, v66
    v_sub_f32 v66, v50, v64
    v_mul_f32 v66, s72, v66
    v_exp_f32 v66, v66
    s_nop 0
    v_add_f32 v65, v65, v66
    v_sub_f32 v66, v51, v64
    v_mul_f32 v66, s72, v66
    v_exp_f32 v66, v66
    s_nop 0
    v_add_f32 v65, v65, v66
    v_sub_f32 v66, v52, v64
    v_mul_f32 v66, s72, v66
    v_exp_f32 v66, v66
    s_nop 0
    v_add_f32 v65, v65, v66
    v_sub_f32 v66, v53, v64
    v_mul_f32 v66, s72, v66
    v_exp_f32 v66, v66
    s_nop 0
    v_add_f32 v65, v65, v66
    v_sub_f32 v66, v54, v64
    v_mul_f32 v66, s72, v66
    v_exp_f32 v66, v66
    s_nop 0
    v_add_f32 v65, v65, v66
    v_sub_f32 v66, v55, v64
    v_mul_f32 v66, s72, v66
    v_exp_f32 v66, v66
    s_nop 0
    v_add_f32 v65, v65, v66
    v_sub_f32 v66, v56, v64
    v_mul_f32 v66, s72, v66
    v_exp_f32 v66, v66
    s_nop 0
    v_add_f32 v65, v65, v66
    v_sub_f32 v66, v57, v64
    v_mul_f32 v66, s72, v66
    v_exp_f32 v66, v66
    s_nop 0
    v_add_f32 v65, v65, v66
    v_sub_f32 v66, v58, v64
    v_mul_f32 v66, s72, v66
    v_exp_f32 v66, v66
    s_nop 0
    v_add_f32 v65, v65, v66
    v_sub_f32 v66, v59, v64
    v_mul_f32 v66, s72, v66
    v_exp_f32 v66, v66
    s_nop 0
    v_add_f32 v65, v65, v66
    v_sub_f32 v66, v60, v64
    v_mul_f32 v66, s72, v66
    v_exp_f32 v66, v66
    s_nop 0
    v_add_f32 v65, v65, v66
    v_sub_f32 v66, v61, v64
    v_mul_f32 v66, s72, v66
    v_exp_f32 v66, v66
    s_nop 0
    v_add_f32 v65, v65, v66
    v_sub_f32 v66, v62, v64
    v_mul_f32 v66, s72, v66
    v_exp_f32 v66, v66
    s_nop 0
    v_add_f32 v65, v65, v66
    v_sub_f32 v66, v63, v64
    v_mul_f32 v66, s72, v66
    v_exp_f32 v66, v66
    s_nop 0
    v_add_f32 v65, v65, v66
    s_nop 1
    v_add_f32_dpp v65, v65, v65 quad_perm:[1,0,3,2] row_mask:0xf bank_mask:0xf
    s_nop 1
    v_add_f32_dpp v65, v65, v65 quad_perm:[2,3,0,1] row_mask:0xf bank_mask:0xf
    s_nop 1
    v_add_f32_dpp v65, v65, v65 row_half_mirror row_mask:0xf bank_mask:0xf
    s_nop 1
    v_add_f32_dpp v65, v65, v65 row_mirror row_mask:0xf bank_mask:0xf
    v_mov_b32 v66, v65
    s_nop 1
    v_permlane16_swap_b32 v65, v66
    v_add_f32 v65, v65, v66
    v_mov_b32 v66, v65
    s_nop 1
    v_permlane32_swap_b32 v65, v66
    v_add_f32 v65, v65, v66
    v_mov_b32 v67, 0
    s_lshl_b32 s46, s42, 5
    v_add_u32 v66, s46, v67
    ds_write_b64 v66, v[64:65] offset:128
    s_lshl_b32 s46, s42, 2
    v_mov_b32 v66, s46
    s_waitcnt lgkmcnt(0)
    v_mov_b32 v68, s50
    ds_write_b32 v66, v68 offset:48
    s_nop 1
L_lw_8:
    ds_read_b128 v[8:11], v5 offset:48
    s_waitcnt lgkmcnt(0)
    v_min_u32 v8, v8, v9
    v_min3_u32 v8, v8, v10, v11
    v_cmp_gt_u32 vcc, s50, v8
    s_nop 1
    s_cbranch_vccz L_lwd_9
    s_sleep 1
    s_sub_u32 s49, s49, 1
    s_cmp_gt_i32 s49, 0
    s_cbranch_scc1 L_lw_8
L_lwd_9:
    ds_read_b64 v[32:33], v67 offset:128
    ds_read_b64 v[34:35], v67 offset:160
    ds_read_b64 v[36:37], v67 offset:192
    ds_read_b64 v[38:39], v67 offset:224
    s_waitcnt lgkmcnt(0)
    v_max_f32 v64, v32, v34
    v_max_f32 v64, v64, v36
    v_max_f32 v64, v64, v38
    v_mov_b32 v65, 0
    v_sub_f32 v66, v32, v64
    v_mul_f32 v66, s72, v66
    v_exp_f32 v66, v66
    s_nop 0
    v_fma_f32 v65, v66, v33, v65
    v_sub_f32 v66, v34, v64
    v_mul_f32 v66, s72, v66
    v_exp_f32 v66, v66
    s_nop 0
    v_fma_f32 v65, v66, v35, v65
    v_sub_f32 v66, v36, v64
    v_mul_f32 v66, s72, v66
    v_exp_f32 v66, v66
    s_nop 0
    v_fma_f32 v65, v66, v37, v65
    v_sub_f32 v66, v38, v64
    v_mul_f32 v66, s72, v66
    v_exp_f32 v66, v66
    s_nop 0
    v_fma_f32 v65, v66, v39, v65
    ds_write_b64 v67, v[64:65] offset:256
    v_lshrrev_b32 v68, 4, v2
    v_lshlrev_b32 v68, 4, v68
    v_bfe_u32 v66, v2, 3, 1
    v_lshl_add_u32 v68, v66, 6, v68
    v_and_b32 v66, 7, v2
    v_lshl_add_u32 v68, v66, 1, v68
    v_rcp_f32 v69, v65
    s_lshl_b32 s46, s42, 11
    v_add_u32 v68, s46, v68
    v_sub_f32 v66, v48, v64
    v_mul_f32 v66, s72, v66
    v_exp_f32 v66, v66
    s_nop 0
    v_mul_f32 v66, v66, v69
    v_cvt_pk_bf16_f32 v66, v66, v66
    ds_write_b16 v68, v66 offset:9216
    v_sub_f32 v66, v49, v64
    v_mul_f32 v66, s72, v66
    v_exp_f32 v66, v66
    s_nop 0
    v_mul_f32 v66, v66, v69
    v_cvt_pk_bf16_f32 v66, v66, v66
    ds_write_b16 v68, v66 offset:9344
    v_sub_f32 v66, v50, v64
    v_mul_f32 v66, s72, v66
    v_exp_f32 v66, v66
    s_nop 0
    v_mul_f32 v66, v66, v69
    v_cvt_pk_bf16_f32 v66, v66, v66
    ds_write_b16 v68, v66 offset:9472
    v_sub_f32 v66, v51, v64
    v_mul_f32 v66, s72, v66
    v_exp_f32 v66, v66
    s_nop 0
    v_mul_f32 v66, v66, v69
    v_cvt_pk_bf16_f32 v66, v66, v66
    ds_write_b16 v68, v66 offset:9600
    v_sub_f32 v66, v52, v64
    v_mul_f32 v66, s72, v66
    v_exp_f32 v66, v66
    s_nop 0
    v_mul_f32 v66, v66, v69
    v_cvt_pk_bf16_f32 v66, v66, v66
    ds_write_b16 v68, v66 offset:9728
    v_sub_f32 v66, v53, v64
    v_mul_f32 v66, s72, v66
    v_exp_f32 v66, v66
    s_nop 0
    v_mul_f32 v66, v66, v69
    v_cvt_pk_bf16_f32 v66, v66, v66
    ds_write_b16 v68, v66 offset:9856
    v_sub_f32 v66, v54, v64
    v_mul_f32 v66, s72, v66
    v_exp_f32 v66, v66
    s_nop 0
    v_mul_f32 v66, v66, v69
    v_cvt_pk_bf16_f32 v66, v66, v66
    ds_write_b16 v68, v66 offset:9984
    v_sub_f32 v66, v55, v64
    v_mul_f32 v66, s72, v66
    v_exp_f32 v66, v66
    s_nop 0
    v_mul_f32 v66, v66, v69
    v_cvt_pk_bf16_f32 v66, v66, v66
    ds_write_b16 v68, v66 offset:10112
    v_sub_f32 v66, v56, v64
    v_mul_f32 v66, s72, v66
    v_exp_f32 v66, v66
    s_nop 0
    v_mul_f32 v66, v66, v69
    v_cvt_pk_bf16_f32 v66, v66, v66
    ds_write_b16 v68, v66 offset:10240
    v_sub_f32 v66, v57, v64
    v_mul_f32 v66, s72, v66
    v_exp_f32 v66, v66
    s_nop 0
    v_mul_f32 v66, v66, v69
    v_cvt_pk_bf16_f32 v66, v66, v66
    ds_write_b16 v68, v66 offset:10368
    v_sub_f32 v66, v58, v64
    v_mul_f32 v66, s72, v66
    v_exp_f32 v66, v66
    s_nop 0
    v_mul_f32 v66, v66, v69
    v_cvt_pk_bf16_f32 v66, v66, v66
    ds_write_b16 v68, v66 offset:10496
    v_sub_f32 v66, v59, v64
    v_mul_f32 v66, s72, v66
    v_exp_f32 v66, v66
    s_nop 0
    v_mul_f32 v66, v66, v69
    v_cvt_pk_bf16_f32 v66, v66, v66
    ds_write_b16 v68, v66 offset:10624
    v_sub_f32 v66, v60, v64
    v_mul_f32 v66, s72, v66
    v_exp_f32 v66, v66
    s_nop 0
    v_mul_f32 v66, v66, v69
    v_cvt_pk_bf16_f32 v66, v66, v66
    ds_write_b16 v68, v66 offset:10752
    v_sub_f32 v66, v61, v64
    v_mul_f32 v66, s72, v66
    v_exp_f32 v66, v66
    s_nop 0
    v_mul_f32 v66, v66, v69
    v_cvt_pk_bf16_f32 v66, v66, v66
    ds_write_b16 v68, v66 offset:10880
    v_sub_f32 v66, v62, v64
    v_mul_f32 v66, s72, v66
    v_exp_f32 v66, v66
    s_nop 0
    v_mul_f32 v66, v66, v69
    v_cvt_pk_bf16_f32 v66, v66, v66
    ds_write_b16 v68, v66 offset:11008
    v_sub_f32 v66, v63, v64
    v_mul_f32 v66, s72, v66
    v_exp_f32 v66, v66
    s_nop 0
    v_mul_f32 v66, v66, v69
    v_cvt_pk_bf16_f32 v66, v66, v66
    ds_write_b16 v68, v66 offset:11136
    v_lshrrev_b32 v7, 4, v2
    v_lshlrev_b32 v7, 4, v7
    v_add_u32 v7, s46, v7
    s_waitcnt lgkmcnt(0)
    v_mov_b32 v16, 0
    v_mov_b32 v17, 0
    v_mov_b32 v18, 0
    v_mov_b32 v19, 0
    v_mov_b32 v20, 0
    v_mov_b32 v21, 0
    v_mov_b32 v22, 0
    v_mov_b32 v23, 0
    v_mov_b32 v24, 0
    v_mov_b32 v25, 0
    v_mov_b32 v26, 0
    v_mov_b32 v27, 0
    v_mov_b32 v28, 0
    v_mov_b32 v29, 0
    v_mov_b32 v30, 0
    v_mov_b32 v31, 0
    v_mov_b32 v32, 0
    v_mov_b32 v33, 0
    v_mov_b32 v34, 0
    v_mov_b32 v35, 0
    v_mov_b32 v36, 0
    v_mov_b32 v37, 0
    v_mov_b32 v38, 0
    v_mov_b32 v39, 0
    v_mov_b32 v40, 0
    v_mov_b32 v41, 0
    v_mov_b32 v42, 0
    v_mov_b32 v43, 0
    v_mov_b32 v44, 0
    v_mov_b32 v45, 0
    v_mov_b32 v46, 0
    v_mov_b32 v47, 0
    s_waitcnt vmcnt(11)
    s_add_u32 s48, s75, 98304
    buffer_load_dwordx4 v[184:187], v3, s[64:67], s48 offen offset:0 nt
    ds_read_b128 v[80:83], v7 offset:9216
    s_waitcnt vmcnt(24)
    s_waitcnt vmcnt(23)
    v_perm_b32 v48, v120, v116, s43
    v_perm_b32 v52, v120, v116, s44
    v_perm_b32 v56, v121, v117, s43
    v_perm_b32 v60, v121, v117, s44
    v_perm_b32 v64, v122, v118, s43
    v_perm_b32 v68, v122, v118, s44
    v_perm_b32 v72, v123, v119, s43
    v_perm_b32 v76, v123, v119, s44
    s_waitcnt vmcnt(11)
    buffer_load_dwordx4 v[116:119], v3, s[64:67], s48 offen offset:1024 nt
    s_waitcnt vmcnt(23)
    s_waitcnt vmcnt(22)
    v_perm_b32 v49, v128, v124, s43
    v_perm_b32 v53, v128, v124, s44
    v_perm_b32 v57, v129, v125, s43
    v_perm_b32 v61, v129, v125, s44
    v_perm_b32 v65, v130, v126, s43
    v_perm_b32 v69, v130, v126, s44
    v_perm_b32 v73, v131, v127, s43
    v_perm_b32 v77, v131, v127, s44
    s_waitcnt vmcnt(11)
    buffer_load_dwordx4 v[120:123], v3, s[64:67], s48 offen offset:2048 nt
    s_waitcnt vmcnt(22)
    s_waitcnt vmcnt(21)
    v_perm_b32 v50, v136, v132, s43
    v_perm_b32 v54, v136, v132, s44
    v_perm_b32 v58, v137, v133, s43
    v_perm_b32 v62, v137, v133, s44
    v_perm_b32 v66, v138, v134, s43
    v_perm_b32 v70, v138, v134, s44
    v_perm_b32 v74, v139, v135, s43
    v_perm_b32 v78, v139, v135, s44
    s_waitcnt vmcnt(11)
    buffer_load_dwordx4 v[124:127], v3, s[64:67], s48 offen offset:3072 nt
    s_waitcnt vmcnt(21)
    s_waitcnt vmcnt(20)
    v_perm_b32 v51, v92, v88, s43
    v_perm_b32 v55, v92, v88, s44
    v_perm_b32 v59, v93, v89, s43
    v_perm_b32 v63, v93, v89, s44
    v_perm_b32 v67, v94, v90, s43
    v_perm_b32 v71, v94, v90, s44
    v_perm_b32 v75, v95, v91, s43
    v_perm_b32 v79, v95, v91, s44
    s_waitcnt lgkmcnt(0)
    v_mfma_f32_16x16x32_bf16 v[16:19], v[48:51], v[80:83], v[16:19]
    v_mfma_f32_16x16x32_bf16 v[20:23], v[52:55], v[80:83], v[20:23]
    v_mfma_f32_16x16x32_bf16 v[24:27], v[56:59], v[80:83], v[24:27]
    v_mfma_f32_16x16x32_bf16 v[28:31], v[60:63], v[80:83], v[28:31]
    v_mfma_f32_16x16x32_bf16 v[32:35], v[64:67], v[80:83], v[32:35]
    v_mfma_f32_16x16x32_bf16 v[36:39], v[68:71], v[80:83], v[36:39]
    v_mfma_f32_16x16x32_bf16 v[40:43], v[72:75], v[80:83], v[40:43]
    v_mfma_f32_16x16x32_bf16 v[44:47], v[76:79], v[80:83], v[44:47]
    s_waitcnt vmcnt(11)
    buffer_load_dwordx4 v[88:91], v4, s[64:67], s48 offen offset:0 nt
    ds_read_b128 v[84:87], v7 offset:9280
    s_waitcnt vmcnt(20)
    s_waitcnt vmcnt(19)
    v_perm_b32 v48, v100, v96, s43
    v_perm_b32 v52, v100, v96, s44
    v_perm_b32 v56, v101, v97, s43
    v_perm_b32 v60, v101, v97, s44
    v_perm_b32 v64, v102, v98, s43
    v_perm_b32 v68, v102, v98, s44
    v_perm_b32 v72, v103, v99, s43
    v_perm_b32 v76, v103, v99, s44
    s_waitcnt vmcnt(11)
    buffer_load_dwordx4 v[92:95], v4, s[64:67], s48 offen offset:1024 nt
    s_waitcnt vmcnt(19)
    s_waitcnt vmcnt(18)
    v_perm_b32 v49, v108, v104, s43
    v_perm_b32 v53, v108, v104, s44
    v_perm_b32 v57, v109, v105, s43
    v_perm_b32 v61, v109, v105, s44
    v_perm_b32 v65, v110, v106, s43
    v_perm_b32 v69, v110, v106, s44
    v_perm_b32 v73, v111, v107, s43
    v_perm_b32 v77, v111, v107, s44
    s_waitcnt vmcnt(11)
    buffer_load_dwordx4 v[96:99], v4, s[64:67], s48 offen offset:2048 nt
    s_waitcnt vmcnt(18)
    s_waitcnt vmcnt(17)
    v_perm_b32 v50, v140, v112, s43
    v_perm_b32 v54, v140, v112, s44
    v_perm_b32 v58, v141, v113, s43
    v_perm_b32 v62, v141, v113, s44
    v_perm_b32 v66, v142, v114, s43
    v_perm_b32 v70, v142, v114, s44
    v_perm_b32 v74, v143, v115, s43
    v_perm_b32 v78, v143, v115, s44
    s_waitcnt vmcnt(11)
    buffer_load_dwordx4 v[100:103], v4, s[64:67], s48 offen offset:3072 nt
    s_waitcnt vmcnt(17)
    s_waitcnt vmcnt(16)
    v_perm_b32 v51, v148, v144, s43
    v_perm_b32 v55, v148, v144, s44
    v_perm_b32 v59, v149, v145, s43
    v_perm_b32 v63, v149, v145, s44
    v_perm_b32 v67, v150, v146, s43
    v_perm_b32 v71, v150, v146, s44
    v_perm_b32 v75, v151, v147, s43
    v_perm_b32 v79, v151, v147, s44
    s_waitcnt lgkmcnt(0)
    v_mfma_f32_16x16x32_bf16 v[16:19], v[48:51], v[84:87], v[16:19]
    v_mfma_f32_16x16x32_bf16 v[20:23], v[52:55], v[84:87], v[20:23]
    v_mfma_f32_16x16x32_bf16 v[24:27], v[56:59], v[84:87], v[24:27]
    v_mfma_f32_16x16x32_bf16 v[28:31], v[60:63], v[84:87], v[28:31]
    v_mfma_f32_16x16x32_bf16 v[32:35], v[64:67], v[84:87], v[32:35]
    v_mfma_f32_16x16x32_bf16 v[36:39], v[68:71], v[84:87], v[36:39]
    v_mfma_f32_16x16x32_bf16 v[40:43], v[72:75], v[84:87], v[40:43]
    v_mfma_f32_16x16x32_bf16 v[44:47], v[76:79], v[84:87], v[44:47]
    s_waitcnt vmcnt(11)
    s_add_u32 s48, s75, 131072
    buffer_load_dwordx4 v[104:107], v3, s[64:67], s48 offen offset:0 nt
    ds_read_b128 v[80:83], v7 offset:9344
    s_waitcnt vmcnt(16)
    s_waitcnt vmcnt(15)
    v_perm_b32 v48, v156, v152, s43
    v_perm_b32 v52, v156, v152, s44
    v_perm_b32 v56, v157, v153, s43
    v_perm_b32 v60, v157, v153, s44
    v_perm_b32 v64, v158, v154, s43
    v_perm_b32 v68, v158, v154, s44
    v_perm_b32 v72, v159, v155, s43
    v_perm_b32 v76, v159, v155, s44
    s_waitcnt vmcnt(11)
    buffer_load_dwordx4 v[108:111], v3, s[64:67], s48 offen offset:1024 nt
    s_waitcnt vmcnt(15)
    s_waitcnt vmcnt(14)
    v_perm_b32 v49, v164, v160, s43
    v_perm_b32 v53, v164, v160, s44
    v_perm_b32 v57, v165, v161, s43
    v_perm_b32 v61, v165, v161, s44
    v_perm_b32 v65, v166, v162, s43
    v_perm_b32 v69, v166, v162, s44
    v_perm_b32 v73, v167, v163, s43
    v_perm_b32 v77, v167, v163, s44
    s_waitcnt vmcnt(11)
    buffer_load_dwordx4 v[112:115], v3, s[64:67], s48 offen offset:2048 nt
    s_waitcnt vmcnt(14)
    s_waitcnt vmcnt(13)
    v_perm_b32 v50, v172, v168, s43
    v_perm_b32 v54, v172, v168, s44
    v_perm_b32 v58, v173, v169, s43
    v_perm_b32 v62, v173, v169, s44
    v_perm_b32 v66, v174, v170, s43
    v_perm_b32 v70, v174, v170, s44
    v_perm_b32 v74, v175, v171, s43
    v_perm_b32 v78, v175, v171, s44
    s_waitcnt vmcnt(11)
    buffer_load_dwordx4 v[128:131], v3, s[64:67], s48 offen offset:3072 nt
    s_waitcnt vmcnt(13)
    s_waitcnt vmcnt(12)
    v_perm_b32 v51, v180, v176, s43
    v_perm_b32 v55, v180, v176, s44
    v_perm_b32 v59, v181, v177, s43
    v_perm_b32 v63, v181, v177, s44
    v_perm_b32 v67, v182, v178, s43
    v_perm_b32 v71, v182, v178, s44
    v_perm_b32 v75, v183, v179, s43
    v_perm_b32 v79, v183, v179, s44
    s_waitcnt lgkmcnt(0)
    v_mfma_f32_16x16x32_bf16 v[16:19], v[48:51], v[80:83], v[16:19]
    v_mfma_f32_16x16x32_bf16 v[20:23], v[52:55], v[80:83], v[20:23]
    v_mfma_f32_16x16x32_bf16 v[24:27], v[56:59], v[80:83], v[24:27]
    v_mfma_f32_16x16x32_bf16 v[28:31], v[60:63], v[80:83], v[28:31]
    v_mfma_f32_16x16x32_bf16 v[32:35], v[64:67], v[80:83], v[32:35]
    v_mfma_f32_16x16x32_bf16 v[36:39], v[68:71], v[80:83], v[36:39]
    v_mfma_f32_16x16x32_bf16 v[40:43], v[72:75], v[80:83], v[40:43]
    v_mfma_f32_16x16x32_bf16 v[44:47], v[76:79], v[80:83], v[44:47]
    buffer_load_dwordx4 v[132:135], v4, s[64:67], s48 offen offset:0 nt
    ds_read_b128 v[84:87], v7 offset:9408
    buffer_load_dwordx4 v[136:139], v4, s[64:67], s48 offen offset:1024 nt
    s_waitcnt vmcnt(13)
    s_waitcnt vmcnt(12)
    v_perm_b32 v48, v116, v184, s43
    v_perm_b32 v52, v116, v184, s44
    v_perm_b32 v56, v117, v185, s43
    v_perm_b32 v60, v117, v185, s44
    v_perm_b32 v64, v118, v186, s43
    v_perm_b32 v68, v118, v186, s44
    v_perm_b32 v72, v119, v187, s43
    v_perm_b32 v76, v119, v187, s44
    buffer_load_dwordx4 v[116:119], v4, s[64:67], s48 offen offset:2048 nt
    buffer_load_dwordx4 v[140:143], v4, s[64:67], s48 offen offset:3072 nt
    s_waitcnt vmcnt(13)
    s_waitcnt vmcnt(12)
    v_perm_b32 v49, v124, v120, s43
    v_perm_b32 v53, v124, v120, s44
    v_perm_b32 v57, v125, v121, s43
    v_perm_b32 v61, v125, v121, s44
    v_perm_b32 v65, v126, v122, s43
    v_perm_b32 v69, v126, v122, s44
    v_perm_b32 v73, v127, v123, s43
    v_perm_b32 v77, v127, v123, s44
    s_add_u32 s48, s75, 163840
    buffer_load_dwordx4 v[120:123], v3, s[64:67], s48 offen offset:0 nt
    buffer_load_dwordx4 v[124:127], v3, s[64:67], s48 offen offset:1024 nt
    s_waitcnt vmcnt(13)
    s_waitcnt vmcnt(12)
    v_perm_b32 v50, v92, v88, s43
    v_perm_b32 v54, v92, v88, s44
    v_perm_b32 v58, v93, v89, s43
    v_perm_b32 v62, v93, v89, s44
    v_perm_b32 v66, v94, v90, s43
    v_perm_b32 v70, v94, v90, s44
    v_perm_b32 v74, v95, v91, s43
    v_perm_b32 v78, v95, v91, s44
    buffer_load_dwordx4 v[88:91], v3, s[64:67], s48 offen offset:2048 nt
    buffer_load_dwordx4 v[92:95], v3, s[64:67], s48 offen offset:3072 nt
    s_waitcnt vmcnt(13)
    s_waitcnt vmcnt(12)
    v_perm_b32 v51, v100, v96, s43
    v_perm_b32 v55, v100, v96, s44
    v_perm_b32 v59, v101, v97, s43
    v_perm_b32 v63, v101, v97, s44
    v_perm_b32 v67, v102, v98, s43
    v_perm_b32 v71, v102, v98, s44
    v_perm_b32 v75, v103, v99, s43
    v_perm_b32 v79, v103, v99, s44
    s_waitcnt lgkmcnt(0)
    v_mfma_f32_16x16x32_bf16 v[16:19], v[48:51], v[84:87], v[16:19]
    v_mfma_f32_16x16x32_bf16 v[20:23], v[52:55], v[84:87], v[20:23]
    v_mfma_f32_16x16x32_bf16 v[24:27], v[56:59], v[84:87], v[24:27]
    v_mfma_f32_16x16x32_bf16 v[28:31], v[60:63], v[84:87], v[28:31]
    v_mfma_f32_16x16x32_bf16 v[32:35], v[64:67], v[84:87], v[32:35]
    v_mfma_f32_16x16x32_bf16 v[36:39], v[68:71], v[84:87], v[36:39]
    v_mfma_f32_16x16x32_bf16 v[40:43], v[72:75], v[84:87], v[40:43]
    v_mfma_f32_16x16x32_bf16 v[44:47], v[76:79], v[84:87], v[44:47]
    buffer_load_dwordx4 v[96:99], v4, s[64:67], s48 offen offset:0 nt
    ds_read_b128 v[80:83], v7 offset:9472
    buffer_load_dwordx4 v[100:103], v4, s[64:67], s48 offen offset:1024 nt
    s_waitcnt vmcnt(13)
    s_waitcnt vmcnt(12)
    v_perm_b32 v48, v108, v104, s43
    v_perm_b32 v52, v108, v104, s44
    v_perm_b32 v56, v109, v105, s43
    v_perm_b32 v60, v109, v105, s44
    v_perm_b32 v64, v110, v106, s43
    v_perm_b32 v68, v110, v106, s44
    v_perm_b32 v72, v111, v107, s43
    v_perm_b32 v76, v111, v107, s44
    buffer_load_dwordx4 v[104:107], v4, s[64:67], s48 offen offset:2048 nt
    buffer_load_dwordx4 v[108:111], v4, s[64:67], s48 offen offset:3072 nt
    s_waitcnt vmcnt(13)
    s_waitcnt vmcnt(12)
    v_perm_b32 v49, v128, v112, s43
    v_perm_b32 v53, v128, v112, s44
    v_perm_b32 v57, v129, v113, s43
    v_perm_b32 v61, v129, v113, s44
    v_perm_b32 v65, v130, v114, s43
    v_perm_b32 v69, v130, v114, s44
    v_perm_b32 v73, v131, v115, s43
    v_perm_b32 v77, v131, v115, s44
    s_add_u32 s48, s75, 196608
    buffer_load_dwordx4 v[112:115], v3, s[64:67], s48 offen offset:0 nt
    buffer_load_dwordx4 v[128:131], v3, s[64:67], s48 offen offset:1024 nt
    s_waitcnt vmcnt(13)
    s_waitcnt vmcnt(12)
    v_perm_b32 v50, v136, v132, s43
    v_perm_b32 v54, v136, v132, s44
    v_perm_b32 v58, v137, v133, s43
    v_perm_b32 v62, v137, v133, s44
    v_perm_b32 v66, v138, v134, s43
    v_perm_b32 v70, v138, v134, s44
    v_perm_b32 v74, v139, v135, s43
    v_perm_b32 v78, v139, v135, s44
    buffer_load_dwordx4 v[132:135], v3, s[64:67], s48 offen offset:2048 nt
    buffer_load_dwordx4 v[136:139], v3, s[64:67], s48 offen offset:3072 nt
    s_waitcnt vmcnt(13)
    s_waitcnt vmcnt(12)
    v_perm_b32 v51, v140, v116, s43
    v_perm_b32 v55, v140, v116, s44
    v_perm_b32 v59, v141, v117, s43
    v_perm_b32 v63, v141, v117, s44
    v_perm_b32 v67, v142, v118, s43
    v_perm_b32 v71, v142, v118, s44
    v_perm_b32 v75, v143, v119, s43
    v_perm_b32 v79, v143, v119, s44
    s_waitcnt lgkmcnt(0)
    v_mfma_f32_16x16x32_bf16 v[16:19], v[48:51], v[80:83], v[16:19]
    v_mfma_f32_16x16x32_bf16 v[20:23], v[52:55], v[80:83], v[20:23]
    v_mfma_f32_16x16x32_bf16 v[24:27], v[56:59], v[80:83], v[24:27]
    v_mfma_f32_16x16x32_bf16 v[28:31], v[60:63], v[80:83], v[28:31]
    v_mfma_f32_16x16x32_bf16 v[32:35], v[64:67], v[80:83], v[32:35]
    v_mfma_f32_16x16x32_bf16 v[36:39], v[68:71], v[80:83], v[36:39]
    v_mfma_f32_16x16x32_bf16 v[40:43], v[72:75], v[80:83], v[40:43]
    v_mfma_f32_16x16x32_bf16 v[44:47], v[76:79], v[80:83], v[44:47]
    buffer_load_dwordx4 v[116:119], v4, s[64:67], s48 offen offset:0 nt
    ds_read_b128 v[84:87], v7 offset:9536
    buffer_load_dwordx4 v[140:143], v4, s[64:67], s48 offen offset:1024 nt
    s_waitcnt vmcnt(13)
    s_waitcnt vmcnt(12)
    v_perm_b32 v48, v124, v120, s43
    v_perm_b32 v52, v124, v120, s44
    v_perm_b32 v56, v125, v121, s43
    v_perm_b32 v60, v125, v121, s44
    v_perm_b32 v64, v126, v122, s43
    v_perm_b32 v68, v126, v122, s44
    v_perm_b32 v72, v127, v123, s43
    v_perm_b32 v76, v127, v123, s44
    buffer_load_dwordx4 v[120:123], v4, s[64:67], s48 offen offset:2048 nt
    buffer_load_dwordx4 v[124:127], v4, s[64:67], s48 offen offset:3072 nt
    s_waitcnt vmcnt(13)
    s_waitcnt vmcnt(12)
    v_perm_b32 v49, v92, v88, s43
    v_perm_b32 v53, v92, v88, s44
    v_perm_b32 v57, v93, v89, s43
    v_perm_b32 v61, v93, v89, s44
    v_perm_b32 v65, v94, v90, s43
    v_perm_b32 v69, v94, v90, s44
    v_perm_b32 v73, v95, v91, s43
    v_perm_b32 v77, v95, v91, s44
    s_add_u32 s48, s75, 229376
    buffer_load_dwordx4 v[88:91], v3, s[64:67], s48 offen offset:0 nt
    buffer_load_dwordx4 v[92:95], v3, s[64:67], s48 offen offset:1024 nt
    s_waitcnt vmcnt(13)
    s_waitcnt vmcnt(12)
    v_perm_b32 v50, v100, v96, s43
    v_perm_b32 v54, v100, v96, s44
    v_perm_b32 v58, v101, v97, s43
    v_perm_b32 v62, v101, v97, s44
    v_perm_b32 v66, v102, v98, s43
    v_perm_b32 v70, v102, v98, s44
    v_perm_b32 v74, v103, v99, s43
    v_perm_b32 v78, v103, v99, s44
    buffer_load_dwordx4 v[96:99], v3, s[64:67], s48 offen offset:2048 nt
    buffer_load_dwordx4 v[100:103], v3, s[64:67], s48 offen offset:3072 nt
    s_waitcnt vmcnt(13)
    s_waitcnt vmcnt(12)
    v_perm_b32 v51, v108, v104, s43
    v_perm_b32 v55, v108, v104, s44
    v_perm_b32 v59, v109, v105, s43
    v_perm_b32 v63, v109, v105, s44
    v_perm_b32 v67, v110, v106, s43
    v_perm_b32 v71, v110, v106, s44
    v_perm_b32 v75, v111, v107, s43
    v_perm_b32 v79, v111, v107, s44
    s_waitcnt lgkmcnt(0)
    v_mfma_f32_16x16x32_bf16 v[16:19], v[48:51], v[84:87], v[16:19]
    v_mfma_f32_16x16x32_bf16 v[20:23], v[52:55], v[84:87], v[20:23]
    v_mfma_f32_16x16x32_bf16 v[24:27], v[56:59], v[84:87], v[24:27]
    v_mfma_f32_16x16x32_bf16 v[28:31], v[60:63], v[84:87], v[28:31]
    v_mfma_f32_16x16x32_bf16 v[32:35], v[64:67], v[84:87], v[32:35]
    v_mfma_f32_16x16x32_bf16 v[36:39], v[68:71], v[84:87], v[36:39]
    v_mfma_f32_16x16x32_bf16 v[40:43], v[72:75], v[84:87], v[40:43]
    v_mfma_f32_16x16x32_bf16 v[44:47], v[76:79], v[84:87], v[44:47]
    buffer_load_dwordx4 v[104:107], v4, s[64:67], s48 offen offset:0 nt
    ds_read_b128 v[80:83], v7 offset:9600
    buffer_load_dwordx4 v[108:111], v4, s[64:67], s48 offen offset:1024 nt
    s_waitcnt vmcnt(13)
    s_waitcnt vmcnt(12)
    v_perm_b32 v48, v128, v112, s43
    v_perm_b32 v52, v128, v112, s44
    v_perm_b32 v56, v129, v113, s43
    v_perm_b32 v60, v129, v113, s44
    v_perm_b32 v64, v130, v114, s43
    v_perm_b32 v68, v130, v114, s44
    v_perm_b32 v72, v131, v115, s43
    v_perm_b32 v76, v131, v115, s44
    buffer_load_dwordx4 v[112:115], v4, s[64:67], s48 offen offset:2048 nt
    buffer_load_dwordx4 v[128:131], v4, s[64:67], s48 offen offset:3072 nt
    s_waitcnt vmcnt(13)
    s_waitcnt vmcnt(12)
    v_perm_b32 v49, v136, v132, s43
    v_perm_b32 v53, v136, v132, s44
    v_perm_b32 v57, v137, v133, s43
    v_perm_b32 v61, v137, v133, s44
    v_perm_b32 v65, v138, v134, s43
    v_perm_b32 v69, v138, v134, s44
    v_perm_b32 v73, v139, v135, s43
    v_perm_b32 v77, v139, v135, s44
    s_add_u32 s48, s75, 262144
    buffer_load_dwordx4 v[132:135], v3, s[64:67], s48 offen offset:0 nt
    buffer_load_dwordx4 v[136:139], v3, s[64:67], s48 offen offset:1024 nt
    s_waitcnt vmcnt(13)
    s_waitcnt vmcnt(12)
    v_perm_b32 v50, v140, v116, s43
    v_perm_b32 v54, v140, v116, s44
    v_perm_b32 v58, v141, v117, s43
    v_perm_b32 v62, v141, v117, s44
    v_perm_b32 v66, v142, v118, s43
    v_perm_b32 v70, v142, v118, s44
    v_perm_b32 v74, v143, v119, s43
    v_perm_b32 v78, v143, v119, s44
    buffer_load_dwordx4 v[116:119], v3, s[64:67], s48 offen offset:2048 nt
    buffer_load_dwordx4 v[140:143], v3, s[64:67], s48 offen offset:3072 nt
    s_waitcnt vmcnt(13)
    s_waitcnt vmcnt(12)
    v_perm_b32 v51, v124, v120, s43
    v_perm_b32 v55, v124, v120, s44
    v_perm_b32 v59, v125, v121, s43
    v_perm_b32 v63, v125, v121, s44
    v_perm_b32 v67, v126, v122, s43
    v_perm_b32 v71, v126, v122, s44
    v_perm_b32 v75, v127, v123, s43
    v_perm_b32 v79, v127, v123, s44
    s_waitcnt lgkmcnt(0)
    v_mfma_f32_16x16x32_bf16 v[16:19], v[48:51], v[80:83], v[16:19]
    v_mfma_f32_16x16x32_bf16 v[20:23], v[52:55], v[80:83], v[20:23]
    v_mfma_f32_16x16x32_bf16 v[24:27], v[56:59], v[80:83], v[24:27]
    v_mfma_f32_16x16x32_bf16 v[28:31], v[60:63], v[80:83], v[28:31]
    v_mfma_f32_16x16x32_bf16 v[32:35], v[64:67], v[80:83], v[32:35]
    v_mfma_f32_16x16x32_bf16 v[36:39], v[68:71], v[80:83], v[36:39]
    v_mfma_f32_16x16x32_bf16 v[40:43], v[72:75], v[80:83], v[40:43]
    v_mfma_f32_16x16x32_bf16 v[44:47], v[76:79], v[80:83], v[44:47]
    buffer_load_dwordx4 v[120:123], v4, s[64:67], s48 offen offset:0 nt
    ds_read_b128 v[84:87], v7 offset:9664
    buffer_load_dwordx4 v[124:127], v4, s[64:67], s48 offen offset:1024 nt
    s_waitcnt vmcnt(13)
    s_waitcnt vmcnt(12)
    v_perm_b32 v48, v92, v88, s43
    v_perm_b32 v52, v92, v88, s44
    v_perm_b32 v56, v93, v89, s43
    v_perm_b32 v60, v93, v89, s44
    v_perm_b32 v64, v94, v90, s43
    v_perm_b32 v68, v94, v90, s44
    v_perm_b32 v72, v95, v91, s43
    v_perm_b32 v76, v95, v91, s44
    buffer_load_dwordx4 v[88:91], v4, s[64:67], s48 offen offset:2048 nt
    buffer_load_dwordx4 v[92:95], v4, s[64:67], s48 offen offset:3072 nt
    s_waitcnt vmcnt(13)
    s_waitcnt vmcnt(12)
    v_perm_b32 v49, v100, v96, s43
    v_perm_b32 v53, v100, v96, s44
    v_perm_b32 v57, v101, v97, s43
    v_perm_b32 v61, v101, v97, s44
    v_perm_b32 v65, v102, v98, s43
    v_perm_b32 v69, v102, v98, s44
    v_perm_b32 v73, v103, v99, s43
    v_perm_b32 v77, v103, v99, s44
    s_add_u32 s48, s75, 294912
    buffer_load_dwordx4 v[96:99], v3, s[64:67], s48 offen offset:0 nt
    buffer_load_dwordx4 v[100:103], v3, s[64:67], s48 offen offset:1024 nt
    s_waitcnt vmcnt(13)
    s_waitcnt vmcnt(12)
    v_perm_b32 v50, v108, v104, s43
    v_perm_b32 v54, v108, v104, s44
    v_perm_b32 v58, v109, v105, s43
    v_perm_b32 v62, v109, v105, s44
    v_perm_b32 v66, v110, v106, s43
    v_perm_b32 v70, v110, v106, s44
    v_perm_b32 v74, v111, v107, s43
    v_perm_b32 v78, v111, v107, s44
    buffer_load_dwordx4 v[104:107], v3, s[64:67], s48 offen offset:2048 nt
    buffer_load_dwordx4 v[108:111], v3, s[64:67], s48 offen offset:3072 nt
    s_waitcnt vmcnt(13)
    s_waitcnt vmcnt(12)
    v_perm_b32 v51, v128, v112, s43
    v_perm_b32 v55, v128, v112, s44
    v_perm_b32 v59, v129, v113, s43
    v_perm_b32 v63, v129, v113, s44
    v_perm_b32 v67, v130, v114, s43
    v_perm_b32 v71, v130, v114, s44
    v_perm_b32 v75, v131, v115, s43
    v_perm_b32 v79, v131, v115, s44
    s_waitcnt lgkmcnt(0)
    v_mfma_f32_16x16x32_bf16 v[16:19], v[48:51], v[84:87], v[16:19]
    v_mfma_f32_16x16x32_bf16 v[20:23], v[52:55], v[84:87], v[20:23]
    v_mfma_f32_16x16x32_bf16 v[24:27], v[56:59], v[84:87], v[24:27]
    v_mfma_f32_16x16x32_bf16 v[28:31], v[60:63], v[84:87], v[28:31]
    v_mfma_f32_16x16x32_bf16 v[32:35], v[64:67], v[84:87], v[32:35]
    v_mfma_f32_16x16x32_bf16 v[36:39], v[68:71], v[84:87], v[36:39]
    v_mfma_f32_16x16x32_bf16 v[40:43], v[72:75], v[84:87], v[40:43]
    v_mfma_f32_16x16x32_bf16 v[44:47], v[76:79], v[84:87], v[44:47]
    buffer_load_dwordx4 v[112:115], v4, s[64:67], s48 offen offset:0 nt
    ds_read_b128 v[80:83], v7 offset:9728
    buffer_load_dwordx4 v[128:131], v4, s[64:67], s48 offen offset:1024 nt
    s_waitcnt vmcnt(13)
    s_waitcnt vmcnt(12)
    v_perm_b32 v48, v136, v132, s43
    v_perm_b32 v52, v136, v132, s44
    v_perm_b32 v56, v137, v133, s43
    v_perm_b32 v60, v137, v133, s44
    v_perm_b32 v64, v138, v134, s43
    v_perm_b32 v68, v138, v134, s44
    v_perm_b32 v72, v139, v135, s43
    v_perm_b32 v76, v139, v135, s44
    buffer_load_dwordx4 v[132:135], v4, s[64:67], s48 offen offset:2048 nt
    buffer_load_dwordx4 v[136:139], v4, s[64:67], s48 offen offset:3072 nt
    s_waitcnt vmcnt(13)
    s_waitcnt vmcnt(12)
    v_perm_b32 v49, v140, v116, s43
    v_perm_b32 v53, v140, v116, s44
    v_perm_b32 v57, v141, v117, s43
    v_perm_b32 v61, v141, v117, s44
    v_perm_b32 v65, v142, v118, s43
    v_perm_b32 v69, v142, v118, s44
    v_perm_b32 v73, v143, v119, s43
    v_perm_b32 v77, v143, v119, s44
    s_add_u32 s48, s75, 327680
    buffer_load_dwordx4 v[116:119], v3, s[64:67], s48 offen offset:0 nt
    buffer_load_dwordx4 v[140:143], v3, s[64:67], s48 offen offset:1024 nt
    s_waitcnt vmcnt(13)
    s_waitcnt vmcnt(12)
    v_perm_b32 v50, v124, v120, s43
    v_perm_b32 v54, v124, v120, s44
    v_perm_b32 v58, v125, v121, s43
    v_perm_b32 v62, v125, v121, s44
    v_perm_b32 v66, v126, v122, s43
    v_perm_b32 v70, v126, v122, s44
    v_perm_b32 v74, v127, v123, s43
    v_perm_b32 v78, v127, v123, s44
    buffer_load_dwordx4 v[120:123], v3, s[64:67], s48 offen offset:2048 nt
    buffer_load_dwordx4 v[124:127], v3, s[64:67], s48 offen offset:3072 nt
    s_waitcnt vmcnt(13)
    s_waitcnt vmcnt(12)
    v_perm_b32 v51, v92, v88, s43
    v_perm_b32 v55, v92, v88, s44
    v_perm_b32 v59, v93, v89, s43
    v_perm_b32 v63, v93, v89, s44
    v_perm_b32 v67, v94, v90, s43
    v_perm_b32 v71, v94, v90, s44
    v_perm_b32 v75, v95, v91, s43
    v_perm_b32 v79, v95, v91, s44
    s_waitcnt lgkmcnt(0)
    v_mfma_f32_16x16x32_bf16 v[16:19], v[48:51], v[80:83], v[16:19]
    v_mfma_f32_16x16x32_bf16 v[20:23], v[52:55], v[80:83], v[20:23]
    v_mfma_f32_16x16x32_bf16 v[24:27], v[56:59], v[80:83], v[24:27]
    v_mfma_f32_16x16x32_bf16 v[28:31], v[60:63], v[80:83], v[28:31]
    v_mfma_f32_16x16x32_bf16 v[32:35], v[64:67], v[80:83], v[32:35]
    v_mfma_f32_16x16x32_bf16 v[36:39], v[68:71], v[80:83], v[36:39]
    v_mfma_f32_16x16x32_bf16 v[40:43], v[72:75], v[80:83], v[40:43]
    v_mfma_f32_16x16x32_bf16 v[44:47], v[76:79], v[80:83], v[44:47]
    buffer_load_dwordx4 v[88:91], v4, s[64:67], s48 offen offset:0 nt
    ds_read_b128 v[84:87], v7 offset:9792
    buffer_load_dwordx4 v[92:95], v4, s[64:67], s48 offen offset:1024 nt
    s_waitcnt vmcnt(13)
    s_waitcnt vmcnt(12)
    v_perm_b32 v48, v100, v96, s43
    v_perm_b32 v52, v100, v96, s44
    v_perm_b32 v56, v101, v97, s43
    v_perm_b32 v60, v101, v97, s44
    v_perm_b32 v64, v102, v98, s43
    v_perm_b32 v68, v102, v98, s44
    v_perm_b32 v72, v103, v99, s43
    v_perm_b32 v76, v103, v99, s44
    buffer_load_dwordx4 v[96:99], v4, s[64:67], s48 offen offset:2048 nt
    buffer_load_dwordx4 v[100:103], v4, s[64:67], s48 offen offset:3072 nt
    s_waitcnt vmcnt(13)
    s_waitcnt vmcnt(12)
    v_perm_b32 v49, v108, v104, s43
    v_perm_b32 v53, v108, v104, s44
    v_perm_b32 v57, v109, v105, s43
    v_perm_b32 v61, v109, v105, s44
    v_perm_b32 v65, v110, v106, s43
    v_perm_b32 v69, v110, v106, s44
    v_perm_b32 v73, v111, v107, s43
    v_perm_b32 v77, v111, v107, s44
    s_add_u32 s48, s75, 360448
    buffer_load_dwordx4 v[104:107], v3, s[64:67], s48 offen offset:0 nt
    buffer_load_dwordx4 v[108:111], v3, s[64:67], s48 offen offset:1024 nt
    s_waitcnt vmcnt(13)
    s_waitcnt vmcnt(12)
    v_perm_b32 v50, v128, v112, s43
    v_perm_b32 v54, v128, v112, s44
    v_perm_b32 v58, v129, v113, s43
    v_perm_b32 v62, v129, v113, s44
    v_perm_b32 v66, v130, v114, s43
    v_perm_b32 v70, v130, v114, s44
    v_perm_b32 v74, v131, v115, s43
    v_perm_b32 v78, v131, v115, s44
    buffer_load_dwordx4 v[112:115], v3, s[64:67], s48 offen offset:2048 nt
    buffer_load_dwordx4 v[128:131], v3, s[64:67], s48 offen offset:3072 nt
    s_waitcnt vmcnt(13)
    s_waitcnt vmcnt(12)
    v_perm_b32 v51, v136, v132, s43
    v_perm_b32 v55, v136, v132, s44
    v_perm_b32 v59, v137, v133, s43
    v_perm_b32 v63, v137, v133, s44
    v_perm_b32 v67, v138, v134, s43
    v_perm_b32 v71, v138, v134, s44
    v_perm_b32 v75, v139, v135, s43
    v_perm_b32 v79, v139, v135, s44
    s_waitcnt lgkmcnt(0)
    v_mfma_f32_16x16x32_bf16 v[16:19], v[48:51], v[84:87], v[16:19]
    v_mfma_f32_16x16x32_bf16 v[20:23], v[52:55], v[84:87], v[20:23]
    v_mfma_f32_16x16x32_bf16 v[24:27], v[56:59], v[84:87], v[24:27]
    v_mfma_f32_16x16x32_bf16 v[28:31], v[60:63], v[84:87], v[28:31]
    v_mfma_f32_16x16x32_bf16 v[32:35], v[64:67], v[84:87], v[32:35]
    v_mfma_f32_16x16x32_bf16 v[36:39], v[68:71], v[84:87], v[36:39]
    v_mfma_f32_16x16x32_bf16 v[40:43], v[72:75], v[84:87], v[40:43]
    v_mfma_f32_16x16x32_bf16 v[44:47], v[76:79], v[84:87], v[44:47]
    buffer_load_dwordx4 v[132:135], v4, s[64:67], s48 offen offset:0 nt
    ds_read_b128 v[80:83], v7 offset:9856
    buffer_load_dwordx4 v[136:139], v4, s[64:67], s48 offen offset:1024 nt
    s_waitcnt vmcnt(13)
    s_waitcnt vmcnt(12)
    v_perm_b32 v48, v140, v116, s43
    v_perm_b32 v52, v140, v116, s44
    v_perm_b32 v56, v141, v117, s43
    v_perm_b32 v60, v141, v117, s44
    v_perm_b32 v64, v142, v118, s43
    v_perm_b32 v68, v142, v118, s44
    v_perm_b32 v72, v143, v119, s43
    v_perm_b32 v76, v143, v119, s44
    buffer_load_dwordx4 v[116:119], v4, s[64:67], s48 offen offset:2048 nt
    buffer_load_dwordx4 v[140:143], v4, s[64:67], s48 offen offset:3072 nt
    s_waitcnt vmcnt(13)
    s_waitcnt vmcnt(12)
    v_perm_b32 v49, v124, v120, s43
    v_perm_b32 v53, v124, v120, s44
    v_perm_b32 v57, v125, v121, s43
    v_perm_b32 v61, v125, v121, s44
    v_perm_b32 v65, v126, v122, s43
    v_perm_b32 v69, v126, v122, s44
    v_perm_b32 v73, v127, v123, s43
    v_perm_b32 v77, v127, v123, s44
    s_add_u32 s48, s75, 393216
    buffer_load_dwordx4 v[120:123], v3, s[64:67], s48 offen offset:0 nt
    buffer_load_dwordx4 v[124:127], v3, s[64:67], s48 offen offset:1024 nt
    s_waitcnt vmcnt(13)
    s_waitcnt vmcnt(12)
    v_perm_b32 v50, v92, v88, s43
    v_perm_b32 v54, v92, v88, s44
    v_perm_b32 v58, v93, v89, s43
    v_perm_b32 v62, v93, v89, s44
    v_perm_b32 v66, v94, v90, s43
    v_perm_b32 v70, v94, v90, s44
    v_perm_b32 v74, v95, v91, s43
    v_perm_b32 v78, v95, v91, s44
    buffer_load_dwordx4 v[88:91], v3, s[64:67], s48 offen offset:2048 nt
    buffer_load_dwordx4 v[92:95], v3, s[64:67], s48 offen offset:3072 nt
    s_waitcnt vmcnt(13)
    s_waitcnt vmcnt(12)
    v_perm_b32 v51, v100, v96, s43
    v_perm_b32 v55, v100, v96, s44
    v_perm_b32 v59, v101, v97, s43
    v_perm_b32 v63, v101, v97, s44
    v_perm_b32 v67, v102, v98, s43
    v_perm_b32 v71, v102, v98, s44
    v_perm_b32 v75, v103, v99, s43
    v_perm_b32 v79, v103, v99, s44
    s_waitcnt lgkmcnt(0)
    v_mfma_f32_16x16x32_bf16 v[16:19], v[48:51], v[80:83], v[16:19]
    v_mfma_f32_16x16x32_bf16 v[20:23], v[52:55], v[80:83], v[20:23]
    v_mfma_f32_16x16x32_bf16 v[24:27], v[56:59], v[80:83], v[24:27]
    v_mfma_f32_16x16x32_bf16 v[28:31], v[60:63], v[80:83], v[28:31]
    v_mfma_f32_16x16x32_bf16 v[32:35], v[64:67], v[80:83], v[32:35]
    v_mfma_f32_16x16x32_bf16 v[36:39], v[68:71], v[80:83], v[36:39]
    v_mfma_f32_16x16x32_bf16 v[40:43], v[72:75], v[80:83], v[40:43]
    v_mfma_f32_16x16x32_bf16 v[44:47], v[76:79], v[80:83], v[44:47]
    buffer_load_dwordx4 v[96:99], v4, s[64:67], s48 offen offset:0 nt
    ds_read_b128 v[84:87], v7 offset:9920
    buffer_load_dwordx4 v[100:103], v4, s[64:67], s48 offen offset:1024 nt
    s_waitcnt vmcnt(13)
    s_waitcnt vmcnt(12)
    v_perm_b32 v48, v108, v104, s43
    v_perm_b32 v52, v108, v104, s44
    v_perm_b32 v56, v109, v105, s43
    v_perm_b32 v60, v109, v105, s44
    v_perm_b32 v64, v110, v106, s43
    v_perm_b32 v68, v110, v106, s44
    v_perm_b32 v72, v111, v107, s43
    v_perm_b32 v76, v111, v107, s44
    buffer_load_dwordx4 v[104:107], v4, s[64:67], s48 offen offset:2048 nt
    buffer_load_dwordx4 v[108:111], v4, s[64:67], s48 offen offset:3072 nt
    s_waitcnt vmcnt(13)
    s_waitcnt vmcnt(12)
    v_perm_b32 v49, v128, v112, s43
    v_perm_b32 v53, v128, v112, s44
    v_perm_b32 v57, v129, v113, s43
    v_perm_b32 v61, v129, v113, s44
    v_perm_b32 v65, v130, v114, s43
    v_perm_b32 v69, v130, v114, s44
    v_perm_b32 v73, v131, v115, s43
    v_perm_b32 v77, v131, v115, s44
    s_add_u32 s48, s75, 425984
    buffer_load_dwordx4 v[112:115], v3, s[64:67], s48 offen offset:0 nt
    buffer_load_dwordx4 v[128:131], v3, s[64:67], s48 offen offset:1024 nt
    s_waitcnt vmcnt(13)
    s_waitcnt vmcnt(12)
    v_perm_b32 v50, v136, v132, s43
    v_perm_b32 v54, v136, v132, s44
    v_perm_b32 v58, v137, v133, s43
    v_perm_b32 v62, v137, v133, s44
    v_perm_b32 v66, v138, v134, s43
    v_perm_b32 v70, v138, v134, s44
    v_perm_b32 v74, v139, v135, s43
    v_perm_b32 v78, v139, v135, s44
    buffer_load_dwordx4 v[132:135], v3, s[64:67], s48 offen offset:2048 nt
    buffer_load_dwordx4 v[136:139], v3, s[64:67], s48 offen offset:3072 nt
    s_waitcnt vmcnt(13)
    s_waitcnt vmcnt(12)
    v_perm_b32 v51, v140, v116, s43
    v_perm_b32 v55, v140, v116, s44
    v_perm_b32 v59, v141, v117, s43
    v_perm_b32 v63, v141, v117, s44
    v_perm_b32 v67, v142, v118, s43
    v_perm_b32 v71, v142, v118, s44
    v_perm_b32 v75, v143, v119, s43
    v_perm_b32 v79, v143, v119, s44
    s_waitcnt lgkmcnt(0)
    v_mfma_f32_16x16x32_bf16 v[16:19], v[48:51], v[84:87], v[16:19]
    v_mfma_f32_16x16x32_bf16 v[20:23], v[52:55], v[84:87], v[20:23]
    v_mfma_f32_16x16x32_bf16 v[24:27], v[56:59], v[84:87], v[24:27]
    v_mfma_f32_16x16x32_bf16 v[28:31], v[60:63], v[84:87], v[28:31]
    v_mfma_f32_16x16x32_bf16 v[32:35], v[64:67], v[84:87], v[32:35]
    v_mfma_f32_16x16x32_bf16 v[36:39], v[68:71], v[84:87], v[36:39]
    v_mfma_f32_16x16x32_bf16 v[40:43], v[72:75], v[84:87], v[40:43]
    v_mfma_f32_16x16x32_bf16 v[44:47], v[76:79], v[84:87], v[44:47]
    buffer_load_dwordx4 v[116:119], v4, s[64:67], s48 offen offset:0 nt
    ds_read_b128 v[80:83], v7 offset:9984
    buffer_load_dwordx4 v[140:143], v4, s[64:67], s48 offen offset:1024 nt
    s_waitcnt vmcnt(13)
    s_waitcnt vmcnt(12)
    v_perm_b32 v48, v124, v120, s43
    v_perm_b32 v52, v124, v120, s44
    v_perm_b32 v56, v125, v121, s43
    v_perm_b32 v60, v125, v121, s44
    v_perm_b32 v64, v126, v122, s43
    v_perm_b32 v68, v126, v122, s44
    v_perm_b32 v72, v127, v123, s43
    v_perm_b32 v76, v127, v123, s44
    buffer_load_dwordx4 v[120:123], v4, s[64:67], s48 offen offset:2048 nt
    buffer_load_dwordx4 v[124:127], v4, s[64:67], s48 offen offset:3072 nt
    s_waitcnt vmcnt(13)
    s_waitcnt vmcnt(12)
    v_perm_b32 v49, v92, v88, s43
    v_perm_b32 v53, v92, v88, s44
    v_perm_b32 v57, v93, v89, s43
    v_perm_b32 v61, v93, v89, s44
    v_perm_b32 v65, v94, v90, s43
    v_perm_b32 v69, v94, v90, s44
    v_perm_b32 v73, v95, v91, s43
    v_perm_b32 v77, v95, v91, s44
    s_add_u32 s48, s75, 458752
    buffer_load_dwordx4 v[88:91], v3, s[64:67], s48 offen offset:0 nt
    buffer_load_dwordx4 v[92:95], v3, s[64:67], s48 offen offset:1024 nt
    s_waitcnt vmcnt(13)
    s_waitcnt vmcnt(12)
    v_perm_b32 v50, v100, v96, s43
    v_perm_b32 v54, v100, v96, s44
    v_perm_b32 v58, v101, v97, s43
    v_perm_b32 v62, v101, v97, s44
    v_perm_b32 v66, v102, v98, s43
    v_perm_b32 v70, v102, v98, s44
    v_perm_b32 v74, v103, v99, s43
    v_perm_b32 v78, v103, v99, s44
    buffer_load_dwordx4 v[96:99], v3, s[64:67], s48 offen offset:2048 nt
    buffer_load_dwordx4 v[100:103], v3, s[64:67], s48 offen offset:3072 nt
    s_waitcnt vmcnt(13)
    s_waitcnt vmcnt(12)
    v_perm_b32 v51, v108, v104, s43
    v_perm_b32 v55, v108, v104, s44
    v_perm_b32 v59, v109, v105, s43
    v_perm_b32 v63, v109, v105, s44
    v_perm_b32 v67, v110, v106, s43
    v_perm_b32 v71, v110, v106, s44
    v_perm_b32 v75, v111, v107, s43
    v_perm_b32 v79, v111, v107, s44
    s_waitcnt lgkmcnt(0)
    v_mfma_f32_16x16x32_bf16 v[16:19], v[48:51], v[80:83], v[16:19]
    v_mfma_f32_16x16x32_bf16 v[20:23], v[52:55], v[80:83], v[20:23]
    v_mfma_f32_16x16x32_bf16 v[24:27], v[56:59], v[80:83], v[24:27]
    v_mfma_f32_16x16x32_bf16 v[28:31], v[60:63], v[80:83], v[28:31]
    v_mfma_f32_16x16x32_bf16 v[32:35], v[64:67], v[80:83], v[32:35]
    v_mfma_f32_16x16x32_bf16 v[36:39], v[68:71], v[80:83], v[36:39]
    v_mfma_f32_16x16x32_bf16 v[40:43], v[72:75], v[80:83], v[40:43]
    v_mfma_f32_16x16x32_bf16 v[44:47], v[76:79], v[80:83], v[44:47]
    buffer_load_dwordx4 v[104:107], v4, s[64:67], s48 offen offset:0 nt
    ds_read_b128 v[84:87], v7 offset:10048
    buffer_load_dwordx4 v[108:111], v4, s[64:67], s48 offen offset:1024 nt
    s_waitcnt vmcnt(13)
    s_waitcnt vmcnt(12)
    v_perm_b32 v48, v128, v112, s43
    v_perm_b32 v52, v128, v112, s44
    v_perm_b32 v56, v129, v113, s43
    v_perm_b32 v60, v129, v113, s44
    v_perm_b32 v64, v130, v114, s43
    v_perm_b32 v68, v130, v114, s44
    v_perm_b32 v72, v131, v115, s43
    v_perm_b32 v76, v131, v115, s44
    buffer_load_dwordx4 v[112:115], v4, s[64:67], s48 offen offset:2048 nt
    buffer_load_dwordx4 v[128:131], v4, s[64:67], s48 offen offset:3072 nt
    s_waitcnt vmcnt(13)
    s_waitcnt vmcnt(12)
    v_perm_b32 v49, v136, v132, s43
    v_perm_b32 v53, v136, v132, s44
    v_perm_b32 v57, v137, v133, s43
    v_perm_b32 v61, v137, v133, s44
    v_perm_b32 v65, v138, v134, s43
    v_perm_b32 v69, v138, v134, s44
    v_perm_b32 v73, v139, v135, s43
    v_perm_b32 v77, v139, v135, s44
    s_add_u32 s48, s75, 491520
    buffer_load_dwordx4 v[132:135], v3, s[64:67], s48 offen offset:0 nt
    buffer_load_dwordx4 v[136:139], v3, s[64:67], s48 offen offset:1024 nt
    s_waitcnt vmcnt(13)
    s_waitcnt vmcnt(12)
    v_perm_b32 v50, v140, v116, s43
    v_perm_b32 v54, v140, v116, s44
    v_perm_b32 v58, v141, v117, s43
    v_perm_b32 v62, v141, v117, s44
    v_perm_b32 v66, v142, v118, s43
    v_perm_b32 v70, v142, v118, s44
    v_perm_b32 v74, v143, v119, s43
    v_perm_b32 v78, v143, v119, s44
    buffer_load_dwordx4 v[116:119], v3, s[64:67], s48 offen offset:2048 nt
    buffer_load_dwordx4 v[140:143], v3, s[64:67], s48 offen offset:3072 nt
    s_waitcnt vmcnt(13)
    s_waitcnt vmcnt(12)
    v_perm_b32 v51, v124, v120, s43
    v_perm_b32 v55, v124, v120, s44
    v_perm_b32 v59, v125, v121, s43
    v_perm_b32 v63, v125, v121, s44
    v_perm_b32 v67, v126, v122, s43
    v_perm_b32 v71, v126, v122, s44
    v_perm_b32 v75, v127, v123, s43
    v_perm_b32 v79, v127, v123, s44
    s_waitcnt lgkmcnt(0)
    v_mfma_f32_16x16x32_bf16 v[16:19], v[48:51], v[84:87], v[16:19]
    v_mfma_f32_16x16x32_bf16 v[20:23], v[52:55], v[84:87], v[20:23]
    v_mfma_f32_16x16x32_bf16 v[24:27], v[56:59], v[84:87], v[24:27]
    v_mfma_f32_16x16x32_bf16 v[28:31], v[60:63], v[84:87], v[28:31]
    v_mfma_f32_16x16x32_bf16 v[32:35], v[64:67], v[84:87], v[32:35]
    v_mfma_f32_16x16x32_bf16 v[36:39], v[68:71], v[84:87], v[36:39]
    v_mfma_f32_16x16x32_bf16 v[40:43], v[72:75], v[84:87], v[40:43]
    v_mfma_f32_16x16x32_bf16 v[44:47], v[76:79], v[84:87], v[44:47]
    buffer_load_dwordx4 v[120:123], v4, s[64:67], s48 offen offset:0 nt
    ds_read_b128 v[80:83], v7 offset:10112
    buffer_load_dwordx4 v[124:127], v4, s[64:67], s48 offen offset:1024 nt
    s_waitcnt vmcnt(13)
    s_waitcnt vmcnt(12)
    v_perm_b32 v48, v92, v88, s43
    v_perm_b32 v52, v92, v88, s44
    v_perm_b32 v56, v93, v89, s43
    v_perm_b32 v60, v93, v89, s44
    v_perm_b32 v64, v94, v90, s43
    v_perm_b32 v68, v94, v90, s44
    v_perm_b32 v72, v95, v91, s43
    v_perm_b32 v76, v95, v91, s44
    buffer_load_dwordx4 v[88:91], v4, s[64:67], s48 offen offset:2048 nt
    buffer_load_dwordx4 v[92:95], v4, s[64:67], s48 offen offset:3072 nt
    s_waitcnt vmcnt(13)
    s_waitcnt vmcnt(12)
    v_perm_b32 v49, v100, v96, s43
    v_perm_b32 v53, v100, v96, s44
    v_perm_b32 v57, v101, v97, s43
    v_perm_b32 v61, v101, v97, s44
    v_perm_b32 v65, v102, v98, s43
    v_perm_b32 v69, v102, v98, s44
    v_perm_b32 v73, v103, v99, s43
    v_perm_b32 v77, v103, v99, s44
    s_add_u32 s48, s75, 524288
    buffer_load_dwordx4 v[96:99], v3, s[64:67], s48 offen offset:0 nt
    buffer_load_dwordx4 v[100:103], v3, s[64:67], s48 offen offset:1024 nt
    s_waitcnt vmcnt(13)
    s_waitcnt vmcnt(12)
    v_perm_b32 v50, v108, v104, s43
    v_perm_b32 v54, v108, v104, s44
    v_perm_b32 v58, v109, v105, s43
    v_perm_b32 v62, v109, v105, s44
    v_perm_b32 v66, v110, v106, s43
    v_perm_b32 v70, v110, v106, s44
    v_perm_b32 v74, v111, v107, s43
    v_perm_b32 v78, v111, v107, s44
    buffer_load_dwordx4 v[104:107], v3, s[64:67], s48 offen offset:2048 nt
    buffer_load_dwordx4 v[108:111], v3, s[64:67], s48 offen offset:3072 nt
    s_waitcnt vmcnt(13)
    s_waitcnt vmcnt(12)
    v_perm_b32 v51, v128, v112, s43
    v_perm_b32 v55, v128, v112, s44
    v_perm_b32 v59, v129, v113, s43
    v_perm_b32 v63, v129, v113, s44
    v_perm_b32 v67, v130, v114, s43
    v_perm_b32 v71, v130, v114, s44
    v_perm_b32 v75, v131, v115, s43
    v_perm_b32 v79, v131, v115, s44
    s_waitcnt lgkmcnt(0)
    v_mfma_f32_16x16x32_bf16 v[16:19], v[48:51], v[80:83], v[16:19]
    v_mfma_f32_16x16x32_bf16 v[20:23], v[52:55], v[80:83], v[20:23]
    v_mfma_f32_16x16x32_bf16 v[24:27], v[56:59], v[80:83], v[24:27]
    v_mfma_f32_16x16x32_bf16 v[28:31], v[60:63], v[80:83], v[28:31]
    v_mfma_f32_16x16x32_bf16 v[32:35], v[64:67], v[80:83], v[32:35]
    v_mfma_f32_16x16x32_bf16 v[36:39], v[68:71], v[80:83], v[36:39]
    v_mfma_f32_16x16x32_bf16 v[40:43], v[72:75], v[80:83], v[40:43]
    v_mfma_f32_16x16x32_bf16 v[44:47], v[76:79], v[80:83], v[44:47]
    buffer_load_dwordx4 v[112:115], v4, s[64:67], s48 offen offset:0 nt
    ds_read_b128 v[84:87], v7 offset:10176
    buffer_load_dwordx4 v[128:131], v4, s[64:67], s48 offen offset:1024 nt
    s_waitcnt vmcnt(13)
    s_waitcnt vmcnt(12)
    v_perm_b32 v48, v136, v132, s43
    v_perm_b32 v52, v136, v132, s44
    v_perm_b32 v56, v137, v133, s43
    v_perm_b32 v60, v137, v133, s44
    v_perm_b32 v64, v138, v134, s43
    v_perm_b32 v68, v138, v134, s44
    v_perm_b32 v72, v139, v135, s43
    v_perm_b32 v76, v139, v135, s44
    buffer_load_dwordx4 v[132:135], v4, s[64:67], s48 offen offset:2048 nt
    buffer_load_dwordx4 v[136:139], v4, s[64:67], s48 offen offset:3072 nt
    s_waitcnt vmcnt(13)
    s_waitcnt vmcnt(12)
    v_perm_b32 v49, v140, v116, s43
    v_perm_b32 v53, v140, v116, s44
    v_perm_b32 v57, v141, v117, s43
    v_perm_b32 v61, v141, v117, s44
    v_perm_b32 v65, v142, v118, s43
    v_perm_b32 v69, v142, v118, s44
    v_perm_b32 v73, v143, v119, s43
    v_perm_b32 v77, v143, v119, s44
    s_add_u32 s48, s75, 557056
    buffer_load_dwordx4 v[116:119], v3, s[64:67], s48 offen offset:0 nt
    buffer_load_dwordx4 v[140:143], v3, s[64:67], s48 offen offset:1024 nt
    s_waitcnt vmcnt(13)
    s_waitcnt vmcnt(12)
    v_perm_b32 v50, v124, v120, s43
    v_perm_b32 v54, v124, v120, s44
    v_perm_b32 v58, v125, v121, s43
    v_perm_b32 v62, v125, v121, s44
    v_perm_b32 v66, v126, v122, s43
    v_perm_b32 v70, v126, v122, s44
    v_perm_b32 v74, v127, v123, s43
    v_perm_b32 v78, v127, v123, s44
    buffer_load_dwordx4 v[120:123], v3, s[64:67], s48 offen offset:2048 nt
    buffer_load_dwordx4 v[124:127], v3, s[64:67], s48 offen offset:3072 nt
    s_waitcnt vmcnt(13)
    s_waitcnt vmcnt(12)
    v_perm_b32 v51, v92, v88, s43
    v_perm_b32 v55, v92, v88, s44
    v_perm_b32 v59, v93, v89, s43
    v_perm_b32 v63, v93, v89, s44
    v_perm_b32 v67, v94, v90, s43
    v_perm_b32 v71, v94, v90, s44
    v_perm_b32 v75, v95, v91, s43
    v_perm_b32 v79, v95, v91, s44
    s_waitcnt lgkmcnt(0)
    v_mfma_f32_16x16x32_bf16 v[16:19], v[48:51], v[84:87], v[16:19]
    v_mfma_f32_16x16x32_bf16 v[20:23], v[52:55], v[84:87], v[20:23]
    v_mfma_f32_16x16x32_bf16 v[24:27], v[56:59], v[84:87], v[24:27]
    v_mfma_f32_16x16x32_bf16 v[28:31], v[60:63], v[84:87], v[28:31]
    v_mfma_f32_16x16x32_bf16 v[32:35], v[64:67], v[84:87], v[32:35]
    v_mfma_f32_16x16x32_bf16 v[36:39], v[68:71], v[84:87], v[36:39]
    v_mfma_f32_16x16x32_bf16 v[40:43], v[72:75], v[84:87], v[40:43]
    v_mfma_f32_16x16x32_bf16 v[44:47], v[76:79], v[84:87], v[44:47]
    buffer_load_dwordx4 v[88:91], v4, s[64:67], s48 offen offset:0 nt
    ds_read_b128 v[80:83], v7 offset:10240
    buffer_load_dwordx4 v[92:95], v4, s[64:67], s48 offen offset:1024 nt
    s_waitcnt vmcnt(13)
    s_waitcnt vmcnt(12)
    v_perm_b32 v48, v100, v96, s43
    v_perm_b32 v52, v100, v96, s44
    v_perm_b32 v56, v101, v97, s43
    v_perm_b32 v60, v101, v97, s44
    v_perm_b32 v64, v102, v98, s43
    v_perm_b32 v68, v102, v98, s44
    v_perm_b32 v72, v103, v99, s43
    v_perm_b32 v76, v103, v99, s44
    buffer_load_dwordx4 v[96:99], v4, s[64:67], s48 offen offset:2048 nt
    buffer_load_dwordx4 v[100:103], v4, s[64:67], s48 offen offset:3072 nt
    s_waitcnt vmcnt(13)
    s_waitcnt vmcnt(12)
    v_perm_b32 v49, v108, v104, s43
    v_perm_b32 v53, v108, v104, s44
    v_perm_b32 v57, v109, v105, s43
    v_perm_b32 v61, v109, v105, s44
    v_perm_b32 v65, v110, v106, s43
    v_perm_b32 v69, v110, v106, s44
    v_perm_b32 v73, v111, v107, s43
    v_perm_b32 v77, v111, v107, s44
    s_add_u32 s48, s75, 589824
    buffer_load_dwordx4 v[104:107], v3, s[64:67], s48 offen offset:0 nt
    buffer_load_dwordx4 v[108:111], v3, s[64:67], s48 offen offset:1024 nt
    s_waitcnt vmcnt(13)
    s_waitcnt vmcnt(12)
    v_perm_b32 v50, v128, v112, s43
    v_perm_b32 v54, v128, v112, s44
    v_perm_b32 v58, v129, v113, s43
    v_perm_b32 v62, v129, v113, s44
    v_perm_b32 v66, v130, v114, s43
    v_perm_b32 v70, v130, v114, s44
    v_perm_b32 v74, v131, v115, s43
    v_perm_b32 v78, v131, v115, s44
    buffer_load_dwordx4 v[112:115], v3, s[64:67], s48 offen offset:2048 nt
    buffer_load_dwordx4 v[128:131], v3, s[64:67], s48 offen offset:3072 nt
    s_waitcnt vmcnt(13)
    s_waitcnt vmcnt(12)
    v_perm_b32 v51, v136, v132, s43
    v_perm_b32 v55, v136, v132, s44
    v_perm_b32 v59, v137, v133, s43
    v_perm_b32 v63, v137, v133, s44
    v_perm_b32 v67, v138, v134, s43
    v_perm_b32 v71, v138, v134, s44
    v_perm_b32 v75, v139, v135, s43
    v_perm_b32 v79, v139, v135, s44
    s_waitcnt lgkmcnt(0)
    v_mfma_f32_16x16x32_bf16 v[16:19], v[48:51], v[80:83], v[16:19]
    v_mfma_f32_16x16x32_bf16 v[20:23], v[52:55], v[80:83], v[20:23]
    v_mfma_f32_16x16x32_bf16 v[24:27], v[56:59], v[80:83], v[24:27]
    v_mfma_f32_16x16x32_bf16 v[28:31], v[60:63], v[80:83], v[28:31]
    v_mfma_f32_16x16x32_bf16 v[32:35], v[64:67], v[80:83], v[32:35]
    v_mfma_f32_16x16x32_bf16 v[36:39], v[68:71], v[80:83], v[36:39]
    v_mfma_f32_16x16x32_bf16 v[40:43], v[72:75], v[80:83], v[40:43]
    v_mfma_f32_16x16x32_bf16 v[44:47], v[76:79], v[80:83], v[44:47]
    buffer_load_dwordx4 v[132:135], v4, s[64:67], s48 offen offset:0 nt
    ds_read_b128 v[84:87], v7 offset:10304
    buffer_load_dwordx4 v[136:139], v4, s[64:67], s48 offen offset:1024 nt
    s_waitcnt vmcnt(13)
    s_waitcnt vmcnt(12)
    v_perm_b32 v48, v140, v116, s43
    v_perm_b32 v52, v140, v116, s44
    v_perm_b32 v56, v141, v117, s43
    v_perm_b32 v60, v141, v117, s44
    v_perm_b32 v64, v142, v118, s43
    v_perm_b32 v68, v142, v118, s44
    v_perm_b32 v72, v143, v119, s43
    v_perm_b32 v76, v143, v119, s44
    buffer_load_dwordx4 v[116:119], v4, s[64:67], s48 offen offset:2048 nt
    buffer_load_dwordx4 v[140:143], v4, s[64:67], s48 offen offset:3072 nt
    s_waitcnt vmcnt(13)
    s_waitcnt vmcnt(12)
    v_perm_b32 v49, v124, v120, s43
    v_perm_b32 v53, v124, v120, s44
    v_perm_b32 v57, v125, v121, s43
    v_perm_b32 v61, v125, v121, s44
    v_perm_b32 v65, v126, v122, s43
    v_perm_b32 v69, v126, v122, s44
    v_perm_b32 v73, v127, v123, s43
    v_perm_b32 v77, v127, v123, s44
    s_add_u32 s48, s75, 622592
    buffer_load_dwordx4 v[120:123], v3, s[64:67], s48 offen offset:0 nt
    buffer_load_dwordx4 v[124:127], v3, s[64:67], s48 offen offset:1024 nt
    s_waitcnt vmcnt(13)
    s_waitcnt vmcnt(12)
    v_perm_b32 v50, v92, v88, s43
    v_perm_b32 v54, v92, v88, s44
    v_perm_b32 v58, v93, v89, s43
    v_perm_b32 v62, v93, v89, s44
    v_perm_b32 v66, v94, v90, s43
    v_perm_b32 v70, v94, v90, s44
    v_perm_b32 v74, v95, v91, s43
    v_perm_b32 v78, v95, v91, s44
    buffer_load_dwordx4 v[88:91], v3, s[64:67], s48 offen offset:2048 nt
    buffer_load_dwordx4 v[92:95], v3, s[64:67], s48 offen offset:3072 nt
    s_waitcnt vmcnt(13)
    s_waitcnt vmcnt(12)
    v_perm_b32 v51, v100, v96, s43
    v_perm_b32 v55, v100, v96, s44
    v_perm_b32 v59, v101, v97, s43
    v_perm_b32 v63, v101, v97, s44
    v_perm_b32 v67, v102, v98, s43
    v_perm_b32 v71, v102, v98, s44
    v_perm_b32 v75, v103, v99, s43
    v_perm_b32 v79, v103, v99, s44
    s_waitcnt lgkmcnt(0)
    v_mfma_f32_16x16x32_bf16 v[16:19], v[48:51], v[84:87], v[16:19]
    v_mfma_f32_16x16x32_bf16 v[20:23], v[52:55], v[84:87], v[20:23]
    v_mfma_f32_16x16x32_bf16 v[24:27], v[56:59], v[84:87], v[24:27]
    v_mfma_f32_16x16x32_bf16 v[28:31], v[60:63], v[84:87], v[28:31]
    v_mfma_f32_16x16x32_bf16 v[32:35], v[64:67], v[84:87], v[32:35]
    v_mfma_f32_16x16x32_bf16 v[36:39], v[68:71], v[84:87], v[36:39]
    v_mfma_f32_16x16x32_bf16 v[40:43], v[72:75], v[84:87], v[40:43]
    v_mfma_f32_16x16x32_bf16 v[44:47], v[76:79], v[84:87], v[44:47]
    buffer_load_dwordx4 v[96:99], v4, s[64:67], s48 offen offset:0 nt
    ds_read_b128 v[80:83], v7 offset:10368
    buffer_load_dwordx4 v[100:103], v4, s[64:67], s48 offen offset:1024 nt
    s_waitcnt vmcnt(13)
    s_waitcnt vmcnt(12)
    v_perm_b32 v48, v108, v104, s43
    v_perm_b32 v52, v108, v104, s44
    v_perm_b32 v56, v109, v105, s43
    v_perm_b32 v60, v109, v105, s44
    v_perm_b32 v64, v110, v106, s43
    v_perm_b32 v68, v110, v106, s44
    v_perm_b32 v72, v111, v107, s43
    v_perm_b32 v76, v111, v107, s44
    buffer_load_dwordx4 v[104:107], v4, s[64:67], s48 offen offset:2048 nt
    buffer_load_dwordx4 v[108:111], v4, s[64:67], s48 offen offset:3072 nt
    s_waitcnt vmcnt(13)
    s_waitcnt vmcnt(12)
    v_perm_b32 v49, v128, v112, s43
    v_perm_b32 v53, v128, v112, s44
    v_perm_b32 v57, v129, v113, s43
    v_perm_b32 v61, v129, v113, s44
    v_perm_b32 v65, v130, v114, s43
    v_perm_b32 v69, v130, v114, s44
    v_perm_b32 v73, v131, v115, s43
    v_perm_b32 v77, v131, v115, s44
    s_add_u32 s48, s75, 655360
    buffer_load_dwordx4 v[112:115], v3, s[64:67], s48 offen offset:0 nt
    buffer_load_dwordx4 v[128:131], v3, s[64:67], s48 offen offset:1024 nt
    s_waitcnt vmcnt(13)
    s_waitcnt vmcnt(12)
    v_perm_b32 v50, v136, v132, s43
    v_perm_b32 v54, v136, v132, s44
    v_perm_b32 v58, v137, v133, s43
    v_perm_b32 v62, v137, v133, s44
    v_perm_b32 v66, v138, v134, s43
    v_perm_b32 v70, v138, v134, s44
    v_perm_b32 v74, v139, v135, s43
    v_perm_b32 v78, v139, v135, s44
    buffer_load_dwordx4 v[132:135], v3, s[64:67], s48 offen offset:2048 nt
    buffer_load_dwordx4 v[136:139], v3, s[64:67], s48 offen offset:3072 nt
    s_waitcnt vmcnt(13)
    s_waitcnt vmcnt(12)
    v_perm_b32 v51, v140, v116, s43
    v_perm_b32 v55, v140, v116, s44
    v_perm_b32 v59, v141, v117, s43
    v_perm_b32 v63, v141, v117, s44
    v_perm_b32 v67, v142, v118, s43
    v_perm_b32 v71, v142, v118, s44
    v_perm_b32 v75, v143, v119, s43
    v_perm_b32 v79, v143, v119, s44
    s_waitcnt lgkmcnt(0)
    v_mfma_f32_16x16x32_bf16 v[16:19], v[48:51], v[80:83], v[16:19]
    v_mfma_f32_16x16x32_bf16 v[20:23], v[52:55], v[80:83], v[20:23]
    v_mfma_f32_16x16x32_bf16 v[24:27], v[56:59], v[80:83], v[24:27]
    v_mfma_f32_16x16x32_bf16 v[28:31], v[60:63], v[80:83], v[28:31]
    v_mfma_f32_16x16x32_bf16 v[32:35], v[64:67], v[80:83], v[32:35]
    v_mfma_f32_16x16x32_bf16 v[36:39], v[68:71], v[80:83], v[36:39]
    v_mfma_f32_16x16x32_bf16 v[40:43], v[72:75], v[80:83], v[40:43]
    v_mfma_f32_16x16x32_bf16 v[44:47], v[76:79], v[80:83], v[44:47]
    buffer_load_dwordx4 v[116:119], v4, s[64:67], s48 offen offset:0 nt
    ds_read_b128 v[84:87], v7 offset:10432
    buffer_load_dwordx4 v[140:143], v4, s[64:67], s48 offen offset:1024 nt
    s_waitcnt vmcnt(13)
    s_waitcnt vmcnt(12)
    v_perm_b32 v48, v124, v120, s43
    v_perm_b32 v52, v124, v120, s44
    v_perm_b32 v56, v125, v121, s43
    v_perm_b32 v60, v125, v121, s44
    v_perm_b32 v64, v126, v122, s43
    v_perm_b32 v68, v126, v122, s44
    v_perm_b32 v72, v127, v123, s43
    v_perm_b32 v76, v127, v123, s44
    buffer_load_dwordx4 v[120:123], v4, s[64:67], s48 offen offset:2048 nt
    buffer_load_dwordx4 v[124:127], v4, s[64:67], s48 offen offset:3072 nt
    s_waitcnt vmcnt(13)
    s_waitcnt vmcnt(12)
    v_perm_b32 v49, v92, v88, s43
    v_perm_b32 v53, v92, v88, s44
    v_perm_b32 v57, v93, v89, s43
    v_perm_b32 v61, v93, v89, s44
    v_perm_b32 v65, v94, v90, s43
    v_perm_b32 v69, v94, v90, s44
    v_perm_b32 v73, v95, v91, s43
    v_perm_b32 v77, v95, v91, s44
    s_add_u32 s48, s75, 688128
    buffer_load_dwordx4 v[88:91], v3, s[64:67], s48 offen offset:0 nt
    buffer_load_dwordx4 v[92:95], v3, s[64:67], s48 offen offset:1024 nt
    s_waitcnt vmcnt(13)
    s_waitcnt vmcnt(12)
    v_perm_b32 v50, v100, v96, s43
    v_perm_b32 v54, v100, v96, s44
    v_perm_b32 v58, v101, v97, s43
    v_perm_b32 v62, v101, v97, s44
    v_perm_b32 v66, v102, v98, s43
    v_perm_b32 v70, v102, v98, s44
    v_perm_b32 v74, v103, v99, s43
    v_perm_b32 v78, v103, v99, s44
    buffer_load_dwordx4 v[96:99], v3, s[64:67], s48 offen offset:2048 nt
    buffer_load_dwordx4 v[100:103], v3, s[64:67], s48 offen offset:3072 nt
    s_waitcnt vmcnt(13)
    s_waitcnt vmcnt(12)
    v_perm_b32 v51, v108, v104, s43
    v_perm_b32 v55, v108, v104, s44
    v_perm_b32 v59, v109, v105, s43
    v_perm_b32 v63, v109, v105, s44
    v_perm_b32 v67, v110, v106, s43
    v_perm_b32 v71, v110, v106, s44
    v_perm_b32 v75, v111, v107, s43
    v_perm_b32 v79, v111, v107, s44
    s_waitcnt lgkmcnt(0)
    v_mfma_f32_16x16x32_bf16 v[16:19], v[48:51], v[84:87], v[16:19]
    v_mfma_f32_16x16x32_bf16 v[20:23], v[52:55], v[84:87], v[20:23]
    v_mfma_f32_16x16x32_bf16 v[24:27], v[56:59], v[84:87], v[24:27]
    v_mfma_f32_16x16x32_bf16 v[28:31], v[60:63], v[84:87], v[28:31]
    v_mfma_f32_16x16x32_bf16 v[32:35], v[64:67], v[84:87], v[32:35]
    v_mfma_f32_16x16x32_bf16 v[36:39], v[68:71], v[84:87], v[36:39]
    v_mfma_f32_16x16x32_bf16 v[40:43], v[72:75], v[84:87], v[40:43]
    v_mfma_f32_16x16x32_bf16 v[44:47], v[76:79], v[84:87], v[44:47]
    buffer_load_dwordx4 v[104:107], v4, s[64:67], s48 offen offset:0 nt
    ds_read_b128 v[80:83], v7 offset:10496
    buffer_load_dwordx4 v[108:111], v4, s[64:67], s48 offen offset:1024 nt
    s_waitcnt vmcnt(13)
    s_waitcnt vmcnt(12)
    v_perm_b32 v48, v128, v112, s43
    v_perm_b32 v52, v128, v112, s44
    v_perm_b32 v56, v129, v113, s43
    v_perm_b32 v60, v129, v113, s44
    v_perm_b32 v64, v130, v114, s43
    v_perm_b32 v68, v130, v114, s44
    v_perm_b32 v72, v131, v115, s43
    v_perm_b32 v76, v131, v115, s44
    buffer_load_dwordx4 v[112:115], v4, s[64:67], s48 offen offset:2048 nt
    buffer_load_dwordx4 v[128:131], v4, s[64:67], s48 offen offset:3072 nt
    s_waitcnt vmcnt(13)
    s_waitcnt vmcnt(12)
    v_perm_b32 v49, v136, v132, s43
    v_perm_b32 v53, v136, v132, s44
    v_perm_b32 v57, v137, v133, s43
    v_perm_b32 v61, v137, v133, s44
    v_perm_b32 v65, v138, v134, s43
    v_perm_b32 v69, v138, v134, s44
    v_perm_b32 v73, v139, v135, s43
    v_perm_b32 v77, v139, v135, s44
    s_add_u32 s48, s75, 720896
    buffer_load_dwordx4 v[132:135], v3, s[64:67], s48 offen offset:0 nt
    buffer_load_dwordx4 v[136:139], v3, s[64:67], s48 offen offset:1024 nt
    s_waitcnt vmcnt(13)
    s_waitcnt vmcnt(12)
    v_perm_b32 v50, v140, v116, s43
    v_perm_b32 v54, v140, v116, s44
    v_perm_b32 v58, v141, v117, s43
    v_perm_b32 v62, v141, v117, s44
    v_perm_b32 v66, v142, v118, s43
    v_perm_b32 v70, v142, v118, s44
    v_perm_b32 v74, v143, v119, s43
    v_perm_b32 v78, v143, v119, s44
    buffer_load_dwordx4 v[116:119], v3, s[64:67], s48 offen offset:2048 nt
    buffer_load_dwordx4 v[140:143], v3, s[64:67], s48 offen offset:3072 nt
    s_waitcnt vmcnt(13)
    s_waitcnt vmcnt(12)
    v_perm_b32 v51, v124, v120, s43
    v_perm_b32 v55, v124, v120, s44
    v_perm_b32 v59, v125, v121, s43
    v_perm_b32 v63, v125, v121, s44
    v_perm_b32 v67, v126, v122, s43
    v_perm_b32 v71, v126, v122, s44
    v_perm_b32 v75, v127, v123, s43
    v_perm_b32 v79, v127, v123, s44
    s_waitcnt lgkmcnt(0)
    v_mfma_f32_16x16x32_bf16 v[16:19], v[48:51], v[80:83], v[16:19]
    v_mfma_f32_16x16x32_bf16 v[20:23], v[52:55], v[80:83], v[20:23]
    v_mfma_f32_16x16x32_bf16 v[24:27], v[56:59], v[80:83], v[24:27]
    v_mfma_f32_16x16x32_bf16 v[28:31], v[60:63], v[80:83], v[28:31]
    v_mfma_f32_16x16x32_bf16 v[32:35], v[64:67], v[80:83], v[32:35]
    v_mfma_f32_16x16x32_bf16 v[36:39], v[68:71], v[80:83], v[36:39]
    v_mfma_f32_16x16x32_bf16 v[40:43], v[72:75], v[80:83], v[40:43]
    v_mfma_f32_16x16x32_bf16 v[44:47], v[76:79], v[80:83], v[44:47]
    buffer_load_dwordx4 v[120:123], v4, s[64:67], s48 offen offset:0 nt
    ds_read_b128 v[84:87], v7 offset:10560
    buffer_load_dwordx4 v[124:127], v4, s[64:67], s48 offen offset:1024 nt
    s_waitcnt vmcnt(13)
    s_waitcnt vmcnt(12)
    v_perm_b32 v48, v92, v88, s43
    v_perm_b32 v52, v92, v88, s44
    v_perm_b32 v56, v93, v89, s43
    v_perm_b32 v60, v93, v89, s44
    v_perm_b32 v64, v94, v90, s43
    v_perm_b32 v68, v94, v90, s44
    v_perm_b32 v72, v95, v91, s43
    v_perm_b32 v76, v95, v91, s44
    buffer_load_dwordx4 v[88:91], v4, s[64:67], s48 offen offset:2048 nt
    buffer_load_dwordx4 v[92:95], v4, s[64:67], s48 offen offset:3072 nt
    s_waitcnt vmcnt(13)
    s_waitcnt vmcnt(12)
    v_perm_b32 v49, v100, v96, s43
    v_perm_b32 v53, v100, v96, s44
    v_perm_b32 v57, v101, v97, s43
    v_perm_b32 v61, v101, v97, s44
    v_perm_b32 v65, v102, v98, s43
    v_perm_b32 v69, v102, v98, s44
    v_perm_b32 v73, v103, v99, s43
    v_perm_b32 v77, v103, v99, s44
    s_add_u32 s48, s75, 753664
    buffer_load_dwordx4 v[96:99], v3, s[64:67], s48 offen offset:0 nt
    buffer_load_dwordx4 v[100:103], v3, s[64:67], s48 offen offset:1024 nt
    s_waitcnt vmcnt(13)
    s_waitcnt vmcnt(12)
    v_perm_b32 v50, v108, v104, s43
    v_perm_b32 v54, v108, v104, s44
    v_perm_b32 v58, v109, v105, s43
    v_perm_b32 v62, v109, v105, s44
    v_perm_b32 v66, v110, v106, s43
    v_perm_b32 v70, v110, v106, s44
    v_perm_b32 v74, v111, v107, s43
    v_perm_b32 v78, v111, v107, s44
    buffer_load_dwordx4 v[104:107], v3, s[64:67], s48 offen offset:2048 nt
    buffer_load_dwordx4 v[108:111], v3, s[64:67], s48 offen offset:3072 nt
    s_waitcnt vmcnt(13)
    s_waitcnt vmcnt(12)
    v_perm_b32 v51, v128, v112, s43
    v_perm_b32 v55, v128, v112, s44
    v_perm_b32 v59, v129, v113, s43
    v_perm_b32 v63, v129, v113, s44
    v_perm_b32 v67, v130, v114, s43
    v_perm_b32 v71, v130, v114, s44
    v_perm_b32 v75, v131, v115, s43
    v_perm_b32 v79, v131, v115, s44
    s_waitcnt lgkmcnt(0)
    v_mfma_f32_16x16x32_bf16 v[16:19], v[48:51], v[84:87], v[16:19]
    v_mfma_f32_16x16x32_bf16 v[20:23], v[52:55], v[84:87], v[20:23]
    v_mfma_f32_16x16x32_bf16 v[24:27], v[56:59], v[84:87], v[24:27]
    v_mfma_f32_16x16x32_bf16 v[28:31], v[60:63], v[84:87], v[28:31]
    v_mfma_f32_16x16x32_bf16 v[32:35], v[64:67], v[84:87], v[32:35]
    v_mfma_f32_16x16x32_bf16 v[36:39], v[68:71], v[84:87], v[36:39]
    v_mfma_f32_16x16x32_bf16 v[40:43], v[72:75], v[84:87], v[40:43]
    v_mfma_f32_16x16x32_bf16 v[44:47], v[76:79], v[84:87], v[44:47]
    buffer_load_dwordx4 v[112:115], v4, s[64:67], s48 offen offset:0 nt
    ds_read_b128 v[80:83], v7 offset:10624
    buffer_load_dwordx4 v[128:131], v4, s[64:67], s48 offen offset:1024 nt
    s_waitcnt vmcnt(13)
    s_waitcnt vmcnt(12)
    v_perm_b32 v48, v136, v132, s43
    v_perm_b32 v52, v136, v132, s44
    v_perm_b32 v56, v137, v133, s43
    v_perm_b32 v60, v137, v133, s44
    v_perm_b32 v64, v138, v134, s43
    v_perm_b32 v68, v138, v134, s44
    v_perm_b32 v72, v139, v135, s43
    v_perm_b32 v76, v139, v135, s44
    buffer_load_dwordx4 v[132:135], v4, s[64:67], s48 offen offset:2048 nt
    buffer_load_dwordx4 v[136:139], v4, s[64:67], s48 offen offset:3072 nt
    s_waitcnt vmcnt(13)
    s_waitcnt vmcnt(12)
    v_perm_b32 v49, v140, v116, s43
    v_perm_b32 v53, v140, v116, s44
    v_perm_b32 v57, v141, v117, s43
    v_perm_b32 v61, v141, v117, s44
    v_perm_b32 v65, v142, v118, s43
    v_perm_b32 v69, v142, v118, s44
    v_perm_b32 v73, v143, v119, s43
    v_perm_b32 v77, v143, v119, s44
    s_add_u32 s48, s75, 786432
    buffer_load_dwordx4 v[116:119], v3, s[64:67], s48 offen offset:0 nt
    buffer_load_dwordx4 v[140:143], v3, s[64:67], s48 offen offset:1024 nt
    s_waitcnt vmcnt(13)
    s_waitcnt vmcnt(12)
    v_perm_b32 v50, v124, v120, s43
    v_perm_b32 v54, v124, v120, s44
    v_perm_b32 v58, v125, v121, s43
    v_perm_b32 v62, v125, v121, s44
    v_perm_b32 v66, v126, v122, s43
    v_perm_b32 v70, v126, v122, s44
    v_perm_b32 v74, v127, v123, s43
    v_perm_b32 v78, v127, v123, s44
    buffer_load_dwordx4 v[120:123], v3, s[64:67], s48 offen offset:2048 nt
    buffer_load_dwordx4 v[124:127], v3, s[64:67], s48 offen offset:3072 nt
    s_waitcnt vmcnt(13)
    s_waitcnt vmcnt(12)
    v_perm_b32 v51, v92, v88, s43
    v_perm_b32 v55, v92, v88, s44
    v_perm_b32 v59, v93, v89, s43
    v_perm_b32 v63, v93, v89, s44
    v_perm_b32 v67, v94, v90, s43
    v_perm_b32 v71, v94, v90, s44
    v_perm_b32 v75, v95, v91, s43
    v_perm_b32 v79, v95, v91, s44
    s_waitcnt lgkmcnt(0)
    v_mfma_f32_16x16x32_bf16 v[16:19], v[48:51], v[80:83], v[16:19]
    v_mfma_f32_16x16x32_bf16 v[20:23], v[52:55], v[80:83], v[20:23]
    v_mfma_f32_16x16x32_bf16 v[24:27], v[56:59], v[80:83], v[24:27]
    v_mfma_f32_16x16x32_bf16 v[28:31], v[60:63], v[80:83], v[28:31]
    v_mfma_f32_16x16x32_bf16 v[32:35], v[64:67], v[80:83], v[32:35]
    v_mfma_f32_16x16x32_bf16 v[36:39], v[68:71], v[80:83], v[36:39]
    v_mfma_f32_16x16x32_bf16 v[40:43], v[72:75], v[80:83], v[40:43]
    v_mfma_f32_16x16x32_bf16 v[44:47], v[76:79], v[80:83], v[44:47]
    buffer_load_dwordx4 v[88:91], v4, s[64:67], s48 offen offset:0 nt
    ds_read_b128 v[84:87], v7 offset:10688
    buffer_load_dwordx4 v[92:95], v4, s[64:67], s48 offen offset:1024 nt
    s_waitcnt vmcnt(13)
    s_waitcnt vmcnt(12)
    v_perm_b32 v48, v100, v96, s43
    v_perm_b32 v52, v100, v96, s44
    v_perm_b32 v56, v101, v97, s43
    v_perm_b32 v60, v101, v97, s44
    v_perm_b32 v64, v102, v98, s43
    v_perm_b32 v68, v102, v98, s44
    v_perm_b32 v72, v103, v99, s43
    v_perm_b32 v76, v103, v99, s44
    buffer_load_dwordx4 v[96:99], v4, s[64:67], s48 offen offset:2048 nt
    buffer_load_dwordx4 v[100:103], v4, s[64:67], s48 offen offset:3072 nt
    s_waitcnt vmcnt(13)
    s_waitcnt vmcnt(12)
    v_perm_b32 v49, v108, v104, s43
    v_perm_b32 v53, v108, v104, s44
    v_perm_b32 v57, v109, v105, s43
    v_perm_b32 v61, v109, v105, s44
    v_perm_b32 v65, v110, v106, s43
    v_perm_b32 v69, v110, v106, s44
    v_perm_b32 v73, v111, v107, s43
    v_perm_b32 v77, v111, v107, s44
    s_add_u32 s48, s75, 819200
    buffer_load_dwordx4 v[104:107], v3, s[64:67], s48 offen offset:0 nt
    buffer_load_dwordx4 v[108:111], v3, s[64:67], s48 offen offset:1024 nt
    s_waitcnt vmcnt(13)
    s_waitcnt vmcnt(12)
    v_perm_b32 v50, v128, v112, s43
    v_perm_b32 v54, v128, v112, s44
    v_perm_b32 v58, v129, v113, s43
    v_perm_b32 v62, v129, v113, s44
    v_perm_b32 v66, v130, v114, s43
    v_perm_b32 v70, v130, v114, s44
    v_perm_b32 v74, v131, v115, s43
    v_perm_b32 v78, v131, v115, s44
    buffer_load_dwordx4 v[112:115], v3, s[64:67], s48 offen offset:2048 nt
    buffer_load_dwordx4 v[128:131], v3, s[64:67], s48 offen offset:3072 nt
    s_waitcnt vmcnt(13)
    s_waitcnt vmcnt(12)
    v_perm_b32 v51, v136, v132, s43
    v_perm_b32 v55, v136, v132, s44
    v_perm_b32 v59, v137, v133, s43
    v_perm_b32 v63, v137, v133, s44
    v_perm_b32 v67, v138, v134, s43
    v_perm_b32 v71, v138, v134, s44
    v_perm_b32 v75, v139, v135, s43
    v_perm_b32 v79, v139, v135, s44
    s_waitcnt lgkmcnt(0)
    v_mfma_f32_16x16x32_bf16 v[16:19], v[48:51], v[84:87], v[16:19]
    v_mfma_f32_16x16x32_bf16 v[20:23], v[52:55], v[84:87], v[20:23]
    v_mfma_f32_16x16x32_bf16 v[24:27], v[56:59], v[84:87], v[24:27]
    v_mfma_f32_16x16x32_bf16 v[28:31], v[60:63], v[84:87], v[28:31]
    v_mfma_f32_16x16x32_bf16 v[32:35], v[64:67], v[84:87], v[32:35]
    v_mfma_f32_16x16x32_bf16 v[36:39], v[68:71], v[84:87], v[36:39]
    v_mfma_f32_16x16x32_bf16 v[40:43], v[72:75], v[84:87], v[40:43]
    v_mfma_f32_16x16x32_bf16 v[44:47], v[76:79], v[84:87], v[44:47]
    buffer_load_dwordx4 v[132:135], v4, s[64:67], s48 offen offset:0 nt
    ds_read_b128 v[80:83], v7 offset:10752
    buffer_load_dwordx4 v[136:139], v4, s[64:67], s48 offen offset:1024 nt
    s_waitcnt vmcnt(13)
    s_waitcnt vmcnt(12)
    v_perm_b32 v48, v140, v116, s43
    v_perm_b32 v52, v140, v116, s44
    v_perm_b32 v56, v141, v117, s43
    v_perm_b32 v60, v141, v117, s44
    v_perm_b32 v64, v142, v118, s43
    v_perm_b32 v68, v142, v118, s44
    v_perm_b32 v72, v143, v119, s43
    v_perm_b32 v76, v143, v119, s44
    buffer_load_dwordx4 v[116:119], v4, s[64:67], s48 offen offset:2048 nt
    buffer_load_dwordx4 v[140:143], v4, s[64:67], s48 offen offset:3072 nt
    s_waitcnt vmcnt(13)
    s_waitcnt vmcnt(12)
    v_perm_b32 v49, v124, v120, s43
    v_perm_b32 v53, v124, v120, s44
    v_perm_b32 v57, v125, v121, s43
    v_perm_b32 v61, v125, v121, s44
    v_perm_b32 v65, v126, v122, s43
    v_perm_b32 v69, v126, v122, s44
    v_perm_b32 v73, v127, v123, s43
    v_perm_b32 v77, v127, v123, s44
    s_add_u32 s48, s75, 851968
    buffer_load_dwordx4 v[120:123], v3, s[64:67], s48 offen offset:0 nt
    buffer_load_dwordx4 v[124:127], v3, s[64:67], s48 offen offset:1024 nt
    s_waitcnt vmcnt(13)
    s_waitcnt vmcnt(12)
    v_perm_b32 v50, v92, v88, s43
    v_perm_b32 v54, v92, v88, s44
    v_perm_b32 v58, v93, v89, s43
    v_perm_b32 v62, v93, v89, s44
    v_perm_b32 v66, v94, v90, s43
    v_perm_b32 v70, v94, v90, s44
    v_perm_b32 v74, v95, v91, s43
    v_perm_b32 v78, v95, v91, s44
    buffer_load_dwordx4 v[88:91], v3, s[64:67], s48 offen offset:2048 nt
    buffer_load_dwordx4 v[92:95], v3, s[64:67], s48 offen offset:3072 nt
    s_waitcnt vmcnt(13)
    s_waitcnt vmcnt(12)
    v_perm_b32 v51, v100, v96, s43
    v_perm_b32 v55, v100, v96, s44
    v_perm_b32 v59, v101, v97, s43
    v_perm_b32 v63, v101, v97, s44
    v_perm_b32 v67, v102, v98, s43
    v_perm_b32 v71, v102, v98, s44
    v_perm_b32 v75, v103, v99, s43
    v_perm_b32 v79, v103, v99, s44
    s_waitcnt lgkmcnt(0)
    v_mfma_f32_16x16x32_bf16 v[16:19], v[48:51], v[80:83], v[16:19]
    v_mfma_f32_16x16x32_bf16 v[20:23], v[52:55], v[80:83], v[20:23]
    v_mfma_f32_16x16x32_bf16 v[24:27], v[56:59], v[80:83], v[24:27]
    v_mfma_f32_16x16x32_bf16 v[28:31], v[60:63], v[80:83], v[28:31]
    v_mfma_f32_16x16x32_bf16 v[32:35], v[64:67], v[80:83], v[32:35]
    v_mfma_f32_16x16x32_bf16 v[36:39], v[68:71], v[80:83], v[36:39]
    v_mfma_f32_16x16x32_bf16 v[40:43], v[72:75], v[80:83], v[40:43]
    v_mfma_f32_16x16x32_bf16 v[44:47], v[76:79], v[80:83], v[44:47]
    buffer_load_dwordx4 v[96:99], v4, s[64:67], s48 offen offset:0 nt
    ds_read_b128 v[84:87], v7 offset:10816
    buffer_load_dwordx4 v[100:103], v4, s[64:67], s48 offen offset:1024 nt
    s_waitcnt vmcnt(13)
    s_waitcnt vmcnt(12)
    v_perm_b32 v48, v108, v104, s43
    v_perm_b32 v52, v108, v104, s44
    v_perm_b32 v56, v109, v105, s43
    v_perm_b32 v60, v109, v105, s44
    v_perm_b32 v64, v110, v106, s43
    v_perm_b32 v68, v110, v106, s44
    v_perm_b32 v72, v111, v107, s43
    v_perm_b32 v76, v111, v107, s44
    buffer_load_dwordx4 v[104:107], v4, s[64:67], s48 offen offset:2048 nt
    buffer_load_dwordx4 v[108:111], v4, s[64:67], s48 offen offset:3072 nt
    s_waitcnt vmcnt(13)
    s_waitcnt vmcnt(12)
    v_perm_b32 v49, v128, v112, s43
    v_perm_b32 v53, v128, v112, s44
    v_perm_b32 v57, v129, v113, s43
    v_perm_b32 v61, v129, v113, s44
    v_perm_b32 v65, v130, v114, s43
    v_perm_b32 v69, v130, v114, s44
    v_perm_b32 v73, v131, v115, s43
    v_perm_b32 v77, v131, v115, s44
    s_add_u32 s48, s75, 884736
    buffer_load_dwordx4 v[112:115], v3, s[64:67], s48 offen offset:0 nt
    buffer_load_dwordx4 v[128:131], v3, s[64:67], s48 offen offset:1024 nt
    s_waitcnt vmcnt(13)
    s_waitcnt vmcnt(12)
    v_perm_b32 v50, v136, v132, s43
    v_perm_b32 v54, v136, v132, s44
    v_perm_b32 v58, v137, v133, s43
    v_perm_b32 v62, v137, v133, s44
    v_perm_b32 v66, v138, v134, s43
    v_perm_b32 v70, v138, v134, s44
    v_perm_b32 v74, v139, v135, s43
    v_perm_b32 v78, v139, v135, s44
    buffer_load_dwordx4 v[132:135], v3, s[64:67], s48 offen offset:2048 nt
    buffer_load_dwordx4 v[136:139], v3, s[64:67], s48 offen offset:3072 nt
    s_waitcnt vmcnt(13)
    s_waitcnt vmcnt(12)
    v_perm_b32 v51, v140, v116, s43
    v_perm_b32 v55, v140, v116, s44
    v_perm_b32 v59, v141, v117, s43
    v_perm_b32 v63, v141, v117, s44
    v_perm_b32 v67, v142, v118, s43
    v_perm_b32 v71, v142, v118, s44
    v_perm_b32 v75, v143, v119, s43
    v_perm_b32 v79, v143, v119, s44
    s_waitcnt lgkmcnt(0)
    v_mfma_f32_16x16x32_bf16 v[16:19], v[48:51], v[84:87], v[16:19]
    v_mfma_f32_16x16x32_bf16 v[20:23], v[52:55], v[84:87], v[20:23]
    v_mfma_f32_16x16x32_bf16 v[24:27], v[56:59], v[84:87], v[24:27]
    v_mfma_f32_16x16x32_bf16 v[28:31], v[60:63], v[84:87], v[28:31]
    v_mfma_f32_16x16x32_bf16 v[32:35], v[64:67], v[84:87], v[32:35]
    v_mfma_f32_16x16x32_bf16 v[36:39], v[68:71], v[84:87], v[36:39]
    v_mfma_f32_16x16x32_bf16 v[40:43], v[72:75], v[84:87], v[40:43]
    v_mfma_f32_16x16x32_bf16 v[44:47], v[76:79], v[84:87], v[44:47]
    buffer_load_dwordx4 v[116:119], v4, s[64:67], s48 offen offset:0 nt
    ds_read_b128 v[80:83], v7 offset:10880
    buffer_load_dwordx4 v[140:143], v4, s[64:67], s48 offen offset:1024 nt
    s_waitcnt vmcnt(13)
    s_waitcnt vmcnt(12)
    v_perm_b32 v48, v124, v120, s43
    v_perm_b32 v52, v124, v120, s44
    v_perm_b32 v56, v125, v121, s43
    v_perm_b32 v60, v125, v121, s44
    v_perm_b32 v64, v126, v122, s43
    v_perm_b32 v68, v126, v122, s44
    v_perm_b32 v72, v127, v123, s43
    v_perm_b32 v76, v127, v123, s44
    buffer_load_dwordx4 v[120:123], v4, s[64:67], s48 offen offset:2048 nt
    buffer_load_dwordx4 v[124:127], v4, s[64:67], s48 offen offset:3072 nt
    s_waitcnt vmcnt(13)
    s_waitcnt vmcnt(12)
    v_perm_b32 v49, v92, v88, s43
    v_perm_b32 v53, v92, v88, s44
    v_perm_b32 v57, v93, v89, s43
    v_perm_b32 v61, v93, v89, s44
    v_perm_b32 v65, v94, v90, s43
    v_perm_b32 v69, v94, v90, s44
    v_perm_b32 v73, v95, v91, s43
    v_perm_b32 v77, v95, v91, s44
    s_add_u32 s48, s75, 917504
    buffer_load_dwordx4 v[88:91], v3, s[64:67], s48 offen offset:0 nt
    buffer_load_dwordx4 v[92:95], v3, s[64:67], s48 offen offset:1024 nt
    s_waitcnt vmcnt(13)
    s_waitcnt vmcnt(12)
    v_perm_b32 v50, v100, v96, s43
    v_perm_b32 v54, v100, v96, s44
    v_perm_b32 v58, v101, v97, s43
    v_perm_b32 v62, v101, v97, s44
    v_perm_b32 v66, v102, v98, s43
    v_perm_b32 v70, v102, v98, s44
    v_perm_b32 v74, v103, v99, s43
    v_perm_b32 v78, v103, v99, s44
    buffer_load_dwordx4 v[96:99], v3, s[64:67], s48 offen offset:2048 nt
    buffer_load_dwordx4 v[100:103], v3, s[64:67], s48 offen offset:3072 nt
    s_waitcnt vmcnt(13)
    s_waitcnt vmcnt(12)
    v_perm_b32 v51, v108, v104, s43
    v_perm_b32 v55, v108, v104, s44
    v_perm_b32 v59, v109, v105, s43
    v_perm_b32 v63, v109, v105, s44
    v_perm_b32 v67, v110, v106, s43
    v_perm_b32 v71, v110, v106, s44
    v_perm_b32 v75, v111, v107, s43
    v_perm_b32 v79, v111, v107, s44
    s_waitcnt lgkmcnt(0)
    v_mfma_f32_16x16x32_bf16 v[16:19], v[48:51], v[80:83], v[16:19]
    v_mfma_f32_16x16x32_bf16 v[20:23], v[52:55], v[80:83], v[20:23]
    v_mfma_f32_16x16x32_bf16 v[24:27], v[56:59], v[80:83], v[24:27]
    v_mfma_f32_16x16x32_bf16 v[28:31], v[60:63], v[80:83], v[28:31]
    v_mfma_f32_16x16x32_bf16 v[32:35], v[64:67], v[80:83], v[32:35]
    v_mfma_f32_16x16x32_bf16 v[36:39], v[68:71], v[80:83], v[36:39]
    v_mfma_f32_16x16x32_bf16 v[40:43], v[72:75], v[80:83], v[40:43]
    v_mfma_f32_16x16x32_bf16 v[44:47], v[76:79], v[80:83], v[44:47]
    buffer_load_dwordx4 v[104:107], v4, s[64:67], s48 offen offset:0 nt
    ds_read_b128 v[84:87], v7 offset:10944
    buffer_load_dwordx4 v[108:111], v4, s[64:67], s48 offen offset:1024 nt
    s_waitcnt vmcnt(13)
    s_waitcnt vmcnt(12)
    v_perm_b32 v48, v128, v112, s43
    v_perm_b32 v52, v128, v112, s44
    v_perm_b32 v56, v129, v113, s43
    v_perm_b32 v60, v129, v113, s44
    v_perm_b32 v64, v130, v114, s43
    v_perm_b32 v68, v130, v114, s44
    v_perm_b32 v72, v131, v115, s43
    v_perm_b32 v76, v131, v115, s44
    buffer_load_dwordx4 v[112:115], v4, s[64:67], s48 offen offset:2048 nt
    buffer_load_dwordx4 v[128:131], v4, s[64:67], s48 offen offset:3072 nt
    s_waitcnt vmcnt(13)
    s_waitcnt vmcnt(12)
    v_perm_b32 v49, v136, v132, s43
    v_perm_b32 v53, v136, v132, s44
    v_perm_b32 v57, v137, v133, s43
    v_perm_b32 v61, v137, v133, s44
    v_perm_b32 v65, v138, v134, s43
    v_perm_b32 v69, v138, v134, s44
    v_perm_b32 v73, v139, v135, s43
    v_perm_b32 v77, v139, v135, s44
    s_add_u32 s48, s75, 950272
    buffer_load_dwordx4 v[136:139], v3, s[64:67], s48 offen offset:0 nt
    buffer_load_dwordx4 v[144:147], v3, s[64:67], s48 offen offset:1024 nt
    s_waitcnt vmcnt(13)
    s_waitcnt vmcnt(12)
    v_perm_b32 v50, v140, v116, s43
    v_perm_b32 v54, v140, v116, s44
    v_perm_b32 v58, v141, v117, s43
    v_perm_b32 v62, v141, v117, s44
    v_perm_b32 v66, v142, v118, s43
    v_perm_b32 v70, v142, v118, s44
    v_perm_b32 v74, v143, v119, s43
    v_perm_b32 v78, v143, v119, s44
    buffer_load_dwordx4 v[140:143], v3, s[64:67], s48 offen offset:2048 nt
    buffer_load_dwordx4 v[148:151], v3, s[64:67], s48 offen offset:3072 nt
    s_waitcnt vmcnt(13)
    s_waitcnt vmcnt(12)
    v_perm_b32 v51, v124, v120, s43
    v_perm_b32 v55, v124, v120, s44
    v_perm_b32 v59, v125, v121, s43
    v_perm_b32 v63, v125, v121, s44
    v_perm_b32 v67, v126, v122, s43
    v_perm_b32 v71, v126, v122, s44
    v_perm_b32 v75, v127, v123, s43
    v_perm_b32 v79, v127, v123, s44
    s_waitcnt lgkmcnt(0)
    v_mfma_f32_16x16x32_bf16 v[16:19], v[48:51], v[84:87], v[16:19]
    v_mfma_f32_16x16x32_bf16 v[20:23], v[52:55], v[84:87], v[20:23]
    v_mfma_f32_16x16x32_bf16 v[24:27], v[56:59], v[84:87], v[24:27]
    v_mfma_f32_16x16x32_bf16 v[28:31], v[60:63], v[84:87], v[28:31]
    v_mfma_f32_16x16x32_bf16 v[32:35], v[64:67], v[84:87], v[32:35]
    v_mfma_f32_16x16x32_bf16 v[36:39], v[68:71], v[84:87], v[36:39]
    v_mfma_f32_16x16x32_bf16 v[40:43], v[72:75], v[84:87], v[40:43]
    v_mfma_f32_16x16x32_bf16 v[44:47], v[76:79], v[84:87], v[44:47]
    buffer_load_dwordx4 v[152:155], v4, s[64:67], s48 offen offset:0 nt
    ds_read_b128 v[80:83], v7 offset:11008
    buffer_load_dwordx4 v[156:159], v4, s[64:67], s48 offen offset:1024 nt
    s_waitcnt vmcnt(13)
    s_waitcnt vmcnt(12)
    v_perm_b32 v48, v92, v88, s43
    v_perm_b32 v52, v92, v88, s44
    v_perm_b32 v56, v93, v89, s43
    v_perm_b32 v60, v93, v89, s44
    v_perm_b32 v64, v94, v90, s43
    v_perm_b32 v68, v94, v90, s44
    v_perm_b32 v72, v95, v91, s43
    v_perm_b32 v76, v95, v91, s44
    buffer_load_dwordx4 v[160:163], v4, s[64:67], s48 offen offset:2048 nt
    buffer_load_dwordx4 v[164:167], v4, s[64:67], s48 offen offset:3072 nt
    s_waitcnt vmcnt(13)
    s_waitcnt vmcnt(12)
    v_perm_b32 v49, v100, v96, s43
    v_perm_b32 v53, v100, v96, s44
    v_perm_b32 v57, v101, v97, s43
    v_perm_b32 v61, v101, v97, s44
    v_perm_b32 v65, v102, v98, s43
    v_perm_b32 v69, v102, v98, s44
    v_perm_b32 v73, v103, v99, s43
    v_perm_b32 v77, v103, v99, s44
    s_add_u32 s48, s75, 983040
    buffer_load_dwordx4 v[168:171], v3, s[64:67], s48 offen offset:0 nt
    buffer_load_dwordx4 v[172:175], v3, s[64:67], s48 offen offset:1024 nt
    s_waitcnt vmcnt(13)
    s_waitcnt vmcnt(12)
    v_perm_b32 v50, v108, v104, s43
    v_perm_b32 v54, v108, v104, s44
    v_perm_b32 v58, v109, v105, s43
    v_perm_b32 v62, v109, v105, s44
    v_perm_b32 v66, v110, v106, s43
    v_perm_b32 v70, v110, v106, s44
    v_perm_b32 v74, v111, v107, s43
    v_perm_b32 v78, v111, v107, s44
    buffer_load_dwordx4 v[176:179], v3, s[64:67], s48 offen offset:2048 nt
    buffer_load_dwordx4 v[180:183], v3, s[64:67], s48 offen offset:3072 nt
    s_waitcnt vmcnt(13)
    s_waitcnt vmcnt(12)
    v_perm_b32 v51, v128, v112, s43
    v_perm_b32 v55, v128, v112, s44
    v_perm_b32 v59, v129, v113, s43
    v_perm_b32 v63, v129, v113, s44
    v_perm_b32 v67, v130, v114, s43
    v_perm_b32 v71, v130, v114, s44
    v_perm_b32 v75, v131, v115, s43
    v_perm_b32 v79, v131, v115, s44
    s_waitcnt lgkmcnt(0)
    v_mfma_f32_16x16x32_bf16 v[16:19], v[48:51], v[80:83], v[16:19]
    v_mfma_f32_16x16x32_bf16 v[20:23], v[52:55], v[80:83], v[20:23]
    v_mfma_f32_16x16x32_bf16 v[24:27], v[56:59], v[80:83], v[24:27]
    v_mfma_f32_16x16x32_bf16 v[28:31], v[60:63], v[80:83], v[28:31]
    v_mfma_f32_16x16x32_bf16 v[32:35], v[64:67], v[80:83], v[32:35]
    v_mfma_f32_16x16x32_bf16 v[36:39], v[68:71], v[80:83], v[36:39]
    v_mfma_f32_16x16x32_bf16 v[40:43], v[72:75], v[80:83], v[40:43]
    v_mfma_f32_16x16x32_bf16 v[44:47], v[76:79], v[80:83], v[44:47]
    buffer_load_dwordx4 v[184:187], v4, s[64:67], s48 offen offset:0 nt
    ds_read_b128 v[84:87], v7 offset:11072
    buffer_load_dwordx4 v[188:191], v4, s[64:67], s48 offen offset:1024 nt
    s_waitcnt vmcnt(13)
    s_waitcnt vmcnt(12)
    v_perm_b32 v48, v144, v136, s43
    v_perm_b32 v52, v144, v136, s44
    v_perm_b32 v56, v145, v137, s43
    v_perm_b32 v60, v145, v137, s44
    v_perm_b32 v64, v146, v138, s43
    v_perm_b32 v68, v146, v138, s44
    v_perm_b32 v72, v147, v139, s43
    v_perm_b32 v76, v147, v139, s44
    buffer_load_dwordx4 v[136:139], v4, s[64:67], s48 offen offset:2048 nt
    buffer_load_dwordx4 v[144:147], v4, s[64:67], s48 offen offset:3072 nt
    s_waitcnt vmcnt(13)
    s_waitcnt vmcnt(12)
    v_perm_b32 v49, v148, v140, s43
    v_perm_b32 v53, v148, v140, s44
    v_perm_b32 v57, v149, v141, s43
    v_perm_b32 v61, v149, v141, s44
    v_perm_b32 v65, v150, v142, s43
    v_perm_b32 v69, v150, v142, s44
    v_perm_b32 v73, v151, v143, s43
    v_perm_b32 v77, v151, v143, s44
    s_add_u32 s48, s75, 1015808
    buffer_load_dwordx4 v[140:143], v3, s[64:67], s48 offen offset:0 nt
    buffer_load_dwordx4 v[148:151], v3, s[64:67], s48 offen offset:1024 nt
    s_waitcnt vmcnt(13)
    s_waitcnt vmcnt(12)
    v_perm_b32 v50, v156, v152, s43
    v_perm_b32 v54, v156, v152, s44
    v_perm_b32 v58, v157, v153, s43
    v_perm_b32 v62, v157, v153, s44
    v_perm_b32 v66, v158, v154, s43
    v_perm_b32 v70, v158, v154, s44
    v_perm_b32 v74, v159, v155, s43
    v_perm_b32 v78, v159, v155, s44
    buffer_load_dwordx4 v[152:155], v3, s[64:67], s48 offen offset:2048 nt
    buffer_load_dwordx4 v[156:159], v3, s[64:67], s48 offen offset:3072 nt
    s_waitcnt vmcnt(13)
    s_waitcnt vmcnt(12)
    v_perm_b32 v51, v164, v160, s43
    v_perm_b32 v55, v164, v160, s44
    v_perm_b32 v59, v165, v161, s43
    v_perm_b32 v63, v165, v161, s44
    v_perm_b32 v67, v166, v162, s43
    v_perm_b32 v71, v166, v162, s44
    v_perm_b32 v75, v167, v163, s43
    v_perm_b32 v79, v167, v163, s44
    s_waitcnt lgkmcnt(0)
    v_mfma_f32_16x16x32_bf16 v[16:19], v[48:51], v[84:87], v[16:19]
    v_mfma_f32_16x16x32_bf16 v[20:23], v[52:55], v[84:87], v[20:23]
    v_mfma_f32_16x16x32_bf16 v[24:27], v[56:59], v[84:87], v[24:27]
    v_mfma_f32_16x16x32_bf16 v[28:31], v[60:63], v[84:87], v[28:31]
    v_mfma_f32_16x16x32_bf16 v[32:35], v[64:67], v[84:87], v[32:35]
    v_mfma_f32_16x16x32_bf16 v[36:39], v[68:71], v[84:87], v[36:39]
    v_mfma_f32_16x16x32_bf16 v[40:43], v[72:75], v[84:87], v[40:43]
    v_mfma_f32_16x16x32_bf16 v[44:47], v[76:79], v[84:87], v[44:47]
    buffer_load_dwordx4 v[160:163], v4, s[64:67], s48 offen offset:0 nt
    ds_read_b128 v[80:83], v7 offset:11136
    buffer_load_dwordx4 v[164:167], v4, s[64:67], s48 offen offset:1024 nt
    s_waitcnt vmcnt(13)
    s_waitcnt vmcnt(12)
    v_perm_b32 v48, v172, v168, s43
    v_perm_b32 v52, v172, v168, s44
    v_perm_b32 v56, v173, v169, s43
    v_perm_b32 v60, v173, v169, s44
    v_perm_b32 v64, v174, v170, s43
    v_perm_b32 v68, v174, v170, s44
    v_perm_b32 v72, v175, v171, s43
    v_perm_b32 v76, v175, v171, s44
    buffer_load_dwordx4 v[168:171], v4, s[64:67], s48 offen offset:2048 nt
    buffer_load_dwordx4 v[172:175], v4, s[64:67], s48 offen offset:3072 nt
    s_waitcnt vmcnt(13)
    s_waitcnt vmcnt(12)
    v_perm_b32 v49, v180, v176, s43
    v_perm_b32 v53, v180, v176, s44
    v_perm_b32 v57, v181, v177, s43
    v_perm_b32 v61, v181, v177, s44
    v_perm_b32 v65, v182, v178, s43
    v_perm_b32 v69, v182, v178, s44
    v_perm_b32 v73, v183, v179, s43
    v_perm_b32 v77, v183, v179, s44
    s_add_u32 s48, s75, 0
    buffer_load_dwordx4 v[88:91], v3, s[76:79], s48 offen offset:0 nt
    buffer_load_dwordx4 v[92:95], v3, s[76:79], s48 offen offset:1024 nt
    s_waitcnt vmcnt(13)
    s_waitcnt vmcnt(12)
    v_perm_b32 v50, v188, v184, s43
    v_perm_b32 v54, v188, v184, s44
    v_perm_b32 v58, v189, v185, s43
    v_perm_b32 v62, v189, v185, s44
    v_perm_b32 v66, v190, v186, s43
    v_perm_b32 v70, v190, v186, s44
    v_perm_b32 v74, v191, v187, s43
    v_perm_b32 v78, v191, v187, s44
    buffer_load_dwordx4 v[96:99], v3, s[76:79], s48 offen offset:2048 nt
    buffer_load_dwordx4 v[100:103], v3, s[76:79], s48 offen offset:3072 nt
    s_waitcnt vmcnt(13)
    s_waitcnt vmcnt(12)
    v_perm_b32 v51, v144, v136, s43
    v_perm_b32 v55, v144, v136, s44
    v_perm_b32 v59, v145, v137, s43
    v_perm_b32 v63, v145, v137, s44
    v_perm_b32 v67, v146, v138, s43
    v_perm_b32 v71, v146, v138, s44
    v_perm_b32 v75, v147, v139, s43
    v_perm_b32 v79, v147, v139, s44
    s_waitcnt lgkmcnt(0)
    v_mfma_f32_16x16x32_bf16 v[16:19], v[48:51], v[80:83], v[16:19]
    v_mfma_f32_16x16x32_bf16 v[20:23], v[52:55], v[80:83], v[20:23]
    v_mfma_f32_16x16x32_bf16 v[24:27], v[56:59], v[80:83], v[24:27]
    v_mfma_f32_16x16x32_bf16 v[28:31], v[60:63], v[80:83], v[28:31]
    v_mfma_f32_16x16x32_bf16 v[32:35], v[64:67], v[80:83], v[32:35]
    v_mfma_f32_16x16x32_bf16 v[36:39], v[68:71], v[80:83], v[36:39]
    v_mfma_f32_16x16x32_bf16 v[40:43], v[72:75], v[80:83], v[40:43]
    v_mfma_f32_16x16x32_bf16 v[44:47], v[76:79], v[80:83], v[44:47]
    buffer_load_dwordx4 v[104:107], v4, s[76:79], s48 offen offset:0 nt
    ds_read_b128 v[84:87], v7 offset:11200
    buffer_load_dwordx4 v[108:111], v4, s[76:79], s48 offen offset:1024 nt
    s_waitcnt vmcnt(13)
    s_waitcnt vmcnt(12)
    v_perm_b32 v48, v148, v140, s43
    v_perm_b32 v52, v148, v140, s44
    v_perm_b32 v56, v149, v141, s43
    v_perm_b32 v60, v149, v141, s44
    v_perm_b32 v64, v150, v142, s43
    v_perm_b32 v68, v150, v142, s44
    v_perm_b32 v72, v151, v143, s43
    v_perm_b32 v76, v151, v143, s44
    buffer_load_dwordx4 v[112:115], v4, s[76:79], s48 offen offset:2048 nt
    buffer_load_dwordx4 v[116:119], v4, s[76:79], s48 offen offset:3072 nt
    s_waitcnt vmcnt(13)
    s_waitcnt vmcnt(12)
    v_perm_b32 v49, v156, v152, s43
    v_perm_b32 v53, v156, v152, s44
    v_perm_b32 v57, v157, v153, s43
    v_perm_b32 v61, v157, v153, s44
    v_perm_b32 v65, v158, v154, s43
    v_perm_b32 v69, v158, v154, s44
    v_perm_b32 v73, v159, v155, s43
    v_perm_b32 v77, v159, v155, s44
    s_add_u32 s48, s75, 32768
    buffer_load_dwordx4 v[120:123], v3, s[76:79], s48 offen offset:0 nt
    buffer_load_dwordx4 v[124:127], v3, s[76:79], s48 offen offset:1024 nt
    s_waitcnt vmcnt(13)
    s_waitcnt vmcnt(12)
    v_perm_b32 v50, v164, v160, s43
    v_perm_b32 v54, v164, v160, s44
    v_perm_b32 v58, v165, v161, s43
    v_perm_b32 v62, v165, v161, s44
    v_perm_b32 v66, v166, v162, s43
    v_perm_b32 v70, v166, v162, s44
    v_perm_b32 v74, v167, v163, s43
    v_perm_b32 v78, v167, v163, s44
    buffer_load_dwordx4 v[128:131], v3, s[76:79], s48 offen offset:2048 nt
    buffer_load_dwordx4 v[132:135], v3, s[76:79], s48 offen offset:3072 nt
    s_waitcnt vmcnt(13)
    s_waitcnt vmcnt(12)
    v_perm_b32 v51, v172, v168, s43
    v_perm_b32 v55, v172, v168, s44
    v_perm_b32 v59, v173, v169, s43
    v_perm_b32 v63, v173, v169, s44
    v_perm_b32 v67, v174, v170, s43
    v_perm_b32 v71, v174, v170, s44
    v_perm_b32 v75, v175, v171, s43
    v_perm_b32 v79, v175, v171, s44
    s_waitcnt lgkmcnt(0)
    v_mfma_f32_16x16x32_bf16 v[16:19], v[48:51], v[84:87], v[16:19]
    v_mfma_f32_16x16x32_bf16 v[20:23], v[52:55], v[84:87], v[20:23]
    v_mfma_f32_16x16x32_bf16 v[24:27], v[56:59], v[84:87], v[24:27]
    v_mfma_f32_16x16x32_bf16 v[28:31], v[60:63], v[84:87], v[28:31]
    v_mfma_f32_16x16x32_bf16 v[32:35], v[64:67], v[84:87], v[32:35]
    v_mfma_f32_16x16x32_bf16 v[36:39], v[68:71], v[84:87], v[36:39]
    v_mfma_f32_16x16x32_bf16 v[40:43], v[72:75], v[84:87], v[40:43]
    v_mfma_f32_16x16x32_bf16 v[44:47], v[76:79], v[84:87], v[44:47]
    v_and_b32 v13, 15, v2
    v_cmp_gt_u32 vcc, 1, v13
    v_lshlrev_b32 v12, 9, v13
    v_lshrrev_b32 v13, 4, v2
    v_lshl_add_u32 v12, v13, 7, v12
    s_lshl_b32 s46, s42, 11
    v_add_u32 v12, s46, v12
    s_mov_b64 s[90:91], vcc
    s_mov_b64 exec, s[90:91]
    ds_write_b32 v12, v16 offset:17408
    ds_write_b32 v12, v17 offset:17440
    ds_write_b32 v12, v18 offset:17472
    ds_write_b32 v12, v19 offset:17504
    ds_write_b32 v12, v20 offset:17412
    ds_write_b32 v12, v21 offset:17444
    ds_write_b32 v12, v22 offset:17476
    ds_write_b32 v12, v23 offset:17508
    ds_write_b32 v12, v24 offset:17416
    ds_write_b32 v12, v25 offset:17448
    ds_write_b32 v12, v26 offset:17480
    ds_write_b32 v12, v27 offset:17512
    ds_write_b32 v12, v28 offset:17420
    ds_write_b32 v12, v29 offset:17452
    ds_write_b32 v12, v30 offset:17484
    ds_write_b32 v12, v31 offset:17516
    ds_write_b32 v12, v32 offset:17424
    ds_write_b32 v12, v33 offset:17456
    ds_write_b32 v12, v34 offset:17488
    ds_write_b32 v12, v35 offset:17520
    ds_write_b32 v12, v36 offset:17428
    ds_write_b32 v12, v37 offset:17460
    ds_write_b32 v12, v38 offset:17492
    ds_write_b32 v12, v39 offset:17524
    ds_write_b32 v12, v40 offset:17432
    ds_write_b32 v12, v41 offset:17464
    ds_write_b32 v12, v42 offset:17496
    ds_write_b32 v12, v43 offset:17528
    ds_write_b32 v12, v44 offset:17436
    ds_write_b32 v12, v45 offset:17468
    ds_write_b32 v12, v46 offset:17500
    ds_write_b32 v12, v47 offset:17532
    s_mov_b64 exec, -1
    s_lshl_b32 s46, s42, 2
    v_mov_b32 v13, s46
    s_waitcnt lgkmcnt(0)
    v_mov_b32 v12, s50
    ds_write_b32 v13, v12 offset:32
    s_waitcnt vmcnt(11)
    s_add_u32 m0, s87, 0
    s_nop 0
    buffer_load_dwordx4 v4, s[76:79], s48 offen offset:0 nt lds
    s_waitcnt vmcnt(11)
    s_add_u32 m0, s87, 0
    s_nop 0
    buffer_load_dwordx4 v4, s[76:79], s48 offen offset:1024 nt lds
    s_waitcnt vmcnt(11)
    s_add_u32 m0, s87, 0
    s_nop 0
    buffer_load_dwordx4 v4, s[76:79], s48 offen offset:2048 nt lds
    s_waitcnt vmcnt(11)
    s_add_u32 m0, s87, 0
    s_nop 0
    buffer_load_dwordx4 v4, s[76:79], s48 offen offset:3072 nt lds
    s_waitcnt vmcnt(11)
    s_add_u32 s48, s75, 65536
    s_add_u32 m0, s87, 4096
    s_nop 0
    buffer_load_dwordx4 v3, s[76:79], s48 offen offset:0 nt lds
    s_waitcnt vmcnt(11)
    s_add_u32 m0, s87, 4096
    s_nop 0
    buffer_load_dwordx4 v3, s[76:79], s48 offen offset:1024 nt lds
    s_waitcnt vmcnt(11)
    s_add_u32 m0, s87, 4096
    s_nop 0
    buffer_load_dwordx4 v3, s[76:79], s48 offen offset:2048 nt lds
    s_waitcnt vmcnt(11)
    s_add_u32 m0, s87, 4096
    s_nop 0
    buffer_load_dwordx4 v3, s[76:79], s48 offen offset:3072 nt lds
    s_waitcnt vmcnt(11)
    s_add_u32 m0, s87, 8192
    s_nop 0
    buffer_load_dwordx4 v4, s[76:79], s48 offen offset:0 nt lds
    s_waitcnt vmcnt(11)
    s_add_u32 m0, s87, 8192
    s_nop 0
    buffer_load_dwordx4 v4, s[76:79], s48 offen offset:1024 nt lds
    s_waitcnt vmcnt(11)
    s_add_u32 m0, s87, 8192
    s_nop 0
    buffer_load_dwordx4 v4, s[76:79], s48 offen offset:2048 nt lds
    s_waitcnt vmcnt(11)
    s_add_u32 m0, s87, 8192
    s_nop 0
    buffer_load_dwordx4 v4, s[76:79], s48 offen offset:3072 nt lds
    s_waitcnt vmcnt(11)
    s_add_u32 s48, s75, 98304
    s_add_u32 m0, s87, 12288
    s_nop 0
    buffer_load_dwordx4 v3, s[76:79], s48 offen offset:0 nt lds
    s_waitcnt vmcnt(11)
    s_add_u32 m0, s87, 12288
    s_nop 0
    buffer_load_dwordx4 v3, s[76:79], s48 offen offset:1024 nt lds
    s_waitcnt vmcnt(11)
    s_add_u32 m0, s87, 12288
    s_nop 0
    buffer_load_dwordx4 v3, s[76:79], s48 offen offset:2048 nt lds
    s_waitcnt vmcnt(11)
    s_add_u32 m0, s87, 12288
    s_nop 0
    buffer_load_dwordx4 v3, s[76:79], s48 offen offset:3072 nt lds
    s_waitcnt vmcnt(11)
    s_add_u32 m0, s87, 16384
    s_nop 0
    buffer_load_dwordx4 v4, s[76:79], s48 offen offset:0 nt lds
    s_waitcnt vmcnt(11)
    s_add_u32 m0, s87, 16384
    s_nop 0
    buffer_load_dwordx4 v4, s[76:79], s48 offen offset:1024 nt lds
    s_waitcnt vmcnt(11)
    s_add_u32 m0, s87, 16384
    s_nop 0
    buffer_load_dwordx4 v4, s[76:79], s48 offen offset:2048 nt lds
    s_waitcnt vmcnt(11)
    s_add_u32 m0, s87, 16384
    s_nop 0
    buffer_load_dwordx4 v4, s[76:79], s48 offen offset:3072 nt lds
    s_waitcnt vmcnt(11)
    s_add_u32 s48, s75, 131072
    s_add_u32 m0, s87, 20480
    s_nop 0
    buffer_load_dwordx4 v3, s[76:79], s48 offen offset:0 nt lds
    s_waitcnt vmcnt(11)
    s_add_u32 m0, s87, 20480
    s_nop 0
    buffer_load_dwordx4 v3, s[76:79], s48 offen offset:1024 nt lds
    s_waitcnt vmcnt(11)
    s_add_u32 m0, s87, 20480
    s_nop 0
    buffer_load_dwordx4 v3, s[76:79], s48 offen offset:2048 nt lds
    s_waitcnt vmcnt(11)
    s_add_u32 m0, s87, 20480
    s_nop 0
    buffer_load_dwordx4 v3, s[76:79], s48 offen offset:3072 nt lds
    s_waitcnt vmcnt(11)
    s_add_u32 m0, s87, 24576
    s_nop 0
    buffer_load_dwordx4 v4, s[76:79], s48 offen offset:0 nt lds
    s_waitcnt vmcnt(11)
    s_add_u32 m0, s87, 24576
    s_nop 0
    buffer_load_dwordx4 v4, s[76:79], s48 offen offset:1024 nt lds
    s_waitcnt vmcnt(11)
    s_add_u32 m0, s87, 24576
    s_nop 0
    buffer_load_dwordx4 v4, s[76:79], s48 offen offset:2048 nt lds
    s_waitcnt vmcnt(11)
    s_add_u32 m0, s87, 24576
    s_nop 0
    buffer_load_dwordx4 v4, s[76:79], s48 offen offset:3072 nt lds
    s_waitcnt vmcnt(11)
    s_add_u32 s48, s75, 163840
    s_add_u32 m0, s87, 28672
    s_nop 0
    buffer_load_dwordx4 v3, s[76:79], s48 offen offset:0 nt lds
    s_waitcnt vmcnt(11)
    s_add_u32 m0, s87, 28672
    s_nop 0
    buffer_load_dwordx4 v3, s[76:79], s48 offen offset:1024 nt lds
    s_waitcnt vmcnt(11)
    s_add_u32 m0, s87, 28672
    s_nop 0
    buffer_load_dwordx4 v3, s[76:79], s48 offen offset:2048 nt lds
    s_waitcnt vmcnt(11)
    s_add_u32 m0, s87, 28672
    s_nop 0
    buffer_load_dwordx4 v3, s[76:79], s48 offen offset:3072 nt lds
    s_waitcnt vmcnt(11)
    buffer_load_dwordx4 v[136:139], v4, s[76:79], s48 offen offset:0 nt
    s_waitcnt vmcnt(11)
    buffer_load_dwordx4 v[140:143], v4, s[76:79], s48 offen offset:1024 nt
    s_waitcnt vmcnt(11)
    buffer_load_dwordx4 v[144:147], v4, s[76:79], s48 offen offset:2048 nt
    s_waitcnt vmcnt(11)
    buffer_load_dwordx4 v[148:151], v4, s[76:79], s48 offen offset:3072 nt
    s_waitcnt vmcnt(11)
    s_add_u32 s48, s75, 196608
    buffer_load_dwordx4 v[152:155], v3, s[76:79], s48 offen offset:0 nt
    s_waitcnt vmcnt(11)
    buffer_load_dwordx4 v[156:159], v3, s[76:79], s48 offen offset:1024 nt
    s_waitcnt vmcnt(11)
    buffer_load_dwordx4 v[160:163], v3, s[76:79], s48 offen offset:2048 nt
    s_waitcnt vmcnt(11)
    buffer_load_dwordx4 v[164:167], v3, s[76:79], s48 offen offset:3072 nt
    s_waitcnt vmcnt(11)
    buffer_load_dwordx4 v[168:171], v4, s[76:79], s48 offen offset:0 nt
    s_waitcnt vmcnt(11)
    buffer_load_dwordx4 v[172:175], v4, s[76:79], s48 offen offset:1024 nt
    s_waitcnt vmcnt(11)
    buffer_load_dwordx4 v[176:179], v4, s[76:79], s48 offen offset:2048 nt
    s_waitcnt vmcnt(11)
    buffer_load_dwordx4 v[180:183], v4, s[76:79], s48 offen offset:3072 nt
    s_waitcnt vmcnt(11)
    s_add_u32 s48, s75, 229376
    buffer_load_dwordx4 v[184:187], v3, s[76:79], s48 offen offset:0 nt
    s_waitcnt vmcnt(11)
    buffer_load_dwordx4 v[188:191], v3, s[76:79], s48 offen offset:1024 nt
    s_waitcnt vmcnt(11)
    buffer_load_dwordx4 v[192:195], v3, s[76:79], s48 offen offset:2048 nt
    s_waitcnt vmcnt(11)
    buffer_load_dwordx4 v[196:199], v3, s[76:79], s48 offen offset:3072 nt
    s_waitcnt vmcnt(11)
    buffer_load_dwordx4 v[200:203], v4, s[76:79], s48 offen offset:0 nt
    s_waitcnt vmcnt(11)
    buffer_load_dwordx4 v[204:207], v4, s[76:79], s48 offen offset:1024 nt
    s_waitcnt vmcnt(11)
    buffer_load_dwordx4 v[208:211], v4, s[76:79], s48 offen offset:2048 nt
    s_waitcnt vmcnt(11)
    buffer_load_dwordx4 v[212:215], v4, s[76:79], s48 offen offset:3072 nt
    s_waitcnt vmcnt(11)
    s_add_u32 s48, s75, 0
    buffer_load_dwordx4 v[216:219], v3, s[92:95], s48 offen offset:0 nt
    s_waitcnt vmcnt(11)
    buffer_load_dwordx4 v[220:223], v3, s[92:95], s48 offen offset:1024 nt
    s_waitcnt vmcnt(11)
    buffer_load_dwordx4 v[224:227], v3, s[92:95], s48 offen offset:2048 nt
    s_waitcnt vmcnt(11)
    buffer_load_dwordx4 v[228:231], v3, s[92:95], s48 offen offset:3072 nt
    s_add_u32 s74, s74, 1
    s_cmp_lt_u32 s74, 2
    s_nop 7
    s_cbranch_scc1 L_stream_loop
    s_endpgm
L_service:
    s_setprio 3
    s_sub_u32 s45, s42, 4
    v_mov_b32 v5, 0
    v_and_b32 v3, 15, v2
    v_cmp_eq_u32 s[68:69], 0, v3
    v_cmp_eq_u32 s[70:71], 0, v2
    v_lshrrev_b32 v14, 4, v2
    v_lshlrev_b32 v12, 13, v14
    v_lshl_add_u32 v12, v3, 4, v12
    v_lshlrev_b32 v13, 10, v14
    v_lshl_add_u32 v13, v3, 4, v13
    s_lshl_b32 s46, s45, 8
    v_lshlrev_b32 v15, 4, v14
    v_add_u32 v15, s46, v15
    v_lshlrev_b32 v16, 7, v14
    v_lshlrev_b32 v17, 3, v2
    s_lshl_b32 s46, s51, 21
    s_add_u32 s56, s40, s46
    s_addc_u32 s57, s41, 0
    s_mov_b32 s58, 0x200000
    s_mov_b32 s59, 0x20000
    s_and_b32 s75, s2, 31
    s_lshl_b32 s75, s75, 16
    s_cmp_lg_u32 s45, 3
    s_cbranch_scc1 L_nq0_10
    v_mov_b32 v24, 0
    v_mov_b32 v25, 0
    v_mov_b32 v26, 0
    v_mov_b32 v27, 0
    v_lshlrev_b32 v20, 4, v2
    s_add_u32 s47, s75, 8192
    buffer_store_dwordx4 v[24:27], v20, s[56:59], s47 offen sc1
L_nq0_10:
    s_lshl_b32 s46, s51, 10
    s_add_u32 s52, s16, s46
    s_addc_u32 s53, s17, 0
    s_mov_b32 s54, 0x400
    s_mov_b32 s55, 0x20000
    v_subrev_u32 v18, 256, v0
    v_lshlrev_b32 v18, 2, v18
    buffer_load_dword v19, v18, s[52:55], 0 offen
    s_and_b32 s46, s2, 31
    s_lshl_b32 s46, s46, 8
    s_add_u32 s60, s22, s46
    s_addc_u32 s61, s23, 0
    s_mov_b32 s62, 0x3fe100
    s_mov_b32 s63, 0x20000
    s_lshl_b32 s47, s45, 20
    buffer_load_dwordx4 v[64:67], v12, s[60:63], s47 offen
    s_add_u32 s47, s47, 32768
    buffer_load_dwordx4 v[68:71], v12, s[60:63], s47 offen
    s_add_u32 s47, s47, 32768
    buffer_load_dwordx4 v[72:75], v12, s[60:63], s47 offen
    s_add_u32 s47, s47, 32768
    buffer_load_dwordx4 v[76:79], v12, s[60:63], s47 offen
    s_add_u32 s47, s47, 32768
    buffer_load_dwordx4 v[80:83], v12, s[60:63], s47 offen
    s_add_u32 s47, s47, 32768
    buffer_load_dwordx4 v[84:87], v12, s[60:63], s47 offen
    s_add_u32 s47, s47, 32768
    buffer_load_dwordx4 v[88:91], v12, s[60:63], s47 offen
    s_add_u32 s47, s47, 32768
    buffer_load_dwordx4 v[92:95], v12, s[60:63], s47 offen
    s_add_u32 s47, s47, 32768
    buffer_load_dwordx4 v[96:99], v12, s[60:63], s47 offen
    s_add_u32 s47, s47, 32768
    buffer_load_dwordx4 v[100:103], v12, s[60:63], s47 offen
    s_add_u32 s47, s47, 32768
    buffer_load_dwordx4 v[104:107], v12, s[60:63], s47 offen
    s_add_u32 s47, s47, 32768
    buffer_load_dwordx4 v[108:111], v12, s[60:63], s47 offen
    s_add_u32 s47, s47, 32768
    buffer_load_dwordx4 v[112:115], v12, s[60:63], s47 offen
    s_add_u32 s47, s47, 32768
    buffer_load_dwordx4 v[116:119], v12, s[60:63], s47 offen
    s_add_u32 s47, s47, 32768
    buffer_load_dwordx4 v[120:123], v12, s[60:63], s47 offen
    s_add_u32 s47, s47, 32768
    buffer_load_dwordx4 v[124:127], v12, s[60:63], s47 offen
    s_add_u32 s47, s47, 32768
    buffer_load_dwordx4 v[128:131], v12, s[60:63], s47 offen
    s_add_u32 s47, s47, 32768
    buffer_load_dwordx4 v[132:135], v12, s[60:63], s47 offen
    s_add_u32 s47, s47, 32768
    buffer_load_dwordx4 v[136:139], v12, s[60:63], s47 offen
    s_add_u32 s47, s47, 32768
    buffer_load_dwordx4 v[140:143], v12, s[60:63], s47 offen
    s_add_u32 s47, s47, 32768
    buffer_load_dwordx4 v[144:147], v12, s[60:63], s47 offen
    s_add_u32 s47, s47, 32768
    buffer_load_dwordx4 v[148:151], v12, s[60:63], s47 offen
    s_add_u32 s47, s47, 32768
    buffer_load_dwordx4 v[152:155], v12, s[60:63], s47 offen
    s_add_u32 s47, s47, 32768
    buffer_load_dwordx4 v[156:159], v12, s[60:63], s47 offen
    s_add_u32 s47, s47, 32768
    buffer_load_dwordx4 v[160:163], v12, s[60:63], s47 offen
    s_add_u32 s47, s47, 32768
    buffer_load_dwordx4 v[164:167], v12, s[60:63], s47 offen
    s_add_u32 s47, s47, 32768
    buffer_load_dwordx4 v[168:171], v12, s[60:63], s47 offen
    s_add_u32 s47, s47, 32768
    buffer_load_dwordx4 v[172:175], v12, s[60:63], s47 offen
    s_add_u32 s47, s47, 32768
    buffer_load_dwordx4 v[176:179], v12, s[60:63], s47 offen
    s_add_u32 s47, s47, 32768
    buffer_load_dwordx4 v[180:183], v12, s[60:63], s47 offen
    s_add_u32 s47, s47, 32768
    buffer_load_dwordx4 v[184:187], v12, s[60:63], s47 offen
    s_add_u32 s47, s47, 32768
    buffer_load_dwordx4 v[188:191], v12, s[60:63], s47 offen
    s_waitcnt vmcnt(32)
    v_lshlrev_b32 v6, 16, v19
    v_and_b32 v7, 0xffff0000, v19
    s_cmp_lg_u32 s45, 3
    s_cbranch_scc1 L_nq1_11
    s_add_u32 s64, s38, 0
    s_addc_u32 s65, s39, 0
    s_mov_b32 s66, 0x100
    s_mov_b32 s67, 0x20000
    s_lshl_b32 s46, s51, 5
    v_mov_b32 v20, s46
    v_mov_b32 v21, 1
    s_mov_b64 exec, 1
    buffer_atomic_add v21, v20, s[64:67], 0 offen sc1
    s_mov_b64 exec, -1
    s_nop 3
L_nq1_11:
    v_subrev_u32 v18, 256, v0
    v_lshlrev_b32 v18, 3, v18
    ds_write_b64 v18, v[6:7] offset:512
    s_lshl_b32 s46, s45, 2
    v_mov_b32 v19, s46
    s_waitcnt lgkmcnt(0)
    v_mov_b32 v20, 1
    ds_write_b32 v19, v20 offset:0
    s_nop 1
L_lw_12:
    ds_read_b128 v[8:11], v5 offset:0
    s_waitcnt lgkmcnt(0)
    v_min_u32 v8, v8, v9
    v_min3_u32 v8, v8, v10, v11
    v_cmp_gt_u32 vcc, 1, v8
    s_nop 1
    s_cbranch_vccz L_lwd_13
    s_sleep 1
    s_sub_u32 s49, s49, 1
    s_cmp_gt_i32 s49, 0
    s_cbranch_scc1 L_lw_12
L_lwd_13:
    v_lshlrev_b32 v18, 5, v2
    ds_read_b128 v[24:27], v18 offset:512
    ds_read_b128 v[28:31], v18 offset:528
    s_waitcnt lgkmcnt(0)
    v_add_f32 v20, v24, v25
    v_add_f32 v20, v20, v26
    v_add_f32 v20, v20, v27
    v_add_f32 v20, v20, v28
    v_add_f32 v20, v20, v29
    v_add_f32 v20, v20, v30
    v_add_f32 v20, v20, v31
    s_nop 1
    v_add_f32_dpp v20, v20, v20 quad_perm:[1,0,3,2] row_mask:0xf bank_mask:0xf
    s_nop 1
    v_add_f32_dpp v20, v20, v20 quad_perm:[2,3,0,1] row_mask:0xf bank_mask:0xf
    s_nop 1
    v_add_f32_dpp v20, v20, v20 row_half_mirror row_mask:0xf bank_mask:0xf
    s_nop 1
    v_add_f32_dpp v20, v20, v20 row_mirror row_mask:0xf bank_mask:0xf
    v_mov_b32 v22, v20
    s_nop 1
    v_permlane16_swap_b32 v20, v22
    v_add_f32 v20, v20, v22
    v_mov_b32 v22, v20
    s_nop 1
    v_permlane32_swap_b32 v20, v22
    v_add_f32 v20, v20, v22
    v_mul_f32 v20, 0x3b000000, v20
    v_mov_b32 v21, 0
    v_sub_f32 v22, v24, v20
    v_fma_f32 v21, v22, v22, v21
    v_sub_f32 v22, v25, v20
    v_fma_f32 v21, v22, v22, v21
    v_sub_f32 v22, v26, v20
    v_fma_f32 v21, v22, v22, v21
    v_sub_f32 v22, v27, v20
    v_fma_f32 v21, v22, v22, v21
    v_sub_f32 v22, v28, v20
    v_fma_f32 v21, v22, v22, v21
    v_sub_f32 v22, v29, v20
    v_fma_f32 v21, v22, v22, v21
    v_sub_f32 v22, v30, v20
    v_fma_f32 v21, v22, v22, v21
    v_sub_f32 v22, v31, v20
    v_fma_f32 v21, v22, v22, v21
    s_nop 1
    v_add_f32_dpp v21, v21, v21 quad_perm:[1,0,3,2] row_mask:0xf bank_mask:0xf
    s_nop 1
    v_add_f32_dpp v21, v21, v21 quad_perm:[2,3,0,1] row_mask:0xf bank_mask:0xf
    s_nop 1
    v_add_f32_dpp v21, v21, v21 row_half_mirror row_mask:0xf bank_mask:0xf
    s_nop 1
    v_add_f32_dpp v21, v21, v21 row_mirror row_mask:0xf bank_mask:0xf
    v_mov_b32 v22, v21
    s_nop 1
    v_permlane16_swap_b32 v21, v22
    v_add_f32 v21, v21, v22
    v_mov_b32 v22, v21
    s_nop 1
    v_permlane32_swap_b32 v21, v22
    v_add_f32 v21, v21, v22
    v_mul_f32 v21, 0x3b000000, v21
    v_cvt_pk_bf16_f32 v20, v20, v20
    v_lshlrev_b32 v20, 16, v20
    v_cvt_pk_bf16_f32 v21, v21, v21
    v_lshlrev_b32 v21, 16, v21
    v_add_f32 v21, 0x3727c5ac, v21
    v_cvt_pk_bf16_f32 v21, v21, v21
    v_lshlrev_b32 v21, 16, v21
    v_sqrt_f32 v21, v21
    s_nop 0
    v_cvt_pk_bf16_f32 v21, v21, v21
    v_lshlrev_b32 v21, 16, v21
    v_rcp_f32 v22, v21
    v_sub_f32 v26, v6, v20
    v_cvt_pk_bf16_f32 v26, v26, v26
    v_lshlrev_b32 v26, 16, v26
    v_mul_f32 v24, v26, v22
    v_fma_f32 v27, -v24, v21, v26
    v_fma_f32 v24, v27, v22, v24
    v_sub_f32 v26, v7, v20
    v_cvt_pk_bf16_f32 v26, v26, v26
    v_lshlrev_b32 v26, 16, v26
    v_mul_f32 v25, v26, v22
    v_fma_f32 v27, -v25, v21, v26
    v_fma_f32 v25, v27, v22, v25
    v_cvt_pk_bf16_f32 v28, v24, v25
    v_lshrrev_b32 v29, 4, v2
    v_lshlrev_b32 v29, 6, v29
    v_and_b32 v30, 1, v2
    v_lshl_add_u32 v29, v30, 5, v29
    v_bfe_u32 v30, v2, 1, 3
    v_lshl_add_u32 v29, v30, 1, v29
    s_lshl_b32 s46, s45, 8
    v_add_u32 v29, s46, v29
    ds_write_b16 v29, v28 offset:5632
    ds_write_b16_d16_hi v29, v28 offset:5648
    s_waitcnt lgkmcnt(0)
    s_waitcnt vmcnt(0)
    v_perm_b32 v192, v68, v64, s43
    v_perm_b32 v196, v68, v64, s44
    v_perm_b32 v200, v69, v65, s43
    v_perm_b32 v204, v69, v65, s44
    v_perm_b32 v208, v70, v66, s43
    v_perm_b32 v212, v70, v66, s44
    v_perm_b32 v216, v71, v67, s43
    v_perm_b32 v220, v71, v67, s44
    v_perm_b32 v193, v76, v72, s43
    v_perm_b32 v197, v76, v72, s44
    v_perm_b32 v201, v77, v73, s43
    v_perm_b32 v205, v77, v73, s44
    v_perm_b32 v209, v78, v74, s43
    v_perm_b32 v213, v78, v74, s44
    v_perm_b32 v217, v79, v75, s43
    v_perm_b32 v221, v79, v75, s44
    v_perm_b32 v194, v84, v80, s43
    v_perm_b32 v198, v84, v80, s44
    v_perm_b32 v202, v85, v81, s43
    v_perm_b32 v206, v85, v81, s44
    v_perm_b32 v210, v86, v82, s43
    v_perm_b32 v214, v86, v82, s44
    v_perm_b32 v218, v87, v83, s43
    v_perm_b32 v222, v87, v83, s44
    v_perm_b32 v195, v92, v88, s43
    v_perm_b32 v199, v92, v88, s44
    v_perm_b32 v203, v93, v89, s43
    v_perm_b32 v207, v93, v89, s44
    v_perm_b32 v211, v94, v90, s43
    v_perm_b32 v215, v94, v90, s44
    v_perm_b32 v219, v95, v91, s43
    v_perm_b32 v223, v95, v91, s44
    v_perm_b32 v64, v100, v96, s43
    v_perm_b32 v68, v100, v96, s44
    v_perm_b32 v72, v101, v97, s43
    v_perm_b32 v76, v101, v97, s44
    v_perm_b32 v80, v102, v98, s43
    v_perm_b32 v84, v102, v98, s44
    v_perm_b32 v88, v103, v99, s43
    v_perm_b32 v92, v103, v99, s44
    v_perm_b32 v65, v108, v104, s43
    v_perm_b32 v69, v108, v104, s44
    v_perm_b32 v73, v109, v105, s43
    v_perm_b32 v77, v109, v105, s44
    v_perm_b32 v81, v110, v106, s43
    v_perm_b32 v85, v110, v106, s44
    v_perm_b32 v89, v111, v107, s43
    v_perm_b32 v93, v111, v107, s44
    v_perm_b32 v66, v116, v112, s43
    v_perm_b32 v70, v116, v112, s44
    v_perm_b32 v74, v117, v113, s43
    v_perm_b32 v78, v117, v113, s44
    v_perm_b32 v82, v118, v114, s43
    v_perm_b32 v86, v118, v114, s44
    v_perm_b32 v90, v119, v115, s43
    v_perm_b32 v94, v119, v115, s44
    v_perm_b32 v67, v124, v120, s43
    v_perm_b32 v71, v124, v120, s44
    v_perm_b32 v75, v125, v121, s43
    v_perm_b32 v79, v125, v121, s44
    v_perm_b32 v83, v126, v122, s43
    v_perm_b32 v87, v126, v122, s44
    v_perm_b32 v91, v127, v123, s43
    v_perm_b32 v95, v127, v123, s44
    v_perm_b32 v96, v132, v128, s43
    v_perm_b32 v100, v132, v128, s44
    v_perm_b32 v104, v133, v129, s43
    v_perm_b32 v108, v133, v129, s44
    v_perm_b32 v112, v134, v130, s43
    v_perm_b32 v116, v134, v130, s44
    v_perm_b32 v120, v135, v131, s43
    v_perm_b32 v124, v135, v131, s44
    v_perm_b32 v97, v140, v136, s43
    v_perm_b32 v101, v140, v136, s44
    v_perm_b32 v105, v141, v137, s43
    v_perm_b32 v109, v141, v137, s44
    v_perm_b32 v113, v142, v138, s43
    v_perm_b32 v117, v142, v138, s44
    v_perm_b32 v121, v143, v139, s43
    v_perm_b32 v125, v143, v139, s44
    v_perm_b32 v98, v148, v144, s43
    v_perm_b32 v102, v148, v144, s44
    v_perm_b32 v106, v149, v145, s43
    v_perm_b32 v110, v149, v145, s44
    v_perm_b32 v114, v150, v146, s43
    v_perm_b32 v118, v150, v146, s44
    v_perm_b32 v122, v151, v147, s43
    v_perm_b32 v126, v151, v147, s44
    v_perm_b32 v99, v156, v152, s43
    v_perm_b32 v103, v156, v152, s44
    v_perm_b32 v107, v157, v153, s43
    v_perm_b32 v111, v157, v153, s44
    v_perm_b32 v115, v158, v154, s43
    v_perm_b32 v119, v158, v154, s44
    v_perm_b32 v123, v159, v155, s43
    v_perm_b32 v127, v159, v155, s44
    v_perm_b32 v128, v164, v160, s43
    v_perm_b32 v132, v164, v160, s44
    v_perm_b32 v136, v165, v161, s43
    v_perm_b32 v140, v165, v161, s44
    v_perm_b32 v144, v166, v162, s43
    v_perm_b32 v148, v166, v162, s44
    v_perm_b32 v152, v167, v163, s43
    v_perm_b32 v156, v167, v163, s44
    v_perm_b32 v129, v172, v168, s43
    v_perm_b32 v133, v172, v168, s44
    v_perm_b32 v137, v173, v169, s43
    v_perm_b32 v141, v173, v169, s44
    v_perm_b32 v145, v174, v170, s43
    v_perm_b32 v149, v174, v170, s44
    v_perm_b32 v153, v175, v171, s43
    v_perm_b32 v157, v175, v171, s44
    v_perm_b32 v130, v180, v176, s43
    v_perm_b32 v134, v180, v176, s44
    v_perm_b32 v138, v181, v177, s43
    v_perm_b32 v142, v181, v177, s44
    v_perm_b32 v146, v182, v178, s43
    v_perm_b32 v150, v182, v178, s44
    v_perm_b32 v154, v183, v179, s43
    v_perm_b32 v158, v183, v179, s44
    v_perm_b32 v131, v188, v184, s43
    v_perm_b32 v135, v188, v184, s44
    v_perm_b32 v139, v189, v185, s43
    v_perm_b32 v143, v189, v185, s44
    v_perm_b32 v147, v190, v186, s43
    v_perm_b32 v151, v190, v186, s44
    v_perm_b32 v155, v191, v187, s43
    v_perm_b32 v159, v191, v187, s44
    ds_read_b128 v[48:51], v15 offset:5632
    ds_read_b128 v[52:55], v15 offset:5696
    ds_read_b128 v[56:59], v15 offset:5760
    ds_read_b128 v[60:63], v15 offset:5824
    v_mov_b32 v224, 0
    v_mov_b32 v225, 0
    v_mov_b32 v226, 0
    v_mov_b32 v227, 0
    v_mov_b32 v228, 0
    v_mov_b32 v229, 0
    v_mov_b32 v230, 0
    v_mov_b32 v231, 0
    v_mov_b32 v232, 0
    v_mov_b32 v233, 0
    v_mov_b32 v234, 0
    v_mov_b32 v235, 0
    v_mov_b32 v236, 0
    v_mov_b32 v237, 0
    v_mov_b32 v238, 0
    v_mov_b32 v239, 0
    v_mov_b32 v240, 0
    v_mov_b32 v241, 0
    v_mov_b32 v242, 0
    v_mov_b32 v243, 0
    v_mov_b32 v244, 0
    v_mov_b32 v245, 0
    v_mov_b32 v246, 0
    v_mov_b32 v247, 0
    v_mov_b32 v248, 0
    v_mov_b32 v249, 0
    v_mov_b32 v250, 0
    v_mov_b32 v251, 0
    v_mov_b32 v252, 0
    v_mov_b32 v253, 0
    v_mov_b32 v254, 0
    v_mov_b32 v255, 0
    s_waitcnt lgkmcnt(0)
    v_mfma_f32_16x16x32_bf16 v[224:227], v[192:195], v[48:51], v[224:227]
    v_mfma_f32_16x16x32_bf16 v[228:231], v[196:199], v[48:51], v[228:231]
    v_mfma_f32_16x16x32_bf16 v[232:235], v[200:203], v[48:51], v[232:235]
    v_mfma_f32_16x16x32_bf16 v[236:239], v[204:207], v[48:51], v[236:239]
    v_mfma_f32_16x16x32_bf16 v[240:243], v[208:211], v[48:51], v[240:243]
    v_mfma_f32_16x16x32_bf16 v[244:247], v[212:215], v[48:51], v[244:247]
    v_mfma_f32_16x16x32_bf16 v[248:251], v[216:219], v[48:51], v[248:251]
    v_mfma_f32_16x16x32_bf16 v[252:255], v[220:223], v[48:51], v[252:255]
    v_mfma_f32_16x16x32_bf16 v[224:227], v[64:67], v[52:55], v[224:227]
    v_mfma_f32_16x16x32_bf16 v[228:231], v[68:71], v[52:55], v[228:231]
    v_mfma_f32_16x16x32_bf16 v[232:235], v[72:75], v[52:55], v[232:235]
    v_mfma_f32_16x16x32_bf16 v[236:239], v[76:79], v[52:55], v[236:239]
    v_mfma_f32_16x16x32_bf16 v[240:243], v[80:83], v[52:55], v[240:243]
    v_mfma_f32_16x16x32_bf16 v[244:247], v[84:87], v[52:55], v[244:247]
    v_mfma_f32_16x16x32_bf16 v[248:251], v[88:91], v[52:55], v[248:251]
    v_mfma_f32_16x16x32_bf16 v[252:255], v[92:95], v[52:55], v[252:255]
    v_mfma_f32_16x16x32_bf16 v[224:227], v[96:99], v[56:59], v[224:227]
    v_mfma_f32_16x16x32_bf16 v[228:231], v[100:103], v[56:59], v[228:231]
    v_mfma_f32_16x16x32_bf16 v[232:235], v[104:107], v[56:59], v[232:235]
    v_mfma_f32_16x16x32_bf16 v[236:239], v[108:111], v[56:59], v[236:239]
    v_mfma_f32_16x16x32_bf16 v[240:243], v[112:115], v[56:59], v[240:243]
    v_mfma_f32_16x16x32_bf16 v[244:247], v[116:119], v[56:59], v[244:247]
    v_mfma_f32_16x16x32_bf16 v[248:251], v[120:123], v[56:59], v[248:251]
    v_mfma_f32_16x16x32_bf16 v[252:255], v[124:127], v[56:59], v[252:255]
    v_mfma_f32_16x16x32_bf16 v[224:227], v[128:131], v[60:63], v[224:227]
    v_mfma_f32_16x16x32_bf16 v[228:231], v[132:135], v[60:63], v[228:231]
    v_mfma_f32_16x16x32_bf16 v[232:235], v[136:139], v[60:63], v[232:235]
    v_mfma_f32_16x16x32_bf16 v[236:239], v[140:143], v[60:63], v[236:239]
    v_mfma_f32_16x16x32_bf16 v[240:243], v[144:147], v[60:63], v[240:243]
    v_mfma_f32_16x16x32_bf16 v[244:247], v[148:151], v[60:63], v[244:247]
    v_mfma_f32_16x16x32_bf16 v[248:251], v[152:155], v[60:63], v[248:251]
    v_mfma_f32_16x16x32_bf16 v[252:255], v[156:159], v[60:63], v[252:255]
    s_lshl_b32 s46, s45, 9
    v_add_u32 v18, s46, v16
    s_mov_b64 exec, s[68:69]
    ds_write_b32 v18, v224 offset:2560
    ds_write_b32 v18, v225 offset:2592
    ds_write_b32 v18, v226 offset:2624
    ds_write_b32 v18, v227 offset:2656
    ds_write_b32 v18, v228 offset:2564
    ds_write_b32 v18, v229 offset:2596
    ds_write_b32 v18, v230 offset:2628
    ds_write_b32 v18, v231 offset:2660
    ds_write_b32 v18, v232 offset:2568
    ds_write_b32 v18, v233 offset:2600
    ds_write_b32 v18, v234 offset:2632
    ds_write_b32 v18, v235 offset:2664
    ds_write_b32 v18, v236 offset:2572
    ds_write_b32 v18, v237 offset:2604
    ds_write_b32 v18, v238 offset:2636
    ds_write_b32 v18, v239 offset:2668
    ds_write_b32 v18, v240 offset:2576
    ds_write_b32 v18, v241 offset:2608
    ds_write_b32 v18, v242 offset:2640
    ds_write_b32 v18, v243 offset:2672
    ds_write_b32 v18, v244 offset:2580
    ds_write_b32 v18, v245 offset:2612
    ds_write_b32 v18, v246 offset:2644
    ds_write_b32 v18, v247 offset:2676
    ds_write_b32 v18, v248 offset:2584
    ds_write_b32 v18, v249 offset:2616
    ds_write_b32 v18, v250 offset:2648
    ds_write_b32 v18, v251 offset:2680
    ds_write_b32 v18, v252 offset:2588
    ds_write_b32 v18, v253 offset:2620
    ds_write_b32 v18, v254 offset:2652
    ds_write_b32 v18, v255 offset:2684
    s_mov_b64 exec, -1
    s_lshl_b32 s46, s45, 2
    v_mov_b32 v19, s46
    s_waitcnt lgkmcnt(0)
    v_mov_b32 v20, 1
    ds_write_b32 v19, v20 offset:16
    s_cmp_lg_u32 s45, 1
    s_cbranch_scc1 L_ng_14
    s_add_u32 s64, s38, 0
    s_addc_u32 s65, s39, 0
    s_mov_b32 s66, 0x100
    s_mov_b32 s67, 0x20000
    s_lshl_b32 s46, s51, 5
    v_mov_b32 v20, s46
    s_nop 1
L_gt_15:
    buffer_load_dword v21, v20, s[64:67], 0 offen sc1
    s_waitcnt vmcnt(0)
    v_cmp_gt_u32 vcc, 32, v21
    s_nop 1
    s_cbranch_vccz L_gtd_16
    s_sleep 8
    s_sub_u32 s49, s49, 1
    s_cmp_gt_i32 s49, 0
    s_cbranch_scc1 L_gt_15
L_gtd_16:
    v_mov_b32 v20, 1
    ds_write_b32 v5, v20 offset:72
    s_nop 3
L_ng_14:
    s_cmp_lg_u32 s45, 0
    s_cbranch_scc1 L_nq_17
    s_nop 1
L_lw_18:
    ds_read_b128 v[8:11], v5 offset:16
    s_waitcnt lgkmcnt(0)
    v_min_u32 v8, v8, v9
    v_min3_u32 v8, v8, v10, v11
    v_cmp_gt_u32 vcc, 1, v8
    s_nop 1
    s_cbranch_vccz L_lwd_19
    s_sleep 1
    s_sub_u32 s49, s49, 1
    s_cmp_gt_i32 s49, 0
    s_cbranch_scc1 L_lw_18
L_lwd_19:
    ds_read_b64 v[24:25], v17 offset:2560
    ds_read_b64 v[26:27], v17 offset:3072
    ds_read_b64 v[28:29], v17 offset:3584
    ds_read_b64 v[30:31], v17 offset:4096
    s_waitcnt lgkmcnt(0)
    v_add_f32 v24, v24, v26
    v_add_f32 v25, v25, v27
    v_add_f32 v24, v24, v28
    v_add_f32 v25, v25, v29
    v_add_f32 v24, v24, v30
    v_add_f32 v25, v25, v31
    v_lshlrev_b32 v18, 2, v2
    v_cvt_pk_bf16_f32 v24, v24, v24
    v_lshlrev_b32 v24, 16, v24
    v_cvt_pk_bf16_f32 v25, v25, v25
    v_lshlrev_b32 v25, 16, v25
    v_or_b32 v24, 1, v24
    v_or_b32 v25, 1, v25
    s_add_u32 s46, s75, 8192
    buffer_store_dwordx2 v[24:25], v17, s[56:59], s46 offen sc1
    s_nop 1
L_lw_20:
    ds_read_b32 v8, v5 offset:72
    s_waitcnt lgkmcnt(0)
    v_cmp_gt_u32 vcc, 1, v8
    s_nop 1
    s_cbranch_vccz L_lwd_21
    s_sleep 1
    s_sub_u32 s49, s49, 1
    s_cmp_gt_i32 s49, 0
    s_cbranch_scc1 L_lw_20
L_lwd_21:
    s_and_b32 s46, s75, 0xfffc0000
    s_add_u32 s46, s46, 8192
    v_lshlrev_b32 v20, 16, v2
    s_nop 1
L_qx_22:
    s_mov_b32 s47, s46
    buffer_load_dwordx2 v[24:25], v17, s[56:59], s47 offen sc1
    s_add_u32 s47, s47, 65536
    buffer_load_dwordx2 v[26:27], v17, s[56:59], s47 offen sc1
    s_add_u32 s47, s47, 65536
    buffer_load_dwordx2 v[28:29], v17, s[56:59], s47 offen sc1
    s_add_u32 s47, s47, 65536
    buffer_load_dwordx2 v[30:31], v17, s[56:59], s47 offen sc1
    s_waitcnt vmcnt(0)
    v_and_b32 v19, v24, v25
    v_and_b32 v19, v19, v26
    v_and_b32 v19, v19, v27
    v_and_b32 v19, v19, v28
    v_and_b32 v19, v19, v29
    v_and_b32 v19, v19, v30
    v_and_b32 v19, v19, v31
    v_and_b32 v19, 1, v19
    v_cmp_eq_u32 vcc, 0, v19
    s_nop 1
    s_cbranch_vccz L_qxd_23
    s_sleep 1
    s_sub_u32 s49, s49, 1
    s_cmp_gt_i32 s49, 0
    s_cbranch_scc1 L_qx_22
L_qxd_23:
    v_perm_b32 v20, v25, v24, s44
    ds_write_b32 v18, v20 offset:4608
    v_perm_b32 v20, v27, v26, s44
    ds_write_b32 v18, v20 offset:4864
    v_perm_b32 v20, v29, v28, s44
    ds_write_b32 v18, v20 offset:5120
    v_perm_b32 v20, v31, v30, s44
    ds_write_b32 v18, v20 offset:5376
    s_waitcnt lgkmcnt(0)
    v_mov_b32 v20, 1
    ds_write_b32 v5, v20 offset:64
    s_nop 3
L_nq_17:
    s_setprio 0
    s_and_b32 s46, s2, 31
    s_lshl_b32 s46, s46, 17
    s_add_u32 s60, s24, s46
    s_addc_u32 s61, s25, 0
    s_mov_b32 s62, 0x20000
    s_mov_b32 s63, 0x20000
    s_lshl_b32 s47, s45, 8
    buffer_load_dwordx4 v[64:67], v13, s[60:63], s47 offen
    s_add_u32 s47, s47, 4096
    buffer_load_dwordx4 v[68:71], v13, s[60:63], s47 offen
    s_add_u32 s47, s47, 4096
    buffer_load_dwordx4 v[72:75], v13, s[60:63], s47 offen
    s_add_u32 s47, s47, 4096
    buffer_load_dwordx4 v[76:79], v13, s[60:63], s47 offen
    s_add_u32 s47, s47, 4096
    buffer_load_dwordx4 v[80:83], v13, s[60:63], s47 offen
    s_add_u32 s47, s47, 4096
    buffer_load_dwordx4 v[84:87], v13, s[60:63], s47 offen
    s_add_u32 s47, s47, 4096
    buffer_load_dwordx4 v[88:91], v13, s[60:63], s47 offen
    s_add_u32 s47, s47, 4096
    buffer_load_dwordx4 v[92:95], v13, s[60:63], s47 offen
    s_add_u32 s47, s47, 4096
    buffer_load_dwordx4 v[96:99], v13, s[60:63], s47 offen
    s_add_u32 s47, s47, 4096
    buffer_load_dwordx4 v[100:103], v13, s[60:63], s47 offen
    s_add_u32 s47, s47, 4096
    buffer_load_dwordx4 v[104:107], v13, s[60:63], s47 offen
    s_add_u32 s47, s47, 4096
    buffer_load_dwordx4 v[108:111], v13, s[60:63], s47 offen
    s_add_u32 s47, s47, 4096
    buffer_load_dwordx4 v[112:115], v13, s[60:63], s47 offen
    s_add_u32 s47, s47, 4096
    buffer_load_dwordx4 v[116:119], v13, s[60:63], s47 offen
    s_add_u32 s47, s47, 4096
    buffer_load_dwordx4 v[120:123], v13, s[60:63], s47 offen
    s_add_u32 s47, s47, 4096
    buffer_load_dwordx4 v[124:127], v13, s[60:63], s47 offen
    s_add_u32 s47, s47, 4096
    buffer_load_dwordx4 v[128:131], v13, s[60:63], s47 offen
    s_add_u32 s47, s47, 4096
    buffer_load_dwordx4 v[132:135], v13, s[60:63], s47 offen
    s_add_u32 s47, s47, 4096
    buffer_load_dwordx4 v[136:139], v13, s[60:63], s47 offen
    s_add_u32 s47, s47, 4096
    buffer_load_dwordx4 v[140:143], v13, s[60:63], s47 offen
    s_add_u32 s47, s47, 4096
    buffer_load_dwordx4 v[144:147], v13, s[60:63], s47 offen
    s_add_u32 s47, s47, 4096
    buffer_load_dwordx4 v[148:151], v13, s[60:63], s47 offen
    s_add_u32 s47, s47, 4096
    buffer_load_dwordx4 v[152:155], v13, s[60:63], s47 offen
    s_add_u32 s47, s47, 4096
    buffer_load_dwordx4 v[156:159], v13, s[60:63], s47 offen
    s_add_u32 s47, s47, 4096
    buffer_load_dwordx4 v[160:163], v13, s[60:63], s47 offen
    s_add_u32 s47, s47, 4096
    buffer_load_dwordx4 v[164:167], v13, s[60:63], s47 offen
    s_add_u32 s47, s47, 4096
    buffer_load_dwordx4 v[168:171], v13, s[60:63], s47 offen
    s_add_u32 s47, s47, 4096
    buffer_load_dwordx4 v[172:175], v13, s[60:63], s47 offen
    s_add_u32 s47, s47, 4096
    buffer_load_dwordx4 v[176:179], v13, s[60:63], s47 offen
    s_add_u32 s47, s47, 4096
    buffer_load_dwordx4 v[180:183], v13, s[60:63], s47 offen
    s_add_u32 s47, s47, 4096
    buffer_load_dwordx4 v[184:187], v13, s[60:63], s47 offen
    s_add_u32 s47, s47, 4096
    buffer_load_dwordx4 v[188:191], v13, s[60:63], s47 offen
    s_waitcnt vmcnt(0)
    v_perm_b32 v192, v68, v64, s43
    v_perm_b32 v196, v68, v64, s44
    v_perm_b32 v200, v69, v65, s43
    v_perm_b32 v204, v69, v65, s44
    v_perm_b32 v208, v70, v66, s43
    v_perm_b32 v212, v70, v66, s44
    v_perm_b32 v216, v71, v67, s43
    v_perm_b32 v220, v71, v67, s44
    v_perm_b32 v193, v76, v72, s43
    v_perm_b32 v197, v76, v72, s44
    v_perm_b32 v201, v77, v73, s43
    v_perm_b32 v205, v77, v73, s44
    v_perm_b32 v209, v78, v74, s43
    v_perm_b32 v213, v78, v74, s44
    v_perm_b32 v217, v79, v75, s43
    v_perm_b32 v221, v79, v75, s44
    v_perm_b32 v194, v84, v80, s43
    v_perm_b32 v198, v84, v80, s44
    v_perm_b32 v202, v85, v81, s43
    v_perm_b32 v206, v85, v81, s44
    v_perm_b32 v210, v86, v82, s43
    v_perm_b32 v214, v86, v82, s44
    v_perm_b32 v218, v87, v83, s43
    v_perm_b32 v222, v87, v83, s44
    v_perm_b32 v195, v92, v88, s43
    v_perm_b32 v199, v92, v88, s44
    v_perm_b32 v203, v93, v89, s43
    v_perm_b32 v207, v93, v89, s44
    v_perm_b32 v211, v94, v90, s43
    v_perm_b32 v215, v94, v90, s44
    v_perm_b32 v219, v95, v91, s43
    v_perm_b32 v223, v95, v91, s44
    v_perm_b32 v64, v100, v96, s43
    v_perm_b32 v68, v100, v96, s44
    v_perm_b32 v72, v101, v97, s43
    v_perm_b32 v76, v101, v97, s44
    v_perm_b32 v80, v102, v98, s43
    v_perm_b32 v84, v102, v98, s44
    v_perm_b32 v88, v103, v99, s43
    v_perm_b32 v92, v103, v99, s44
    v_perm_b32 v65, v108, v104, s43
    v_perm_b32 v69, v108, v104, s44
    v_perm_b32 v73, v109, v105, s43
    v_perm_b32 v77, v109, v105, s44
    v_perm_b32 v81, v110, v106, s43
    v_perm_b32 v85, v110, v106, s44
    v_perm_b32 v89, v111, v107, s43
    v_perm_b32 v93, v111, v107, s44
    v_perm_b32 v66, v116, v112, s43
    v_perm_b32 v70, v116, v112, s44
    v_perm_b32 v74, v117, v113, s43
    v_perm_b32 v78, v117, v113, s44
    v_perm_b32 v82, v118, v114, s43
    v_perm_b32 v86, v118, v114, s44
    v_perm_b32 v90, v119, v115, s43
    v_perm_b32 v94, v119, v115, s44
    v_perm_b32 v67, v124, v120, s43
    v_perm_b32 v71, v124, v120, s44
    v_perm_b32 v75, v125, v121, s43
    v_perm_b32 v79, v125, v121, s44
    v_perm_b32 v83, v126, v122, s43
    v_perm_b32 v87, v126, v122, s44
    v_perm_b32 v91, v127, v123, s43
    v_perm_b32 v95, v127, v123, s44
    v_perm_b32 v96, v132, v128, s43
    v_perm_b32 v100, v132, v128, s44
    v_perm_b32 v104, v133, v129, s43
    v_perm_b32 v108, v133, v129, s44
    v_perm_b32 v112, v134, v130, s43
    v_perm_b32 v116, v134, v130, s44
    v_perm_b32 v120, v135, v131, s43
    v_perm_b32 v124, v135, v131, s44
    v_perm_b32 v97, v140, v136, s43
    v_perm_b32 v101, v140, v136, s44
    v_perm_b32 v105, v141, v137, s43
    v_perm_b32 v109, v141, v137, s44
    v_perm_b32 v113, v142, v138, s43
    v_perm_b32 v117, v142, v138, s44
    v_perm_b32 v121, v143, v139, s43
    v_perm_b32 v125, v143, v139, s44
    v_perm_b32 v98, v148, v144, s43
    v_perm_b32 v102, v148, v144, s44
    v_perm_b32 v106, v149, v145, s43
    v_perm_b32 v110, v149, v145, s44
    v_perm_b32 v114, v150, v146, s43
    v_perm_b32 v118, v150, v146, s44
    v_perm_b32 v122, v151, v147, s43
    v_perm_b32 v126, v151, v147, s44
    v_perm_b32 v99, v156, v152, s43
    v_perm_b32 v103, v156, v152, s44
    v_perm_b32 v107, v157, v153, s43
    v_perm_b32 v111, v157, v153, s44
    v_perm_b32 v115, v158, v154, s43
    v_perm_b32 v119, v158, v154, s44
    v_perm_b32 v123, v159, v155, s43
    v_perm_b32 v127, v159, v155, s44
    v_perm_b32 v128, v164, v160, s43
    v_perm_b32 v132, v164, v160, s44
    v_perm_b32 v136, v165, v161, s43
    v_perm_b32 v140, v165, v161, s44
    v_perm_b32 v144, v166, v162, s43
    v_perm_b32 v148, v166, v162, s44
    v_perm_b32 v152, v167, v163, s43
    v_perm_b32 v156, v167, v163, s44
    v_perm_b32 v129, v172, v168, s43
    v_perm_b32 v133, v172, v168, s44
    v_perm_b32 v137, v173, v169, s43
    v_perm_b32 v141, v173, v169, s44
    v_perm_b32 v145, v174, v170, s43
    v_perm_b32 v149, v174, v170, s44
    v_perm_b32 v153, v175, v171, s43
    v_perm_b32 v157, v175, v171, s44
    v_perm_b32 v130, v180, v176, s43
    v_perm_b32 v134, v180, v176, s44
    v_perm_b32 v138, v181, v177, s43
    v_perm_b32 v142, v181, v177, s44
    v_perm_b32 v146, v182, v178, s43
    v_perm_b32 v150, v182, v178, s44
    v_perm_b32 v154, v183, v179, s43
    v_perm_b32 v158, v183, v179, s44
    v_perm_b32 v131, v188, v184, s43
    v_perm_b32 v135, v188, v184, s44
    v_perm_b32 v139, v189, v185, s43
    v_perm_b32 v143, v189, v185, s44
    v_perm_b32 v147, v190, v186, s43
    v_perm_b32 v151, v190, v186, s44
    v_perm_b32 v155, v191, v187, s43
    v_perm_b32 v159, v191, v187, s44
    s_cmp_lg_u32 s45, 2
    s_cbranch_scc1 L_ng_24
    s_add_u32 s64, s38, 0
    s_addc_u32 s65, s39, 0
    s_mov_b32 s66, 0x100
    s_mov_b32 s67, 0x20000
    s_lshl_b32 s46, s51, 5
    v_mov_b32 v20, s46
    s_nop 1
L_gt_25:
    buffer_load_dword v21, v20, s[64:67], 0 offen offset:4 sc1
    s_waitcnt vmcnt(0)
    v_cmp_gt_u32 vcc, 32, v21
    s_nop 1
    s_cbranch_vccz L_gtd_26
    s_sleep 64
    s_sub_u32 s49, s49, 1
    s_cmp_gt_i32 s49, 0
    s_cbranch_scc1 L_gt_25
L_gtd_26:
    v_mov_b32 v20, 1
    ds_write_b32 v5, v20 offset:76
    s_nop 3
L_ng_24:
    s_nop 1
L_lw_27:
    ds_read_b32 v8, v5 offset:76
    s_waitcnt lgkmcnt(0)
    v_cmp_gt_u32 vcc, 1, v8
    s_nop 1
    s_cbranch_vccz L_lwd_28
    s_sleep 1
    s_sub_u32 s49, s49, 1
    s_cmp_gt_i32 s49, 0
    s_cbranch_scc1 L_lw_27
L_lwd_28:
    s_nop 1
L_lw_29:
    ds_read_b128 v[8:11], v5 offset:32
    s_waitcnt lgkmcnt(0)
    v_min_u32 v8, v8, v9
    v_min3_u32 v8, v8, v10, v11
    v_cmp_gt_u32 vcc, 1, v8
    s_nop 1
    s_cbranch_vccz L_lwd_30
    s_sleep 1
    s_sub_u32 s49, s49, 1
    s_cmp_gt_i32 s49, 0
    s_cbranch_scc1 L_lw_29
L_lwd_30:
    s_setprio 3
    s_lshl_b32 s46, s45, 9
    v_add_u32 v18, s46, v17
    s_lshl_b32 s46, s45, 3
    v_mov_b32 v19, s46
    ds_read_b64 v[24:25], v18 offset:17408
    ds_read_b64 v[26:27], v18 offset:19456
    ds_read_b64 v[28:29], v18 offset:21504
    ds_read_b64 v[30:31], v18 offset:23552
    ds_read_b64 v[32:33], v19 offset:256
    s_waitcnt lgkmcnt(0)
    v_add_f32 v24, v24, v26
    v_add_f32 v25, v25, v27
    v_add_f32 v24, v24, v28
    v_add_f32 v25, v25, v29
    v_add_f32 v24, v24, v30
    v_add_f32 v25, v25, v31
    v_or_b32 v24, 1, v24
    v_or_b32 v25, 1, v25
    v_or_b32 v32, 1, v32
    v_or_b32 v33, 1, v33
    s_and_b32 s46, s75, 0xfffc0000
    s_lshl_b32 s47, s45, 16
    s_add_u32 s46, s46, s47
    s_and_b32 s47, s2, 3
    s_lshl_b32 s47, s47, 10
    s_add_u32 s46, s46, s47
    s_add_u32 s46, s46, 10240
    buffer_store_dwordx2 v[24:25], v17, s[56:59], s46 offen sc1
    s_mov_b64 exec, s[70:71]
    buffer_store_dwordx2 v[32:33], v5, s[56:59], s46 offen offset:512 sc1
    s_mov_b64 exec, -1
    s_add_u32 s46, s75, 10240
    s_nop 1
L_ox_31:
    buffer_load_dwordx2 v[24:25], v17, s[56:59], s46 offen offset:0 sc1
    buffer_load_dwordx2 v[32:33], v5, s[56:59], s46 offen offset:512 sc1
    buffer_load_dwordx2 v[26:27], v17, s[56:59], s46 offen offset:1024 sc1
    buffer_load_dwordx2 v[34:35], v5, s[56:59], s46 offen offset:1536 sc1
    buffer_load_dwordx2 v[28:29], v17, s[56:59], s46 offen offset:2048 sc1
    buffer_load_dwordx2 v[36:37], v5, s[56:59], s46 offen offset:2560 sc1
    buffer_load_dwordx2 v[30:31], v17, s[56:59], s46 offen offset:3072 sc1
    buffer_load_dwordx2 v[38:39], v5, s[56:59], s46 offen offset:3584 sc1
    s_waitcnt vmcnt(0)
    v_and_b32 v19, v24, v25
    v_and_b32 v19, v19, v26
    v_and_b32 v19, v19, v27
    v_and_b32 v19, v19, v28
    v_and_b32 v19, v19, v29
    v_and_b32 v19, v19, v30
    v_and_b32 v19, v19, v31
    v_and_b32 v19, v19, v32
    v_and_b32 v19, v19, v33
    v_and_b32 v19, v19, v34
    v_and_b32 v19, v19, v35
    v_and_b32 v19, v19, v36
    v_and_b32 v19, v19, v37
    v_and_b32 v19, v19, v38
    v_and_b32 v19, v19, v39
    v_and_b32 v19, 1, v19
    v_cmp_eq_u32 vcc, 0, v19
    s_nop 1
    s_cbranch_vccz L_oxd_32
    s_sleep 1
    s_sub_u32 s49, s49, 1
    s_cmp_gt_i32 s49, 0
    s_cbranch_scc1 L_ox_31
L_oxd_32:
    v_mov_b32 v44, v32
    v_max_f32 v44, v44, v34
    v_max_f32 v44, v44, v36
    v_max_f32 v44, v44, v38
    v_mov_b32 v43, 0
    v_mov_b32 v20, 0
    v_mov_b32 v21, 0
    v_sub_f32 v45, v32, v44
    v_mul_f32 v45, s72, v45
    v_exp_f32 v45, v45
    s_nop 0
    v_fma_f32 v43, v45, v33, v43
    v_fma_f32 v20, v45, v24, v20
    v_fma_f32 v21, v45, v25, v21
    v_sub_f32 v45, v34, v44
    v_mul_f32 v45, s72, v45
    v_exp_f32 v45, v45
    s_nop 0
    v_fma_f32 v43, v45, v35, v43
    v_fma_f32 v20, v45, v26, v20
    v_fma_f32 v21, v45, v27, v21
    v_sub_f32 v45, v36, v44
    v_mul_f32 v45, s72, v45
    v_exp_f32 v45, v45
    s_nop 0
    v_fma_f32 v43, v45, v37, v43
    v_fma_f32 v20, v45, v28, v20
    v_fma_f32 v21, v45, v29, v21
    v_sub_f32 v45, v38, v44
    v_mul_f32 v45, s72, v45
    v_exp_f32 v45, v45
    s_nop 0
    v_fma_f32 v43, v45, v39, v43
    v_fma_f32 v20, v45, v30, v20
    v_fma_f32 v21, v45, v31, v21
    v_rcp_f32 v43, v43
    s_nop 0
    v_mul_f32 v24, v20, v43
    v_mul_f32 v25, v21, v43
    v_cvt_pk_bf16_f32 v28, v24, v25
    v_lshrrev_b32 v29, 4, v2
    v_lshlrev_b32 v29, 6, v29
    v_and_b32 v30, 1, v2
    v_lshl_add_u32 v29, v30, 5, v29
    v_bfe_u32 v30, v2, 1, 3
    v_lshl_add_u32 v29, v30, 1, v29
    s_lshl_b32 s46, s45, 8
    v_add_u32 v29, s46, v29
    ds_write_b16 v29, v28 offset:5632
    ds_write_b16_d16_hi v29, v28 offset:5648
    s_waitcnt lgkmcnt(0)
    ds_read_b128 v[48:51], v15 offset:5632
    ds_read_b128 v[52:55], v15 offset:5696
    ds_read_b128 v[56:59], v15 offset:5760
    ds_read_b128 v[60:63], v15 offset:5824
    v_mov_b32 v224, 0
    v_mov_b32 v225, 0
    v_mov_b32 v226, 0
    v_mov_b32 v227, 0
    v_mov_b32 v228, 0
    v_mov_b32 v229, 0
    v_mov_b32 v230, 0
    v_mov_b32 v231, 0
    v_mov_b32 v232, 0
    v_mov_b32 v233, 0
    v_mov_b32 v234, 0
    v_mov_b32 v235, 0
    v_mov_b32 v236, 0
    v_mov_b32 v237, 0
    v_mov_b32 v238, 0
    v_mov_b32 v239, 0
    v_mov_b32 v240, 0
    v_mov_b32 v241, 0
    v_mov_b32 v242, 0
    v_mov_b32 v243, 0
    v_mov_b32 v244, 0
    v_mov_b32 v245, 0
    v_mov_b32 v246, 0
    v_mov_b32 v247, 0
    v_mov_b32 v248, 0
    v_mov_b32 v249, 0
    v_mov_b32 v250, 0
    v_mov_b32 v251, 0
    v_mov_b32 v252, 0
    v_mov_b32 v253, 0
    v_mov_b32 v254, 0
    v_mov_b32 v255, 0
    s_waitcnt lgkmcnt(0)
    v_mfma_f32_16x16x32_bf16 v[224:227], v[192:195], v[48:51], v[224:227]
    v_mfma_f32_16x16x32_bf16 v[228:231], v[196:199], v[48:51], v[228:231]
    v_mfma_f32_16x16x32_bf16 v[232:235], v[200:203], v[48:51], v[232:235]
    v_mfma_f32_16x16x32_bf16 v[236:239], v[204:207], v[48:51], v[236:239]
    v_mfma_f32_16x16x32_bf16 v[240:243], v[208:211], v[48:51], v[240:243]
    v_mfma_f32_16x16x32_bf16 v[244:247], v[212:215], v[48:51], v[244:247]
    v_mfma_f32_16x16x32_bf16 v[248:251], v[216:219], v[48:51], v[248:251]
    v_mfma_f32_16x16x32_bf16 v[252:255], v[220:223], v[48:51], v[252:255]
    v_mfma_f32_16x16x32_bf16 v[224:227], v[64:67], v[52:55], v[224:227]
    v_mfma_f32_16x16x32_bf16 v[228:231], v[68:71], v[52:55], v[228:231]
    v_mfma_f32_16x16x32_bf16 v[232:235], v[72:75], v[52:55], v[232:235]
    v_mfma_f32_16x16x32_bf16 v[236:239], v[76:79], v[52:55], v[236:239]
    v_mfma_f32_16x16x32_bf16 v[240:243], v[80:83], v[52:55], v[240:243]
    v_mfma_f32_16x16x32_bf16 v[244:247], v[84:87], v[52:55], v[244:247]
    v_mfma_f32_16x16x32_bf16 v[248:251], v[88:91], v[52:55], v[248:251]
    v_mfma_f32_16x16x32_bf16 v[252:255], v[92:95], v[52:55], v[252:255]
    v_mfma_f32_16x16x32_bf16 v[224:227], v[96:99], v[56:59], v[224:227]
    v_mfma_f32_16x16x32_bf16 v[228:231], v[100:103], v[56:59], v[228:231]
    v_mfma_f32_16x16x32_bf16 v[232:235], v[104:107], v[56:59], v[232:235]
    v_mfma_f32_16x16x32_bf16 v[236:239], v[108:111], v[56:59], v[236:239]
    v_mfma_f32_16x16x32_bf16 v[240:243], v[112:115], v[56:59], v[240:243]
    v_mfma_f32_16x16x32_bf16 v[244:247], v[116:119], v[56:59], v[244:247]
    v_mfma_f32_16x16x32_bf16 v[248:251], v[120:123], v[56:59], v[248:251]
    v_mfma_f32_16x16x32_bf16 v[252:255], v[124:127], v[56:59], v[252:255]
    v_mfma_f32_16x16x32_bf16 v[224:227], v[128:131], v[60:63], v[224:227]
    v_mfma_f32_16x16x32_bf16 v[228:231], v[132:135], v[60:63], v[228:231]
    v_mfma_f32_16x16x32_bf16 v[232:235], v[136:139], v[60:63], v[232:235]
    v_mfma_f32_16x16x32_bf16 v[236:239], v[140:143], v[60:63], v[236:239]
    v_mfma_f32_16x16x32_bf16 v[240:243], v[144:147], v[60:63], v[240:243]
    v_mfma_f32_16x16x32_bf16 v[244:247], v[148:151], v[60:63], v[244:247]
    v_mfma_f32_16x16x32_bf16 v[248:251], v[152:155], v[60:63], v[248:251]
    v_mfma_f32_16x16x32_bf16 v[252:255], v[156:159], v[60:63], v[252:255]
    s_lshl_b32 s46, s45, 9
    v_add_u32 v18, s46, v16
    s_mov_b64 exec, s[68:69]
    ds_write_b32 v18, v224 offset:6656
    ds_write_b32 v18, v225 offset:6688
    ds_write_b32 v18, v226 offset:6720
    ds_write_b32 v18, v227 offset:6752
    ds_write_b32 v18, v228 offset:6660
    ds_write_b32 v18, v229 offset:6692
    ds_write_b32 v18, v230 offset:6724
    ds_write_b32 v18, v231 offset:6756
    ds_write_b32 v18, v232 offset:6664
    ds_write_b32 v18, v233 offset:6696
    ds_write_b32 v18, v234 offset:6728
    ds_write_b32 v18, v235 offset:6760
    ds_write_b32 v18, v236 offset:6668
    ds_write_b32 v18, v237 offset:6700
    ds_write_b32 v18, v238 offset:6732
    ds_write_b32 v18, v239 offset:6764
    ds_write_b32 v18, v240 offset:6672
    ds_write_b32 v18, v241 offset:6704
    ds_write_b32 v18, v242 offset:6736
    ds_write_b32 v18, v243 offset:6768
    ds_write_b32 v18, v244 offset:6676
    ds_write_b32 v18, v245 offset:6708
    ds_write_b32 v18, v246 offset:6740
    ds_write_b32 v18, v247 offset:6772
    ds_write_b32 v18, v248 offset:6680
    ds_write_b32 v18, v249 offset:6712
    ds_write_b32 v18, v250 offset:6744
    ds_write_b32 v18, v251 offset:6776
    ds_write_b32 v18, v252 offset:6684
    ds_write_b32 v18, v253 offset:6716
    ds_write_b32 v18, v254 offset:6748
    ds_write_b32 v18, v255 offset:6780
    s_mov_b64 exec, -1
    v_add_u32 v18, s46, v17
    s_waitcnt lgkmcnt(0)
    ds_read_b64 v[24:25], v18 offset:6656
    s_add_u32 s46, s46, s75
    s_add_u32 s46, s46, 0
    s_waitcnt lgkmcnt(0)
    v_or_b32 v24, 1, v24
    v_or_b32 v25, 1, v25
    buffer_store_dwordx2 v[24:25], v17, s[56:59], s46 offen sc1
    s_and_b32 s46, s2, 31
    s_lshl_b32 s46, s46, 8
    s_add_u32 s60, s32, s46
    s_addc_u32 s61, s33, 0
    s_mov_b32 s62, 0x3fe100
    s_mov_b32 s63, 0x20000
    s_lshl_b32 s47, s45, 20
    buffer_load_dwordx4 v[64:67], v12, s[60:63], s47 offen
    s_add_u32 s47, s47, 32768
    buffer_load_dwordx4 v[68:71], v12, s[60:63], s47 offen
    s_add_u32 s47, s47, 32768
    buffer_load_dwordx4 v[72:75], v12, s[60:63], s47 offen
    s_add_u32 s47, s47, 32768
    buffer_load_dwordx4 v[76:79], v12, s[60:63], s47 offen
    s_add_u32 s47, s47, 32768
    buffer_load_dwordx4 v[80:83], v12, s[60:63], s47 offen
    s_add_u32 s47, s47, 32768
    buffer_load_dwordx4 v[84:87], v12, s[60:63], s47 offen
    s_add_u32 s47, s47, 32768
    buffer_load_dwordx4 v[88:91], v12, s[60:63], s47 offen
    s_add_u32 s47, s47, 32768
    buffer_load_dwordx4 v[92:95], v12, s[60:63], s47 offen
    s_add_u32 s47, s47, 32768
    buffer_load_dwordx4 v[96:99], v12, s[60:63], s47 offen
    s_add_u32 s47, s47, 32768
    buffer_load_dwordx4 v[100:103], v12, s[60:63], s47 offen
    s_add_u32 s47, s47, 32768
    buffer_load_dwordx4 v[104:107], v12, s[60:63], s47 offen
    s_add_u32 s47, s47, 32768
    buffer_load_dwordx4 v[108:111], v12, s[60:63], s47 offen
    s_add_u32 s47, s47, 32768
    buffer_load_dwordx4 v[112:115], v12, s[60:63], s47 offen
    s_add_u32 s47, s47, 32768
    buffer_load_dwordx4 v[116:119], v12, s[60:63], s47 offen
    s_add_u32 s47, s47, 32768
    buffer_load_dwordx4 v[120:123], v12, s[60:63], s47 offen
    s_add_u32 s47, s47, 32768
    buffer_load_dwordx4 v[124:127], v12, s[60:63], s47 offen
    s_add_u32 s47, s47, 32768
    buffer_load_dwordx4 v[128:131], v12, s[60:63], s47 offen
    s_add_u32 s47, s47, 32768
    buffer_load_dwordx4 v[132:135], v12, s[60:63], s47 offen
    s_add_u32 s47, s47, 32768
    buffer_load_dwordx4 v[136:139], v12, s[60:63], s47 offen
    s_add_u32 s47, s47, 32768
    buffer_load_dwordx4 v[140:143], v12, s[60:63], s47 offen
    s_add_u32 s47, s47, 32768
    buffer_load_dwordx4 v[144:147], v12, s[60:63], s47 offen
    s_add_u32 s47, s47, 32768
    buffer_load_dwordx4 v[148:151], v12, s[60:63], s47 offen
    s_add_u32 s47, s47, 32768
    buffer_load_dwordx4 v[152:155], v12, s[60:63], s47 offen
    s_add_u32 s47, s47, 32768
    buffer_load_dwordx4 v[156:159], v12, s[60:63], s47 offen
    s_add_u32 s47, s47, 32768
    buffer_load_dwordx4 v[160:163], v12, s[60:63], s47 offen
    s_add_u32 s47, s47, 32768
    buffer_load_dwordx4 v[164:167], v12, s[60:63], s47 offen
    s_add_u32 s47, s47, 32768
    buffer_load_dwordx4 v[168:171], v12, s[60:63], s47 offen
    s_add_u32 s47, s47, 32768
    buffer_load_dwordx4 v[172:175], v12, s[60:63], s47 offen
    s_add_u32 s47, s47, 32768
    buffer_load_dwordx4 v[176:179], v12, s[60:63], s47 offen
    s_add_u32 s47, s47, 32768
    buffer_load_dwordx4 v[180:183], v12, s[60:63], s47 offen
    s_add_u32 s47, s47, 32768
    buffer_load_dwordx4 v[184:187], v12, s[60:63], s47 offen
    s_add_u32 s47, s47, 32768
    buffer_load_dwordx4 v[188:191], v12, s[60:63], s47 offen
    s_lshl_b32 s46, s45, 9
    s_add_u32 s46, s46, 0
    s_mov_b32 s96, -1
    s_add_u32 s47, s46, 0
    buffer_load_dwordx2 v[24:25], v17, s[56:59], s47 offen sc1
    s_add_u32 s47, s46, 65536
    buffer_load_dwordx2 v[26:27], v17, s[56:59], s47 offen sc1
    s_add_u32 s47, s46, 131072
    buffer_load_dwordx2 v[28:29], v17, s[56:59], s47 offen sc1
    s_add_u32 s47, s46, 196608
    buffer_load_dwordx2 v[30:31], v17, s[56:59], s47 offen sc1
    s_add_u32 s47, s46, 262144
    buffer_load_dwordx2 v[32:33], v17, s[56:59], s47 offen sc1
    s_add_u32 s47, s46, 327680
    buffer_load_dwordx2 v[34:35], v17, s[56:59], s47 offen sc1
    s_add_u32 s47, s46, 393216
    buffer_load_dwordx2 v[36:37], v17, s[56:59], s47 offen sc1
    s_add_u32 s47, s46, 458752
    buffer_load_dwordx2 v[38:39], v17, s[56:59], s47 offen sc1
    s_add_u32 s47, s46, 524288
    buffer_load_dwordx2 v[40:41], v17, s[56:59], s47 offen sc1
    s_add_u32 s47, s46, 589824
    buffer_load_dwordx2 v[42:43], v17, s[56:59], s47 offen sc1
    s_add_u32 s47, s46, 655360
    buffer_load_dwordx2 v[44:45], v17, s[56:59], s47 offen sc1
    s_add_u32 s47, s46, 720896
    buffer_load_dwordx2 v[48:49], v17, s[56:59], s47 offen sc1
    s_add_u32 s47, s46, 786432
    buffer_load_dwordx2 v[50:51], v17, s[56:59], s47 offen sc1
    s_add_u32 s47, s46, 851968
    buffer_load_dwordx2 v[52:53], v17, s[56:59], s47 offen sc1
    s_add_u32 s47, s46, 917504
    buffer_load_dwordx2 v[54:55], v17, s[56:59], s47 offen sc1
    s_add_u32 s47, s46, 983040
    buffer_load_dwordx2 v[56:57], v17, s[56:59], s47 offen sc1
    s_add_u32 s47, s46, 1048576
    buffer_load_dwordx2 v[58:59], v17, s[56:59], s47 offen sc1
    s_add_u32 s47, s46, 1114112
    buffer_load_dwordx2 v[60:61], v17, s[56:59], s47 offen sc1
    s_add_u32 s47, s46, 1179648
    buffer_load_dwordx2 v[62:63], v17, s[56:59], s47 offen sc1
    s_add_u32 s47, s46, 1245184
    buffer_load_dwordx2 v[224:225], v17, s[56:59], s47 offen sc1
    s_add_u32 s47, s46, 1310720
    buffer_load_dwordx2 v[226:227], v17, s[56:59], s47 offen sc1
    s_add_u32 s47, s46, 1376256
    buffer_load_dwordx2 v[228:229], v17, s[56:59], s47 offen sc1
    s_add_u32 s47, s46, 1441792
    buffer_load_dwordx2 v[230:231], v17, s[56:59], s47 offen sc1
    s_add_u32 s47, s46, 1507328
    buffer_load_dwordx2 v[232:233], v17, s[56:59], s47 offen sc1
    s_add_u32 s47, s46, 1572864
    buffer_load_dwordx2 v[234:235], v17, s[56:59], s47 offen sc1
    s_add_u32 s47, s46, 1638400
    buffer_load_dwordx2 v[236:237], v17, s[56:59], s47 offen sc1
    s_add_u32 s47, s46, 1703936
    buffer_load_dwordx2 v[238:239], v17, s[56:59], s47 offen sc1
    s_add_u32 s47, s46, 1769472
    buffer_load_dwordx2 v[240:241], v17, s[56:59], s47 offen sc1
    s_add_u32 s47, s46, 1835008
    buffer_load_dwordx2 v[242:243], v17, s[56:59], s47 offen sc1
    s_add_u32 s47, s46, 1900544
    buffer_load_dwordx2 v[244:245], v17, s[56:59], s47 offen sc1
    s_add_u32 s47, s46, 1966080
    buffer_load_dwordx2 v[246:247], v17, s[56:59], s47 offen sc1
    s_add_u32 s47, s46, 2031616
    buffer_load_dwordx2 v[248:249], v17, s[56:59], s47 offen sc1
    s_waitcnt vmcnt(32)
    v_perm_b32 v192, v68, v64, s43
    v_perm_b32 v196, v68, v64, s44
    v_perm_b32 v200, v69, v65, s43
    v_perm_b32 v204, v69, v65, s44
    v_perm_b32 v208, v70, v66, s43
    v_perm_b32 v212, v70, v66, s44
    v_perm_b32 v216, v71, v67, s43
    v_perm_b32 v220, v71, v67, s44
    v_perm_b32 v193, v76, v72, s43
    v_perm_b32 v197, v76, v72, s44
    v_perm_b32 v201, v77, v73, s43
    v_perm_b32 v205, v77, v73, s44
    v_perm_b32 v209, v78, v74, s43
    v_perm_b32 v213, v78, v74, s44
    v_perm_b32 v217, v79, v75, s43
    v_perm_b32 v221, v79, v75, s44
    v_perm_b32 v194, v84, v80, s43
    v_perm_b32 v198, v84, v80, s44
    v_perm_b32 v202, v85, v81, s43
    v_perm_b32 v206, v85, v81, s44
    v_perm_b32 v210, v86, v82, s43
    v_perm_b32 v214, v86, v82, s44
    v_perm_b32 v218, v87, v83, s43
    v_perm_b32 v222, v87, v83, s44
    v_perm_b32 v195, v92, v88, s43
    v_perm_b32 v199, v92, v88, s44
    v_perm_b32 v203, v93, v89, s43
    v_perm_b32 v207, v93, v89, s44
    v_perm_b32 v211, v94, v90, s43
    v_perm_b32 v215, v94, v90, s44
    v_perm_b32 v219, v95, v91, s43
    v_perm_b32 v223, v95, v91, s44
    v_perm_b32 v64, v100, v96, s43
    v_perm_b32 v68, v100, v96, s44
    v_perm_b32 v72, v101, v97, s43
    v_perm_b32 v76, v101, v97, s44
    v_perm_b32 v80, v102, v98, s43
    v_perm_b32 v84, v102, v98, s44
    v_perm_b32 v88, v103, v99, s43
    v_perm_b32 v92, v103, v99, s44
    v_perm_b32 v65, v108, v104, s43
    v_perm_b32 v69, v108, v104, s44
    v_perm_b32 v73, v109, v105, s43
    v_perm_b32 v77, v109, v105, s44
    v_perm_b32 v81, v110, v106, s43
    v_perm_b32 v85, v110, v106, s44
    v_perm_b32 v89, v111, v107, s43
    v_perm_b32 v93, v111, v107, s44
    v_perm_b32 v66, v116, v112, s43
    v_perm_b32 v70, v116, v112, s44
    v_perm_b32 v74, v117, v113, s43
    v_perm_b32 v78, v117, v113, s44
    v_perm_b32 v82, v118, v114, s43
    v_perm_b32 v86, v118, v114, s44
    v_perm_b32 v90, v119, v115, s43
    v_perm_b32 v94, v119, v115, s44
    v_perm_b32 v67, v124, v120, s43
    v_perm_b32 v71, v124, v120, s44
    v_perm_b32 v75, v125, v121, s43
    v_perm_b32 v79, v125, v121, s44
    v_perm_b32 v83, v126, v122, s43
    v_perm_b32 v87, v126, v122, s44
    v_perm_b32 v91, v127, v123, s43
    v_perm_b32 v95, v127, v123, s44
    v_perm_b32 v96, v132, v128, s43
    v_perm_b32 v100, v132, v128, s44
    v_perm_b32 v104, v133, v129, s43
    v_perm_b32 v108, v133, v129, s44
    v_perm_b32 v112, v134, v130, s43
    v_perm_b32 v116, v134, v130, s44
    v_perm_b32 v120, v135, v131, s43
    v_perm_b32 v124, v135, v131, s44
    v_perm_b32 v97, v140, v136, s43
    v_perm_b32 v101, v140, v136, s44
    v_perm_b32 v105, v141, v137, s43
    v_perm_b32 v109, v141, v137, s44
    v_perm_b32 v113, v142, v138, s43
    v_perm_b32 v117, v142, v138, s44
    v_perm_b32 v121, v143, v139, s43
    v_perm_b32 v125, v143, v139, s44
    v_perm_b32 v98, v148, v144, s43
    v_perm_b32 v102, v148, v144, s44
    v_perm_b32 v106, v149, v145, s43
    v_perm_b32 v110, v149, v145, s44
    v_perm_b32 v114, v150, v146, s43
    v_perm_b32 v118, v150, v146, s44
    v_perm_b32 v122, v151, v147, s43
    v_perm_b32 v126, v151, v147, s44
    v_perm_b32 v99, v156, v152, s43
    v_perm_b32 v103, v156, v152, s44
    v_perm_b32 v107, v157, v153, s43
    v_perm_b32 v111, v157, v153, s44
    v_perm_b32 v115, v158, v154, s43
    v_perm_b32 v119, v158, v154, s44
    v_perm_b32 v123, v159, v155, s43
    v_perm_b32 v127, v159, v155, s44
    v_perm_b32 v128, v164, v160, s43
    v_perm_b32 v132, v164, v160, s44
    v_perm_b32 v136, v165, v161, s43
    v_perm_b32 v140, v165, v161, s44
    v_perm_b32 v144, v166, v162, s43
    v_perm_b32 v148, v166, v162, s44
    v_perm_b32 v152, v167, v163, s43
    v_perm_b32 v156, v167, v163, s44
    v_perm_b32 v129, v172, v168, s43
    v_perm_b32 v133, v172, v168, s44
    v_perm_b32 v137, v173, v169, s43
    v_perm_b32 v141, v173, v169, s44
    v_perm_b32 v145, v174, v170, s43
    v_perm_b32 v149, v174, v170, s44
    v_perm_b32 v153, v175, v171, s43
    v_perm_b32 v157, v175, v171, s44
    v_perm_b32 v130, v180, v176, s43
    v_perm_b32 v134, v180, v176, s44
    v_perm_b32 v138, v181, v177, s43
    v_perm_b32 v142, v181, v177, s44
    v_perm_b32 v146, v182, v178, s43
    v_perm_b32 v150, v182, v178, s44
    v_perm_b32 v154, v183, v179, s43
    v_perm_b32 v158, v183, v179, s44
    v_perm_b32 v131, v188, v184, s43
    v_perm_b32 v135, v188, v184, s44
    v_perm_b32 v139, v189, v185, s43
    v_perm_b32 v143, v189, v185, s44
    v_perm_b32 v147, v190, v186, s43
    v_perm_b32 v151, v190, v186, s44
    v_perm_b32 v155, v191, v187, s43
    v_perm_b32 v159, v191, v187, s44
    s_branch L_pc_35
L_pf_33:
    s_bitcmp1_b32 s96, 0
    s_cbranch_scc0 L_pk_36
    s_add_u32 s47, s46, 0
    buffer_load_dwordx2 v[24:25], v17, s[56:59], s47 offen sc1
L_pk_36:
    s_bitcmp1_b32 s96, 1
    s_cbranch_scc0 L_pk_37
    s_add_u32 s47, s46, 65536
    buffer_load_dwordx2 v[26:27], v17, s[56:59], s47 offen sc1
L_pk_37:
    s_bitcmp1_b32 s96, 2
    s_cbranch_scc0 L_pk_38
    s_add_u32 s47, s46, 131072
    buffer_load_dwordx2 v[28:29], v17, s[56:59], s47 offen sc1
L_pk_38:
    s_bitcmp1_b32 s96, 3
    s_cbranch_scc0 L_pk_39
    s_add_u32 s47, s46, 196608
    buffer_load_dwordx2 v[30:31], v17, s[56:59], s47 offen sc1
L_pk_39:
    s_bitcmp1_b32 s96, 4
    s_cbranch_scc0 L_pk_40
    s_add_u32 s47, s46, 262144
    buffer_load_dwordx2 v[32:33], v17, s[56:59], s47 offen sc1
L_pk_40:
    s_bitcmp1_b32 s96, 5
    s_cbranch_scc0 L_pk_41
    s_add_u32 s47, s46, 327680
    buffer_load_dwordx2 v[34:35], v17, s[56:59], s47 offen sc1
L_pk_41:
    s_bitcmp1_b32 s96, 6
    s_cbranch_scc0 L_pk_42
    s_add_u32 s47, s46, 393216
    buffer_load_dwordx2 v[36:37], v17, s[56:59], s47 offen sc1
L_pk_42:
    s_bitcmp1_b32 s96, 7
    s_cbranch_scc0 L_pk_43
    s_add_u32 s47, s46, 458752
    buffer_load_dwordx2 v[38:39], v17, s[56:59], s47 offen sc1
L_pk_43:
    s_bitcmp1_b32 s96, 8
    s_cbranch_scc0 L_pk_44
    s_add_u32 s47, s46, 524288
    buffer_load_dwordx2 v[40:41], v17, s[56:59], s47 offen sc1
L_pk_44:
    s_bitcmp1_b32 s96, 9
    s_cbranch_scc0 L_pk_45
    s_add_u32 s47, s46, 589824
    buffer_load_dwordx2 v[42:43], v17, s[56:59], s47 offen sc1
L_pk_45:
    s_bitcmp1_b32 s96, 10
    s_cbranch_scc0 L_pk_46
    s_add_u32 s47, s46, 655360
    buffer_load_dwordx2 v[44:45], v17, s[56:59], s47 offen sc1
L_pk_46:
    s_bitcmp1_b32 s96, 11
    s_cbranch_scc0 L_pk_47
    s_add_u32 s47, s46, 720896
    buffer_load_dwordx2 v[48:49], v17, s[56:59], s47 offen sc1
L_pk_47:
    s_bitcmp1_b32 s96, 12
    s_cbranch_scc0 L_pk_48
    s_add_u32 s47, s46, 786432
    buffer_load_dwordx2 v[50:51], v17, s[56:59], s47 offen sc1
L_pk_48:
    s_bitcmp1_b32 s96, 13
    s_cbranch_scc0 L_pk_49
    s_add_u32 s47, s46, 851968
    buffer_load_dwordx2 v[52:53], v17, s[56:59], s47 offen sc1
L_pk_49:
    s_bitcmp1_b32 s96, 14
    s_cbranch_scc0 L_pk_50
    s_add_u32 s47, s46, 917504
    buffer_load_dwordx2 v[54:55], v17, s[56:59], s47 offen sc1
L_pk_50:
    s_bitcmp1_b32 s96, 15
    s_cbranch_scc0 L_pk_51
    s_add_u32 s47, s46, 983040
    buffer_load_dwordx2 v[56:57], v17, s[56:59], s47 offen sc1
L_pk_51:
    s_bitcmp1_b32 s96, 16
    s_cbranch_scc0 L_pk_52
    s_add_u32 s47, s46, 1048576
    buffer_load_dwordx2 v[58:59], v17, s[56:59], s47 offen sc1
L_pk_52:
    s_bitcmp1_b32 s96, 17
    s_cbranch_scc0 L_pk_53
    s_add_u32 s47, s46, 1114112
    buffer_load_dwordx2 v[60:61], v17, s[56:59], s47 offen sc1
L_pk_53:
    s_bitcmp1_b32 s96, 18
    s_cbranch_scc0 L_pk_54
    s_add_u32 s47, s46, 1179648
    buffer_load_dwordx2 v[62:63], v17, s[56:59], s47 offen sc1
L_pk_54:
    s_bitcmp1_b32 s96, 19
    s_cbranch_scc0 L_pk_55
    s_add_u32 s47, s46, 1245184
    buffer_load_dwordx2 v[224:225], v17, s[56:59], s47 offen sc1
L_pk_55:
    s_bitcmp1_b32 s96, 20
    s_cbranch_scc0 L_pk_56
    s_add_u32 s47, s46, 1310720
    buffer_load_dwordx2 v[226:227], v17, s[56:59], s47 offen sc1
L_pk_56:
    s_bitcmp1_b32 s96, 21
    s_cbranch_scc0 L_pk_57
    s_add_u32 s47, s46, 1376256
    buffer_load_dwordx2 v[228:229], v17, s[56:59], s47 offen sc1
L_pk_57:
    s_bitcmp1_b32 s96, 22
    s_cbranch_scc0 L_pk_58
    s_add_u32 s47, s46, 1441792
    buffer_load_dwordx2 v[230:231], v17, s[56:59], s47 offen sc1
L_pk_58:
    s_bitcmp1_b32 s96, 23
    s_cbranch_scc0 L_pk_59
    s_add_u32 s47, s46, 1507328
    buffer_load_dwordx2 v[232:233], v17, s[56:59], s47 offen sc1
L_pk_59:
    s_bitcmp1_b32 s96, 24
    s_cbranch_scc0 L_pk_60
    s_add_u32 s47, s46, 1572864
    buffer_load_dwordx2 v[234:235], v17, s[56:59], s47 offen sc1
L_pk_60:
    s_bitcmp1_b32 s96, 25
    s_cbranch_scc0 L_pk_61
    s_add_u32 s47, s46, 1638400
    buffer_load_dwordx2 v[236:237], v17, s[56:59], s47 offen sc1
L_pk_61:
    s_bitcmp1_b32 s96, 26
    s_cbranch_scc0 L_pk_62
    s_add_u32 s47, s46, 1703936
    buffer_load_dwordx2 v[238:239], v17, s[56:59], s47 offen sc1
L_pk_62:
    s_bitcmp1_b32 s96, 27
    s_cbranch_scc0 L_pk_63
    s_add_u32 s47, s46, 1769472
    buffer_load_dwordx2 v[240:241], v17, s[56:59], s47 offen sc1
L_pk_63:
    s_bitcmp1_b32 s96, 28
    s_cbranch_scc0 L_pk_64
    s_add_u32 s47, s46, 1835008
    buffer_load_dwordx2 v[242:243], v17, s[56:59], s47 offen sc1
L_pk_64:
    s_bitcmp1_b32 s96, 29
    s_cbranch_scc0 L_pk_65
    s_add_u32 s47, s46, 1900544
    buffer_load_dwordx2 v[244:245], v17, s[56:59], s47 offen sc1
L_pk_65:
    s_bitcmp1_b32 s96, 30
    s_cbranch_scc0 L_pk_66
    s_add_u32 s47, s46, 1966080
    buffer_load_dwordx2 v[246:247], v17, s[56:59], s47 offen sc1
L_pk_66:
    s_bitcmp1_b32 s96, 31
    s_cbranch_scc0 L_pk_67
    s_add_u32 s47, s46, 2031616
    buffer_load_dwordx2 v[248:249], v17, s[56:59], s47 offen sc1
L_pk_67:
L_pc_35:
    s_waitcnt vmcnt(0)
    s_mov_b32 s97, 0
    v_and_b32 v19, v24, v25
    v_and_b32 v19, 1, v19
    v_cmp_eq_u32 s[4:5], 0, v19
    v_and_b32 v19, v26, v27
    v_and_b32 v19, 1, v19
    v_cmp_eq_u32 s[6:7], 0, v19
    v_and_b32 v19, v28, v29
    v_and_b32 v19, 1, v19
    v_cmp_eq_u32 s[8:9], 0, v19
    v_and_b32 v19, v30, v31
    v_and_b32 v19, 1, v19
    v_cmp_eq_u32 s[10:11], 0, v19
    v_and_b32 v19, v32, v33
    v_and_b32 v19, 1, v19
    v_cmp_eq_u32 s[12:13], 0, v19
    v_and_b32 v19, v34, v35
    v_and_b32 v19, 1, v19
    v_cmp_eq_u32 s[14:15], 0, v19
    s_cmp_lg_u64 s[4:5], 0
    s_cselect_b32 s48, 0x1, 0
    s_or_b32 s97, s97, s48
    s_cmp_lg_u64 s[6:7], 0
    s_cselect_b32 s48, 0x2, 0
    s_or_b32 s97, s97, s48
    s_cmp_lg_u64 s[8:9], 0
    s_cselect_b32 s48, 0x4, 0
    s_or_b32 s97, s97, s48
    s_cmp_lg_u64 s[10:11], 0
    s_cselect_b32 s48, 0x8, 0
    s_or_b32 s97, s97, s48
    s_cmp_lg_u64 s[12:13], 0
    s_cselect_b32 s48, 0x10, 0
    s_or_b32 s97, s97, s48
    s_cmp_lg_u64 s[14:15], 0
    s_cselect_b32 s48, 0x20, 0
    s_or_b32 s97, s97, s48
    v_and_b32 v19, v36, v37
    v_and_b32 v19, 1, v19
    v_cmp_eq_u32 s[4:5], 0, v19
    v_and_b32 v19, v38, v39
    v_and_b32 v19, 1, v19
    v_cmp_eq_u32 s[6:7], 0, v19
    v_and_b32 v19, v40, v41
    v_and_b32 v19, 1, v19
    v_cmp_eq_u32 s[8:9], 0, v19
    v_and_b32 v19, v42, v43
    v_and_b32 v19, 1, v19
    v_cmp_eq_u32 s[10:11], 0, v19
    v_and_b32 v19, v44, v45
    v_and_b32 v19, 1, v19
    v_cmp_eq_u32 s[12:13], 0, v19
    v_and_b32 v19, v48, v49
    v_and_b32 v19, 1, v19
    v_cmp_eq_u32 s[14:15], 0, v19
    s_cmp_lg_u64 s[4:5], 0
    s_cselect_b32 s48, 0x40, 0
    s_or_b32 s97, s97, s48
    s_cmp_lg_u64 s[6:7], 0
    s_cselect_b32 s48, 0x80, 0
    s_or_b32 s97, s97, s48
    s_cmp_lg_u64 s[8:9], 0
    s_cselect_b32 s48, 0x100, 0
    s_or_b32 s97, s97, s48
    s_cmp_lg_u64 s[10:11], 0
    s_cselect_b32 s48, 0x200, 0
    s_or_b32 s97, s97, s48
    s_cmp_lg_u64 s[12:13], 0
    s_cselect_b32 s48, 0x400, 0
    s_or_b32 s97, s97, s48
    s_cmp_lg_u64 s[14:15], 0
    s_cselect_b32 s48, 0x800, 0
    s_or_b32 s97, s97, s48
    v_and_b32 v19, v50, v51
    v_and_b32 v19, 1, v19
    v_cmp_eq_u32 s[4:5], 0, v19
    v_and_b32 v19, v52, v53
    v_and_b32 v19, 1, v19
    v_cmp_eq_u32 s[6:7], 0, v19
    v_and_b32 v19, v54, v55
    v_and_b32 v19, 1, v19
    v_cmp_eq_u32 s[8:9], 0, v19
    v_and_b32 v19, v56, v57
    v_and_b32 v19, 1, v19
    v_cmp_eq_u32 s[10:11], 0, v19
    v_and_b32 v19, v58, v59
    v_and_b32 v19, 1, v19
    v_cmp_eq_u32 s[12:13], 0, v19
    v_and_b32 v19, v60, v61
    v_and_b32 v19, 1, v19
    v_cmp_eq_u32 s[14:15], 0, v19
    s_cmp_lg_u64 s[4:5], 0
    s_cselect_b32 s48, 0x1000, 0
    s_or_b32 s97, s97, s48
    s_cmp_lg_u64 s[6:7], 0
    s_cselect_b32 s48, 0x2000, 0
    s_or_b32 s97, s97, s48
    s_cmp_lg_u64 s[8:9], 0
    s_cselect_b32 s48, 0x4000, 0
    s_or_b32 s97, s97, s48
    s_cmp_lg_u64 s[10:11], 0
    s_cselect_b32 s48, 0x8000, 0
    s_or_b32 s97, s97, s48
    s_cmp_lg_u64 s[12:13], 0
    s_cselect_b32 s48, 0x10000, 0
    s_or_b32 s97, s97, s48
    s_cmp_lg_u64 s[14:15], 0
    s_cselect_b32 s48, 0x20000, 0
    s_or_b32 s97, s97, s48
    v_and_b32 v19, v62, v63
    v_and_b32 v19, 1, v19
    v_cmp_eq_u32 s[4:5], 0, v19
    v_and_b32 v19, v224, v225
    v_and_b32 v19, 1, v19
    v_cmp_eq_u32 s[6:7], 0, v19
    v_and_b32 v19, v226, v227
    v_and_b32 v19, 1, v19
    v_cmp_eq_u32 s[8:9], 0, v19
    v_and_b32 v19, v228, v229
    v_and_b32 v19, 1, v19
    v_cmp_eq_u32 s[10:11], 0, v19
    v_and_b32 v19, v230, v231
    v_and_b32 v19, 1, v19
    v_cmp_eq_u32 s[12:13], 0, v19
    v_and_b32 v19, v232, v233
    v_and_b32 v19, 1, v19
    v_cmp_eq_u32 s[14:15], 0, v19
    s_cmp_lg_u64 s[4:5], 0
    s_cselect_b32 s48, 0x40000, 0
    s_or_b32 s97, s97, s48
    s_cmp_lg_u64 s[6:7], 0
    s_cselect_b32 s48, 0x80000, 0
    s_or_b32 s97, s97, s48
    s_cmp_lg_u64 s[8:9], 0
    s_cselect_b32 s48, 0x100000, 0
    s_or_b32 s97, s97, s48
    s_cmp_lg_u64 s[10:11], 0
    s_cselect_b32 s48, 0x200000, 0
    s_or_b32 s97, s97, s48
    s_cmp_lg_u64 s[12:13], 0
    s_cselect_b32 s48, 0x400000, 0
    s_or_b32 s97, s97, s48
    s_cmp_lg_u64 s[14:15], 0
    s_cselect_b32 s48, 0x800000, 0
    s_or_b32 s97, s97, s48
    v_and_b32 v19, v234, v235
    v_and_b32 v19, 1, v19
    v_cmp_eq_u32 s[4:5], 0, v19
    v_and_b32 v19, v236, v237
    v_and_b32 v19, 1, v19
    v_cmp_eq_u32 s[6:7], 0, v19
    v_and_b32 v19, v238, v239
    v_and_b32 v19, 1, v19
    v_cmp_eq_u32 s[8:9], 0, v19
    v_and_b32 v19, v240, v241
    v_and_b32 v19, 1, v19
    v_cmp_eq_u32 s[10:11], 0, v19
    v_and_b32 v19, v242, v243
    v_and_b32 v19, 1, v19
    v_cmp_eq_u32 s[12:13], 0, v19
    v_and_b32 v19, v244, v245
    v_and_b32 v19, 1, v19
    v_cmp_eq_u32 s[14:15], 0, v19
    s_cmp_lg_u64 s[4:5], 0
    s_cselect_b32 s48, 0x1000000, 0
    s_or_b32 s97, s97, s48
    s_cmp_lg_u64 s[6:7], 0
    s_cselect_b32 s48, 0x2000000, 0
    s_or_b32 s97, s97, s48
    s_cmp_lg_u64 s[8:9], 0
    s_cselect_b32 s48, 0x4000000, 0
    s_or_b32 s97, s97, s48
    s_cmp_lg_u64 s[10:11], 0
    s_cselect_b32 s48, 0x8000000, 0
    s_or_b32 s97, s97, s48
    s_cmp_lg_u64 s[12:13], 0
    s_cselect_b32 s48, 0x10000000, 0
    s_or_b32 s97, s97, s48
    s_cmp_lg_u64 s[14:15], 0
    s_cselect_b32 s48, 0x20000000, 0
    s_or_b32 s97, s97, s48
    v_and_b32 v19, v246, v247
    v_and_b32 v19, 1, v19
    v_cmp_eq_u32 s[4:5], 0, v19
    v_and_b32 v19, v248, v249
    v_and_b32 v19, 1, v19
    v_cmp_eq_u32 s[6:7], 0, v19
    s_cmp_lg_u64 s[4:5], 0
    s_cselect_b32 s48, 0x40000000, 0
    s_or_b32 s97, s97, s48
    s_cmp_lg_u64 s[6:7], 0
    s_cselect_b32 s48, 0x80000000, 0
    s_or_b32 s97, s97, s48
    s_mov_b32 s96, s97
    s_cmp_eq_u32 s96, 0
    s_cbranch_scc1 L_pfd_34
    s_sleep 2
    s_sub_u32 s49, s49, 1
    s_cmp_gt_i32 s49, 0
    s_cbranch_scc1 L_pf_33
L_pfd_34:
    v_add_f32 v24, v24, v26
    v_add_f32 v25, v25, v27
    v_add_f32 v24, v24, v28
    v_add_f32 v25, v25, v29
    v_add_f32 v24, v24, v30
    v_add_f32 v25, v25, v31
    v_add_f32 v24, v24, v32
    v_add_f32 v25, v25, v33
    v_add_f32 v24, v24, v34
    v_add_f32 v25, v25, v35
    v_add_f32 v24, v24, v36
    v_add_f32 v25, v25, v37
    v_add_f32 v24, v24, v38
    v_add_f32 v25, v25, v39
    v_add_f32 v24, v24, v40
    v_add_f32 v25, v25, v41
    v_add_f32 v24, v24, v42
    v_add_f32 v25, v25, v43
    v_add_f32 v24, v24, v44
    v_add_f32 v25, v25, v45
    v_add_f32 v24, v24, v48
    v_add_f32 v25, v25, v49
    v_add_f32 v24, v24, v50
    v_add_f32 v25, v25, v51
    v_add_f32 v24, v24, v52
    v_add_f32 v25, v25, v53
    v_add_f32 v24, v24, v54
    v_add_f32 v25, v25, v55
    v_add_f32 v24, v24, v56
    v_add_f32 v25, v25, v57
    v_add_f32 v24, v24, v58
    v_add_f32 v25, v25, v59
    v_add_f32 v24, v24, v60
    v_add_f32 v25, v25, v61
    v_add_f32 v24, v24, v62
    v_add_f32 v25, v25, v63
    v_add_f32 v24, v24, v224
    v_add_f32 v25, v25, v225
    v_add_f32 v24, v24, v226
    v_add_f32 v25, v25, v227
    v_add_f32 v24, v24, v228
    v_add_f32 v25, v25, v229
    v_add_f32 v24, v24, v230
    v_add_f32 v25, v25, v231
    v_add_f32 v24, v24, v232
    v_add_f32 v25, v25, v233
    v_add_f32 v24, v24, v234
    v_add_f32 v25, v25, v235
    v_add_f32 v24, v24, v236
    v_add_f32 v25, v25, v237
    v_add_f32 v24, v24, v238
    v_add_f32 v25, v25, v239
    v_add_f32 v24, v24, v240
    v_add_f32 v25, v25, v241
    v_add_f32 v24, v24, v242
    v_add_f32 v25, v25, v243
    v_add_f32 v24, v24, v244
    v_add_f32 v25, v25, v245
    v_add_f32 v24, v24, v246
    v_add_f32 v25, v25, v247
    v_add_f32 v24, v24, v248
    v_add_f32 v25, v25, v249
    v_cvt_pk_bf16_f32 v24, v24, v24
    v_lshlrev_b32 v24, 16, v24
    v_cvt_pk_bf16_f32 v25, v25, v25
    v_lshlrev_b32 v25, 16, v25
    v_add_f32 v6, v6, v24
    v_add_f32 v7, v7, v25
    v_cvt_pk_bf16_f32 v6, v6, v6
    v_lshlrev_b32 v6, 16, v6
    v_cvt_pk_bf16_f32 v7, v7, v7
    v_lshlrev_b32 v7, 16, v7
    v_subrev_u32 v18, 256, v0
    v_lshlrev_b32 v18, 3, v18
    ds_write_b64 v18, v[6:7] offset:512
    s_lshl_b32 s46, s45, 2
    v_mov_b32 v19, s46
    s_waitcnt lgkmcnt(0)
    v_mov_b32 v20, 2
    ds_write_b32 v19, v20 offset:0
    s_nop 1
L_lw_68:
    ds_read_b128 v[8:11], v5 offset:0
    s_waitcnt lgkmcnt(0)
    v_min_u32 v8, v8, v9
    v_min3_u32 v8, v8, v10, v11
    v_cmp_gt_u32 vcc, 2, v8
    s_nop 1
    s_cbranch_vccz L_lwd_69
    s_sleep 1
    s_sub_u32 s49, s49, 1
    s_cmp_gt_i32 s49, 0
    s_cbranch_scc1 L_lw_68
L_lwd_69:
    v_lshlrev_b32 v18, 5, v2
    ds_read_b128 v[24:27], v18 offset:512
    ds_read_b128 v[28:31], v18 offset:528
    s_waitcnt lgkmcnt(0)
    v_add_f32 v20, v24, v25
    v_add_f32 v20, v20, v26
    v_add_f32 v20, v20, v27
    v_add_f32 v20, v20, v28
    v_add_f32 v20, v20, v29
    v_add_f32 v20, v20, v30
    v_add_f32 v20, v20, v31
    s_nop 1
    v_add_f32_dpp v20, v20, v20 quad_perm:[1,0,3,2] row_mask:0xf bank_mask:0xf
    s_nop 1
    v_add_f32_dpp v20, v20, v20 quad_perm:[2,3,0,1] row_mask:0xf bank_mask:0xf
    s_nop 1
    v_add_f32_dpp v20, v20, v20 row_half_mirror row_mask:0xf bank_mask:0xf
    s_nop 1
    v_add_f32_dpp v20, v20, v20 row_mirror row_mask:0xf bank_mask:0xf
    v_mov_b32 v22, v20
    s_nop 1
    v_permlane16_swap_b32 v20, v22
    v_add_f32 v20, v20, v22
    v_mov_b32 v22, v20
    s_nop 1
    v_permlane32_swap_b32 v20, v22
    v_add_f32 v20, v20, v22
    v_mul_f32 v20, 0x3b000000, v20
    v_mov_b32 v21, 0
    v_sub_f32 v22, v24, v20
    v_fma_f32 v21, v22, v22, v21
    v_sub_f32 v22, v25, v20
    v_fma_f32 v21, v22, v22, v21
    v_sub_f32 v22, v26, v20
    v_fma_f32 v21, v22, v22, v21
    v_sub_f32 v22, v27, v20
    v_fma_f32 v21, v22, v22, v21
    v_sub_f32 v22, v28, v20
    v_fma_f32 v21, v22, v22, v21
    v_sub_f32 v22, v29, v20
    v_fma_f32 v21, v22, v22, v21
    v_sub_f32 v22, v30, v20
    v_fma_f32 v21, v22, v22, v21
    v_sub_f32 v22, v31, v20
    v_fma_f32 v21, v22, v22, v21
    s_nop 1
    v_add_f32_dpp v21, v21, v21 quad_perm:[1,0,3,2] row_mask:0xf bank_mask:0xf
    s_nop 1
    v_add_f32_dpp v21, v21, v21 quad_perm:[2,3,0,1] row_mask:0xf bank_mask:0xf
    s_nop 1
    v_add_f32_dpp v21, v21, v21 row_half_mirror row_mask:0xf bank_mask:0xf
    s_nop 1
    v_add_f32_dpp v21, v21, v21 row_mirror row_mask:0xf bank_mask:0xf
    v_mov_b32 v22, v21
    s_nop 1
    v_permlane16_swap_b32 v21, v22
    v_add_f32 v21, v21, v22
    v_mov_b32 v22, v21
    s_nop 1
    v_permlane32_swap_b32 v21, v22
    v_add_f32 v21, v21, v22
    v_mul_f32 v21, 0x3b000000, v21
    v_cvt_pk_bf16_f32 v20, v20, v20
    v_lshlrev_b32 v20, 16, v20
    v_cvt_pk_bf16_f32 v21, v21, v21
    v_lshlrev_b32 v21, 16, v21
    v_add_f32 v21, 0x3727c5ac, v21
    v_cvt_pk_bf16_f32 v21, v21, v21
    v_lshlrev_b32 v21, 16, v21
    v_sqrt_f32 v21, v21
    s_nop 0
    v_cvt_pk_bf16_f32 v21, v21, v21
    v_lshlrev_b32 v21, 16, v21
    v_rcp_f32 v22, v21
    v_sub_f32 v26, v6, v20
    v_cvt_pk_bf16_f32 v26, v26, v26
    v_lshlrev_b32 v26, 16, v26
    v_mul_f32 v24, v26, v22
    v_fma_f32 v27, -v24, v21, v26
    v_fma_f32 v24, v27, v22, v24
    v_sub_f32 v26, v7, v20
    v_cvt_pk_bf16_f32 v26, v26, v26
    v_lshlrev_b32 v26, 16, v26
    v_mul_f32 v25, v26, v22
    v_fma_f32 v27, -v25, v21, v26
    v_fma_f32 v25, v27, v22, v25
    v_cvt_pk_bf16_f32 v28, v24, v25
    v_lshrrev_b32 v29, 4, v2
    v_lshlrev_b32 v29, 6, v29
    v_and_b32 v30, 1, v2
    v_lshl_add_u32 v29, v30, 5, v29
    v_bfe_u32 v30, v2, 1, 3
    v_lshl_add_u32 v29, v30, 1, v29
    s_lshl_b32 s46, s45, 8
    v_add_u32 v29, s46, v29
    ds_write_b16 v29, v28 offset:5632
    ds_write_b16_d16_hi v29, v28 offset:5648
    s_waitcnt lgkmcnt(0)
    ds_read_b128 v[48:51], v15 offset:5632
    ds_read_b128 v[52:55], v15 offset:5696
    ds_read_b128 v[56:59], v15 offset:5760
    ds_read_b128 v[60:63], v15 offset:5824
    v_mov_b32 v224, 0
    v_mov_b32 v225, 0
    v_mov_b32 v226, 0
    v_mov_b32 v227, 0
    v_mov_b32 v228, 0
    v_mov_b32 v229, 0
    v_mov_b32 v230, 0
    v_mov_b32 v231, 0
    v_mov_b32 v232, 0
    v_mov_b32 v233, 0
    v_mov_b32 v234, 0
    v_mov_b32 v235, 0
    v_mov_b32 v236, 0
    v_mov_b32 v237, 0
    v_mov_b32 v238, 0
    v_mov_b32 v239, 0
    v_mov_b32 v240, 0
    v_mov_b32 v241, 0
    v_mov_b32 v242, 0
    v_mov_b32 v243, 0
    v_mov_b32 v244, 0
    v_mov_b32 v245, 0
    v_mov_b32 v246, 0
    v_mov_b32 v247, 0
    v_mov_b32 v248, 0
    v_mov_b32 v249, 0
    v_mov_b32 v250, 0
    v_mov_b32 v251, 0
    v_mov_b32 v252, 0
    v_mov_b32 v253, 0
    v_mov_b32 v254, 0
    v_mov_b32 v255, 0
    s_waitcnt lgkmcnt(0)
    v_mfma_f32_16x16x32_bf16 v[224:227], v[192:195], v[48:51], v[224:227]
    v_mfma_f32_16x16x32_bf16 v[228:231], v[196:199], v[48:51], v[228:231]
    v_mfma_f32_16x16x32_bf16 v[232:235], v[200:203], v[48:51], v[232:235]
    v_mfma_f32_16x16x32_bf16 v[236:239], v[204:207], v[48:51], v[236:239]
    v_mfma_f32_16x16x32_bf16 v[240:243], v[208:211], v[48:51], v[240:243]
    v_mfma_f32_16x16x32_bf16 v[244:247], v[212:215], v[48:51], v[244:247]
    v_mfma_f32_16x16x32_bf16 v[248:251], v[216:219], v[48:51], v[248:251]
    v_mfma_f32_16x16x32_bf16 v[252:255], v[220:223], v[48:51], v[252:255]
    v_mfma_f32_16x16x32_bf16 v[224:227], v[64:67], v[52:55], v[224:227]
    v_mfma_f32_16x16x32_bf16 v[228:231], v[68:71], v[52:55], v[228:231]
    v_mfma_f32_16x16x32_bf16 v[232:235], v[72:75], v[52:55], v[232:235]
    v_mfma_f32_16x16x32_bf16 v[236:239], v[76:79], v[52:55], v[236:239]
    v_mfma_f32_16x16x32_bf16 v[240:243], v[80:83], v[52:55], v[240:243]
    v_mfma_f32_16x16x32_bf16 v[244:247], v[84:87], v[52:55], v[244:247]
    v_mfma_f32_16x16x32_bf16 v[248:251], v[88:91], v[52:55], v[248:251]
    v_mfma_f32_16x16x32_bf16 v[252:255], v[92:95], v[52:55], v[252:255]
    v_mfma_f32_16x16x32_bf16 v[224:227], v[96:99], v[56:59], v[224:227]
    v_mfma_f32_16x16x32_bf16 v[228:231], v[100:103], v[56:59], v[228:231]
    v_mfma_f32_16x16x32_bf16 v[232:235], v[104:107], v[56:59], v[232:235]
    v_mfma_f32_16x16x32_bf16 v[236:239], v[108:111], v[56:59], v[236:239]
    v_mfma_f32_16x16x32_bf16 v[240:243], v[112:115], v[56:59], v[240:243]
    v_mfma_f32_16x16x32_bf16 v[244:247], v[116:119], v[56:59], v[244:247]
    v_mfma_f32_16x16x32_bf16 v[248:251], v[120:123], v[56:59], v[248:251]
    v_mfma_f32_16x16x32_bf16 v[252:255], v[124:127], v[56:59], v[252:255]
    v_mfma_f32_16x16x32_bf16 v[224:227], v[128:131], v[60:63], v[224:227]
    v_mfma_f32_16x16x32_bf16 v[228:231], v[132:135], v[60:63], v[228:231]
    v_mfma_f32_16x16x32_bf16 v[232:235], v[136:139], v[60:63], v[232:235]
    v_mfma_f32_16x16x32_bf16 v[236:239], v[140:143], v[60:63], v[236:239]
    v_mfma_f32_16x16x32_bf16 v[240:243], v[144:147], v[60:63], v[240:243]
    v_mfma_f32_16x16x32_bf16 v[244:247], v[148:151], v[60:63], v[244:247]
    v_mfma_f32_16x16x32_bf16 v[248:251], v[152:155], v[60:63], v[248:251]
    v_mfma_f32_16x16x32_bf16 v[252:255], v[156:159], v[60:63], v[252:255]
    s_lshl_b32 s46, s45, 9
    v_add_u32 v18, s46, v16
    s_mov_b64 exec, s[68:69]
    ds_write_b32 v18, v224 offset:2560
    ds_write_b32 v18, v225 offset:2592
    ds_write_b32 v18, v226 offset:2624
    ds_write_b32 v18, v227 offset:2656
    ds_write_b32 v18, v228 offset:2564
    ds_write_b32 v18, v229 offset:2596
    ds_write_b32 v18, v230 offset:2628
    ds_write_b32 v18, v231 offset:2660
    ds_write_b32 v18, v232 offset:2568
    ds_write_b32 v18, v233 offset:2600
    ds_write_b32 v18, v234 offset:2632
    ds_write_b32 v18, v235 offset:2664
    ds_write_b32 v18, v236 offset:2572
    ds_write_b32 v18, v237 offset:2604
    ds_write_b32 v18, v238 offset:2636
    ds_write_b32 v18, v239 offset:2668
    ds_write_b32 v18, v240 offset:2576
    ds_write_b32 v18, v241 offset:2608
    ds_write_b32 v18, v242 offset:2640
    ds_write_b32 v18, v243 offset:2672
    ds_write_b32 v18, v244 offset:2580
    ds_write_b32 v18, v245 offset:2612
    ds_write_b32 v18, v246 offset:2644
    ds_write_b32 v18, v247 offset:2676
    ds_write_b32 v18, v248 offset:2584
    ds_write_b32 v18, v249 offset:2616
    ds_write_b32 v18, v250 offset:2648
    ds_write_b32 v18, v251 offset:2680
    ds_write_b32 v18, v252 offset:2588
    ds_write_b32 v18, v253 offset:2620
    ds_write_b32 v18, v254 offset:2652
    ds_write_b32 v18, v255 offset:2684
    s_mov_b64 exec, -1
    s_lshl_b32 s46, s45, 2
    v_mov_b32 v19, s46
    s_waitcnt lgkmcnt(0)
    v_mov_b32 v20, 2
    ds_write_b32 v19, v20 offset:16
    s_cmp_lg_u32 s45, 0
    s_cbranch_scc1 L_nq_70
    s_nop 1
L_lw_71:
    ds_read_b128 v[8:11], v5 offset:16
    s_waitcnt lgkmcnt(0)
    v_min_u32 v8, v8, v9
    v_min3_u32 v8, v8, v10, v11
    v_cmp_gt_u32 vcc, 2, v8
    s_nop 1
    s_cbranch_vccz L_lwd_72
    s_sleep 1
    s_sub_u32 s49, s49, 1
    s_cmp_gt_i32 s49, 0
    s_cbranch_scc1 L_lw_71
L_lwd_72:
    ds_read_b64 v[24:25], v17 offset:2560
    ds_read_b64 v[26:27], v17 offset:3072
    ds_read_b64 v[28:29], v17 offset:3584
    ds_read_b64 v[30:31], v17 offset:4096
    s_waitcnt lgkmcnt(0)
    v_add_f32 v24, v24, v26
    v_add_f32 v25, v25, v27
    v_add_f32 v24, v24, v28
    v_add_f32 v25, v25, v29
    v_add_f32 v24, v24, v30
    v_add_f32 v25, v25, v31
    v_lshlrev_b32 v18, 2, v2
    v_cvt_pk_bf16_f32 v26, v24, v25
    ds_write_b32 v18, v26 offset:4608
    s_waitcnt lgkmcnt(0)
    v_mov_b32 v20, 2
    ds_write_b32 v5, v20 offset:64
    s_nop 3
L_nq_70:
    s_setprio 0
    s_and_b32 s46, s2, 31
    s_lshl_b32 s46, s46, 17
    s_add_u32 s60, s34, s46
    s_addc_u32 s61, s35, 0
    s_mov_b32 s62, 0x20000
    s_mov_b32 s63, 0x20000
    s_lshl_b32 s47, s45, 8
    buffer_load_dwordx4 v[64:67], v13, s[60:63], s47 offen
    s_add_u32 s47, s47, 4096
    buffer_load_dwordx4 v[68:71], v13, s[60:63], s47 offen
    s_add_u32 s47, s47, 4096
    buffer_load_dwordx4 v[72:75], v13, s[60:63], s47 offen
    s_add_u32 s47, s47, 4096
    buffer_load_dwordx4 v[76:79], v13, s[60:63], s47 offen
    s_add_u32 s47, s47, 4096
    buffer_load_dwordx4 v[80:83], v13, s[60:63], s47 offen
    s_add_u32 s47, s47, 4096
    buffer_load_dwordx4 v[84:87], v13, s[60:63], s47 offen
    s_add_u32 s47, s47, 4096
    buffer_load_dwordx4 v[88:91], v13, s[60:63], s47 offen
    s_add_u32 s47, s47, 4096
    buffer_load_dwordx4 v[92:95], v13, s[60:63], s47 offen
    s_add_u32 s47, s47, 4096
    buffer_load_dwordx4 v[96:99], v13, s[60:63], s47 offen
    s_add_u32 s47, s47, 4096
    buffer_load_dwordx4 v[100:103], v13, s[60:63], s47 offen
    s_add_u32 s47, s47, 4096
    buffer_load_dwordx4 v[104:107], v13, s[60:63], s47 offen
    s_add_u32 s47, s47, 4096
    buffer_load_dwordx4 v[108:111], v13, s[60:63], s47 offen
    s_add_u32 s47, s47, 4096
    buffer_load_dwordx4 v[112:115], v13, s[60:63], s47 offen
    s_add_u32 s47, s47, 4096
    buffer_load_dwordx4 v[116:119], v13, s[60:63], s47 offen
    s_add_u32 s47, s47, 4096
    buffer_load_dwordx4 v[120:123], v13, s[60:63], s47 offen
    s_add_u32 s47, s47, 4096
    buffer_load_dwordx4 v[124:127], v13, s[60:63], s47 offen
    s_add_u32 s47, s47, 4096
    buffer_load_dwordx4 v[128:131], v13, s[60:63], s47 offen
    s_add_u32 s47, s47, 4096
    buffer_load_dwordx4 v[132:135], v13, s[60:63], s47 offen
    s_add_u32 s47, s47, 4096
    buffer_load_dwordx4 v[136:139], v13, s[60:63], s47 offen
    s_add_u32 s47, s47, 4096
    buffer_load_dwordx4 v[140:143], v13, s[60:63], s47 offen
    s_add_u32 s47, s47, 4096
    buffer_load_dwordx4 v[144:147], v13, s[60:63], s47 offen
    s_add_u32 s47, s47, 4096
    buffer_load_dwordx4 v[148:151], v13, s[60:63], s47 offen
    s_add_u32 s47, s47, 4096
    buffer_load_dwordx4 v[152:155], v13, s[60:63], s47 offen
    s_add_u32 s47, s47, 4096
    buffer_load_dwordx4 v[156:159], v13, s[60:63], s47 offen
    s_add_u32 s47, s47, 4096
    buffer_load_dwordx4 v[160:163], v13, s[60:63], s47 offen
    s_add_u32 s47, s47, 4096
    buffer_load_dwordx4 v[164:167], v13, s[60:63], s47 offen
    s_add_u32 s47, s47, 4096
    buffer_load_dwordx4 v[168:171], v13, s[60:63], s47 offen
    s_add_u32 s47, s47, 4096
    buffer_load_dwordx4 v[172:175], v13, s[60:63], s47 offen
    s_add_u32 s47, s47, 4096
    buffer_load_dwordx4 v[176:179], v13, s[60:63], s47 offen
    s_add_u32 s47, s47, 4096
    buffer_load_dwordx4 v[180:183], v13, s[60:63], s47 offen
    s_add_u32 s47, s47, 4096
    buffer_load_dwordx4 v[184:187], v13, s[60:63], s47 offen
    s_add_u32 s47, s47, 4096
    buffer_load_dwordx4 v[188:191], v13, s[60:63], s47 offen
    s_waitcnt vmcnt(0)
    v_perm_b32 v192, v68, v64, s43
    v_perm_b32 v196, v68, v64, s44
    v_perm_b32 v200, v69, v65, s43
    v_perm_b32 v204, v69, v65, s44
    v_perm_b32 v208, v70, v66, s43
    v_perm_b32 v212, v70, v66, s44
    v_perm_b32 v216, v71, v67, s43
    v_perm_b32 v220, v71, v67, s44
    v_perm_b32 v193, v76, v72, s43
    v_perm_b32 v197, v76, v72, s44
    v_perm_b32 v201, v77, v73, s43
    v_perm_b32 v205, v77, v73, s44
    v_perm_b32 v209, v78, v74, s43
    v_perm_b32 v213, v78, v74, s44
    v_perm_b32 v217, v79, v75, s43
    v_perm_b32 v221, v79, v75, s44
    v_perm_b32 v194, v84, v80, s43
    v_perm_b32 v198, v84, v80, s44
    v_perm_b32 v202, v85, v81, s43
    v_perm_b32 v206, v85, v81, s44
    v_perm_b32 v210, v86, v82, s43
    v_perm_b32 v214, v86, v82, s44
    v_perm_b32 v218, v87, v83, s43
    v_perm_b32 v222, v87, v83, s44
    v_perm_b32 v195, v92, v88, s43
    v_perm_b32 v199, v92, v88, s44
    v_perm_b32 v203, v93, v89, s43
    v_perm_b32 v207, v93, v89, s44
    v_perm_b32 v211, v94, v90, s43
    v_perm_b32 v215, v94, v90, s44
    v_perm_b32 v219, v95, v91, s43
    v_perm_b32 v223, v95, v91, s44
    v_perm_b32 v64, v100, v96, s43
    v_perm_b32 v68, v100, v96, s44
    v_perm_b32 v72, v101, v97, s43
    v_perm_b32 v76, v101, v97, s44
    v_perm_b32 v80, v102, v98, s43
    v_perm_b32 v84, v102, v98, s44
    v_perm_b32 v88, v103, v99, s43
    v_perm_b32 v92, v103, v99, s44
    v_perm_b32 v65, v108, v104, s43
    v_perm_b32 v69, v108, v104, s44
    v_perm_b32 v73, v109, v105, s43
    v_perm_b32 v77, v109, v105, s44
    v_perm_b32 v81, v110, v106, s43
    v_perm_b32 v85, v110, v106, s44
    v_perm_b32 v89, v111, v107, s43
    v_perm_b32 v93, v111, v107, s44
    v_perm_b32 v66, v116, v112, s43
    v_perm_b32 v70, v116, v112, s44
    v_perm_b32 v74, v117, v113, s43
    v_perm_b32 v78, v117, v113, s44
    v_perm_b32 v82, v118, v114, s43
    v_perm_b32 v86, v118, v114, s44
    v_perm_b32 v90, v119, v115, s43
    v_perm_b32 v94, v119, v115, s44
    v_perm_b32 v67, v124, v120, s43
    v_perm_b32 v71, v124, v120, s44
    v_perm_b32 v75, v125, v121, s43
    v_perm_b32 v79, v125, v121, s44
    v_perm_b32 v83, v126, v122, s43
    v_perm_b32 v87, v126, v122, s44
    v_perm_b32 v91, v127, v123, s43
    v_perm_b32 v95, v127, v123, s44
    v_perm_b32 v96, v132, v128, s43
    v_perm_b32 v100, v132, v128, s44
    v_perm_b32 v104, v133, v129, s43
    v_perm_b32 v108, v133, v129, s44
    v_perm_b32 v112, v134, v130, s43
    v_perm_b32 v116, v134, v130, s44
    v_perm_b32 v120, v135, v131, s43
    v_perm_b32 v124, v135, v131, s44
    v_perm_b32 v97, v140, v136, s43
    v_perm_b32 v101, v140, v136, s44
    v_perm_b32 v105, v141, v137, s43
    v_perm_b32 v109, v141, v137, s44
    v_perm_b32 v113, v142, v138, s43
    v_perm_b32 v117, v142, v138, s44
    v_perm_b32 v121, v143, v139, s43
    v_perm_b32 v125, v143, v139, s44
    v_perm_b32 v98, v148, v144, s43
    v_perm_b32 v102, v148, v144, s44
    v_perm_b32 v106, v149, v145, s43
    v_perm_b32 v110, v149, v145, s44
    v_perm_b32 v114, v150, v146, s43
    v_perm_b32 v118, v150, v146, s44
    v_perm_b32 v122, v151, v147, s43
    v_perm_b32 v126, v151, v147, s44
    v_perm_b32 v99, v156, v152, s43
    v_perm_b32 v103, v156, v152, s44
    v_perm_b32 v107, v157, v153, s43
    v_perm_b32 v111, v157, v153, s44
    v_perm_b32 v115, v158, v154, s43
    v_perm_b32 v119, v158, v154, s44
    v_perm_b32 v123, v159, v155, s43
    v_perm_b32 v127, v159, v155, s44
    v_perm_b32 v128, v164, v160, s43
    v_perm_b32 v132, v164, v160, s44
    v_perm_b32 v136, v165, v161, s43
    v_perm_b32 v140, v165, v161, s44
    v_perm_b32 v144, v166, v162, s43
    v_perm_b32 v148, v166, v162, s44
    v_perm_b32 v152, v167, v163, s43
    v_perm_b32 v156, v167, v163, s44
    v_perm_b32 v129, v172, v168, s43
    v_perm_b32 v133, v172, v168, s44
    v_perm_b32 v137, v173, v169, s43
    v_perm_b32 v141, v173, v169, s44
    v_perm_b32 v145, v174, v170, s43
    v_perm_b32 v149, v174, v170, s44
    v_perm_b32 v153, v175, v171, s43
    v_perm_b32 v157, v175, v171, s44
    v_perm_b32 v130, v180, v176, s43
    v_perm_b32 v134, v180, v176, s44
    v_perm_b32 v138, v181, v177, s43
    v_perm_b32 v142, v181, v177, s44
    v_perm_b32 v146, v182, v178, s43
    v_perm_b32 v150, v182, v178, s44
    v_perm_b32 v154, v183, v179, s43
    v_perm_b32 v158, v183, v179, s44
    v_perm_b32 v131, v188, v184, s43
    v_perm_b32 v135, v188, v184, s44
    v_perm_b32 v139, v189, v185, s43
    v_perm_b32 v143, v189, v185, s44
    v_perm_b32 v147, v190, v186, s43
    v_perm_b32 v151, v190, v186, s44
    v_perm_b32 v155, v191, v187, s43
    v_perm_b32 v159, v191, v187, s44
    s_nop 1
L_lw_73:
    ds_read_b128 v[8:11], v5 offset:32
    s_waitcnt lgkmcnt(0)
    v_min_u32 v8, v8, v9
    v_min3_u32 v8, v8, v10, v11
    v_cmp_gt_u32 vcc, 2, v8
    s_nop 1
    s_cbranch_vccz L_lwd_74
    s_sleep 1
    s_sub_u32 s49, s49, 1
    s_cmp_gt_i32 s49, 0
    s_cbranch_scc1 L_lw_73
L_lwd_74:
    s_setprio 3
    ds_read_b64 v[24:25], v17 offset:17408
    ds_read_b64 v[26:27], v17 offset:19456
    ds_read_b64 v[28:29], v17 offset:21504
    ds_read_b64 v[30:31], v17 offset:23552
    s_waitcnt lgkmcnt(0)
    v_add_f32 v24, v24, v26
    v_add_f32 v25, v25, v27
    v_add_f32 v24, v24, v28
    v_add_f32 v25, v25, v29
    v_add_f32 v24, v24, v30
    v_add_f32 v25, v25, v31
    v_cvt_pk_bf16_f32 v28, v24, v25
    v_lshrrev_b32 v29, 4, v2
    v_lshlrev_b32 v29, 6, v29
    v_and_b32 v30, 1, v2
    v_lshl_add_u32 v29, v30, 5, v29
    v_bfe_u32 v30, v2, 1, 3
    v_lshl_add_u32 v29, v30, 1, v29
    s_lshl_b32 s46, s45, 8
    v_add_u32 v29, s46, v29
    ds_write_b16 v29, v28 offset:5632
    ds_write_b16_d16_hi v29, v28 offset:5648
    s_waitcnt lgkmcnt(0)
    ds_read_b128 v[48:51], v15 offset:5632
    ds_read_b128 v[52:55], v15 offset:5696
    ds_read_b128 v[56:59], v15 offset:5760
    ds_read_b128 v[60:63], v15 offset:5824
    v_mov_b32 v224, 0
    v_mov_b32 v225, 0
    v_mov_b32 v226, 0
    v_mov_b32 v227, 0
    v_mov_b32 v228, 0
    v_mov_b32 v229, 0
    v_mov_b32 v230, 0
    v_mov_b32 v231, 0
    v_mov_b32 v232, 0
    v_mov_b32 v233, 0
    v_mov_b32 v234, 0
    v_mov_b32 v235, 0
    v_mov_b32 v236, 0
    v_mov_b32 v237, 0
    v_mov_b32 v238, 0
    v_mov_b32 v239, 0
    v_mov_b32 v240, 0
    v_mov_b32 v241, 0
    v_mov_b32 v242, 0
    v_mov_b32 v243, 0
    v_mov_b32 v244, 0
    v_mov_b32 v245, 0
    v_mov_b32 v246, 0
    v_mov_b32 v247, 0
    v_mov_b32 v248, 0
    v_mov_b32 v249, 0
    v_mov_b32 v250, 0
    v_mov_b32 v251, 0
    v_mov_b32 v252, 0
    v_mov_b32 v253, 0
    v_mov_b32 v254, 0
    v_mov_b32 v255, 0
    s_waitcnt lgkmcnt(0)
    v_mfma_f32_16x16x32_bf16 v[224:227], v[192:195], v[48:51], v[224:227]
    v_mfma_f32_16x16x32_bf16 v[228:231], v[196:199], v[48:51], v[228:231]
    v_mfma_f32_16x16x32_bf16 v[232:235], v[200:203], v[48:51], v[232:235]
    v_mfma_f32_16x16x32_bf16 v[236:239], v[204:207], v[48:51], v[236:239]
    v_mfma_f32_16x16x32_bf16 v[240:243], v[208:211], v[48:51], v[240:243]
    v_mfma_f32_16x16x32_bf16 v[244:247], v[212:215], v[48:51], v[244:247]
    v_mfma_f32_16x16x32_bf16 v[248:251], v[216:219], v[48:51], v[248:251]
    v_mfma_f32_16x16x32_bf16 v[252:255], v[220:223], v[48:51], v[252:255]
    v_mfma_f32_16x16x32_bf16 v[224:227], v[64:67], v[52:55], v[224:227]
    v_mfma_f32_16x16x32_bf16 v[228:231], v[68:71], v[52:55], v[228:231]
    v_mfma_f32_16x16x32_bf16 v[232:235], v[72:75], v[52:55], v[232:235]
    v_mfma_f32_16x16x32_bf16 v[236:239], v[76:79], v[52:55], v[236:239]
    v_mfma_f32_16x16x32_bf16 v[240:243], v[80:83], v[52:55], v[240:243]
    v_mfma_f32_16x16x32_bf16 v[244:247], v[84:87], v[52:55], v[244:247]
    v_mfma_f32_16x16x32_bf16 v[248:251], v[88:91], v[52:55], v[248:251]
    v_mfma_f32_16x16x32_bf16 v[252:255], v[92:95], v[52:55], v[252:255]
    v_mfma_f32_16x16x32_bf16 v[224:227], v[96:99], v[56:59], v[224:227]
    v_mfma_f32_16x16x32_bf16 v[228:231], v[100:103], v[56:59], v[228:231]
    v_mfma_f32_16x16x32_bf16 v[232:235], v[104:107], v[56:59], v[232:235]
    v_mfma_f32_16x16x32_bf16 v[236:239], v[108:111], v[56:59], v[236:239]
    v_mfma_f32_16x16x32_bf16 v[240:243], v[112:115], v[56:59], v[240:243]
    v_mfma_f32_16x16x32_bf16 v[244:247], v[116:119], v[56:59], v[244:247]
    v_mfma_f32_16x16x32_bf16 v[248:251], v[120:123], v[56:59], v[248:251]
    v_mfma_f32_16x16x32_bf16 v[252:255], v[124:127], v[56:59], v[252:255]
    v_mfma_f32_16x16x32_bf16 v[224:227], v[128:131], v[60:63], v[224:227]
    v_mfma_f32_16x16x32_bf16 v[228:231], v[132:135], v[60:63], v[228:231]
    v_mfma_f32_16x16x32_bf16 v[232:235], v[136:139], v[60:63], v[232:235]
    v_mfma_f32_16x16x32_bf16 v[236:239], v[140:143], v[60:63], v[236:239]
    v_mfma_f32_16x16x32_bf16 v[240:243], v[144:147], v[60:63], v[240:243]
    v_mfma_f32_16x16x32_bf16 v[244:247], v[148:151], v[60:63], v[244:247]
    v_mfma_f32_16x16x32_bf16 v[248:251], v[152:155], v[60:63], v[248:251]
    v_mfma_f32_16x16x32_bf16 v[252:255], v[156:159], v[60:63], v[252:255]
    s_lshl_b32 s46, s45, 9
    v_add_u32 v18, s46, v16
    s_mov_b64 exec, s[68:69]
    ds_write_b32 v18, v224 offset:6656
    ds_write_b32 v18, v225 offset:6688
    ds_write_b32 v18, v226 offset:6720
    ds_write_b32 v18, v227 offset:6752
    ds_write_b32 v18, v228 offset:6660
    ds_write_b32 v18, v229 offset:6692
    ds_write_b32 v18, v230 offset:6724
    ds_write_b32 v18, v231 offset:6756
    ds_write_b32 v18, v232 offset:6664
    ds_write_b32 v18, v233 offset:6696
    ds_write_b32 v18, v234 offset:6728
    ds_write_b32 v18, v235 offset:6760
    ds_write_b32 v18, v236 offset:6668
    ds_write_b32 v18, v237 offset:6700
    ds_write_b32 v18, v238 offset:6732
    ds_write_b32 v18, v239 offset:6764
    ds_write_b32 v18, v240 offset:6672
    ds_write_b32 v18, v241 offset:6704
    ds_write_b32 v18, v242 offset:6736
    ds_write_b32 v18, v243 offset:6768
    ds_write_b32 v18, v244 offset:6676
    ds_write_b32 v18, v245 offset:6708
    ds_write_b32 v18, v246 offset:6740
    ds_write_b32 v18, v247 offset:6772
    ds_write_b32 v18, v248 offset:6680
    ds_write_b32 v18, v249 offset:6712
    ds_write_b32 v18, v250 offset:6744
    ds_write_b32 v18, v251 offset:6776
    ds_write_b32 v18, v252 offset:6684
    ds_write_b32 v18, v253 offset:6716
    ds_write_b32 v18, v254 offset:6748
    ds_write_b32 v18, v255 offset:6780
    s_mov_b64 exec, -1
    v_add_u32 v18, s46, v17
    s_waitcnt lgkmcnt(0)
    ds_read_b64 v[24:25], v18 offset:6656
    s_add_u32 s46, s46, s75
    s_add_u32 s46, s46, 2048
    s_waitcnt lgkmcnt(0)
    v_or_b32 v24, 1, v24
    v_or_b32 v25, 1, v25
    buffer_store_dwordx2 v[24:25], v17, s[56:59], s46 offen sc1
    s_and_b32 s46, s2, 31
    s_lshl_b32 s46, s46, 8
    s_add_u32 s60, s22, s46
    s_addc_u32 s61, s23, 0
    s_mov_b32 s62, 0x3fe100
    s_mov_b32 s63, 0x20000
    s_lshl_b32 s47, s45, 20
    buffer_load_dwordx4 v[64:67], v12, s[60:63], s47 offen
    s_add_u32 s47, s47, 32768
    buffer_load_dwordx4 v[68:71], v12, s[60:63], s47 offen
    s_add_u32 s47, s47, 32768
    buffer_load_dwordx4 v[72:75], v12, s[60:63], s47 offen
    s_add_u32 s47, s47, 32768
    buffer_load_dwordx4 v[76:79], v12, s[60:63], s47 offen
    s_add_u32 s47, s47, 32768
    buffer_load_dwordx4 v[80:83], v12, s[60:63], s47 offen
    s_add_u32 s47, s47, 32768
    buffer_load_dwordx4 v[84:87], v12, s[60:63], s47 offen
    s_add_u32 s47, s47, 32768
    buffer_load_dwordx4 v[88:91], v12, s[60:63], s47 offen
    s_add_u32 s47, s47, 32768
    buffer_load_dwordx4 v[92:95], v12, s[60:63], s47 offen
    s_add_u32 s47, s47, 32768
    buffer_load_dwordx4 v[96:99], v12, s[60:63], s47 offen
    s_add_u32 s47, s47, 32768
    buffer_load_dwordx4 v[100:103], v12, s[60:63], s47 offen
    s_add_u32 s47, s47, 32768
    buffer_load_dwordx4 v[104:107], v12, s[60:63], s47 offen
    s_add_u32 s47, s47, 32768
    buffer_load_dwordx4 v[108:111], v12, s[60:63], s47 offen
    s_add_u32 s47, s47, 32768
    buffer_load_dwordx4 v[112:115], v12, s[60:63], s47 offen
    s_add_u32 s47, s47, 32768
    buffer_load_dwordx4 v[116:119], v12, s[60:63], s47 offen
    s_add_u32 s47, s47, 32768
    buffer_load_dwordx4 v[120:123], v12, s[60:63], s47 offen
    s_add_u32 s47, s47, 32768
    buffer_load_dwordx4 v[124:127], v12, s[60:63], s47 offen
    s_add_u32 s47, s47, 32768
    buffer_load_dwordx4 v[128:131], v12, s[60:63], s47 offen
    s_add_u32 s47, s47, 32768
    buffer_load_dwordx4 v[132:135], v12, s[60:63], s47 offen
    s_add_u32 s47, s47, 32768
    buffer_load_dwordx4 v[136:139], v12, s[60:63], s47 offen
    s_add_u32 s47, s47, 32768
    buffer_load_dwordx4 v[140:143], v12, s[60:63], s47 offen
    s_add_u32 s47, s47, 32768
    buffer_load_dwordx4 v[144:147], v12, s[60:63], s47 offen
    s_add_u32 s47, s47, 32768
    buffer_load_dwordx4 v[148:151], v12, s[60:63], s47 offen
    s_add_u32 s47, s47, 32768
    buffer_load_dwordx4 v[152:155], v12, s[60:63], s47 offen
    s_add_u32 s47, s47, 32768
    buffer_load_dwordx4 v[156:159], v12, s[60:63], s47 offen
    s_add_u32 s47, s47, 32768
    buffer_load_dwordx4 v[160:163], v12, s[60:63], s47 offen
    s_add_u32 s47, s47, 32768
    buffer_load_dwordx4 v[164:167], v12, s[60:63], s47 offen
    s_add_u32 s47, s47, 32768
    buffer_load_dwordx4 v[168:171], v12, s[60:63], s47 offen
    s_add_u32 s47, s47, 32768
    buffer_load_dwordx4 v[172:175], v12, s[60:63], s47 offen
    s_add_u32 s47, s47, 32768
    buffer_load_dwordx4 v[176:179], v12, s[60:63], s47 offen
    s_add_u32 s47, s47, 32768
    buffer_load_dwordx4 v[180:183], v12, s[60:63], s47 offen
    s_add_u32 s47, s47, 32768
    buffer_load_dwordx4 v[184:187], v12, s[60:63], s47 offen
    s_add_u32 s47, s47, 32768
    buffer_load_dwordx4 v[188:191], v12, s[60:63], s47 offen
    s_lshl_b32 s46, s45, 9
    s_add_u32 s46, s46, 2048
    s_mov_b32 s96, -1
    s_add_u32 s47, s46, 0
    buffer_load_dwordx2 v[24:25], v17, s[56:59], s47 offen sc1
    s_add_u32 s47, s46, 65536
    buffer_load_dwordx2 v[26:27], v17, s[56:59], s47 offen sc1
    s_add_u32 s47, s46, 131072
    buffer_load_dwordx2 v[28:29], v17, s[56:59], s47 offen sc1
    s_add_u32 s47, s46, 196608
    buffer_load_dwordx2 v[30:31], v17, s[56:59], s47 offen sc1
    s_add_u32 s47, s46, 262144
    buffer_load_dwordx2 v[32:33], v17, s[56:59], s47 offen sc1
    s_add_u32 s47, s46, 327680
    buffer_load_dwordx2 v[34:35], v17, s[56:59], s47 offen sc1
    s_add_u32 s47, s46, 393216
    buffer_load_dwordx2 v[36:37], v17, s[56:59], s47 offen sc1
    s_add_u32 s47, s46, 458752
    buffer_load_dwordx2 v[38:39], v17, s[56:59], s47 offen sc1
    s_add_u32 s47, s46, 524288
    buffer_load_dwordx2 v[40:41], v17, s[56:59], s47 offen sc1
    s_add_u32 s47, s46, 589824
    buffer_load_dwordx2 v[42:43], v17, s[56:59], s47 offen sc1
    s_add_u32 s47, s46, 655360
    buffer_load_dwordx2 v[44:45], v17, s[56:59], s47 offen sc1
    s_add_u32 s47, s46, 720896
    buffer_load_dwordx2 v[48:49], v17, s[56:59], s47 offen sc1
    s_add_u32 s47, s46, 786432
    buffer_load_dwordx2 v[50:51], v17, s[56:59], s47 offen sc1
    s_add_u32 s47, s46, 851968
    buffer_load_dwordx2 v[52:53], v17, s[56:59], s47 offen sc1
    s_add_u32 s47, s46, 917504
    buffer_load_dwordx2 v[54:55], v17, s[56:59], s47 offen sc1
    s_add_u32 s47, s46, 983040
    buffer_load_dwordx2 v[56:57], v17, s[56:59], s47 offen sc1
    s_add_u32 s47, s46, 1048576
    buffer_load_dwordx2 v[58:59], v17, s[56:59], s47 offen sc1
    s_add_u32 s47, s46, 1114112
    buffer_load_dwordx2 v[60:61], v17, s[56:59], s47 offen sc1
    s_add_u32 s47, s46, 1179648
    buffer_load_dwordx2 v[62:63], v17, s[56:59], s47 offen sc1
    s_add_u32 s47, s46, 1245184
    buffer_load_dwordx2 v[224:225], v17, s[56:59], s47 offen sc1
    s_add_u32 s47, s46, 1310720
    buffer_load_dwordx2 v[226:227], v17, s[56:59], s47 offen sc1
    s_add_u32 s47, s46, 1376256
    buffer_load_dwordx2 v[228:229], v17, s[56:59], s47 offen sc1
    s_add_u32 s47, s46, 1441792
    buffer_load_dwordx2 v[230:231], v17, s[56:59], s47 offen sc1
    s_add_u32 s47, s46, 1507328
    buffer_load_dwordx2 v[232:233], v17, s[56:59], s47 offen sc1
    s_add_u32 s47, s46, 1572864
    buffer_load_dwordx2 v[234:235], v17, s[56:59], s47 offen sc1
    s_add_u32 s47, s46, 1638400
    buffer_load_dwordx2 v[236:237], v17, s[56:59], s47 offen sc1
    s_add_u32 s47, s46, 1703936
    buffer_load_dwordx2 v[238:239], v17, s[56:59], s47 offen sc1
    s_add_u32 s47, s46, 1769472
    buffer_load_dwordx2 v[240:241], v17, s[56:59], s47 offen sc1
    s_add_u32 s47, s46, 1835008
    buffer_load_dwordx2 v[242:243], v17, s[56:59], s47 offen sc1
    s_add_u32 s47, s46, 1900544
    buffer_load_dwordx2 v[244:245], v17, s[56:59], s47 offen sc1
    s_add_u32 s47, s46, 1966080
    buffer_load_dwordx2 v[246:247], v17, s[56:59], s47 offen sc1
    s_add_u32 s47, s46, 2031616
    buffer_load_dwordx2 v[248:249], v17, s[56:59], s47 offen sc1
    s_waitcnt vmcnt(32)
    v_perm_b32 v192, v68, v64, s43
    v_perm_b32 v196, v68, v64, s44
    v_perm_b32 v200, v69, v65, s43
    v_perm_b32 v204, v69, v65, s44
    v_perm_b32 v208, v70, v66, s43
    v_perm_b32 v212, v70, v66, s44
    v_perm_b32 v216, v71, v67, s43
    v_perm_b32 v220, v71, v67, s44
    v_perm_b32 v193, v76, v72, s43
    v_perm_b32 v197, v76, v72, s44
    v_perm_b32 v201, v77, v73, s43
    v_perm_b32 v205, v77, v73, s44
    v_perm_b32 v209, v78, v74, s43
    v_perm_b32 v213, v78, v74, s44
    v_perm_b32 v217, v79, v75, s43
    v_perm_b32 v221, v79, v75, s44
    v_perm_b32 v194, v84, v80, s43
    v_perm_b32 v198, v84, v80, s44
    v_perm_b32 v202, v85, v81, s43
    v_perm_b32 v206, v85, v81, s44
    v_perm_b32 v210, v86, v82, s43
    v_perm_b32 v214, v86, v82, s44
    v_perm_b32 v218, v87, v83, s43
    v_perm_b32 v222, v87, v83, s44
    v_perm_b32 v195, v92, v88, s43
    v_perm_b32 v199, v92, v88, s44
    v_perm_b32 v203, v93, v89, s43
    v_perm_b32 v207, v93, v89, s44
    v_perm_b32 v211, v94, v90, s43
    v_perm_b32 v215, v94, v90, s44
    v_perm_b32 v219, v95, v91, s43
    v_perm_b32 v223, v95, v91, s44
    v_perm_b32 v64, v100, v96, s43
    v_perm_b32 v68, v100, v96, s44
    v_perm_b32 v72, v101, v97, s43
    v_perm_b32 v76, v101, v97, s44
    v_perm_b32 v80, v102, v98, s43
    v_perm_b32 v84, v102, v98, s44
    v_perm_b32 v88, v103, v99, s43
    v_perm_b32 v92, v103, v99, s44
    v_perm_b32 v65, v108, v104, s43
    v_perm_b32 v69, v108, v104, s44
    v_perm_b32 v73, v109, v105, s43
    v_perm_b32 v77, v109, v105, s44
    v_perm_b32 v81, v110, v106, s43
    v_perm_b32 v85, v110, v106, s44
    v_perm_b32 v89, v111, v107, s43
    v_perm_b32 v93, v111, v107, s44
    v_perm_b32 v66, v116, v112, s43
    v_perm_b32 v70, v116, v112, s44
    v_perm_b32 v74, v117, v113, s43
    v_perm_b32 v78, v117, v113, s44
    v_perm_b32 v82, v118, v114, s43
    v_perm_b32 v86, v118, v114, s44
    v_perm_b32 v90, v119, v115, s43
    v_perm_b32 v94, v119, v115, s44
    v_perm_b32 v67, v124, v120, s43
    v_perm_b32 v71, v124, v120, s44
    v_perm_b32 v75, v125, v121, s43
    v_perm_b32 v79, v125, v121, s44
    v_perm_b32 v83, v126, v122, s43
    v_perm_b32 v87, v126, v122, s44
    v_perm_b32 v91, v127, v123, s43
    v_perm_b32 v95, v127, v123, s44
    v_perm_b32 v96, v132, v128, s43
    v_perm_b32 v100, v132, v128, s44
    v_perm_b32 v104, v133, v129, s43
    v_perm_b32 v108, v133, v129, s44
    v_perm_b32 v112, v134, v130, s43
    v_perm_b32 v116, v134, v130, s44
    v_perm_b32 v120, v135, v131, s43
    v_perm_b32 v124, v135, v131, s44
    v_perm_b32 v97, v140, v136, s43
    v_perm_b32 v101, v140, v136, s44
    v_perm_b32 v105, v141, v137, s43
    v_perm_b32 v109, v141, v137, s44
    v_perm_b32 v113, v142, v138, s43
    v_perm_b32 v117, v142, v138, s44
    v_perm_b32 v121, v143, v139, s43
    v_perm_b32 v125, v143, v139, s44
    v_perm_b32 v98, v148, v144, s43
    v_perm_b32 v102, v148, v144, s44
    v_perm_b32 v106, v149, v145, s43
    v_perm_b32 v110, v149, v145, s44
    v_perm_b32 v114, v150, v146, s43
    v_perm_b32 v118, v150, v146, s44
    v_perm_b32 v122, v151, v147, s43
    v_perm_b32 v126, v151, v147, s44
    v_perm_b32 v99, v156, v152, s43
    v_perm_b32 v103, v156, v152, s44
    v_perm_b32 v107, v157, v153, s43
    v_perm_b32 v111, v157, v153, s44
    v_perm_b32 v115, v158, v154, s43
    v_perm_b32 v119, v158, v154, s44
    v_perm_b32 v123, v159, v155, s43
    v_perm_b32 v127, v159, v155, s44
    v_perm_b32 v128, v164, v160, s43
    v_perm_b32 v132, v164, v160, s44
    v_perm_b32 v136, v165, v161, s43
    v_perm_b32 v140, v165, v161, s44
    v_perm_b32 v144, v166, v162, s43
    v_perm_b32 v148, v166, v162, s44
    v_perm_b32 v152, v167, v163, s43
    v_perm_b32 v156, v167, v163, s44
    v_perm_b32 v129, v172, v168, s43
    v_perm_b32 v133, v172, v168, s44
    v_perm_b32 v137, v173, v169, s43
    v_perm_b32 v141, v173, v169, s44
    v_perm_b32 v145, v174, v170, s43
    v_perm_b32 v149, v174, v170, s44
    v_perm_b32 v153, v175, v171, s43
    v_perm_b32 v157, v175, v171, s44
    v_perm_b32 v130, v180, v176, s43
    v_perm_b32 v134, v180, v176, s44
    v_perm_b32 v138, v181, v177, s43
    v_perm_b32 v142, v181, v177, s44
    v_perm_b32 v146, v182, v178, s43
    v_perm_b32 v150, v182, v178, s44
    v_perm_b32 v154, v183, v179, s43
    v_perm_b32 v158, v183, v179, s44
    v_perm_b32 v131, v188, v184, s43
    v_perm_b32 v135, v188, v184, s44
    v_perm_b32 v139, v189, v185, s43
    v_perm_b32 v143, v189, v185, s44
    v_perm_b32 v147, v190, v186, s43
    v_perm_b32 v151, v190, v186, s44
    v_perm_b32 v155, v191, v187, s43
    v_perm_b32 v159, v191, v187, s44
    s_branch L_pc_77
L_pf_75:
    s_bitcmp1_b32 s96, 0
    s_cbranch_scc0 L_pk_78
    s_add_u32 s47, s46, 0
    buffer_load_dwordx2 v[24:25], v17, s[56:59], s47 offen sc1
L_pk_78:
    s_bitcmp1_b32 s96, 1
    s_cbranch_scc0 L_pk_79
    s_add_u32 s47, s46, 65536
    buffer_load_dwordx2 v[26:27], v17, s[56:59], s47 offen sc1
L_pk_79:
    s_bitcmp1_b32 s96, 2
    s_cbranch_scc0 L_pk_80
    s_add_u32 s47, s46, 131072
    buffer_load_dwordx2 v[28:29], v17, s[56:59], s47 offen sc1
L_pk_80:
    s_bitcmp1_b32 s96, 3
    s_cbranch_scc0 L_pk_81
    s_add_u32 s47, s46, 196608
    buffer_load_dwordx2 v[30:31], v17, s[56:59], s47 offen sc1
L_pk_81:
    s_bitcmp1_b32 s96, 4
    s_cbranch_scc0 L_pk_82
    s_add_u32 s47, s46, 262144
    buffer_load_dwordx2 v[32:33], v17, s[56:59], s47 offen sc1
L_pk_82:
    s_bitcmp1_b32 s96, 5
    s_cbranch_scc0 L_pk_83
    s_add_u32 s47, s46, 327680
    buffer_load_dwordx2 v[34:35], v17, s[56:59], s47 offen sc1
L_pk_83:
    s_bitcmp1_b32 s96, 6
    s_cbranch_scc0 L_pk_84
    s_add_u32 s47, s46, 393216
    buffer_load_dwordx2 v[36:37], v17, s[56:59], s47 offen sc1
L_pk_84:
    s_bitcmp1_b32 s96, 7
    s_cbranch_scc0 L_pk_85
    s_add_u32 s47, s46, 458752
    buffer_load_dwordx2 v[38:39], v17, s[56:59], s47 offen sc1
L_pk_85:
    s_bitcmp1_b32 s96, 8
    s_cbranch_scc0 L_pk_86
    s_add_u32 s47, s46, 524288
    buffer_load_dwordx2 v[40:41], v17, s[56:59], s47 offen sc1
L_pk_86:
    s_bitcmp1_b32 s96, 9
    s_cbranch_scc0 L_pk_87
    s_add_u32 s47, s46, 589824
    buffer_load_dwordx2 v[42:43], v17, s[56:59], s47 offen sc1
L_pk_87:
    s_bitcmp1_b32 s96, 10
    s_cbranch_scc0 L_pk_88
    s_add_u32 s47, s46, 655360
    buffer_load_dwordx2 v[44:45], v17, s[56:59], s47 offen sc1
L_pk_88:
    s_bitcmp1_b32 s96, 11
    s_cbranch_scc0 L_pk_89
    s_add_u32 s47, s46, 720896
    buffer_load_dwordx2 v[48:49], v17, s[56:59], s47 offen sc1
L_pk_89:
    s_bitcmp1_b32 s96, 12
    s_cbranch_scc0 L_pk_90
    s_add_u32 s47, s46, 786432
    buffer_load_dwordx2 v[50:51], v17, s[56:59], s47 offen sc1
L_pk_90:
    s_bitcmp1_b32 s96, 13
    s_cbranch_scc0 L_pk_91
    s_add_u32 s47, s46, 851968
    buffer_load_dwordx2 v[52:53], v17, s[56:59], s47 offen sc1
L_pk_91:
    s_bitcmp1_b32 s96, 14
    s_cbranch_scc0 L_pk_92
    s_add_u32 s47, s46, 917504
    buffer_load_dwordx2 v[54:55], v17, s[56:59], s47 offen sc1
L_pk_92:
    s_bitcmp1_b32 s96, 15
    s_cbranch_scc0 L_pk_93
    s_add_u32 s47, s46, 983040
    buffer_load_dwordx2 v[56:57], v17, s[56:59], s47 offen sc1
L_pk_93:
    s_bitcmp1_b32 s96, 16
    s_cbranch_scc0 L_pk_94
    s_add_u32 s47, s46, 1048576
    buffer_load_dwordx2 v[58:59], v17, s[56:59], s47 offen sc1
L_pk_94:
    s_bitcmp1_b32 s96, 17
    s_cbranch_scc0 L_pk_95
    s_add_u32 s47, s46, 1114112
    buffer_load_dwordx2 v[60:61], v17, s[56:59], s47 offen sc1
L_pk_95:
    s_bitcmp1_b32 s96, 18
    s_cbranch_scc0 L_pk_96
    s_add_u32 s47, s46, 1179648
    buffer_load_dwordx2 v[62:63], v17, s[56:59], s47 offen sc1
L_pk_96:
    s_bitcmp1_b32 s96, 19
    s_cbranch_scc0 L_pk_97
    s_add_u32 s47, s46, 1245184
    buffer_load_dwordx2 v[224:225], v17, s[56:59], s47 offen sc1
L_pk_97:
    s_bitcmp1_b32 s96, 20
    s_cbranch_scc0 L_pk_98
    s_add_u32 s47, s46, 1310720
    buffer_load_dwordx2 v[226:227], v17, s[56:59], s47 offen sc1
L_pk_98:
    s_bitcmp1_b32 s96, 21
    s_cbranch_scc0 L_pk_99
    s_add_u32 s47, s46, 1376256
    buffer_load_dwordx2 v[228:229], v17, s[56:59], s47 offen sc1
L_pk_99:
    s_bitcmp1_b32 s96, 22
    s_cbranch_scc0 L_pk_100
    s_add_u32 s47, s46, 1441792
    buffer_load_dwordx2 v[230:231], v17, s[56:59], s47 offen sc1
L_pk_100:
    s_bitcmp1_b32 s96, 23
    s_cbranch_scc0 L_pk_101
    s_add_u32 s47, s46, 1507328
    buffer_load_dwordx2 v[232:233], v17, s[56:59], s47 offen sc1
L_pk_101:
    s_bitcmp1_b32 s96, 24
    s_cbranch_scc0 L_pk_102
    s_add_u32 s47, s46, 1572864
    buffer_load_dwordx2 v[234:235], v17, s[56:59], s47 offen sc1
L_pk_102:
    s_bitcmp1_b32 s96, 25
    s_cbranch_scc0 L_pk_103
    s_add_u32 s47, s46, 1638400
    buffer_load_dwordx2 v[236:237], v17, s[56:59], s47 offen sc1
L_pk_103:
    s_bitcmp1_b32 s96, 26
    s_cbranch_scc0 L_pk_104
    s_add_u32 s47, s46, 1703936
    buffer_load_dwordx2 v[238:239], v17, s[56:59], s47 offen sc1
L_pk_104:
    s_bitcmp1_b32 s96, 27
    s_cbranch_scc0 L_pk_105
    s_add_u32 s47, s46, 1769472
    buffer_load_dwordx2 v[240:241], v17, s[56:59], s47 offen sc1
L_pk_105:
    s_bitcmp1_b32 s96, 28
    s_cbranch_scc0 L_pk_106
    s_add_u32 s47, s46, 1835008
    buffer_load_dwordx2 v[242:243], v17, s[56:59], s47 offen sc1
L_pk_106:
    s_bitcmp1_b32 s96, 29
    s_cbranch_scc0 L_pk_107
    s_add_u32 s47, s46, 1900544
    buffer_load_dwordx2 v[244:245], v17, s[56:59], s47 offen sc1
L_pk_107:
    s_bitcmp1_b32 s96, 30
    s_cbranch_scc0 L_pk_108
    s_add_u32 s47, s46, 1966080
    buffer_load_dwordx2 v[246:247], v17, s[56:59], s47 offen sc1
L_pk_108:
    s_bitcmp1_b32 s96, 31
    s_cbranch_scc0 L_pk_109
    s_add_u32 s47, s46, 2031616
    buffer_load_dwordx2 v[248:249], v17, s[56:59], s47 offen sc1
L_pk_109:
L_pc_77:
    s_waitcnt vmcnt(0)
    s_mov_b32 s97, 0
    v_and_b32 v19, v24, v25
    v_and_b32 v19, 1, v19
    v_cmp_eq_u32 s[4:5], 0, v19
    v_and_b32 v19, v26, v27
    v_and_b32 v19, 1, v19
    v_cmp_eq_u32 s[6:7], 0, v19
    v_and_b32 v19, v28, v29
    v_and_b32 v19, 1, v19
    v_cmp_eq_u32 s[8:9], 0, v19
    v_and_b32 v19, v30, v31
    v_and_b32 v19, 1, v19
    v_cmp_eq_u32 s[10:11], 0, v19
    v_and_b32 v19, v32, v33
    v_and_b32 v19, 1, v19
    v_cmp_eq_u32 s[12:13], 0, v19
    v_and_b32 v19, v34, v35
    v_and_b32 v19, 1, v19
    v_cmp_eq_u32 s[14:15], 0, v19
    s_cmp_lg_u64 s[4:5], 0
    s_cselect_b32 s48, 0x1, 0
    s_or_b32 s97, s97, s48
    s_cmp_lg_u64 s[6:7], 0
    s_cselect_b32 s48, 0x2, 0
    s_or_b32 s97, s97, s48
    s_cmp_lg_u64 s[8:9], 0
    s_cselect_b32 s48, 0x4, 0
    s_or_b32 s97, s97, s48
    s_cmp_lg_u64 s[10:11], 0
    s_cselect_b32 s48, 0x8, 0
    s_or_b32 s97, s97, s48
    s_cmp_lg_u64 s[12:13], 0
    s_cselect_b32 s48, 0x10, 0
    s_or_b32 s97, s97, s48
    s_cmp_lg_u64 s[14:15], 0
    s_cselect_b32 s48, 0x20, 0
    s_or_b32 s97, s97, s48
    v_and_b32 v19, v36, v37
    v_and_b32 v19, 1, v19
    v_cmp_eq_u32 s[4:5], 0, v19
    v_and_b32 v19, v38, v39
    v_and_b32 v19, 1, v19
    v_cmp_eq_u32 s[6:7], 0, v19
    v_and_b32 v19, v40, v41
    v_and_b32 v19, 1, v19
    v_cmp_eq_u32 s[8:9], 0, v19
    v_and_b32 v19, v42, v43
    v_and_b32 v19, 1, v19
    v_cmp_eq_u32 s[10:11], 0, v19
    v_and_b32 v19, v44, v45
    v_and_b32 v19, 1, v19
    v_cmp_eq_u32 s[12:13], 0, v19
    v_and_b32 v19, v48, v49
    v_and_b32 v19, 1, v19
    v_cmp_eq_u32 s[14:15], 0, v19
    s_cmp_lg_u64 s[4:5], 0
    s_cselect_b32 s48, 0x40, 0
    s_or_b32 s97, s97, s48
    s_cmp_lg_u64 s[6:7], 0
    s_cselect_b32 s48, 0x80, 0
    s_or_b32 s97, s97, s48
    s_cmp_lg_u64 s[8:9], 0
    s_cselect_b32 s48, 0x100, 0
    s_or_b32 s97, s97, s48
    s_cmp_lg_u64 s[10:11], 0
    s_cselect_b32 s48, 0x200, 0
    s_or_b32 s97, s97, s48
    s_cmp_lg_u64 s[12:13], 0
    s_cselect_b32 s48, 0x400, 0
    s_or_b32 s97, s97, s48
    s_cmp_lg_u64 s[14:15], 0
    s_cselect_b32 s48, 0x800, 0
    s_or_b32 s97, s97, s48
    v_and_b32 v19, v50, v51
    v_and_b32 v19, 1, v19
    v_cmp_eq_u32 s[4:5], 0, v19
    v_and_b32 v19, v52, v53
    v_and_b32 v19, 1, v19
    v_cmp_eq_u32 s[6:7], 0, v19
    v_and_b32 v19, v54, v55
    v_and_b32 v19, 1, v19
    v_cmp_eq_u32 s[8:9], 0, v19
    v_and_b32 v19, v56, v57
    v_and_b32 v19, 1, v19
    v_cmp_eq_u32 s[10:11], 0, v19
    v_and_b32 v19, v58, v59
    v_and_b32 v19, 1, v19
    v_cmp_eq_u32 s[12:13], 0, v19
    v_and_b32 v19, v60, v61
    v_and_b32 v19, 1, v19
    v_cmp_eq_u32 s[14:15], 0, v19
    s_cmp_lg_u64 s[4:5], 0
    s_cselect_b32 s48, 0x1000, 0
    s_or_b32 s97, s97, s48
    s_cmp_lg_u64 s[6:7], 0
    s_cselect_b32 s48, 0x2000, 0
    s_or_b32 s97, s97, s48
    s_cmp_lg_u64 s[8:9], 0
    s_cselect_b32 s48, 0x4000, 0
    s_or_b32 s97, s97, s48
    s_cmp_lg_u64 s[10:11], 0
    s_cselect_b32 s48, 0x8000, 0
    s_or_b32 s97, s97, s48
    s_cmp_lg_u64 s[12:13], 0
    s_cselect_b32 s48, 0x10000, 0
    s_or_b32 s97, s97, s48
    s_cmp_lg_u64 s[14:15], 0
    s_cselect_b32 s48, 0x20000, 0
    s_or_b32 s97, s97, s48
    v_and_b32 v19, v62, v63
    v_and_b32 v19, 1, v19
    v_cmp_eq_u32 s[4:5], 0, v19
    v_and_b32 v19, v224, v225
    v_and_b32 v19, 1, v19
    v_cmp_eq_u32 s[6:7], 0, v19
    v_and_b32 v19, v226, v227
    v_and_b32 v19, 1, v19
    v_cmp_eq_u32 s[8:9], 0, v19
    v_and_b32 v19, v228, v229
    v_and_b32 v19, 1, v19
    v_cmp_eq_u32 s[10:11], 0, v19
    v_and_b32 v19, v230, v231
    v_and_b32 v19, 1, v19
    v_cmp_eq_u32 s[12:13], 0, v19
    v_and_b32 v19, v232, v233
    v_and_b32 v19, 1, v19
    v_cmp_eq_u32 s[14:15], 0, v19
    s_cmp_lg_u64 s[4:5], 0
    s_cselect_b32 s48, 0x40000, 0
    s_or_b32 s97, s97, s48
    s_cmp_lg_u64 s[6:7], 0
    s_cselect_b32 s48, 0x80000, 0
    s_or_b32 s97, s97, s48
    s_cmp_lg_u64 s[8:9], 0
    s_cselect_b32 s48, 0x100000, 0
    s_or_b32 s97, s97, s48
    s_cmp_lg_u64 s[10:11], 0
    s_cselect_b32 s48, 0x200000, 0
    s_or_b32 s97, s97, s48
    s_cmp_lg_u64 s[12:13], 0
    s_cselect_b32 s48, 0x400000, 0
    s_or_b32 s97, s97, s48
    s_cmp_lg_u64 s[14:15], 0
    s_cselect_b32 s48, 0x800000, 0
    s_or_b32 s97, s97, s48
    v_and_b32 v19, v234, v235
    v_and_b32 v19, 1, v19
    v_cmp_eq_u32 s[4:5], 0, v19
    v_and_b32 v19, v236, v237
    v_and_b32 v19, 1, v19
    v_cmp_eq_u32 s[6:7], 0, v19
    v_and_b32 v19, v238, v239
    v_and_b32 v19, 1, v19
    v_cmp_eq_u32 s[8:9], 0, v19
    v_and_b32 v19, v240, v241
    v_and_b32 v19, 1, v19
    v_cmp_eq_u32 s[10:11], 0, v19
    v_and_b32 v19, v242, v243
    v_and_b32 v19, 1, v19
    v_cmp_eq_u32 s[12:13], 0, v19
    v_and_b32 v19, v244, v245
    v_and_b32 v19, 1, v19
    v_cmp_eq_u32 s[14:15], 0, v19
    s_cmp_lg_u64 s[4:5], 0
    s_cselect_b32 s48, 0x1000000, 0
    s_or_b32 s97, s97, s48
    s_cmp_lg_u64 s[6:7], 0
    s_cselect_b32 s48, 0x2000000, 0
    s_or_b32 s97, s97, s48
    s_cmp_lg_u64 s[8:9], 0
    s_cselect_b32 s48, 0x4000000, 0
    s_or_b32 s97, s97, s48
    s_cmp_lg_u64 s[10:11], 0
    s_cselect_b32 s48, 0x8000000, 0
    s_or_b32 s97, s97, s48
    s_cmp_lg_u64 s[12:13], 0
    s_cselect_b32 s48, 0x10000000, 0
    s_or_b32 s97, s97, s48
    s_cmp_lg_u64 s[14:15], 0
    s_cselect_b32 s48, 0x20000000, 0
    s_or_b32 s97, s97, s48
    v_and_b32 v19, v246, v247
    v_and_b32 v19, 1, v19
    v_cmp_eq_u32 s[4:5], 0, v19
    v_and_b32 v19, v248, v249
    v_and_b32 v19, 1, v19
    v_cmp_eq_u32 s[6:7], 0, v19
    s_cmp_lg_u64 s[4:5], 0
    s_cselect_b32 s48, 0x40000000, 0
    s_or_b32 s97, s97, s48
    s_cmp_lg_u64 s[6:7], 0
    s_cselect_b32 s48, 0x80000000, 0
    s_or_b32 s97, s97, s48
    s_mov_b32 s96, s97
    s_cmp_eq_u32 s96, 0
    s_cbranch_scc1 L_pfd_76
    s_sleep 2
    s_sub_u32 s49, s49, 1
    s_cmp_gt_i32 s49, 0
    s_cbranch_scc1 L_pf_75
L_pfd_76:
    v_add_f32 v24, v24, v26
    v_add_f32 v25, v25, v27
    v_add_f32 v24, v24, v28
    v_add_f32 v25, v25, v29
    v_add_f32 v24, v24, v30
    v_add_f32 v25, v25, v31
    v_add_f32 v24, v24, v32
    v_add_f32 v25, v25, v33
    v_add_f32 v24, v24, v34
    v_add_f32 v25, v25, v35
    v_add_f32 v24, v24, v36
    v_add_f32 v25, v25, v37
    v_add_f32 v24, v24, v38
    v_add_f32 v25, v25, v39
    v_add_f32 v24, v24, v40
    v_add_f32 v25, v25, v41
    v_add_f32 v24, v24, v42
    v_add_f32 v25, v25, v43
    v_add_f32 v24, v24, v44
    v_add_f32 v25, v25, v45
    v_add_f32 v24, v24, v48
    v_add_f32 v25, v25, v49
    v_add_f32 v24, v24, v50
    v_add_f32 v25, v25, v51
    v_add_f32 v24, v24, v52
    v_add_f32 v25, v25, v53
    v_add_f32 v24, v24, v54
    v_add_f32 v25, v25, v55
    v_add_f32 v24, v24, v56
    v_add_f32 v25, v25, v57
    v_add_f32 v24, v24, v58
    v_add_f32 v25, v25, v59
    v_add_f32 v24, v24, v60
    v_add_f32 v25, v25, v61
    v_add_f32 v24, v24, v62
    v_add_f32 v25, v25, v63
    v_add_f32 v24, v24, v224
    v_add_f32 v25, v25, v225
    v_add_f32 v24, v24, v226
    v_add_f32 v25, v25, v227
    v_add_f32 v24, v24, v228
    v_add_f32 v25, v25, v229
    v_add_f32 v24, v24, v230
    v_add_f32 v25, v25, v231
    v_add_f32 v24, v24, v232
    v_add_f32 v25, v25, v233
    v_add_f32 v24, v24, v234
    v_add_f32 v25, v25, v235
    v_add_f32 v24, v24, v236
    v_add_f32 v25, v25, v237
    v_add_f32 v24, v24, v238
    v_add_f32 v25, v25, v239
    v_add_f32 v24, v24, v240
    v_add_f32 v25, v25, v241
    v_add_f32 v24, v24, v242
    v_add_f32 v25, v25, v243
    v_add_f32 v24, v24, v244
    v_add_f32 v25, v25, v245
    v_add_f32 v24, v24, v246
    v_add_f32 v25, v25, v247
    v_add_f32 v24, v24, v248
    v_add_f32 v25, v25, v249
    v_cvt_pk_bf16_f32 v24, v24, v24
    v_lshlrev_b32 v24, 16, v24
    v_cvt_pk_bf16_f32 v25, v25, v25
    v_lshlrev_b32 v25, 16, v25
    v_add_f32 v6, v6, v24
    v_add_f32 v7, v7, v25
    v_cvt_pk_bf16_f32 v6, v6, v6
    v_lshlrev_b32 v6, 16, v6
    v_cvt_pk_bf16_f32 v7, v7, v7
    v_lshlrev_b32 v7, 16, v7
    v_subrev_u32 v18, 256, v0
    v_lshlrev_b32 v18, 3, v18
    ds_write_b64 v18, v[6:7] offset:512
    s_lshl_b32 s46, s45, 2
    v_mov_b32 v19, s46
    s_waitcnt lgkmcnt(0)
    v_mov_b32 v20, 3
    ds_write_b32 v19, v20 offset:0
    s_nop 1
L_lw_110:
    ds_read_b128 v[8:11], v5 offset:0
    s_waitcnt lgkmcnt(0)
    v_min_u32 v8, v8, v9
    v_min3_u32 v8, v8, v10, v11
    v_cmp_gt_u32 vcc, 3, v8
    s_nop 1
    s_cbranch_vccz L_lwd_111
    s_sleep 1
    s_sub_u32 s49, s49, 1
    s_cmp_gt_i32 s49, 0
    s_cbranch_scc1 L_lw_110
L_lwd_111:
    v_lshlrev_b32 v18, 5, v2
    ds_read_b128 v[24:27], v18 offset:512
    ds_read_b128 v[28:31], v18 offset:528
    s_waitcnt lgkmcnt(0)
    v_add_f32 v20, v24, v25
    v_add_f32 v20, v20, v26
    v_add_f32 v20, v20, v27
    v_add_f32 v20, v20, v28
    v_add_f32 v20, v20, v29
    v_add_f32 v20, v20, v30
    v_add_f32 v20, v20, v31
    s_nop 1
    v_add_f32_dpp v20, v20, v20 quad_perm:[1,0,3,2] row_mask:0xf bank_mask:0xf
    s_nop 1
    v_add_f32_dpp v20, v20, v20 quad_perm:[2,3,0,1] row_mask:0xf bank_mask:0xf
    s_nop 1
    v_add_f32_dpp v20, v20, v20 row_half_mirror row_mask:0xf bank_mask:0xf
    s_nop 1
    v_add_f32_dpp v20, v20, v20 row_mirror row_mask:0xf bank_mask:0xf
    v_mov_b32 v22, v20
    s_nop 1
    v_permlane16_swap_b32 v20, v22
    v_add_f32 v20, v20, v22
    v_mov_b32 v22, v20
    s_nop 1
    v_permlane32_swap_b32 v20, v22
    v_add_f32 v20, v20, v22
    v_mul_f32 v20, 0x3b000000, v20
    v_mov_b32 v21, 0
    v_sub_f32 v22, v24, v20
    v_fma_f32 v21, v22, v22, v21
    v_sub_f32 v22, v25, v20
    v_fma_f32 v21, v22, v22, v21
    v_sub_f32 v22, v26, v20
    v_fma_f32 v21, v22, v22, v21
    v_sub_f32 v22, v27, v20
    v_fma_f32 v21, v22, v22, v21
    v_sub_f32 v22, v28, v20
    v_fma_f32 v21, v22, v22, v21
    v_sub_f32 v22, v29, v20
    v_fma_f32 v21, v22, v22, v21
    v_sub_f32 v22, v30, v20
    v_fma_f32 v21, v22, v22, v21
    v_sub_f32 v22, v31, v20
    v_fma_f32 v21, v22, v22, v21
    s_nop 1
    v_add_f32_dpp v21, v21, v21 quad_perm:[1,0,3,2] row_mask:0xf bank_mask:0xf
    s_nop 1
    v_add_f32_dpp v21, v21, v21 quad_perm:[2,3,0,1] row_mask:0xf bank_mask:0xf
    s_nop 1
    v_add_f32_dpp v21, v21, v21 row_half_mirror row_mask:0xf bank_mask:0xf
    s_nop 1
    v_add_f32_dpp v21, v21, v21 row_mirror row_mask:0xf bank_mask:0xf
    v_mov_b32 v22, v21
    s_nop 1
    v_permlane16_swap_b32 v21, v22
    v_add_f32 v21, v21, v22
    v_mov_b32 v22, v21
    s_nop 1
    v_permlane32_swap_b32 v21, v22
    v_add_f32 v21, v21, v22
    v_mul_f32 v21, 0x3b000000, v21
    v_cvt_pk_bf16_f32 v20, v20, v20
    v_lshlrev_b32 v20, 16, v20
    v_cvt_pk_bf16_f32 v21, v21, v21
    v_lshlrev_b32 v21, 16, v21
    v_add_f32 v21, 0x3727c5ac, v21
    v_cvt_pk_bf16_f32 v21, v21, v21
    v_lshlrev_b32 v21, 16, v21
    v_sqrt_f32 v21, v21
    s_nop 0
    v_cvt_pk_bf16_f32 v21, v21, v21
    v_lshlrev_b32 v21, 16, v21
    v_rcp_f32 v22, v21
    v_sub_f32 v26, v6, v20
    v_cvt_pk_bf16_f32 v26, v26, v26
    v_lshlrev_b32 v26, 16, v26
    v_mul_f32 v24, v26, v22
    v_fma_f32 v27, -v24, v21, v26
    v_fma_f32 v24, v27, v22, v24
    v_sub_f32 v26, v7, v20
    v_cvt_pk_bf16_f32 v26, v26, v26
    v_lshlrev_b32 v26, 16, v26
    v_mul_f32 v25, v26, v22
    v_fma_f32 v27, -v25, v21, v26
    v_fma_f32 v25, v27, v22, v25
    v_cvt_pk_bf16_f32 v28, v24, v25
    v_lshrrev_b32 v29, 4, v2
    v_lshlrev_b32 v29, 6, v29
    v_and_b32 v30, 1, v2
    v_lshl_add_u32 v29, v30, 5, v29
    v_bfe_u32 v30, v2, 1, 3
    v_lshl_add_u32 v29, v30, 1, v29
    s_lshl_b32 s46, s45, 8
    v_add_u32 v29, s46, v29
    ds_write_b16 v29, v28 offset:5632
    ds_write_b16_d16_hi v29, v28 offset:5648
    s_waitcnt lgkmcnt(0)
    ds_read_b128 v[48:51], v15 offset:5632
    ds_read_b128 v[52:55], v15 offset:5696
    ds_read_b128 v[56:59], v15 offset:5760
    ds_read_b128 v[60:63], v15 offset:5824
    v_mov_b32 v224, 0
    v_mov_b32 v225, 0
    v_mov_b32 v226, 0
    v_mov_b32 v227, 0
    v_mov_b32 v228, 0
    v_mov_b32 v229, 0
    v_mov_b32 v230, 0
    v_mov_b32 v231, 0
    v_mov_b32 v232, 0
    v_mov_b32 v233, 0
    v_mov_b32 v234, 0
    v_mov_b32 v235, 0
    v_mov_b32 v236, 0
    v_mov_b32 v237, 0
    v_mov_b32 v238, 0
    v_mov_b32 v239, 0
    v_mov_b32 v240, 0
    v_mov_b32 v241, 0
    v_mov_b32 v242, 0
    v_mov_b32 v243, 0
    v_mov_b32 v244, 0
    v_mov_b32 v245, 0
    v_mov_b32 v246, 0
    v_mov_b32 v247, 0
    v_mov_b32 v248, 0
    v_mov_b32 v249, 0
    v_mov_b32 v250, 0
    v_mov_b32 v251, 0
    v_mov_b32 v252, 0
    v_mov_b32 v253, 0
    v_mov_b32 v254, 0
    v_mov_b32 v255, 0
    s_waitcnt lgkmcnt(0)
    v_mfma_f32_16x16x32_bf16 v[224:227], v[192:195], v[48:51], v[224:227]
    v_mfma_f32_16x16x32_bf16 v[228:231], v[196:199], v[48:51], v[228:231]
    v_mfma_f32_16x16x32_bf16 v[232:235], v[200:203], v[48:51], v[232:235]
    v_mfma_f32_16x16x32_bf16 v[236:239], v[204:207], v[48:51], v[236:239]
    v_mfma_f32_16x16x32_bf16 v[240:243], v[208:211], v[48:51], v[240:243]
    v_mfma_f32_16x16x32_bf16 v[244:247], v[212:215], v[48:51], v[244:247]
    v_mfma_f32_16x16x32_bf16 v[248:251], v[216:219], v[48:51], v[248:251]
    v_mfma_f32_16x16x32_bf16 v[252:255], v[220:223], v[48:51], v[252:255]
    v_mfma_f32_16x16x32_bf16 v[224:227], v[64:67], v[52:55], v[224:227]
    v_mfma_f32_16x16x32_bf16 v[228:231], v[68:71], v[52:55], v[228:231]
    v_mfma_f32_16x16x32_bf16 v[232:235], v[72:75], v[52:55], v[232:235]
    v_mfma_f32_16x16x32_bf16 v[236:239], v[76:79], v[52:55], v[236:239]
    v_mfma_f32_16x16x32_bf16 v[240:243], v[80:83], v[52:55], v[240:243]
    v_mfma_f32_16x16x32_bf16 v[244:247], v[84:87], v[52:55], v[244:247]
    v_mfma_f32_16x16x32_bf16 v[248:251], v[88:91], v[52:55], v[248:251]
    v_mfma_f32_16x16x32_bf16 v[252:255], v[92:95], v[52:55], v[252:255]
    v_mfma_f32_16x16x32_bf16 v[224:227], v[96:99], v[56:59], v[224:227]
    v_mfma_f32_16x16x32_bf16 v[228:231], v[100:103], v[56:59], v[228:231]
    v_mfma_f32_16x16x32_bf16 v[232:235], v[104:107], v[56:59], v[232:235]
    v_mfma_f32_16x16x32_bf16 v[236:239], v[108:111], v[56:59], v[236:239]
    v_mfma_f32_16x16x32_bf16 v[240:243], v[112:115], v[56:59], v[240:243]
    v_mfma_f32_16x16x32_bf16 v[244:247], v[116:119], v[56:59], v[244:247]
    v_mfma_f32_16x16x32_bf16 v[248:251], v[120:123], v[56:59], v[248:251]
    v_mfma_f32_16x16x32_bf16 v[252:255], v[124:127], v[56:59], v[252:255]
    v_mfma_f32_16x16x32_bf16 v[224:227], v[128:131], v[60:63], v[224:227]
    v_mfma_f32_16x16x32_bf16 v[228:231], v[132:135], v[60:63], v[228:231]
    v_mfma_f32_16x16x32_bf16 v[232:235], v[136:139], v[60:63], v[232:235]
    v_mfma_f32_16x16x32_bf16 v[236:239], v[140:143], v[60:63], v[236:239]
    v_mfma_f32_16x16x32_bf16 v[240:243], v[144:147], v[60:63], v[240:243]
    v_mfma_f32_16x16x32_bf16 v[244:247], v[148:151], v[60:63], v[244:247]
    v_mfma_f32_16x16x32_bf16 v[248:251], v[152:155], v[60:63], v[248:251]
    v_mfma_f32_16x16x32_bf16 v[252:255], v[156:159], v[60:63], v[252:255]
    s_lshl_b32 s46, s45, 9
    v_add_u32 v18, s46, v16
    s_mov_b64 exec, s[68:69]
    ds_write_b32 v18, v224 offset:2560
    ds_write_b32 v18, v225 offset:2592
    ds_write_b32 v18, v226 offset:2624
    ds_write_b32 v18, v227 offset:2656
    ds_write_b32 v18, v228 offset:2564
    ds_write_b32 v18, v229 offset:2596
    ds_write_b32 v18, v230 offset:2628
    ds_write_b32 v18, v231 offset:2660
    ds_write_b32 v18, v232 offset:2568
    ds_write_b32 v18, v233 offset:2600
    ds_write_b32 v18, v234 offset:2632
    ds_write_b32 v18, v235 offset:2664
    ds_write_b32 v18, v236 offset:2572
    ds_write_b32 v18, v237 offset:2604
    ds_write_b32 v18, v238 offset:2636
    ds_write_b32 v18, v239 offset:2668
    ds_write_b32 v18, v240 offset:2576
    ds_write_b32 v18, v241 offset:2608
    ds_write_b32 v18, v242 offset:2640
    ds_write_b32 v18, v243 offset:2672
    ds_write_b32 v18, v244 offset:2580
    ds_write_b32 v18, v245 offset:2612
    ds_write_b32 v18, v246 offset:2644
    ds_write_b32 v18, v247 offset:2676
    ds_write_b32 v18, v248 offset:2584
    ds_write_b32 v18, v249 offset:2616
    ds_write_b32 v18, v250 offset:2648
    ds_write_b32 v18, v251 offset:2680
    ds_write_b32 v18, v252 offset:2588
    ds_write_b32 v18, v253 offset:2620
    ds_write_b32 v18, v254 offset:2652
    ds_write_b32 v18, v255 offset:2684
    s_mov_b64 exec, -1
    s_lshl_b32 s46, s45, 2
    v_mov_b32 v19, s46
    s_waitcnt lgkmcnt(0)
    v_mov_b32 v20, 3
    ds_write_b32 v19, v20 offset:16
    s_cmp_lg_u32 s45, 0
    s_cbranch_scc1 L_nq_112
    s_nop 1
L_lw_113:
    ds_read_b128 v[8:11], v5 offset:16
    s_waitcnt lgkmcnt(0)
    v_min_u32 v8, v8, v9
    v_min3_u32 v8, v8, v10, v11
    v_cmp_gt_u32 vcc, 3, v8
    s_nop 1
    s_cbranch_vccz L_lwd_114
    s_sleep 1
    s_sub_u32 s49, s49, 1
    s_cmp_gt_i32 s49, 0
    s_cbranch_scc1 L_lw_113
L_lwd_114:
    ds_read_b64 v[24:25], v17 offset:2560
    ds_read_b64 v[26:27], v17 offset:3072
    ds_read_b64 v[28:29], v17 offset:3584
    ds_read_b64 v[30:31], v17 offset:4096
    s_waitcnt lgkmcnt(0)
    v_add_f32 v24, v24, v26
    v_add_f32 v25, v25, v27
    v_add_f32 v24, v24, v28
    v_add_f32 v25, v25, v29
    v_add_f32 v24, v24, v30
    v_add_f32 v25, v25, v31
    v_lshlrev_b32 v18, 2, v2
    v_cvt_pk_bf16_f32 v24, v24, v24
    v_lshlrev_b32 v24, 16, v24
    v_cvt_pk_bf16_f32 v25, v25, v25
    v_lshlrev_b32 v25, 16, v25
    v_or_b32 v24, 1, v24
    v_or_b32 v25, 1, v25
    s_add_u32 s46, s75, 9216
    buffer_store_dwordx2 v[24:25], v17, s[56:59], s46 offen sc1
    s_and_b32 s46, s75, 0xfffc0000
    s_add_u32 s46, s46, 9216
    v_lshlrev_b32 v20, 16, v2
    s_nop 1
L_qx_115:
    s_mov_b32 s47, s46
    buffer_load_dwordx2 v[24:25], v17, s[56:59], s47 offen sc1
    s_add_u32 s47, s47, 65536
    buffer_load_dwordx2 v[26:27], v17, s[56:59], s47 offen sc1
    s_add_u32 s47, s47, 65536
    buffer_load_dwordx2 v[28:29], v17, s[56:59], s47 offen sc1
    s_add_u32 s47, s47, 65536
    buffer_load_dwordx2 v[30:31], v17, s[56:59], s47 offen sc1
    s_waitcnt vmcnt(0)
    v_and_b32 v19, v24, v25
    v_and_b32 v19, v19, v26
    v_and_b32 v19, v19, v27
    v_and_b32 v19, v19, v28
    v_and_b32 v19, v19, v29
    v_and_b32 v19, v19, v30
    v_and_b32 v19, v19, v31
    v_and_b32 v19, 1, v19
    v_cmp_eq_u32 vcc, 0, v19
    s_nop 1
    s_cbranch_vccz L_qxd_116
    s_sleep 1
    s_sub_u32 s49, s49, 1
    s_cmp_gt_i32 s49, 0
    s_cbranch_scc1 L_qx_115
L_qxd_116:
    v_perm_b32 v20, v25, v24, s44
    ds_write_b32 v18, v20 offset:4608
    v_perm_b32 v20, v27, v26, s44
    ds_write_b32 v18, v20 offset:4864
    v_perm_b32 v20, v29, v28, s44
    ds_write_b32 v18, v20 offset:5120
    v_perm_b32 v20, v31, v30, s44
    ds_write_b32 v18, v20 offset:5376
    s_waitcnt lgkmcnt(0)
    v_mov_b32 v20, 3
    ds_write_b32 v5, v20 offset:64
    s_nop 3
L_nq_112:
    s_setprio 0
    s_and_b32 s46, s2, 31
    s_lshl_b32 s46, s46, 17
    s_add_u32 s60, s24, s46
    s_addc_u32 s61, s25, 0
    s_mov_b32 s62, 0x20000
    s_mov_b32 s63, 0x20000
    s_lshl_b32 s47, s45, 8
    buffer_load_dwordx4 v[64:67], v13, s[60:63], s47 offen
    s_add_u32 s47, s47, 4096
    buffer_load_dwordx4 v[68:71], v13, s[60:63], s47 offen
    s_add_u32 s47, s47, 4096
    buffer_load_dwordx4 v[72:75], v13, s[60:63], s47 offen
    s_add_u32 s47, s47, 4096
    buffer_load_dwordx4 v[76:79], v13, s[60:63], s47 offen
    s_add_u32 s47, s47, 4096
    buffer_load_dwordx4 v[80:83], v13, s[60:63], s47 offen
    s_add_u32 s47, s47, 4096
    buffer_load_dwordx4 v[84:87], v13, s[60:63], s47 offen
    s_add_u32 s47, s47, 4096
    buffer_load_dwordx4 v[88:91], v13, s[60:63], s47 offen
    s_add_u32 s47, s47, 4096
    buffer_load_dwordx4 v[92:95], v13, s[60:63], s47 offen
    s_add_u32 s47, s47, 4096
    buffer_load_dwordx4 v[96:99], v13, s[60:63], s47 offen
    s_add_u32 s47, s47, 4096
    buffer_load_dwordx4 v[100:103], v13, s[60:63], s47 offen
    s_add_u32 s47, s47, 4096
    buffer_load_dwordx4 v[104:107], v13, s[60:63], s47 offen
    s_add_u32 s47, s47, 4096
    buffer_load_dwordx4 v[108:111], v13, s[60:63], s47 offen
    s_add_u32 s47, s47, 4096
    buffer_load_dwordx4 v[112:115], v13, s[60:63], s47 offen
    s_add_u32 s47, s47, 4096
    buffer_load_dwordx4 v[116:119], v13, s[60:63], s47 offen
    s_add_u32 s47, s47, 4096
    buffer_load_dwordx4 v[120:123], v13, s[60:63], s47 offen
    s_add_u32 s47, s47, 4096
    buffer_load_dwordx4 v[124:127], v13, s[60:63], s47 offen
    s_add_u32 s47, s47, 4096
    buffer_load_dwordx4 v[128:131], v13, s[60:63], s47 offen
    s_add_u32 s47, s47, 4096
    buffer_load_dwordx4 v[132:135], v13, s[60:63], s47 offen
    s_add_u32 s47, s47, 4096
    buffer_load_dwordx4 v[136:139], v13, s[60:63], s47 offen
    s_add_u32 s47, s47, 4096
    buffer_load_dwordx4 v[140:143], v13, s[60:63], s47 offen
    s_add_u32 s47, s47, 4096
    buffer_load_dwordx4 v[144:147], v13, s[60:63], s47 offen
    s_add_u32 s47, s47, 4096
    buffer_load_dwordx4 v[148:151], v13, s[60:63], s47 offen
    s_add_u32 s47, s47, 4096
    buffer_load_dwordx4 v[152:155], v13, s[60:63], s47 offen
    s_add_u32 s47, s47, 4096
    buffer_load_dwordx4 v[156:159], v13, s[60:63], s47 offen
    s_add_u32 s47, s47, 4096
    buffer_load_dwordx4 v[160:163], v13, s[60:63], s47 offen
    s_add_u32 s47, s47, 4096
    buffer_load_dwordx4 v[164:167], v13, s[60:63], s47 offen
    s_add_u32 s47, s47, 4096
    buffer_load_dwordx4 v[168:171], v13, s[60:63], s47 offen
    s_add_u32 s47, s47, 4096
    buffer_load_dwordx4 v[172:175], v13, s[60:63], s47 offen
    s_add_u32 s47, s47, 4096
    buffer_load_dwordx4 v[176:179], v13, s[60:63], s47 offen
    s_add_u32 s47, s47, 4096
    buffer_load_dwordx4 v[180:183], v13, s[60:63], s47 offen
    s_add_u32 s47, s47, 4096
    buffer_load_dwordx4 v[184:187], v13, s[60:63], s47 offen
    s_add_u32 s47, s47, 4096
    buffer_load_dwordx4 v[188:191], v13, s[60:63], s47 offen
    s_waitcnt vmcnt(0)
    v_perm_b32 v192, v68, v64, s43
    v_perm_b32 v196, v68, v64, s44
    v_perm_b32 v200, v69, v65, s43
    v_perm_b32 v204, v69, v65, s44
    v_perm_b32 v208, v70, v66, s43
    v_perm_b32 v212, v70, v66, s44
    v_perm_b32 v216, v71, v67, s43
    v_perm_b32 v220, v71, v67, s44
    v_perm_b32 v193, v76, v72, s43
    v_perm_b32 v197, v76, v72, s44
    v_perm_b32 v201, v77, v73, s43
    v_perm_b32 v205, v77, v73, s44
    v_perm_b32 v209, v78, v74, s43
    v_perm_b32 v213, v78, v74, s44
    v_perm_b32 v217, v79, v75, s43
    v_perm_b32 v221, v79, v75, s44
    v_perm_b32 v194, v84, v80, s43
    v_perm_b32 v198, v84, v80, s44
    v_perm_b32 v202, v85, v81, s43
    v_perm_b32 v206, v85, v81, s44
    v_perm_b32 v210, v86, v82, s43
    v_perm_b32 v214, v86, v82, s44
    v_perm_b32 v218, v87, v83, s43
    v_perm_b32 v222, v87, v83, s44
    v_perm_b32 v195, v92, v88, s43
    v_perm_b32 v199, v92, v88, s44
    v_perm_b32 v203, v93, v89, s43
    v_perm_b32 v207, v93, v89, s44
    v_perm_b32 v211, v94, v90, s43
    v_perm_b32 v215, v94, v90, s44
    v_perm_b32 v219, v95, v91, s43
    v_perm_b32 v223, v95, v91, s44
    v_perm_b32 v64, v100, v96, s43
    v_perm_b32 v68, v100, v96, s44
    v_perm_b32 v72, v101, v97, s43
    v_perm_b32 v76, v101, v97, s44
    v_perm_b32 v80, v102, v98, s43
    v_perm_b32 v84, v102, v98, s44
    v_perm_b32 v88, v103, v99, s43
    v_perm_b32 v92, v103, v99, s44
    v_perm_b32 v65, v108, v104, s43
    v_perm_b32 v69, v108, v104, s44
    v_perm_b32 v73, v109, v105, s43
    v_perm_b32 v77, v109, v105, s44
    v_perm_b32 v81, v110, v106, s43
    v_perm_b32 v85, v110, v106, s44
    v_perm_b32 v89, v111, v107, s43
    v_perm_b32 v93, v111, v107, s44
    v_perm_b32 v66, v116, v112, s43
    v_perm_b32 v70, v116, v112, s44
    v_perm_b32 v74, v117, v113, s43
    v_perm_b32 v78, v117, v113, s44
    v_perm_b32 v82, v118, v114, s43
    v_perm_b32 v86, v118, v114, s44
    v_perm_b32 v90, v119, v115, s43
    v_perm_b32 v94, v119, v115, s44
    v_perm_b32 v67, v124, v120, s43
    v_perm_b32 v71, v124, v120, s44
    v_perm_b32 v75, v125, v121, s43
    v_perm_b32 v79, v125, v121, s44
    v_perm_b32 v83, v126, v122, s43
    v_perm_b32 v87, v126, v122, s44
    v_perm_b32 v91, v127, v123, s43
    v_perm_b32 v95, v127, v123, s44
    v_perm_b32 v96, v132, v128, s43
    v_perm_b32 v100, v132, v128, s44
    v_perm_b32 v104, v133, v129, s43
    v_perm_b32 v108, v133, v129, s44
    v_perm_b32 v112, v134, v130, s43
    v_perm_b32 v116, v134, v130, s44
    v_perm_b32 v120, v135, v131, s43
    v_perm_b32 v124, v135, v131, s44
    v_perm_b32 v97, v140, v136, s43
    v_perm_b32 v101, v140, v136, s44
    v_perm_b32 v105, v141, v137, s43
    v_perm_b32 v109, v141, v137, s44
    v_perm_b32 v113, v142, v138, s43
    v_perm_b32 v117, v142, v138, s44
    v_perm_b32 v121, v143, v139, s43
    v_perm_b32 v125, v143, v139, s44
    v_perm_b32 v98, v148, v144, s43
    v_perm_b32 v102, v148, v144, s44
    v_perm_b32 v106, v149, v145, s43
    v_perm_b32 v110, v149, v145, s44
    v_perm_b32 v114, v150, v146, s43
    v_perm_b32 v118, v150, v146, s44
    v_perm_b32 v122, v151, v147, s43
    v_perm_b32 v126, v151, v147, s44
    v_perm_b32 v99, v156, v152, s43
    v_perm_b32 v103, v156, v152, s44
    v_perm_b32 v107, v157, v153, s43
    v_perm_b32 v111, v157, v153, s44
    v_perm_b32 v115, v158, v154, s43
    v_perm_b32 v119, v158, v154, s44
    v_perm_b32 v123, v159, v155, s43
    v_perm_b32 v127, v159, v155, s44
    v_perm_b32 v128, v164, v160, s43
    v_perm_b32 v132, v164, v160, s44
    v_perm_b32 v136, v165, v161, s43
    v_perm_b32 v140, v165, v161, s44
    v_perm_b32 v144, v166, v162, s43
    v_perm_b32 v148, v166, v162, s44
    v_perm_b32 v152, v167, v163, s43
    v_perm_b32 v156, v167, v163, s44
    v_perm_b32 v129, v172, v168, s43
    v_perm_b32 v133, v172, v168, s44
    v_perm_b32 v137, v173, v169, s43
    v_perm_b32 v141, v173, v169, s44
    v_perm_b32 v145, v174, v170, s43
    v_perm_b32 v149, v174, v170, s44
    v_perm_b32 v153, v175, v171, s43
    v_perm_b32 v157, v175, v171, s44
    v_perm_b32 v130, v180, v176, s43
    v_perm_b32 v134, v180, v176, s44
    v_perm_b32 v138, v181, v177, s43
    v_perm_b32 v142, v181, v177, s44
    v_perm_b32 v146, v182, v178, s43
    v_perm_b32 v150, v182, v178, s44
    v_perm_b32 v154, v183, v179, s43
    v_perm_b32 v158, v183, v179, s44
    v_perm_b32 v131, v188, v184, s43
    v_perm_b32 v135, v188, v184, s44
    v_perm_b32 v139, v189, v185, s43
    v_perm_b32 v143, v189, v185, s44
    v_perm_b32 v147, v190, v186, s43
    v_perm_b32 v151, v190, v186, s44
    v_perm_b32 v155, v191, v187, s43
    v_perm_b32 v159, v191, v187, s44
    s_nop 1
L_lw_117:
    ds_read_b128 v[8:11], v5 offset:32
    s_waitcnt lgkmcnt(0)
    v_min_u32 v8, v8, v9
    v_min3_u32 v8, v8, v10, v11
    v_cmp_gt_u32 vcc, 3, v8
    s_nop 1
    s_cbranch_vccz L_lwd_118
    s_sleep 1
    s_sub_u32 s49, s49, 1
    s_cmp_gt_i32 s49, 0
    s_cbranch_scc1 L_lw_117
L_lwd_118:
    s_setprio 3
    s_lshl_b32 s46, s45, 9
    v_add_u32 v18, s46, v17
    s_lshl_b32 s46, s45, 3
    v_mov_b32 v19, s46
    ds_read_b64 v[24:25], v18 offset:17408
    ds_read_b64 v[26:27], v18 offset:19456
    ds_read_b64 v[28:29], v18 offset:21504
    ds_read_b64 v[30:31], v18 offset:23552
    ds_read_b64 v[32:33], v19 offset:256
    s_waitcnt lgkmcnt(0)
    v_add_f32 v24, v24, v26
    v_add_f32 v25, v25, v27
    v_add_f32 v24, v24, v28
    v_add_f32 v25, v25, v29
    v_add_f32 v24, v24, v30
    v_add_f32 v25, v25, v31
    v_or_b32 v24, 1, v24
    v_or_b32 v25, 1, v25
    v_or_b32 v32, 1, v32
    v_or_b32 v33, 1, v33
    s_and_b32 s46, s75, 0xfffc0000
    s_lshl_b32 s47, s45, 16
    s_add_u32 s46, s46, s47
    s_and_b32 s47, s2, 3
    s_lshl_b32 s47, s47, 10
    s_add_u32 s46, s46, s47
    s_add_u32 s46, s46, 14336
    buffer_store_dwordx2 v[24:25], v17, s[56:59], s46 offen sc1
    s_mov_b64 exec, s[70:71]
    buffer_store_dwordx2 v[32:33], v5, s[56:59], s46 offen offset:512 sc1
    s_mov_b64 exec, -1
    s_add_u32 s46, s75, 14336
    s_nop 1
L_ox_119:
    buffer_load_dwordx2 v[24:25], v17, s[56:59], s46 offen offset:0 sc1
    buffer_load_dwordx2 v[32:33], v5, s[56:59], s46 offen offset:512 sc1
    buffer_load_dwordx2 v[26:27], v17, s[56:59], s46 offen offset:1024 sc1
    buffer_load_dwordx2 v[34:35], v5, s[56:59], s46 offen offset:1536 sc1
    buffer_load_dwordx2 v[28:29], v17, s[56:59], s46 offen offset:2048 sc1
    buffer_load_dwordx2 v[36:37], v5, s[56:59], s46 offen offset:2560 sc1
    buffer_load_dwordx2 v[30:31], v17, s[56:59], s46 offen offset:3072 sc1
    buffer_load_dwordx2 v[38:39], v5, s[56:59], s46 offen offset:3584 sc1
    s_waitcnt vmcnt(0)
    v_and_b32 v19, v24, v25
    v_and_b32 v19, v19, v26
    v_and_b32 v19, v19, v27
    v_and_b32 v19, v19, v28
    v_and_b32 v19, v19, v29
    v_and_b32 v19, v19, v30
    v_and_b32 v19, v19, v31
    v_and_b32 v19, v19, v32
    v_and_b32 v19, v19, v33
    v_and_b32 v19, v19, v34
    v_and_b32 v19, v19, v35
    v_and_b32 v19, v19, v36
    v_and_b32 v19, v19, v37
    v_and_b32 v19, v19, v38
    v_and_b32 v19, v19, v39
    v_and_b32 v19, 1, v19
    v_cmp_eq_u32 vcc, 0, v19
    s_nop 1
    s_cbranch_vccz L_oxd_120
    s_sleep 1
    s_sub_u32 s49, s49, 1
    s_cmp_gt_i32 s49, 0
    s_cbranch_scc1 L_ox_119
L_oxd_120:
    v_mov_b32 v44, v32
    v_max_f32 v44, v44, v34
    v_max_f32 v44, v44, v36
    v_max_f32 v44, v44, v38
    v_mov_b32 v43, 0
    v_mov_b32 v20, 0
    v_mov_b32 v21, 0
    v_sub_f32 v45, v32, v44
    v_mul_f32 v45, s72, v45
    v_exp_f32 v45, v45
    s_nop 0
    v_fma_f32 v43, v45, v33, v43
    v_fma_f32 v20, v45, v24, v20
    v_fma_f32 v21, v45, v25, v21
    v_sub_f32 v45, v34, v44
    v_mul_f32 v45, s72, v45
    v_exp_f32 v45, v45
    s_nop 0
    v_fma_f32 v43, v45, v35, v43
    v_fma_f32 v20, v45, v26, v20
    v_fma_f32 v21, v45, v27, v21
    v_sub_f32 v45, v36, v44
    v_mul_f32 v45, s72, v45
    v_exp_f32 v45, v45
    s_nop 0
    v_fma_f32 v43, v45, v37, v43
    v_fma_f32 v20, v45, v28, v20
    v_fma_f32 v21, v45, v29, v21
    v_sub_f32 v45, v38, v44
    v_mul_f32 v45, s72, v45
    v_exp_f32 v45, v45
    s_nop 0
    v_fma_f32 v43, v45, v39, v43
    v_fma_f32 v20, v45, v30, v20
    v_fma_f32 v21, v45, v31, v21
    v_rcp_f32 v43, v43
    s_nop 0
    v_mul_f32 v24, v20, v43
    v_mul_f32 v25, v21, v43
    v_cvt_pk_bf16_f32 v28, v24, v25
    v_lshrrev_b32 v29, 4, v2
    v_lshlrev_b32 v29, 6, v29
    v_and_b32 v30, 1, v2
    v_lshl_add_u32 v29, v30, 5, v29
    v_bfe_u32 v30, v2, 1, 3
    v_lshl_add_u32 v29, v30, 1, v29
    s_lshl_b32 s46, s45, 8
    v_add_u32 v29, s46, v29
    ds_write_b16 v29, v28 offset:5632
    ds_write_b16_d16_hi v29, v28 offset:5648
    s_waitcnt lgkmcnt(0)
    ds_read_b128 v[48:51], v15 offset:5632
    ds_read_b128 v[52:55], v15 offset:5696
    ds_read_b128 v[56:59], v15 offset:5760
    ds_read_b128 v[60:63], v15 offset:5824
    v_mov_b32 v224, 0
    v_mov_b32 v225, 0
    v_mov_b32 v226, 0
    v_mov_b32 v227, 0
    v_mov_b32 v228, 0
    v_mov_b32 v229, 0
    v_mov_b32 v230, 0
    v_mov_b32 v231, 0
    v_mov_b32 v232, 0
    v_mov_b32 v233, 0
    v_mov_b32 v234, 0
    v_mov_b32 v235, 0
    v_mov_b32 v236, 0
    v_mov_b32 v237, 0
    v_mov_b32 v238, 0
    v_mov_b32 v239, 0
    v_mov_b32 v240, 0
    v_mov_b32 v241, 0
    v_mov_b32 v242, 0
    v_mov_b32 v243, 0
    v_mov_b32 v244, 0
    v_mov_b32 v245, 0
    v_mov_b32 v246, 0
    v_mov_b32 v247, 0
    v_mov_b32 v248, 0
    v_mov_b32 v249, 0
    v_mov_b32 v250, 0
    v_mov_b32 v251, 0
    v_mov_b32 v252, 0
    v_mov_b32 v253, 0
    v_mov_b32 v254, 0
    v_mov_b32 v255, 0
    s_waitcnt lgkmcnt(0)
    v_mfma_f32_16x16x32_bf16 v[224:227], v[192:195], v[48:51], v[224:227]
    v_mfma_f32_16x16x32_bf16 v[228:231], v[196:199], v[48:51], v[228:231]
    v_mfma_f32_16x16x32_bf16 v[232:235], v[200:203], v[48:51], v[232:235]
    v_mfma_f32_16x16x32_bf16 v[236:239], v[204:207], v[48:51], v[236:239]
    v_mfma_f32_16x16x32_bf16 v[240:243], v[208:211], v[48:51], v[240:243]
    v_mfma_f32_16x16x32_bf16 v[244:247], v[212:215], v[48:51], v[244:247]
    v_mfma_f32_16x16x32_bf16 v[248:251], v[216:219], v[48:51], v[248:251]
    v_mfma_f32_16x16x32_bf16 v[252:255], v[220:223], v[48:51], v[252:255]
    v_mfma_f32_16x16x32_bf16 v[224:227], v[64:67], v[52:55], v[224:227]
    v_mfma_f32_16x16x32_bf16 v[228:231], v[68:71], v[52:55], v[228:231]
    v_mfma_f32_16x16x32_bf16 v[232:235], v[72:75], v[52:55], v[232:235]
    v_mfma_f32_16x16x32_bf16 v[236:239], v[76:79], v[52:55], v[236:239]
    v_mfma_f32_16x16x32_bf16 v[240:243], v[80:83], v[52:55], v[240:243]
    v_mfma_f32_16x16x32_bf16 v[244:247], v[84:87], v[52:55], v[244:247]
    v_mfma_f32_16x16x32_bf16 v[248:251], v[88:91], v[52:55], v[248:251]
    v_mfma_f32_16x16x32_bf16 v[252:255], v[92:95], v[52:55], v[252:255]
    v_mfma_f32_16x16x32_bf16 v[224:227], v[96:99], v[56:59], v[224:227]
    v_mfma_f32_16x16x32_bf16 v[228:231], v[100:103], v[56:59], v[228:231]
    v_mfma_f32_16x16x32_bf16 v[232:235], v[104:107], v[56:59], v[232:235]
    v_mfma_f32_16x16x32_bf16 v[236:239], v[108:111], v[56:59], v[236:239]
    v_mfma_f32_16x16x32_bf16 v[240:243], v[112:115], v[56:59], v[240:243]
    v_mfma_f32_16x16x32_bf16 v[244:247], v[116:119], v[56:59], v[244:247]
    v_mfma_f32_16x16x32_bf16 v[248:251], v[120:123], v[56:59], v[248:251]
    v_mfma_f32_16x16x32_bf16 v[252:255], v[124:127], v[56:59], v[252:255]
    v_mfma_f32_16x16x32_bf16 v[224:227], v[128:131], v[60:63], v[224:227]
    v_mfma_f32_16x16x32_bf16 v[228:231], v[132:135], v[60:63], v[228:231]
    v_mfma_f32_16x16x32_bf16 v[232:235], v[136:139], v[60:63], v[232:235]
    v_mfma_f32_16x16x32_bf16 v[236:239], v[140:143], v[60:63], v[236:239]
    v_mfma_f32_16x16x32_bf16 v[240:243], v[144:147], v[60:63], v[240:243]
    v_mfma_f32_16x16x32_bf16 v[244:247], v[148:151], v[60:63], v[244:247]
    v_mfma_f32_16x16x32_bf16 v[248:251], v[152:155], v[60:63], v[248:251]
    v_mfma_f32_16x16x32_bf16 v[252:255], v[156:159], v[60:63], v[252:255]
    s_lshl_b32 s46, s45, 9
    v_add_u32 v18, s46, v16
    s_mov_b64 exec, s[68:69]
    ds_write_b32 v18, v224 offset:6656
    ds_write_b32 v18, v225 offset:6688
    ds_write_b32 v18, v226 offset:6720
    ds_write_b32 v18, v227 offset:6752
    ds_write_b32 v18, v228 offset:6660
    ds_write_b32 v18, v229 offset:6692
    ds_write_b32 v18, v230 offset:6724
    ds_write_b32 v18, v231 offset:6756
    ds_write_b32 v18, v232 offset:6664
    ds_write_b32 v18, v233 offset:6696
    ds_write_b32 v18, v234 offset:6728
    ds_write_b32 v18, v235 offset:6760
    ds_write_b32 v18, v236 offset:6668
    ds_write_b32 v18, v237 offset:6700
    ds_write_b32 v18, v238 offset:6732
    ds_write_b32 v18, v239 offset:6764
    ds_write_b32 v18, v240 offset:6672
    ds_write_b32 v18, v241 offset:6704
    ds_write_b32 v18, v242 offset:6736
    ds_write_b32 v18, v243 offset:6768
    ds_write_b32 v18, v244 offset:6676
    ds_write_b32 v18, v245 offset:6708
    ds_write_b32 v18, v246 offset:6740
    ds_write_b32 v18, v247 offset:6772
    ds_write_b32 v18, v248 offset:6680
    ds_write_b32 v18, v249 offset:6712
    ds_write_b32 v18, v250 offset:6744
    ds_write_b32 v18, v251 offset:6776
    ds_write_b32 v18, v252 offset:6684
    ds_write_b32 v18, v253 offset:6716
    ds_write_b32 v18, v254 offset:6748
    ds_write_b32 v18, v255 offset:6780
    s_mov_b64 exec, -1
    v_add_u32 v18, s46, v17
    s_waitcnt lgkmcnt(0)
    ds_read_b64 v[24:25], v18 offset:6656
    s_add_u32 s46, s46, s75
    s_add_u32 s46, s46, 4096
    s_waitcnt lgkmcnt(0)
    v_or_b32 v24, 1, v24
    v_or_b32 v25, 1, v25
    buffer_store_dwordx2 v[24:25], v17, s[56:59], s46 offen sc1
    s_and_b32 s46, s2, 31
    s_lshl_b32 s46, s46, 8
    s_add_u32 s60, s32, s46
    s_addc_u32 s61, s33, 0
    s_mov_b32 s62, 0x3fe100
    s_mov_b32 s63, 0x20000
    s_lshl_b32 s47, s45, 20
    buffer_load_dwordx4 v[64:67], v12, s[60:63], s47 offen
    s_add_u32 s47, s47, 32768
    buffer_load_dwordx4 v[68:71], v12, s[60:63], s47 offen
    s_add_u32 s47, s47, 32768
    buffer_load_dwordx4 v[72:75], v12, s[60:63], s47 offen
    s_add_u32 s47, s47, 32768
    buffer_load_dwordx4 v[76:79], v12, s[60:63], s47 offen
    s_add_u32 s47, s47, 32768
    buffer_load_dwordx4 v[80:83], v12, s[60:63], s47 offen
    s_add_u32 s47, s47, 32768
    buffer_load_dwordx4 v[84:87], v12, s[60:63], s47 offen
    s_add_u32 s47, s47, 32768
    buffer_load_dwordx4 v[88:91], v12, s[60:63], s47 offen
    s_add_u32 s47, s47, 32768
    buffer_load_dwordx4 v[92:95], v12, s[60:63], s47 offen
    s_add_u32 s47, s47, 32768
    buffer_load_dwordx4 v[96:99], v12, s[60:63], s47 offen
    s_add_u32 s47, s47, 32768
    buffer_load_dwordx4 v[100:103], v12, s[60:63], s47 offen
    s_add_u32 s47, s47, 32768
    buffer_load_dwordx4 v[104:107], v12, s[60:63], s47 offen
    s_add_u32 s47, s47, 32768
    buffer_load_dwordx4 v[108:111], v12, s[60:63], s47 offen
    s_add_u32 s47, s47, 32768
    buffer_load_dwordx4 v[112:115], v12, s[60:63], s47 offen
    s_add_u32 s47, s47, 32768
    buffer_load_dwordx4 v[116:119], v12, s[60:63], s47 offen
    s_add_u32 s47, s47, 32768
    buffer_load_dwordx4 v[120:123], v12, s[60:63], s47 offen
    s_add_u32 s47, s47, 32768
    buffer_load_dwordx4 v[124:127], v12, s[60:63], s47 offen
    s_add_u32 s47, s47, 32768
    buffer_load_dwordx4 v[128:131], v12, s[60:63], s47 offen
    s_add_u32 s47, s47, 32768
    buffer_load_dwordx4 v[132:135], v12, s[60:63], s47 offen
    s_add_u32 s47, s47, 32768
    buffer_load_dwordx4 v[136:139], v12, s[60:63], s47 offen
    s_add_u32 s47, s47, 32768
    buffer_load_dwordx4 v[140:143], v12, s[60:63], s47 offen
    s_add_u32 s47, s47, 32768
    buffer_load_dwordx4 v[144:147], v12, s[60:63], s47 offen
    s_add_u32 s47, s47, 32768
    buffer_load_dwordx4 v[148:151], v12, s[60:63], s47 offen
    s_add_u32 s47, s47, 32768
    buffer_load_dwordx4 v[152:155], v12, s[60:63], s47 offen
    s_add_u32 s47, s47, 32768
    buffer_load_dwordx4 v[156:159], v12, s[60:63], s47 offen
    s_add_u32 s47, s47, 32768
    buffer_load_dwordx4 v[160:163], v12, s[60:63], s47 offen
    s_add_u32 s47, s47, 32768
    buffer_load_dwordx4 v[164:167], v12, s[60:63], s47 offen
    s_add_u32 s47, s47, 32768
    buffer_load_dwordx4 v[168:171], v12, s[60:63], s47 offen
    s_add_u32 s47, s47, 32768
    buffer_load_dwordx4 v[172:175], v12, s[60:63], s47 offen
    s_add_u32 s47, s47, 32768
    buffer_load_dwordx4 v[176:179], v12, s[60:63], s47 offen
    s_add_u32 s47, s47, 32768
    buffer_load_dwordx4 v[180:183], v12, s[60:63], s47 offen
    s_add_u32 s47, s47, 32768
    buffer_load_dwordx4 v[184:187], v12, s[60:63], s47 offen
    s_add_u32 s47, s47, 32768
    buffer_load_dwordx4 v[188:191], v12, s[60:63], s47 offen
    s_lshl_b32 s46, s45, 9
    s_add_u32 s46, s46, 4096
    s_mov_b32 s96, -1
    s_add_u32 s47, s46, 0
    buffer_load_dwordx2 v[24:25], v17, s[56:59], s47 offen sc1
    s_add_u32 s47, s46, 65536
    buffer_load_dwordx2 v[26:27], v17, s[56:59], s47 offen sc1
    s_add_u32 s47, s46, 131072
    buffer_load_dwordx2 v[28:29], v17, s[56:59], s47 offen sc1
    s_add_u32 s47, s46, 196608
    buffer_load_dwordx2 v[30:31], v17, s[56:59], s47 offen sc1
    s_add_u32 s47, s46, 262144
    buffer_load_dwordx2 v[32:33], v17, s[56:59], s47 offen sc1
    s_add_u32 s47, s46, 327680
    buffer_load_dwordx2 v[34:35], v17, s[56:59], s47 offen sc1
    s_add_u32 s47, s46, 393216
    buffer_load_dwordx2 v[36:37], v17, s[56:59], s47 offen sc1
    s_add_u32 s47, s46, 458752
    buffer_load_dwordx2 v[38:39], v17, s[56:59], s47 offen sc1
    s_add_u32 s47, s46, 524288
    buffer_load_dwordx2 v[40:41], v17, s[56:59], s47 offen sc1
    s_add_u32 s47, s46, 589824
    buffer_load_dwordx2 v[42:43], v17, s[56:59], s47 offen sc1
    s_add_u32 s47, s46, 655360
    buffer_load_dwordx2 v[44:45], v17, s[56:59], s47 offen sc1
    s_add_u32 s47, s46, 720896
    buffer_load_dwordx2 v[48:49], v17, s[56:59], s47 offen sc1
    s_add_u32 s47, s46, 786432
    buffer_load_dwordx2 v[50:51], v17, s[56:59], s47 offen sc1
    s_add_u32 s47, s46, 851968
    buffer_load_dwordx2 v[52:53], v17, s[56:59], s47 offen sc1
    s_add_u32 s47, s46, 917504
    buffer_load_dwordx2 v[54:55], v17, s[56:59], s47 offen sc1
    s_add_u32 s47, s46, 983040
    buffer_load_dwordx2 v[56:57], v17, s[56:59], s47 offen sc1
    s_add_u32 s47, s46, 1048576
    buffer_load_dwordx2 v[58:59], v17, s[56:59], s47 offen sc1
    s_add_u32 s47, s46, 1114112
    buffer_load_dwordx2 v[60:61], v17, s[56:59], s47 offen sc1
    s_add_u32 s47, s46, 1179648
    buffer_load_dwordx2 v[62:63], v17, s[56:59], s47 offen sc1
    s_add_u32 s47, s46, 1245184
    buffer_load_dwordx2 v[224:225], v17, s[56:59], s47 offen sc1
    s_add_u32 s47, s46, 1310720
    buffer_load_dwordx2 v[226:227], v17, s[56:59], s47 offen sc1
    s_add_u32 s47, s46, 1376256
    buffer_load_dwordx2 v[228:229], v17, s[56:59], s47 offen sc1
    s_add_u32 s47, s46, 1441792
    buffer_load_dwordx2 v[230:231], v17, s[56:59], s47 offen sc1
    s_add_u32 s47, s46, 1507328
    buffer_load_dwordx2 v[232:233], v17, s[56:59], s47 offen sc1
    s_add_u32 s47, s46, 1572864
    buffer_load_dwordx2 v[234:235], v17, s[56:59], s47 offen sc1
    s_add_u32 s47, s46, 1638400
    buffer_load_dwordx2 v[236:237], v17, s[56:59], s47 offen sc1
    s_add_u32 s47, s46, 1703936
    buffer_load_dwordx2 v[238:239], v17, s[56:59], s47 offen sc1
    s_add_u32 s47, s46, 1769472
    buffer_load_dwordx2 v[240:241], v17, s[56:59], s47 offen sc1
    s_add_u32 s47, s46, 1835008
    buffer_load_dwordx2 v[242:243], v17, s[56:59], s47 offen sc1
    s_add_u32 s47, s46, 1900544
    buffer_load_dwordx2 v[244:245], v17, s[56:59], s47 offen sc1
    s_add_u32 s47, s46, 1966080
    buffer_load_dwordx2 v[246:247], v17, s[56:59], s47 offen sc1
    s_add_u32 s47, s46, 2031616
    buffer_load_dwordx2 v[248:249], v17, s[56:59], s47 offen sc1
    s_waitcnt vmcnt(32)
    v_perm_b32 v192, v68, v64, s43
    v_perm_b32 v196, v68, v64, s44
    v_perm_b32 v200, v69, v65, s43
    v_perm_b32 v204, v69, v65, s44
    v_perm_b32 v208, v70, v66, s43
    v_perm_b32 v212, v70, v66, s44
    v_perm_b32 v216, v71, v67, s43
    v_perm_b32 v220, v71, v67, s44
    v_perm_b32 v193, v76, v72, s43
    v_perm_b32 v197, v76, v72, s44
    v_perm_b32 v201, v77, v73, s43
    v_perm_b32 v205, v77, v73, s44
    v_perm_b32 v209, v78, v74, s43
    v_perm_b32 v213, v78, v74, s44
    v_perm_b32 v217, v79, v75, s43
    v_perm_b32 v221, v79, v75, s44
    v_perm_b32 v194, v84, v80, s43
    v_perm_b32 v198, v84, v80, s44
    v_perm_b32 v202, v85, v81, s43
    v_perm_b32 v206, v85, v81, s44
    v_perm_b32 v210, v86, v82, s43
    v_perm_b32 v214, v86, v82, s44
    v_perm_b32 v218, v87, v83, s43
    v_perm_b32 v222, v87, v83, s44
    v_perm_b32 v195, v92, v88, s43
    v_perm_b32 v199, v92, v88, s44
    v_perm_b32 v203, v93, v89, s43
    v_perm_b32 v207, v93, v89, s44
    v_perm_b32 v211, v94, v90, s43
    v_perm_b32 v215, v94, v90, s44
    v_perm_b32 v219, v95, v91, s43
    v_perm_b32 v223, v95, v91, s44
    v_perm_b32 v64, v100, v96, s43
    v_perm_b32 v68, v100, v96, s44
    v_perm_b32 v72, v101, v97, s43
    v_perm_b32 v76, v101, v97, s44
    v_perm_b32 v80, v102, v98, s43
    v_perm_b32 v84, v102, v98, s44
    v_perm_b32 v88, v103, v99, s43
    v_perm_b32 v92, v103, v99, s44
    v_perm_b32 v65, v108, v104, s43
    v_perm_b32 v69, v108, v104, s44
    v_perm_b32 v73, v109, v105, s43
    v_perm_b32 v77, v109, v105, s44
    v_perm_b32 v81, v110, v106, s43
    v_perm_b32 v85, v110, v106, s44
    v_perm_b32 v89, v111, v107, s43
    v_perm_b32 v93, v111, v107, s44
    v_perm_b32 v66, v116, v112, s43
    v_perm_b32 v70, v116, v112, s44
    v_perm_b32 v74, v117, v113, s43
    v_perm_b32 v78, v117, v113, s44
    v_perm_b32 v82, v118, v114, s43
    v_perm_b32 v86, v118, v114, s44
    v_perm_b32 v90, v119, v115, s43
    v_perm_b32 v94, v119, v115, s44
    v_perm_b32 v67, v124, v120, s43
    v_perm_b32 v71, v124, v120, s44
    v_perm_b32 v75, v125, v121, s43
    v_perm_b32 v79, v125, v121, s44
    v_perm_b32 v83, v126, v122, s43
    v_perm_b32 v87, v126, v122, s44
    v_perm_b32 v91, v127, v123, s43
    v_perm_b32 v95, v127, v123, s44
    v_perm_b32 v96, v132, v128, s43
    v_perm_b32 v100, v132, v128, s44
    v_perm_b32 v104, v133, v129, s43
    v_perm_b32 v108, v133, v129, s44
    v_perm_b32 v112, v134, v130, s43
    v_perm_b32 v116, v134, v130, s44
    v_perm_b32 v120, v135, v131, s43
    v_perm_b32 v124, v135, v131, s44
    v_perm_b32 v97, v140, v136, s43
    v_perm_b32 v101, v140, v136, s44
    v_perm_b32 v105, v141, v137, s43
    v_perm_b32 v109, v141, v137, s44
    v_perm_b32 v113, v142, v138, s43
    v_perm_b32 v117, v142, v138, s44
    v_perm_b32 v121, v143, v139, s43
    v_perm_b32 v125, v143, v139, s44
    v_perm_b32 v98, v148, v144, s43
    v_perm_b32 v102, v148, v144, s44
    v_perm_b32 v106, v149, v145, s43
    v_perm_b32 v110, v149, v145, s44
    v_perm_b32 v114, v150, v146, s43
    v_perm_b32 v118, v150, v146, s44
    v_perm_b32 v122, v151, v147, s43
    v_perm_b32 v126, v151, v147, s44
    v_perm_b32 v99, v156, v152, s43
    v_perm_b32 v103, v156, v152, s44
    v_perm_b32 v107, v157, v153, s43
    v_perm_b32 v111, v157, v153, s44
    v_perm_b32 v115, v158, v154, s43
    v_perm_b32 v119, v158, v154, s44
    v_perm_b32 v123, v159, v155, s43
    v_perm_b32 v127, v159, v155, s44
    v_perm_b32 v128, v164, v160, s43
    v_perm_b32 v132, v164, v160, s44
    v_perm_b32 v136, v165, v161, s43
    v_perm_b32 v140, v165, v161, s44
    v_perm_b32 v144, v166, v162, s43
    v_perm_b32 v148, v166, v162, s44
    v_perm_b32 v152, v167, v163, s43
    v_perm_b32 v156, v167, v163, s44
    v_perm_b32 v129, v172, v168, s43
    v_perm_b32 v133, v172, v168, s44
    v_perm_b32 v137, v173, v169, s43
    v_perm_b32 v141, v173, v169, s44
    v_perm_b32 v145, v174, v170, s43
    v_perm_b32 v149, v174, v170, s44
    v_perm_b32 v153, v175, v171, s43
    v_perm_b32 v157, v175, v171, s44
    v_perm_b32 v130, v180, v176, s43
    v_perm_b32 v134, v180, v176, s44
    v_perm_b32 v138, v181, v177, s43
    v_perm_b32 v142, v181, v177, s44
    v_perm_b32 v146, v182, v178, s43
    v_perm_b32 v150, v182, v178, s44
    v_perm_b32 v154, v183, v179, s43
    v_perm_b32 v158, v183, v179, s44
    v_perm_b32 v131, v188, v184, s43
    v_perm_b32 v135, v188, v184, s44
    v_perm_b32 v139, v189, v185, s43
    v_perm_b32 v143, v189, v185, s44
    v_perm_b32 v147, v190, v186, s43
    v_perm_b32 v151, v190, v186, s44
    v_perm_b32 v155, v191, v187, s43
    v_perm_b32 v159, v191, v187, s44
    s_branch L_pc_123
L_pf_121:
    s_bitcmp1_b32 s96, 0
    s_cbranch_scc0 L_pk_124
    s_add_u32 s47, s46, 0
    buffer_load_dwordx2 v[24:25], v17, s[56:59], s47 offen sc1
L_pk_124:
    s_bitcmp1_b32 s96, 1
    s_cbranch_scc0 L_pk_125
    s_add_u32 s47, s46, 65536
    buffer_load_dwordx2 v[26:27], v17, s[56:59], s47 offen sc1
L_pk_125:
    s_bitcmp1_b32 s96, 2
    s_cbranch_scc0 L_pk_126
    s_add_u32 s47, s46, 131072
    buffer_load_dwordx2 v[28:29], v17, s[56:59], s47 offen sc1
L_pk_126:
    s_bitcmp1_b32 s96, 3
    s_cbranch_scc0 L_pk_127
    s_add_u32 s47, s46, 196608
    buffer_load_dwordx2 v[30:31], v17, s[56:59], s47 offen sc1
L_pk_127:
    s_bitcmp1_b32 s96, 4
    s_cbranch_scc0 L_pk_128
    s_add_u32 s47, s46, 262144
    buffer_load_dwordx2 v[32:33], v17, s[56:59], s47 offen sc1
L_pk_128:
    s_bitcmp1_b32 s96, 5
    s_cbranch_scc0 L_pk_129
    s_add_u32 s47, s46, 327680
    buffer_load_dwordx2 v[34:35], v17, s[56:59], s47 offen sc1
L_pk_129:
    s_bitcmp1_b32 s96, 6
    s_cbranch_scc0 L_pk_130
    s_add_u32 s47, s46, 393216
    buffer_load_dwordx2 v[36:37], v17, s[56:59], s47 offen sc1
L_pk_130:
    s_bitcmp1_b32 s96, 7
    s_cbranch_scc0 L_pk_131
    s_add_u32 s47, s46, 458752
    buffer_load_dwordx2 v[38:39], v17, s[56:59], s47 offen sc1
L_pk_131:
    s_bitcmp1_b32 s96, 8
    s_cbranch_scc0 L_pk_132
    s_add_u32 s47, s46, 524288
    buffer_load_dwordx2 v[40:41], v17, s[56:59], s47 offen sc1
L_pk_132:
    s_bitcmp1_b32 s96, 9
    s_cbranch_scc0 L_pk_133
    s_add_u32 s47, s46, 589824
    buffer_load_dwordx2 v[42:43], v17, s[56:59], s47 offen sc1
L_pk_133:
    s_bitcmp1_b32 s96, 10
    s_cbranch_scc0 L_pk_134
    s_add_u32 s47, s46, 655360
    buffer_load_dwordx2 v[44:45], v17, s[56:59], s47 offen sc1
L_pk_134:
    s_bitcmp1_b32 s96, 11
    s_cbranch_scc0 L_pk_135
    s_add_u32 s47, s46, 720896
    buffer_load_dwordx2 v[48:49], v17, s[56:59], s47 offen sc1
L_pk_135:
    s_bitcmp1_b32 s96, 12
    s_cbranch_scc0 L_pk_136
    s_add_u32 s47, s46, 786432
    buffer_load_dwordx2 v[50:51], v17, s[56:59], s47 offen sc1
L_pk_136:
    s_bitcmp1_b32 s96, 13
    s_cbranch_scc0 L_pk_137
    s_add_u32 s47, s46, 851968
    buffer_load_dwordx2 v[52:53], v17, s[56:59], s47 offen sc1
L_pk_137:
    s_bitcmp1_b32 s96, 14
    s_cbranch_scc0 L_pk_138
    s_add_u32 s47, s46, 917504
    buffer_load_dwordx2 v[54:55], v17, s[56:59], s47 offen sc1
L_pk_138:
    s_bitcmp1_b32 s96, 15
    s_cbranch_scc0 L_pk_139
    s_add_u32 s47, s46, 983040
    buffer_load_dwordx2 v[56:57], v17, s[56:59], s47 offen sc1
L_pk_139:
    s_bitcmp1_b32 s96, 16
    s_cbranch_scc0 L_pk_140
    s_add_u32 s47, s46, 1048576
    buffer_load_dwordx2 v[58:59], v17, s[56:59], s47 offen sc1
L_pk_140:
    s_bitcmp1_b32 s96, 17
    s_cbranch_scc0 L_pk_141
    s_add_u32 s47, s46, 1114112
    buffer_load_dwordx2 v[60:61], v17, s[56:59], s47 offen sc1
L_pk_141:
    s_bitcmp1_b32 s96, 18
    s_cbranch_scc0 L_pk_142
    s_add_u32 s47, s46, 1179648
    buffer_load_dwordx2 v[62:63], v17, s[56:59], s47 offen sc1
L_pk_142:
    s_bitcmp1_b32 s96, 19
    s_cbranch_scc0 L_pk_143
    s_add_u32 s47, s46, 1245184
    buffer_load_dwordx2 v[224:225], v17, s[56:59], s47 offen sc1
L_pk_143:
    s_bitcmp1_b32 s96, 20
    s_cbranch_scc0 L_pk_144
    s_add_u32 s47, s46, 1310720
    buffer_load_dwordx2 v[226:227], v17, s[56:59], s47 offen sc1
L_pk_144:
    s_bitcmp1_b32 s96, 21
    s_cbranch_scc0 L_pk_145
    s_add_u32 s47, s46, 1376256
    buffer_load_dwordx2 v[228:229], v17, s[56:59], s47 offen sc1
L_pk_145:
    s_bitcmp1_b32 s96, 22
    s_cbranch_scc0 L_pk_146
    s_add_u32 s47, s46, 1441792
    buffer_load_dwordx2 v[230:231], v17, s[56:59], s47 offen sc1
L_pk_146:
    s_bitcmp1_b32 s96, 23
    s_cbranch_scc0 L_pk_147
    s_add_u32 s47, s46, 1507328
    buffer_load_dwordx2 v[232:233], v17, s[56:59], s47 offen sc1
L_pk_147:
    s_bitcmp1_b32 s96, 24
    s_cbranch_scc0 L_pk_148
    s_add_u32 s47, s46, 1572864
    buffer_load_dwordx2 v[234:235], v17, s[56:59], s47 offen sc1
L_pk_148:
    s_bitcmp1_b32 s96, 25
    s_cbranch_scc0 L_pk_149
    s_add_u32 s47, s46, 1638400
    buffer_load_dwordx2 v[236:237], v17, s[56:59], s47 offen sc1
L_pk_149:
    s_bitcmp1_b32 s96, 26
    s_cbranch_scc0 L_pk_150
    s_add_u32 s47, s46, 1703936
    buffer_load_dwordx2 v[238:239], v17, s[56:59], s47 offen sc1
L_pk_150:
    s_bitcmp1_b32 s96, 27
    s_cbranch_scc0 L_pk_151
    s_add_u32 s47, s46, 1769472
    buffer_load_dwordx2 v[240:241], v17, s[56:59], s47 offen sc1
L_pk_151:
    s_bitcmp1_b32 s96, 28
    s_cbranch_scc0 L_pk_152
    s_add_u32 s47, s46, 1835008
    buffer_load_dwordx2 v[242:243], v17, s[56:59], s47 offen sc1
L_pk_152:
    s_bitcmp1_b32 s96, 29
    s_cbranch_scc0 L_pk_153
    s_add_u32 s47, s46, 1900544
    buffer_load_dwordx2 v[244:245], v17, s[56:59], s47 offen sc1
L_pk_153:
    s_bitcmp1_b32 s96, 30
    s_cbranch_scc0 L_pk_154
    s_add_u32 s47, s46, 1966080
    buffer_load_dwordx2 v[246:247], v17, s[56:59], s47 offen sc1
L_pk_154:
    s_bitcmp1_b32 s96, 31
    s_cbranch_scc0 L_pk_155
    s_add_u32 s47, s46, 2031616
    buffer_load_dwordx2 v[248:249], v17, s[56:59], s47 offen sc1
L_pk_155:
L_pc_123:
    s_waitcnt vmcnt(0)
    s_mov_b32 s97, 0
    v_and_b32 v19, v24, v25
    v_and_b32 v19, 1, v19
    v_cmp_eq_u32 s[4:5], 0, v19
    v_and_b32 v19, v26, v27
    v_and_b32 v19, 1, v19
    v_cmp_eq_u32 s[6:7], 0, v19
    v_and_b32 v19, v28, v29
    v_and_b32 v19, 1, v19
    v_cmp_eq_u32 s[8:9], 0, v19
    v_and_b32 v19, v30, v31
    v_and_b32 v19, 1, v19
    v_cmp_eq_u32 s[10:11], 0, v19
    v_and_b32 v19, v32, v33
    v_and_b32 v19, 1, v19
    v_cmp_eq_u32 s[12:13], 0, v19
    v_and_b32 v19, v34, v35
    v_and_b32 v19, 1, v19
    v_cmp_eq_u32 s[14:15], 0, v19
    s_cmp_lg_u64 s[4:5], 0
    s_cselect_b32 s48, 0x1, 0
    s_or_b32 s97, s97, s48
    s_cmp_lg_u64 s[6:7], 0
    s_cselect_b32 s48, 0x2, 0
    s_or_b32 s97, s97, s48
    s_cmp_lg_u64 s[8:9], 0
    s_cselect_b32 s48, 0x4, 0
    s_or_b32 s97, s97, s48
    s_cmp_lg_u64 s[10:11], 0
    s_cselect_b32 s48, 0x8, 0
    s_or_b32 s97, s97, s48
    s_cmp_lg_u64 s[12:13], 0
    s_cselect_b32 s48, 0x10, 0
    s_or_b32 s97, s97, s48
    s_cmp_lg_u64 s[14:15], 0
    s_cselect_b32 s48, 0x20, 0
    s_or_b32 s97, s97, s48
    v_and_b32 v19, v36, v37
    v_and_b32 v19, 1, v19
    v_cmp_eq_u32 s[4:5], 0, v19
    v_and_b32 v19, v38, v39
    v_and_b32 v19, 1, v19
    v_cmp_eq_u32 s[6:7], 0, v19
    v_and_b32 v19, v40, v41
    v_and_b32 v19, 1, v19
    v_cmp_eq_u32 s[8:9], 0, v19
    v_and_b32 v19, v42, v43
    v_and_b32 v19, 1, v19
    v_cmp_eq_u32 s[10:11], 0, v19
    v_and_b32 v19, v44, v45
    v_and_b32 v19, 1, v19
    v_cmp_eq_u32 s[12:13], 0, v19
    v_and_b32 v19, v48, v49
    v_and_b32 v19, 1, v19
    v_cmp_eq_u32 s[14:15], 0, v19
    s_cmp_lg_u64 s[4:5], 0
    s_cselect_b32 s48, 0x40, 0
    s_or_b32 s97, s97, s48
    s_cmp_lg_u64 s[6:7], 0
    s_cselect_b32 s48, 0x80, 0
    s_or_b32 s97, s97, s48
    s_cmp_lg_u64 s[8:9], 0
    s_cselect_b32 s48, 0x100, 0
    s_or_b32 s97, s97, s48
    s_cmp_lg_u64 s[10:11], 0
    s_cselect_b32 s48, 0x200, 0
    s_or_b32 s97, s97, s48
    s_cmp_lg_u64 s[12:13], 0
    s_cselect_b32 s48, 0x400, 0
    s_or_b32 s97, s97, s48
    s_cmp_lg_u64 s[14:15], 0
    s_cselect_b32 s48, 0x800, 0
    s_or_b32 s97, s97, s48
    v_and_b32 v19, v50, v51
    v_and_b32 v19, 1, v19
    v_cmp_eq_u32 s[4:5], 0, v19
    v_and_b32 v19, v52, v53
    v_and_b32 v19, 1, v19
    v_cmp_eq_u32 s[6:7], 0, v19
    v_and_b32 v19, v54, v55
    v_and_b32 v19, 1, v19
    v_cmp_eq_u32 s[8:9], 0, v19
    v_and_b32 v19, v56, v57
    v_and_b32 v19, 1, v19
    v_cmp_eq_u32 s[10:11], 0, v19
    v_and_b32 v19, v58, v59
    v_and_b32 v19, 1, v19
    v_cmp_eq_u32 s[12:13], 0, v19
    v_and_b32 v19, v60, v61
    v_and_b32 v19, 1, v19
    v_cmp_eq_u32 s[14:15], 0, v19
    s_cmp_lg_u64 s[4:5], 0
    s_cselect_b32 s48, 0x1000, 0
    s_or_b32 s97, s97, s48
    s_cmp_lg_u64 s[6:7], 0
    s_cselect_b32 s48, 0x2000, 0
    s_or_b32 s97, s97, s48
    s_cmp_lg_u64 s[8:9], 0
    s_cselect_b32 s48, 0x4000, 0
    s_or_b32 s97, s97, s48
    s_cmp_lg_u64 s[10:11], 0
    s_cselect_b32 s48, 0x8000, 0
    s_or_b32 s97, s97, s48
    s_cmp_lg_u64 s[12:13], 0
    s_cselect_b32 s48, 0x10000, 0
    s_or_b32 s97, s97, s48
    s_cmp_lg_u64 s[14:15], 0
    s_cselect_b32 s48, 0x20000, 0
    s_or_b32 s97, s97, s48
    v_and_b32 v19, v62, v63
    v_and_b32 v19, 1, v19
    v_cmp_eq_u32 s[4:5], 0, v19
    v_and_b32 v19, v224, v225
    v_and_b32 v19, 1, v19
    v_cmp_eq_u32 s[6:7], 0, v19
    v_and_b32 v19, v226, v227
    v_and_b32 v19, 1, v19
    v_cmp_eq_u32 s[8:9], 0, v19
    v_and_b32 v19, v228, v229
    v_and_b32 v19, 1, v19
    v_cmp_eq_u32 s[10:11], 0, v19
    v_and_b32 v19, v230, v231
    v_and_b32 v19, 1, v19
    v_cmp_eq_u32 s[12:13], 0, v19
    v_and_b32 v19, v232, v233
    v_and_b32 v19, 1, v19
    v_cmp_eq_u32 s[14:15], 0, v19
    s_cmp_lg_u64 s[4:5], 0
    s_cselect_b32 s48, 0x40000, 0
    s_or_b32 s97, s97, s48
    s_cmp_lg_u64 s[6:7], 0
    s_cselect_b32 s48, 0x80000, 0
    s_or_b32 s97, s97, s48
    s_cmp_lg_u64 s[8:9], 0
    s_cselect_b32 s48, 0x100000, 0
    s_or_b32 s97, s97, s48
    s_cmp_lg_u64 s[10:11], 0
    s_cselect_b32 s48, 0x200000, 0
    s_or_b32 s97, s97, s48
    s_cmp_lg_u64 s[12:13], 0
    s_cselect_b32 s48, 0x400000, 0
    s_or_b32 s97, s97, s48
    s_cmp_lg_u64 s[14:15], 0
    s_cselect_b32 s48, 0x800000, 0
    s_or_b32 s97, s97, s48
    v_and_b32 v19, v234, v235
    v_and_b32 v19, 1, v19
    v_cmp_eq_u32 s[4:5], 0, v19
    v_and_b32 v19, v236, v237
    v_and_b32 v19, 1, v19
    v_cmp_eq_u32 s[6:7], 0, v19
    v_and_b32 v19, v238, v239
    v_and_b32 v19, 1, v19
    v_cmp_eq_u32 s[8:9], 0, v19
    v_and_b32 v19, v240, v241
    v_and_b32 v19, 1, v19
    v_cmp_eq_u32 s[10:11], 0, v19
    v_and_b32 v19, v242, v243
    v_and_b32 v19, 1, v19
    v_cmp_eq_u32 s[12:13], 0, v19
    v_and_b32 v19, v244, v245
    v_and_b32 v19, 1, v19
    v_cmp_eq_u32 s[14:15], 0, v19
    s_cmp_lg_u64 s[4:5], 0
    s_cselect_b32 s48, 0x1000000, 0
    s_or_b32 s97, s97, s48
    s_cmp_lg_u64 s[6:7], 0
    s_cselect_b32 s48, 0x2000000, 0
    s_or_b32 s97, s97, s48
    s_cmp_lg_u64 s[8:9], 0
    s_cselect_b32 s48, 0x4000000, 0
    s_or_b32 s97, s97, s48
    s_cmp_lg_u64 s[10:11], 0
    s_cselect_b32 s48, 0x8000000, 0
    s_or_b32 s97, s97, s48
    s_cmp_lg_u64 s[12:13], 0
    s_cselect_b32 s48, 0x10000000, 0
    s_or_b32 s97, s97, s48
    s_cmp_lg_u64 s[14:15], 0
    s_cselect_b32 s48, 0x20000000, 0
    s_or_b32 s97, s97, s48
    v_and_b32 v19, v246, v247
    v_and_b32 v19, 1, v19
    v_cmp_eq_u32 s[4:5], 0, v19
    v_and_b32 v19, v248, v249
    v_and_b32 v19, 1, v19
    v_cmp_eq_u32 s[6:7], 0, v19
    s_cmp_lg_u64 s[4:5], 0
    s_cselect_b32 s48, 0x40000000, 0
    s_or_b32 s97, s97, s48
    s_cmp_lg_u64 s[6:7], 0
    s_cselect_b32 s48, 0x80000000, 0
    s_or_b32 s97, s97, s48
    s_mov_b32 s96, s97
    s_cmp_eq_u32 s96, 0
    s_cbranch_scc1 L_pfd_122
    s_sleep 2
    s_sub_u32 s49, s49, 1
    s_cmp_gt_i32 s49, 0
    s_cbranch_scc1 L_pf_121
L_pfd_122:
    v_add_f32 v24, v24, v26
    v_add_f32 v25, v25, v27
    v_add_f32 v24, v24, v28
    v_add_f32 v25, v25, v29
    v_add_f32 v24, v24, v30
    v_add_f32 v25, v25, v31
    v_add_f32 v24, v24, v32
    v_add_f32 v25, v25, v33
    v_add_f32 v24, v24, v34
    v_add_f32 v25, v25, v35
    v_add_f32 v24, v24, v36
    v_add_f32 v25, v25, v37
    v_add_f32 v24, v24, v38
    v_add_f32 v25, v25, v39
    v_add_f32 v24, v24, v40
    v_add_f32 v25, v25, v41
    v_add_f32 v24, v24, v42
    v_add_f32 v25, v25, v43
    v_add_f32 v24, v24, v44
    v_add_f32 v25, v25, v45
    v_add_f32 v24, v24, v48
    v_add_f32 v25, v25, v49
    v_add_f32 v24, v24, v50
    v_add_f32 v25, v25, v51
    v_add_f32 v24, v24, v52
    v_add_f32 v25, v25, v53
    v_add_f32 v24, v24, v54
    v_add_f32 v25, v25, v55
    v_add_f32 v24, v24, v56
    v_add_f32 v25, v25, v57
    v_add_f32 v24, v24, v58
    v_add_f32 v25, v25, v59
    v_add_f32 v24, v24, v60
    v_add_f32 v25, v25, v61
    v_add_f32 v24, v24, v62
    v_add_f32 v25, v25, v63
    v_add_f32 v24, v24, v224
    v_add_f32 v25, v25, v225
    v_add_f32 v24, v24, v226
    v_add_f32 v25, v25, v227
    v_add_f32 v24, v24, v228
    v_add_f32 v25, v25, v229
    v_add_f32 v24, v24, v230
    v_add_f32 v25, v25, v231
    v_add_f32 v24, v24, v232
    v_add_f32 v25, v25, v233
    v_add_f32 v24, v24, v234
    v_add_f32 v25, v25, v235
    v_add_f32 v24, v24, v236
    v_add_f32 v25, v25, v237
    v_add_f32 v24, v24, v238
    v_add_f32 v25, v25, v239
    v_add_f32 v24, v24, v240
    v_add_f32 v25, v25, v241
    v_add_f32 v24, v24, v242
    v_add_f32 v25, v25, v243
    v_add_f32 v24, v24, v244
    v_add_f32 v25, v25, v245
    v_add_f32 v24, v24, v246
    v_add_f32 v25, v25, v247
    v_add_f32 v24, v24, v248
    v_add_f32 v25, v25, v249
    v_cvt_pk_bf16_f32 v24, v24, v24
    v_lshlrev_b32 v24, 16, v24
    v_cvt_pk_bf16_f32 v25, v25, v25
    v_lshlrev_b32 v25, 16, v25
    v_add_f32 v6, v6, v24
    v_add_f32 v7, v7, v25
    v_cvt_pk_bf16_f32 v6, v6, v6
    v_lshlrev_b32 v6, 16, v6
    v_cvt_pk_bf16_f32 v7, v7, v7
    v_lshlrev_b32 v7, 16, v7
    v_subrev_u32 v18, 256, v0
    v_lshlrev_b32 v18, 3, v18
    ds_write_b64 v18, v[6:7] offset:512
    s_lshl_b32 s46, s45, 2
    v_mov_b32 v19, s46
    s_waitcnt lgkmcnt(0)
    v_mov_b32 v20, 4
    ds_write_b32 v19, v20 offset:0
    s_nop 1
L_lw_156:
    ds_read_b128 v[8:11], v5 offset:0
    s_waitcnt lgkmcnt(0)
    v_min_u32 v8, v8, v9
    v_min3_u32 v8, v8, v10, v11
    v_cmp_gt_u32 vcc, 4, v8
    s_nop 1
    s_cbranch_vccz L_lwd_157
    s_sleep 1
    s_sub_u32 s49, s49, 1
    s_cmp_gt_i32 s49, 0
    s_cbranch_scc1 L_lw_156
L_lwd_157:
    v_lshlrev_b32 v18, 5, v2
    ds_read_b128 v[24:27], v18 offset:512
    ds_read_b128 v[28:31], v18 offset:528
    s_waitcnt lgkmcnt(0)
    v_add_f32 v20, v24, v25
    v_add_f32 v20, v20, v26
    v_add_f32 v20, v20, v27
    v_add_f32 v20, v20, v28
    v_add_f32 v20, v20, v29
    v_add_f32 v20, v20, v30
    v_add_f32 v20, v20, v31
    s_nop 1
    v_add_f32_dpp v20, v20, v20 quad_perm:[1,0,3,2] row_mask:0xf bank_mask:0xf
    s_nop 1
    v_add_f32_dpp v20, v20, v20 quad_perm:[2,3,0,1] row_mask:0xf bank_mask:0xf
    s_nop 1
    v_add_f32_dpp v20, v20, v20 row_half_mirror row_mask:0xf bank_mask:0xf
    s_nop 1
    v_add_f32_dpp v20, v20, v20 row_mirror row_mask:0xf bank_mask:0xf
    v_mov_b32 v22, v20
    s_nop 1
    v_permlane16_swap_b32 v20, v22
    v_add_f32 v20, v20, v22
    v_mov_b32 v22, v20
    s_nop 1
    v_permlane32_swap_b32 v20, v22
    v_add_f32 v20, v20, v22
    v_mul_f32 v20, 0x3b000000, v20
    v_mov_b32 v21, 0
    v_sub_f32 v22, v24, v20
    v_fma_f32 v21, v22, v22, v21
    v_sub_f32 v22, v25, v20
    v_fma_f32 v21, v22, v22, v21
    v_sub_f32 v22, v26, v20
    v_fma_f32 v21, v22, v22, v21
    v_sub_f32 v22, v27, v20
    v_fma_f32 v21, v22, v22, v21
    v_sub_f32 v22, v28, v20
    v_fma_f32 v21, v22, v22, v21
    v_sub_f32 v22, v29, v20
    v_fma_f32 v21, v22, v22, v21
    v_sub_f32 v22, v30, v20
    v_fma_f32 v21, v22, v22, v21
    v_sub_f32 v22, v31, v20
    v_fma_f32 v21, v22, v22, v21
    s_nop 1
    v_add_f32_dpp v21, v21, v21 quad_perm:[1,0,3,2] row_mask:0xf bank_mask:0xf
    s_nop 1
    v_add_f32_dpp v21, v21, v21 quad_perm:[2,3,0,1] row_mask:0xf bank_mask:0xf
    s_nop 1
    v_add_f32_dpp v21, v21, v21 row_half_mirror row_mask:0xf bank_mask:0xf
    s_nop 1
    v_add_f32_dpp v21, v21, v21 row_mirror row_mask:0xf bank_mask:0xf
    v_mov_b32 v22, v21
    s_nop 1
    v_permlane16_swap_b32 v21, v22
    v_add_f32 v21, v21, v22
    v_mov_b32 v22, v21
    s_nop 1
    v_permlane32_swap_b32 v21, v22
    v_add_f32 v21, v21, v22
    v_mul_f32 v21, 0x3b000000, v21
    v_cvt_pk_bf16_f32 v20, v20, v20
    v_lshlrev_b32 v20, 16, v20
    v_cvt_pk_bf16_f32 v21, v21, v21
    v_lshlrev_b32 v21, 16, v21
    v_add_f32 v21, 0x3727c5ac, v21
    v_cvt_pk_bf16_f32 v21, v21, v21
    v_lshlrev_b32 v21, 16, v21
    v_sqrt_f32 v21, v21
    s_nop 0
    v_cvt_pk_bf16_f32 v21, v21, v21
    v_lshlrev_b32 v21, 16, v21
    v_rcp_f32 v22, v21
    v_sub_f32 v26, v6, v20
    v_cvt_pk_bf16_f32 v26, v26, v26
    v_lshlrev_b32 v26, 16, v26
    v_mul_f32 v24, v26, v22
    v_fma_f32 v27, -v24, v21, v26
    v_fma_f32 v24, v27, v22, v24
    v_sub_f32 v26, v7, v20
    v_cvt_pk_bf16_f32 v26, v26, v26
    v_lshlrev_b32 v26, 16, v26
    v_mul_f32 v25, v26, v22
    v_fma_f32 v27, -v25, v21, v26
    v_fma_f32 v25, v27, v22, v25
    v_cvt_pk_bf16_f32 v28, v24, v25
    v_lshrrev_b32 v29, 4, v2
    v_lshlrev_b32 v29, 6, v29
    v_and_b32 v30, 1, v2
    v_lshl_add_u32 v29, v30, 5, v29
    v_bfe_u32 v30, v2, 1, 3
    v_lshl_add_u32 v29, v30, 1, v29
    s_lshl_b32 s46, s45, 8
    v_add_u32 v29, s46, v29
    ds_write_b16 v29, v28 offset:5632
    ds_write_b16_d16_hi v29, v28 offset:5648
    s_waitcnt lgkmcnt(0)
    ds_read_b128 v[48:51], v15 offset:5632
    ds_read_b128 v[52:55], v15 offset:5696
    ds_read_b128 v[56:59], v15 offset:5760
    ds_read_b128 v[60:63], v15 offset:5824
    v_mov_b32 v224, 0
    v_mov_b32 v225, 0
    v_mov_b32 v226, 0
    v_mov_b32 v227, 0
    v_mov_b32 v228, 0
    v_mov_b32 v229, 0
    v_mov_b32 v230, 0
    v_mov_b32 v231, 0
    v_mov_b32 v232, 0
    v_mov_b32 v233, 0
    v_mov_b32 v234, 0
    v_mov_b32 v235, 0
    v_mov_b32 v236, 0
    v_mov_b32 v237, 0
    v_mov_b32 v238, 0
    v_mov_b32 v239, 0
    v_mov_b32 v240, 0
    v_mov_b32 v241, 0
    v_mov_b32 v242, 0
    v_mov_b32 v243, 0
    v_mov_b32 v244, 0
    v_mov_b32 v245, 0
    v_mov_b32 v246, 0
    v_mov_b32 v247, 0
    v_mov_b32 v248, 0
    v_mov_b32 v249, 0
    v_mov_b32 v250, 0
    v_mov_b32 v251, 0
    v_mov_b32 v252, 0
    v_mov_b32 v253, 0
    v_mov_b32 v254, 0
    v_mov_b32 v255, 0
    s_waitcnt lgkmcnt(0)
    v_mfma_f32_16x16x32_bf16 v[224:227], v[192:195], v[48:51], v[224:227]
    v_mfma_f32_16x16x32_bf16 v[228:231], v[196:199], v[48:51], v[228:231]
    v_mfma_f32_16x16x32_bf16 v[232:235], v[200:203], v[48:51], v[232:235]
    v_mfma_f32_16x16x32_bf16 v[236:239], v[204:207], v[48:51], v[236:239]
    v_mfma_f32_16x16x32_bf16 v[240:243], v[208:211], v[48:51], v[240:243]
    v_mfma_f32_16x16x32_bf16 v[244:247], v[212:215], v[48:51], v[244:247]
    v_mfma_f32_16x16x32_bf16 v[248:251], v[216:219], v[48:51], v[248:251]
    v_mfma_f32_16x16x32_bf16 v[252:255], v[220:223], v[48:51], v[252:255]
    v_mfma_f32_16x16x32_bf16 v[224:227], v[64:67], v[52:55], v[224:227]
    v_mfma_f32_16x16x32_bf16 v[228:231], v[68:71], v[52:55], v[228:231]
    v_mfma_f32_16x16x32_bf16 v[232:235], v[72:75], v[52:55], v[232:235]
    v_mfma_f32_16x16x32_bf16 v[236:239], v[76:79], v[52:55], v[236:239]
    v_mfma_f32_16x16x32_bf16 v[240:243], v[80:83], v[52:55], v[240:243]
    v_mfma_f32_16x16x32_bf16 v[244:247], v[84:87], v[52:55], v[244:247]
    v_mfma_f32_16x16x32_bf16 v[248:251], v[88:91], v[52:55], v[248:251]
    v_mfma_f32_16x16x32_bf16 v[252:255], v[92:95], v[52:55], v[252:255]
    v_mfma_f32_16x16x32_bf16 v[224:227], v[96:99], v[56:59], v[224:227]
    v_mfma_f32_16x16x32_bf16 v[228:231], v[100:103], v[56:59], v[228:231]
    v_mfma_f32_16x16x32_bf16 v[232:235], v[104:107], v[56:59], v[232:235]
    v_mfma_f32_16x16x32_bf16 v[236:239], v[108:111], v[56:59], v[236:239]
    v_mfma_f32_16x16x32_bf16 v[240:243], v[112:115], v[56:59], v[240:243]
    v_mfma_f32_16x16x32_bf16 v[244:247], v[116:119], v[56:59], v[244:247]
    v_mfma_f32_16x16x32_bf16 v[248:251], v[120:123], v[56:59], v[248:251]
    v_mfma_f32_16x16x32_bf16 v[252:255], v[124:127], v[56:59], v[252:255]
    v_mfma_f32_16x16x32_bf16 v[224:227], v[128:131], v[60:63], v[224:227]
    v_mfma_f32_16x16x32_bf16 v[228:231], v[132:135], v[60:63], v[228:231]
    v_mfma_f32_16x16x32_bf16 v[232:235], v[136:139], v[60:63], v[232:235]
    v_mfma_f32_16x16x32_bf16 v[236:239], v[140:143], v[60:63], v[236:239]
    v_mfma_f32_16x16x32_bf16 v[240:243], v[144:147], v[60:63], v[240:243]
    v_mfma_f32_16x16x32_bf16 v[244:247], v[148:151], v[60:63], v[244:247]
    v_mfma_f32_16x16x32_bf16 v[248:251], v[152:155], v[60:63], v[248:251]
    v_mfma_f32_16x16x32_bf16 v[252:255], v[156:159], v[60:63], v[252:255]
    s_lshl_b32 s46, s45, 9
    v_add_u32 v18, s46, v16
    s_mov_b64 exec, s[68:69]
    ds_write_b32 v18, v224 offset:2560
    ds_write_b32 v18, v225 offset:2592
    ds_write_b32 v18, v226 offset:2624
    ds_write_b32 v18, v227 offset:2656
    ds_write_b32 v18, v228 offset:2564
    ds_write_b32 v18, v229 offset:2596
    ds_write_b32 v18, v230 offset:2628
    ds_write_b32 v18, v231 offset:2660
    ds_write_b32 v18, v232 offset:2568
    ds_write_b32 v18, v233 offset:2600
    ds_write_b32 v18, v234 offset:2632
    ds_write_b32 v18, v235 offset:2664
    ds_write_b32 v18, v236 offset:2572
    ds_write_b32 v18, v237 offset:2604
    ds_write_b32 v18, v238 offset:2636
    ds_write_b32 v18, v239 offset:2668
    ds_write_b32 v18, v240 offset:2576
    ds_write_b32 v18, v241 offset:2608
    ds_write_b32 v18, v242 offset:2640
    ds_write_b32 v18, v243 offset:2672
    ds_write_b32 v18, v244 offset:2580
    ds_write_b32 v18, v245 offset:2612
    ds_write_b32 v18, v246 offset:2644
    ds_write_b32 v18, v247 offset:2676
    ds_write_b32 v18, v248 offset:2584
    ds_write_b32 v18, v249 offset:2616
    ds_write_b32 v18, v250 offset:2648
    ds_write_b32 v18, v251 offset:2680
    ds_write_b32 v18, v252 offset:2588
    ds_write_b32 v18, v253 offset:2620
    ds_write_b32 v18, v254 offset:2652
    ds_write_b32 v18, v255 offset:2684
    s_mov_b64 exec, -1
    s_lshl_b32 s46, s45, 2
    v_mov_b32 v19, s46
    s_waitcnt lgkmcnt(0)
    v_mov_b32 v20, 4
    ds_write_b32 v19, v20 offset:16
    s_cmp_lg_u32 s45, 0
    s_cbranch_scc1 L_nq_158
    s_nop 1
L_lw_159:
    ds_read_b128 v[8:11], v5 offset:16
    s_waitcnt lgkmcnt(0)
    v_min_u32 v8, v8, v9
    v_min3_u32 v8, v8, v10, v11
    v_cmp_gt_u32 vcc, 4, v8
    s_nop 1
    s_cbranch_vccz L_lwd_160
    s_sleep 1
    s_sub_u32 s49, s49, 1
    s_cmp_gt_i32 s49, 0
    s_cbranch_scc1 L_lw_159
L_lwd_160:
    ds_read_b64 v[24:25], v17 offset:2560
    ds_read_b64 v[26:27], v17 offset:3072
    ds_read_b64 v[28:29], v17 offset:3584
    ds_read_b64 v[30:31], v17 offset:4096
    s_waitcnt lgkmcnt(0)
    v_add_f32 v24, v24, v26
    v_add_f32 v25, v25, v27
    v_add_f32 v24, v24, v28
    v_add_f32 v25, v25, v29
    v_add_f32 v24, v24, v30
    v_add_f32 v25, v25, v31
    v_lshlrev_b32 v18, 2, v2
    v_cvt_pk_bf16_f32 v26, v24, v25
    ds_write_b32 v18, v26 offset:4608
    s_waitcnt lgkmcnt(0)
    v_mov_b32 v20, 4
    ds_write_b32 v5, v20 offset:64
    s_nop 3
L_nq_158:
    s_setprio 0
    s_and_b32 s46, s2, 31
    s_lshl_b32 s46, s46, 17
    s_add_u32 s60, s34, s46
    s_addc_u32 s61, s35, 0
    s_mov_b32 s62, 0x20000
    s_mov_b32 s63, 0x20000
    s_lshl_b32 s47, s45, 8
    buffer_load_dwordx4 v[64:67], v13, s[60:63], s47 offen
    s_add_u32 s47, s47, 4096
    buffer_load_dwordx4 v[68:71], v13, s[60:63], s47 offen
    s_add_u32 s47, s47, 4096
    buffer_load_dwordx4 v[72:75], v13, s[60:63], s47 offen
    s_add_u32 s47, s47, 4096
    buffer_load_dwordx4 v[76:79], v13, s[60:63], s47 offen
    s_add_u32 s47, s47, 4096
    buffer_load_dwordx4 v[80:83], v13, s[60:63], s47 offen
    s_add_u32 s47, s47, 4096
    buffer_load_dwordx4 v[84:87], v13, s[60:63], s47 offen
    s_add_u32 s47, s47, 4096
    buffer_load_dwordx4 v[88:91], v13, s[60:63], s47 offen
    s_add_u32 s47, s47, 4096
    buffer_load_dwordx4 v[92:95], v13, s[60:63], s47 offen
    s_add_u32 s47, s47, 4096
    buffer_load_dwordx4 v[96:99], v13, s[60:63], s47 offen
    s_add_u32 s47, s47, 4096
    buffer_load_dwordx4 v[100:103], v13, s[60:63], s47 offen
    s_add_u32 s47, s47, 4096
    buffer_load_dwordx4 v[104:107], v13, s[60:63], s47 offen
    s_add_u32 s47, s47, 4096
    buffer_load_dwordx4 v[108:111], v13, s[60:63], s47 offen
    s_add_u32 s47, s47, 4096
    buffer_load_dwordx4 v[112:115], v13, s[60:63], s47 offen
    s_add_u32 s47, s47, 4096
    buffer_load_dwordx4 v[116:119], v13, s[60:63], s47 offen
    s_add_u32 s47, s47, 4096
    buffer_load_dwordx4 v[120:123], v13, s[60:63], s47 offen
    s_add_u32 s47, s47, 4096
    buffer_load_dwordx4 v[124:127], v13, s[60:63], s47 offen
    s_add_u32 s47, s47, 4096
    buffer_load_dwordx4 v[128:131], v13, s[60:63], s47 offen
    s_add_u32 s47, s47, 4096
    buffer_load_dwordx4 v[132:135], v13, s[60:63], s47 offen
    s_add_u32 s47, s47, 4096
    buffer_load_dwordx4 v[136:139], v13, s[60:63], s47 offen
    s_add_u32 s47, s47, 4096
    buffer_load_dwordx4 v[140:143], v13, s[60:63], s47 offen
    s_add_u32 s47, s47, 4096
    buffer_load_dwordx4 v[144:147], v13, s[60:63], s47 offen
    s_add_u32 s47, s47, 4096
    buffer_load_dwordx4 v[148:151], v13, s[60:63], s47 offen
    s_add_u32 s47, s47, 4096
    buffer_load_dwordx4 v[152:155], v13, s[60:63], s47 offen
    s_add_u32 s47, s47, 4096
    buffer_load_dwordx4 v[156:159], v13, s[60:63], s47 offen
    s_add_u32 s47, s47, 4096
    buffer_load_dwordx4 v[160:163], v13, s[60:63], s47 offen
    s_add_u32 s47, s47, 4096
    buffer_load_dwordx4 v[164:167], v13, s[60:63], s47 offen
    s_add_u32 s47, s47, 4096
    buffer_load_dwordx4 v[168:171], v13, s[60:63], s47 offen
    s_add_u32 s47, s47, 4096
    buffer_load_dwordx4 v[172:175], v13, s[60:63], s47 offen
    s_add_u32 s47, s47, 4096
    buffer_load_dwordx4 v[176:179], v13, s[60:63], s47 offen
    s_add_u32 s47, s47, 4096
    buffer_load_dwordx4 v[180:183], v13, s[60:63], s47 offen
    s_add_u32 s47, s47, 4096
    buffer_load_dwordx4 v[184:187], v13, s[60:63], s47 offen
    s_add_u32 s47, s47, 4096
    buffer_load_dwordx4 v[188:191], v13, s[60:63], s47 offen
    s_waitcnt vmcnt(0)
    v_perm_b32 v192, v68, v64, s43
    v_perm_b32 v196, v68, v64, s44
    v_perm_b32 v200, v69, v65, s43
    v_perm_b32 v204, v69, v65, s44
    v_perm_b32 v208, v70, v66, s43
    v_perm_b32 v212, v70, v66, s44
    v_perm_b32 v216, v71, v67, s43
    v_perm_b32 v220, v71, v67, s44
    v_perm_b32 v193, v76, v72, s43
    v_perm_b32 v197, v76, v72, s44
    v_perm_b32 v201, v77, v73, s43
    v_perm_b32 v205, v77, v73, s44
    v_perm_b32 v209, v78, v74, s43
    v_perm_b32 v213, v78, v74, s44
    v_perm_b32 v217, v79, v75, s43
    v_perm_b32 v221, v79, v75, s44
    v_perm_b32 v194, v84, v80, s43
    v_perm_b32 v198, v84, v80, s44
    v_perm_b32 v202, v85, v81, s43
    v_perm_b32 v206, v85, v81, s44
    v_perm_b32 v210, v86, v82, s43
    v_perm_b32 v214, v86, v82, s44
    v_perm_b32 v218, v87, v83, s43
    v_perm_b32 v222, v87, v83, s44
    v_perm_b32 v195, v92, v88, s43
    v_perm_b32 v199, v92, v88, s44
    v_perm_b32 v203, v93, v89, s43
    v_perm_b32 v207, v93, v89, s44
    v_perm_b32 v211, v94, v90, s43
    v_perm_b32 v215, v94, v90, s44
    v_perm_b32 v219, v95, v91, s43
    v_perm_b32 v223, v95, v91, s44
    v_perm_b32 v64, v100, v96, s43
    v_perm_b32 v68, v100, v96, s44
    v_perm_b32 v72, v101, v97, s43
    v_perm_b32 v76, v101, v97, s44
    v_perm_b32 v80, v102, v98, s43
    v_perm_b32 v84, v102, v98, s44
    v_perm_b32 v88, v103, v99, s43
    v_perm_b32 v92, v103, v99, s44
    v_perm_b32 v65, v108, v104, s43
    v_perm_b32 v69, v108, v104, s44
    v_perm_b32 v73, v109, v105, s43
    v_perm_b32 v77, v109, v105, s44
    v_perm_b32 v81, v110, v106, s43
    v_perm_b32 v85, v110, v106, s44
    v_perm_b32 v89, v111, v107, s43
    v_perm_b32 v93, v111, v107, s44
    v_perm_b32 v66, v116, v112, s43
    v_perm_b32 v70, v116, v112, s44
    v_perm_b32 v74, v117, v113, s43
    v_perm_b32 v78, v117, v113, s44
    v_perm_b32 v82, v118, v114, s43
    v_perm_b32 v86, v118, v114, s44
    v_perm_b32 v90, v119, v115, s43
    v_perm_b32 v94, v119, v115, s44
    v_perm_b32 v67, v124, v120, s43
    v_perm_b32 v71, v124, v120, s44
    v_perm_b32 v75, v125, v121, s43
    v_perm_b32 v79, v125, v121, s44
    v_perm_b32 v83, v126, v122, s43
    v_perm_b32 v87, v126, v122, s44
    v_perm_b32 v91, v127, v123, s43
    v_perm_b32 v95, v127, v123, s44
    v_perm_b32 v96, v132, v128, s43
    v_perm_b32 v100, v132, v128, s44
    v_perm_b32 v104, v133, v129, s43
    v_perm_b32 v108, v133, v129, s44
    v_perm_b32 v112, v134, v130, s43
    v_perm_b32 v116, v134, v130, s44
    v_perm_b32 v120, v135, v131, s43
    v_perm_b32 v124, v135, v131, s44
    v_perm_b32 v97, v140, v136, s43
    v_perm_b32 v101, v140, v136, s44
    v_perm_b32 v105, v141, v137, s43
    v_perm_b32 v109, v141, v137, s44
    v_perm_b32 v113, v142, v138, s43
    v_perm_b32 v117, v142, v138, s44
    v_perm_b32 v121, v143, v139, s43
    v_perm_b32 v125, v143, v139, s44
    v_perm_b32 v98, v148, v144, s43
    v_perm_b32 v102, v148, v144, s44
    v_perm_b32 v106, v149, v145, s43
    v_perm_b32 v110, v149, v145, s44
    v_perm_b32 v114, v150, v146, s43
    v_perm_b32 v118, v150, v146, s44
    v_perm_b32 v122, v151, v147, s43
    v_perm_b32 v126, v151, v147, s44
    v_perm_b32 v99, v156, v152, s43
    v_perm_b32 v103, v156, v152, s44
    v_perm_b32 v107, v157, v153, s43
    v_perm_b32 v111, v157, v153, s44
    v_perm_b32 v115, v158, v154, s43
    v_perm_b32 v119, v158, v154, s44
    v_perm_b32 v123, v159, v155, s43
    v_perm_b32 v127, v159, v155, s44
    v_perm_b32 v128, v164, v160, s43
    v_perm_b32 v132, v164, v160, s44
    v_perm_b32 v136, v165, v161, s43
    v_perm_b32 v140, v165, v161, s44
    v_perm_b32 v144, v166, v162, s43
    v_perm_b32 v148, v166, v162, s44
    v_perm_b32 v152, v167, v163, s43
    v_perm_b32 v156, v167, v163, s44
    v_perm_b32 v129, v172, v168, s43
    v_perm_b32 v133, v172, v168, s44
    v_perm_b32 v137, v173, v169, s43
    v_perm_b32 v141, v173, v169, s44
    v_perm_b32 v145, v174, v170, s43
    v_perm_b32 v149, v174, v170, s44
    v_perm_b32 v153, v175, v171, s43
    v_perm_b32 v157, v175, v171, s44
    v_perm_b32 v130, v180, v176, s43
    v_perm_b32 v134, v180, v176, s44
    v_perm_b32 v138, v181, v177, s43
    v_perm_b32 v142, v181, v177, s44
    v_perm_b32 v146, v182, v178, s43
    v_perm_b32 v150, v182, v178, s44
    v_perm_b32 v154, v183, v179, s43
    v_perm_b32 v158, v183, v179, s44
    v_perm_b32 v131, v188, v184, s43
    v_perm_b32 v135, v188, v184, s44
    v_perm_b32 v139, v189, v185, s43
    v_perm_b32 v143, v189, v185, s44
    v_perm_b32 v147, v190, v186, s43
    v_perm_b32 v151, v190, v186, s44
    v_perm_b32 v155, v191, v187, s43
    v_perm_b32 v159, v191, v187, s44
    s_nop 1
L_lw_161:
    ds_read_b128 v[8:11], v5 offset:32
    s_waitcnt lgkmcnt(0)
    v_min_u32 v8, v8, v9
    v_min3_u32 v8, v8, v10, v11
    v_cmp_gt_u32 vcc, 4, v8
    s_nop 1
    s_cbranch_vccz L_lwd_162
    s_sleep 1
    s_sub_u32 s49, s49, 1
    s_cmp_gt_i32 s49, 0
    s_cbranch_scc1 L_lw_161
L_lwd_162:
    s_setprio 3
    ds_read_b64 v[24:25], v17 offset:17408
    ds_read_b64 v[26:27], v17 offset:19456
    ds_read_b64 v[28:29], v17 offset:21504
    ds_read_b64 v[30:31], v17 offset:23552
    s_waitcnt lgkmcnt(0)
    v_add_f32 v24, v24, v26
    v_add_f32 v25, v25, v27
    v_add_f32 v24, v24, v28
    v_add_f32 v25, v25, v29
    v_add_f32 v24, v24, v30
    v_add_f32 v25, v25, v31
    v_cvt_pk_bf16_f32 v28, v24, v25
    v_lshrrev_b32 v29, 4, v2
    v_lshlrev_b32 v29, 6, v29
    v_and_b32 v30, 1, v2
    v_lshl_add_u32 v29, v30, 5, v29
    v_bfe_u32 v30, v2, 1, 3
    v_lshl_add_u32 v29, v30, 1, v29
    s_lshl_b32 s46, s45, 8
    v_add_u32 v29, s46, v29
    ds_write_b16 v29, v28 offset:5632
    ds_write_b16_d16_hi v29, v28 offset:5648
    s_waitcnt lgkmcnt(0)
    ds_read_b128 v[48:51], v15 offset:5632
    ds_read_b128 v[52:55], v15 offset:5696
    ds_read_b128 v[56:59], v15 offset:5760
    ds_read_b128 v[60:63], v15 offset:5824
    v_mov_b32 v224, 0
    v_mov_b32 v225, 0
    v_mov_b32 v226, 0
    v_mov_b32 v227, 0
    v_mov_b32 v228, 0
    v_mov_b32 v229, 0
    v_mov_b32 v230, 0
    v_mov_b32 v231, 0
    v_mov_b32 v232, 0
    v_mov_b32 v233, 0
    v_mov_b32 v234, 0
    v_mov_b32 v235, 0
    v_mov_b32 v236, 0
    v_mov_b32 v237, 0
    v_mov_b32 v238, 0
    v_mov_b32 v239, 0
    v_mov_b32 v240, 0
    v_mov_b32 v241, 0
    v_mov_b32 v242, 0
    v_mov_b32 v243, 0
    v_mov_b32 v244, 0
    v_mov_b32 v245, 0
    v_mov_b32 v246, 0
    v_mov_b32 v247, 0
    v_mov_b32 v248, 0
    v_mov_b32 v249, 0
    v_mov_b32 v250, 0
    v_mov_b32 v251, 0
    v_mov_b32 v252, 0
    v_mov_b32 v253, 0
    v_mov_b32 v254, 0
    v_mov_b32 v255, 0
    s_waitcnt lgkmcnt(0)
    v_mfma_f32_16x16x32_bf16 v[224:227], v[192:195], v[48:51], v[224:227]
    v_mfma_f32_16x16x32_bf16 v[228:231], v[196:199], v[48:51], v[228:231]
    v_mfma_f32_16x16x32_bf16 v[232:235], v[200:203], v[48:51], v[232:235]
    v_mfma_f32_16x16x32_bf16 v[236:239], v[204:207], v[48:51], v[236:239]
    v_mfma_f32_16x16x32_bf16 v[240:243], v[208:211], v[48:51], v[240:243]
    v_mfma_f32_16x16x32_bf16 v[244:247], v[212:215], v[48:51], v[244:247]
    v_mfma_f32_16x16x32_bf16 v[248:251], v[216:219], v[48:51], v[248:251]
    v_mfma_f32_16x16x32_bf16 v[252:255], v[220:223], v[48:51], v[252:255]
    v_mfma_f32_16x16x32_bf16 v[224:227], v[64:67], v[52:55], v[224:227]
    v_mfma_f32_16x16x32_bf16 v[228:231], v[68:71], v[52:55], v[228:231]
    v_mfma_f32_16x16x32_bf16 v[232:235], v[72:75], v[52:55], v[232:235]
    v_mfma_f32_16x16x32_bf16 v[236:239], v[76:79], v[52:55], v[236:239]
    v_mfma_f32_16x16x32_bf16 v[240:243], v[80:83], v[52:55], v[240:243]
    v_mfma_f32_16x16x32_bf16 v[244:247], v[84:87], v[52:55], v[244:247]
    v_mfma_f32_16x16x32_bf16 v[248:251], v[88:91], v[52:55], v[248:251]
    v_mfma_f32_16x16x32_bf16 v[252:255], v[92:95], v[52:55], v[252:255]
    v_mfma_f32_16x16x32_bf16 v[224:227], v[96:99], v[56:59], v[224:227]
    v_mfma_f32_16x16x32_bf16 v[228:231], v[100:103], v[56:59], v[228:231]
    v_mfma_f32_16x16x32_bf16 v[232:235], v[104:107], v[56:59], v[232:235]
    v_mfma_f32_16x16x32_bf16 v[236:239], v[108:111], v[56:59], v[236:239]
    v_mfma_f32_16x16x32_bf16 v[240:243], v[112:115], v[56:59], v[240:243]
    v_mfma_f32_16x16x32_bf16 v[244:247], v[116:119], v[56:59], v[244:247]
    v_mfma_f32_16x16x32_bf16 v[248:251], v[120:123], v[56:59], v[248:251]
    v_mfma_f32_16x16x32_bf16 v[252:255], v[124:127], v[56:59], v[252:255]
    v_mfma_f32_16x16x32_bf16 v[224:227], v[128:131], v[60:63], v[224:227]
    v_mfma_f32_16x16x32_bf16 v[228:231], v[132:135], v[60:63], v[228:231]
    v_mfma_f32_16x16x32_bf16 v[232:235], v[136:139], v[60:63], v[232:235]
    v_mfma_f32_16x16x32_bf16 v[236:239], v[140:143], v[60:63], v[236:239]
    v_mfma_f32_16x16x32_bf16 v[240:243], v[144:147], v[60:63], v[240:243]
    v_mfma_f32_16x16x32_bf16 v[244:247], v[148:151], v[60:63], v[244:247]
    v_mfma_f32_16x16x32_bf16 v[248:251], v[152:155], v[60:63], v[248:251]
    v_mfma_f32_16x16x32_bf16 v[252:255], v[156:159], v[60:63], v[252:255]
    s_lshl_b32 s46, s45, 9
    v_add_u32 v18, s46, v16
    s_mov_b64 exec, s[68:69]
    ds_write_b32 v18, v224 offset:6656
    ds_write_b32 v18, v225 offset:6688
    ds_write_b32 v18, v226 offset:6720
    ds_write_b32 v18, v227 offset:6752
    ds_write_b32 v18, v228 offset:6660
    ds_write_b32 v18, v229 offset:6692
    ds_write_b32 v18, v230 offset:6724
    ds_write_b32 v18, v231 offset:6756
    ds_write_b32 v18, v232 offset:6664
    ds_write_b32 v18, v233 offset:6696
    ds_write_b32 v18, v234 offset:6728
    ds_write_b32 v18, v235 offset:6760
    ds_write_b32 v18, v236 offset:6668
    ds_write_b32 v18, v237 offset:6700
    ds_write_b32 v18, v238 offset:6732
    ds_write_b32 v18, v239 offset:6764
    ds_write_b32 v18, v240 offset:6672
    ds_write_b32 v18, v241 offset:6704
    ds_write_b32 v18, v242 offset:6736
    ds_write_b32 v18, v243 offset:6768
    ds_write_b32 v18, v244 offset:6676
    ds_write_b32 v18, v245 offset:6708
    ds_write_b32 v18, v246 offset:6740
    ds_write_b32 v18, v247 offset:6772
    ds_write_b32 v18, v248 offset:6680
    ds_write_b32 v18, v249 offset:6712
    ds_write_b32 v18, v250 offset:6744
    ds_write_b32 v18, v251 offset:6776
    ds_write_b32 v18, v252 offset:6684
    ds_write_b32 v18, v253 offset:6716
    ds_write_b32 v18, v254 offset:6748
    ds_write_b32 v18, v255 offset:6780
    s_mov_b64 exec, -1
    v_add_u32 v18, s46, v17
    s_waitcnt lgkmcnt(0)
    ds_read_b64 v[24:25], v18 offset:6656
    s_add_u32 s46, s46, s75
    s_add_u32 s46, s46, 6144
    s_waitcnt lgkmcnt(0)
    v_or_b32 v24, 1, v24
    v_or_b32 v25, 1, v25
    buffer_store_dwordx2 v[24:25], v17, s[56:59], s46 offen sc1
    s_cmp_lg_u32 s75, 0
    s_cbranch_scc1 L_end
    s_lshl_b32 s46, s45, 9
    s_add_u32 s46, s46, 6144
    s_mov_b32 s96, -1
L_pf_163:
    s_bitcmp1_b32 s96, 0
    s_cbranch_scc0 L_pk_166
    s_add_u32 s47, s46, 0
    buffer_load_dwordx2 v[24:25], v17, s[56:59], s47 offen sc1
L_pk_166:
    s_bitcmp1_b32 s96, 1
    s_cbranch_scc0 L_pk_167
    s_add_u32 s47, s46, 65536
    buffer_load_dwordx2 v[26:27], v17, s[56:59], s47 offen sc1
L_pk_167:
    s_bitcmp1_b32 s96, 2
    s_cbranch_scc0 L_pk_168
    s_add_u32 s47, s46, 131072
    buffer_load_dwordx2 v[28:29], v17, s[56:59], s47 offen sc1
L_pk_168:
    s_bitcmp1_b32 s96, 3
    s_cbranch_scc0 L_pk_169
    s_add_u32 s47, s46, 196608
    buffer_load_dwordx2 v[30:31], v17, s[56:59], s47 offen sc1
L_pk_169:
    s_bitcmp1_b32 s96, 4
    s_cbranch_scc0 L_pk_170
    s_add_u32 s47, s46, 262144
    buffer_load_dwordx2 v[32:33], v17, s[56:59], s47 offen sc1
L_pk_170:
    s_bitcmp1_b32 s96, 5
    s_cbranch_scc0 L_pk_171
    s_add_u32 s47, s46, 327680
    buffer_load_dwordx2 v[34:35], v17, s[56:59], s47 offen sc1
L_pk_171:
    s_bitcmp1_b32 s96, 6
    s_cbranch_scc0 L_pk_172
    s_add_u32 s47, s46, 393216
    buffer_load_dwordx2 v[36:37], v17, s[56:59], s47 offen sc1
L_pk_172:
    s_bitcmp1_b32 s96, 7
    s_cbranch_scc0 L_pk_173
    s_add_u32 s47, s46, 458752
    buffer_load_dwordx2 v[38:39], v17, s[56:59], s47 offen sc1
L_pk_173:
    s_bitcmp1_b32 s96, 8
    s_cbranch_scc0 L_pk_174
    s_add_u32 s47, s46, 524288
    buffer_load_dwordx2 v[40:41], v17, s[56:59], s47 offen sc1
L_pk_174:
    s_bitcmp1_b32 s96, 9
    s_cbranch_scc0 L_pk_175
    s_add_u32 s47, s46, 589824
    buffer_load_dwordx2 v[42:43], v17, s[56:59], s47 offen sc1
L_pk_175:
    s_bitcmp1_b32 s96, 10
    s_cbranch_scc0 L_pk_176
    s_add_u32 s47, s46, 655360
    buffer_load_dwordx2 v[44:45], v17, s[56:59], s47 offen sc1
L_pk_176:
    s_bitcmp1_b32 s96, 11
    s_cbranch_scc0 L_pk_177
    s_add_u32 s47, s46, 720896
    buffer_load_dwordx2 v[48:49], v17, s[56:59], s47 offen sc1
L_pk_177:
    s_bitcmp1_b32 s96, 12
    s_cbranch_scc0 L_pk_178
    s_add_u32 s47, s46, 786432
    buffer_load_dwordx2 v[50:51], v17, s[56:59], s47 offen sc1
L_pk_178:
    s_bitcmp1_b32 s96, 13
    s_cbranch_scc0 L_pk_179
    s_add_u32 s47, s46, 851968
    buffer_load_dwordx2 v[52:53], v17, s[56:59], s47 offen sc1
L_pk_179:
    s_bitcmp1_b32 s96, 14
    s_cbranch_scc0 L_pk_180
    s_add_u32 s47, s46, 917504
    buffer_load_dwordx2 v[54:55], v17, s[56:59], s47 offen sc1
L_pk_180:
    s_bitcmp1_b32 s96, 15
    s_cbranch_scc0 L_pk_181
    s_add_u32 s47, s46, 983040
    buffer_load_dwordx2 v[56:57], v17, s[56:59], s47 offen sc1
L_pk_181:
    s_bitcmp1_b32 s96, 16
    s_cbranch_scc0 L_pk_182
    s_add_u32 s47, s46, 1048576
    buffer_load_dwordx2 v[58:59], v17, s[56:59], s47 offen sc1
L_pk_182:
    s_bitcmp1_b32 s96, 17
    s_cbranch_scc0 L_pk_183
    s_add_u32 s47, s46, 1114112
    buffer_load_dwordx2 v[60:61], v17, s[56:59], s47 offen sc1
L_pk_183:
    s_bitcmp1_b32 s96, 18
    s_cbranch_scc0 L_pk_184
    s_add_u32 s47, s46, 1179648
    buffer_load_dwordx2 v[62:63], v17, s[56:59], s47 offen sc1
L_pk_184:
    s_bitcmp1_b32 s96, 19
    s_cbranch_scc0 L_pk_185
    s_add_u32 s47, s46, 1245184
    buffer_load_dwordx2 v[224:225], v17, s[56:59], s47 offen sc1
L_pk_185:
    s_bitcmp1_b32 s96, 20
    s_cbranch_scc0 L_pk_186
    s_add_u32 s47, s46, 1310720
    buffer_load_dwordx2 v[226:227], v17, s[56:59], s47 offen sc1
L_pk_186:
    s_bitcmp1_b32 s96, 21
    s_cbranch_scc0 L_pk_187
    s_add_u32 s47, s46, 1376256
    buffer_load_dwordx2 v[228:229], v17, s[56:59], s47 offen sc1
L_pk_187:
    s_bitcmp1_b32 s96, 22
    s_cbranch_scc0 L_pk_188
    s_add_u32 s47, s46, 1441792
    buffer_load_dwordx2 v[230:231], v17, s[56:59], s47 offen sc1
L_pk_188:
    s_bitcmp1_b32 s96, 23
    s_cbranch_scc0 L_pk_189
    s_add_u32 s47, s46, 1507328
    buffer_load_dwordx2 v[232:233], v17, s[56:59], s47 offen sc1
L_pk_189:
    s_bitcmp1_b32 s96, 24
    s_cbranch_scc0 L_pk_190
    s_add_u32 s47, s46, 1572864
    buffer_load_dwordx2 v[234:235], v17, s[56:59], s47 offen sc1
L_pk_190:
    s_bitcmp1_b32 s96, 25
    s_cbranch_scc0 L_pk_191
    s_add_u32 s47, s46, 1638400
    buffer_load_dwordx2 v[236:237], v17, s[56:59], s47 offen sc1
L_pk_191:
    s_bitcmp1_b32 s96, 26
    s_cbranch_scc0 L_pk_192
    s_add_u32 s47, s46, 1703936
    buffer_load_dwordx2 v[238:239], v17, s[56:59], s47 offen sc1
L_pk_192:
    s_bitcmp1_b32 s96, 27
    s_cbranch_scc0 L_pk_193
    s_add_u32 s47, s46, 1769472
    buffer_load_dwordx2 v[240:241], v17, s[56:59], s47 offen sc1
L_pk_193:
    s_bitcmp1_b32 s96, 28
    s_cbranch_scc0 L_pk_194
    s_add_u32 s47, s46, 1835008
    buffer_load_dwordx2 v[242:243], v17, s[56:59], s47 offen sc1
L_pk_194:
    s_bitcmp1_b32 s96, 29
    s_cbranch_scc0 L_pk_195
    s_add_u32 s47, s46, 1900544
    buffer_load_dwordx2 v[244:245], v17, s[56:59], s47 offen sc1
L_pk_195:
    s_bitcmp1_b32 s96, 30
    s_cbranch_scc0 L_pk_196
    s_add_u32 s47, s46, 1966080
    buffer_load_dwordx2 v[246:247], v17, s[56:59], s47 offen sc1
L_pk_196:
    s_bitcmp1_b32 s96, 31
    s_cbranch_scc0 L_pk_197
    s_add_u32 s47, s46, 2031616
    buffer_load_dwordx2 v[248:249], v17, s[56:59], s47 offen sc1
L_pk_197:
L_pc_165:
    s_waitcnt vmcnt(0)
    s_mov_b32 s97, 0
    v_and_b32 v19, v24, v25
    v_and_b32 v19, 1, v19
    v_cmp_eq_u32 s[4:5], 0, v19
    v_and_b32 v19, v26, v27
    v_and_b32 v19, 1, v19
    v_cmp_eq_u32 s[6:7], 0, v19
    v_and_b32 v19, v28, v29
    v_and_b32 v19, 1, v19
    v_cmp_eq_u32 s[8:9], 0, v19
    v_and_b32 v19, v30, v31
    v_and_b32 v19, 1, v19
    v_cmp_eq_u32 s[10:11], 0, v19
    v_and_b32 v19, v32, v33
    v_and_b32 v19, 1, v19
    v_cmp_eq_u32 s[12:13], 0, v19
    v_and_b32 v19, v34, v35
    v_and_b32 v19, 1, v19
    v_cmp_eq_u32 s[14:15], 0, v19
    s_cmp_lg_u64 s[4:5], 0
    s_cselect_b32 s48, 0x1, 0
    s_or_b32 s97, s97, s48
    s_cmp_lg_u64 s[6:7], 0
    s_cselect_b32 s48, 0x2, 0
    s_or_b32 s97, s97, s48
    s_cmp_lg_u64 s[8:9], 0
    s_cselect_b32 s48, 0x4, 0
    s_or_b32 s97, s97, s48
    s_cmp_lg_u64 s[10:11], 0
    s_cselect_b32 s48, 0x8, 0
    s_or_b32 s97, s97, s48
    s_cmp_lg_u64 s[12:13], 0
    s_cselect_b32 s48, 0x10, 0
    s_or_b32 s97, s97, s48
    s_cmp_lg_u64 s[14:15], 0
    s_cselect_b32 s48, 0x20, 0
    s_or_b32 s97, s97, s48
    v_and_b32 v19, v36, v37
    v_and_b32 v19, 1, v19
    v_cmp_eq_u32 s[4:5], 0, v19
    v_and_b32 v19, v38, v39
    v_and_b32 v19, 1, v19
    v_cmp_eq_u32 s[6:7], 0, v19
    v_and_b32 v19, v40, v41
    v_and_b32 v19, 1, v19
    v_cmp_eq_u32 s[8:9], 0, v19
    v_and_b32 v19, v42, v43
    v_and_b32 v19, 1, v19
    v_cmp_eq_u32 s[10:11], 0, v19
    v_and_b32 v19, v44, v45
    v_and_b32 v19, 1, v19
    v_cmp_eq_u32 s[12:13], 0, v19
    v_and_b32 v19, v48, v49
    v_and_b32 v19, 1, v19
    v_cmp_eq_u32 s[14:15], 0, v19
    s_cmp_lg_u64 s[4:5], 0
    s_cselect_b32 s48, 0x40, 0
    s_or_b32 s97, s97, s48
    s_cmp_lg_u64 s[6:7], 0
    s_cselect_b32 s48, 0x80, 0
    s_or_b32 s97, s97, s48
    s_cmp_lg_u64 s[8:9], 0
    s_cselect_b32 s48, 0x100, 0
    s_or_b32 s97, s97, s48
    s_cmp_lg_u64 s[10:11], 0
    s_cselect_b32 s48, 0x200, 0
    s_or_b32 s97, s97, s48
    s_cmp_lg_u64 s[12:13], 0
    s_cselect_b32 s48, 0x400, 0
    s_or_b32 s97, s97, s48
    s_cmp_lg_u64 s[14:15], 0
    s_cselect_b32 s48, 0x800, 0
    s_or_b32 s97, s97, s48
    v_and_b32 v19, v50, v51
    v_and_b32 v19, 1, v19
    v_cmp_eq_u32 s[4:5], 0, v19
    v_and_b32 v19, v52, v53
    v_and_b32 v19, 1, v19
    v_cmp_eq_u32 s[6:7], 0, v19
    v_and_b32 v19, v54, v55
    v_and_b32 v19, 1, v19
    v_cmp_eq_u32 s[8:9], 0, v19
    v_and_b32 v19, v56, v57
    v_and_b32 v19, 1, v19
    v_cmp_eq_u32 s[10:11], 0, v19
    v_and_b32 v19, v58, v59
    v_and_b32 v19, 1, v19
    v_cmp_eq_u32 s[12:13], 0, v19
    v_and_b32 v19, v60, v61
    v_and_b32 v19, 1, v19
    v_cmp_eq_u32 s[14:15], 0, v19
    s_cmp_lg_u64 s[4:5], 0
    s_cselect_b32 s48, 0x1000, 0
    s_or_b32 s97, s97, s48
    s_cmp_lg_u64 s[6:7], 0
    s_cselect_b32 s48, 0x2000, 0
    s_or_b32 s97, s97, s48
    s_cmp_lg_u64 s[8:9], 0
    s_cselect_b32 s48, 0x4000, 0
    s_or_b32 s97, s97, s48
    s_cmp_lg_u64 s[10:11], 0
    s_cselect_b32 s48, 0x8000, 0
    s_or_b32 s97, s97, s48
    s_cmp_lg_u64 s[12:13], 0
    s_cselect_b32 s48, 0x10000, 0
    s_or_b32 s97, s97, s48
    s_cmp_lg_u64 s[14:15], 0
    s_cselect_b32 s48, 0x20000, 0
    s_or_b32 s97, s97, s48
    v_and_b32 v19, v62, v63
    v_and_b32 v19, 1, v19
    v_cmp_eq_u32 s[4:5], 0, v19
    v_and_b32 v19, v224, v225
    v_and_b32 v19, 1, v19
    v_cmp_eq_u32 s[6:7], 0, v19
    v_and_b32 v19, v226, v227
    v_and_b32 v19, 1, v19
    v_cmp_eq_u32 s[8:9], 0, v19
    v_and_b32 v19, v228, v229
    v_and_b32 v19, 1, v19
    v_cmp_eq_u32 s[10:11], 0, v19
    v_and_b32 v19, v230, v231
    v_and_b32 v19, 1, v19
    v_cmp_eq_u32 s[12:13], 0, v19
    v_and_b32 v19, v232, v233
    v_and_b32 v19, 1, v19
    v_cmp_eq_u32 s[14:15], 0, v19
    s_cmp_lg_u64 s[4:5], 0
    s_cselect_b32 s48, 0x40000, 0
    s_or_b32 s97, s97, s48
    s_cmp_lg_u64 s[6:7], 0
    s_cselect_b32 s48, 0x80000, 0
    s_or_b32 s97, s97, s48
    s_cmp_lg_u64 s[8:9], 0
    s_cselect_b32 s48, 0x100000, 0
    s_or_b32 s97, s97, s48
    s_cmp_lg_u64 s[10:11], 0
    s_cselect_b32 s48, 0x200000, 0
    s_or_b32 s97, s97, s48
    s_cmp_lg_u64 s[12:13], 0
    s_cselect_b32 s48, 0x400000, 0
    s_or_b32 s97, s97, s48
    s_cmp_lg_u64 s[14:15], 0
    s_cselect_b32 s48, 0x800000, 0
    s_or_b32 s97, s97, s48
    v_and_b32 v19, v234, v235
    v_and_b32 v19, 1, v19
    v_cmp_eq_u32 s[4:5], 0, v19
    v_and_b32 v19, v236, v237
    v_and_b32 v19, 1, v19
    v_cmp_eq_u32 s[6:7], 0, v19
    v_and_b32 v19, v238, v239
    v_and_b32 v19, 1, v19
    v_cmp_eq_u32 s[8:9], 0, v19
    v_and_b32 v19, v240, v241
    v_and_b32 v19, 1, v19
    v_cmp_eq_u32 s[10:11], 0, v19
    v_and_b32 v19, v242, v243
    v_and_b32 v19, 1, v19
    v_cmp_eq_u32 s[12:13], 0, v19
    v_and_b32 v19, v244, v245
    v_and_b32 v19, 1, v19
    v_cmp_eq_u32 s[14:15], 0, v19
    s_cmp_lg_u64 s[4:5], 0
    s_cselect_b32 s48, 0x1000000, 0
    s_or_b32 s97, s97, s48
    s_cmp_lg_u64 s[6:7], 0
    s_cselect_b32 s48, 0x2000000, 0
    s_or_b32 s97, s97, s48
    s_cmp_lg_u64 s[8:9], 0
    s_cselect_b32 s48, 0x4000000, 0
    s_or_b32 s97, s97, s48
    s_cmp_lg_u64 s[10:11], 0
    s_cselect_b32 s48, 0x8000000, 0
    s_or_b32 s97, s97, s48
    s_cmp_lg_u64 s[12:13], 0
    s_cselect_b32 s48, 0x10000000, 0
    s_or_b32 s97, s97, s48
    s_cmp_lg_u64 s[14:15], 0
    s_cselect_b32 s48, 0x20000000, 0
    s_or_b32 s97, s97, s48
    v_and_b32 v19, v246, v247
    v_and_b32 v19, 1, v19
    v_cmp_eq_u32 s[4:5], 0, v19
    v_and_b32 v19, v248, v249
    v_and_b32 v19, 1, v19
    v_cmp_eq_u32 s[6:7], 0, v19
    s_cmp_lg_u64 s[4:5], 0
    s_cselect_b32 s48, 0x40000000, 0
    s_or_b32 s97, s97, s48
    s_cmp_lg_u64 s[6:7], 0
    s_cselect_b32 s48, 0x80000000, 0
    s_or_b32 s97, s97, s48
    s_mov_b32 s96, s97
    s_cmp_eq_u32 s96, 0
    s_cbranch_scc1 L_pfd_164
    s_sleep 2
    s_sub_u32 s49, s49, 1
    s_cmp_gt_i32 s49, 0
    s_cbranch_scc1 L_pf_163
L_pfd_164:
    v_add_f32 v24, v24, v26
    v_add_f32 v25, v25, v27
    v_add_f32 v24, v24, v28
    v_add_f32 v25, v25, v29
    v_add_f32 v24, v24, v30
    v_add_f32 v25, v25, v31
    v_add_f32 v24, v24, v32
    v_add_f32 v25, v25, v33
    v_add_f32 v24, v24, v34
    v_add_f32 v25, v25, v35
    v_add_f32 v24, v24, v36
    v_add_f32 v25, v25, v37
    v_add_f32 v24, v24, v38
    v_add_f32 v25, v25, v39
    v_add_f32 v24, v24, v40
    v_add_f32 v25, v25, v41
    v_add_f32 v24, v24, v42
    v_add_f32 v25, v25, v43
    v_add_f32 v24, v24, v44
    v_add_f32 v25, v25, v45
    v_add_f32 v24, v24, v48
    v_add_f32 v25, v25, v49
    v_add_f32 v24, v24, v50
    v_add_f32 v25, v25, v51
    v_add_f32 v24, v24, v52
    v_add_f32 v25, v25, v53
    v_add_f32 v24, v24, v54
    v_add_f32 v25, v25, v55
    v_add_f32 v24, v24, v56
    v_add_f32 v25, v25, v57
    v_add_f32 v24, v24, v58
    v_add_f32 v25, v25, v59
    v_add_f32 v24, v24, v60
    v_add_f32 v25, v25, v61
    v_add_f32 v24, v24, v62
    v_add_f32 v25, v25, v63
    v_add_f32 v24, v24, v224
    v_add_f32 v25, v25, v225
    v_add_f32 v24, v24, v226
    v_add_f32 v25, v25, v227
    v_add_f32 v24, v24, v228
    v_add_f32 v25, v25, v229
    v_add_f32 v24, v24, v230
    v_add_f32 v25, v25, v231
    v_add_f32 v24, v24, v232
    v_add_f32 v25, v25, v233
    v_add_f32 v24, v24, v234
    v_add_f32 v25, v25, v235
    v_add_f32 v24, v24, v236
    v_add_f32 v25, v25, v237
    v_add_f32 v24, v24, v238
    v_add_f32 v25, v25, v239
    v_add_f32 v24, v24, v240
    v_add_f32 v25, v25, v241
    v_add_f32 v24, v24, v242
    v_add_f32 v25, v25, v243
    v_add_f32 v24, v24, v244
    v_add_f32 v25, v25, v245
    v_add_f32 v24, v24, v246
    v_add_f32 v25, v25, v247
    v_add_f32 v24, v24, v248
    v_add_f32 v25, v25, v249
    v_cvt_pk_bf16_f32 v24, v24, v24
    v_lshlrev_b32 v24, 16, v24
    v_cvt_pk_bf16_f32 v25, v25, v25
    v_lshlrev_b32 v25, 16, v25
    v_add_f32 v6, v6, v24
    v_add_f32 v7, v7, v25
    v_cvt_pk_bf16_f32 v6, v6, v6
    v_lshlrev_b32 v6, 16, v6
    v_cvt_pk_bf16_f32 v7, v7, v7
    v_lshlrev_b32 v7, 16, v7
    s_lshl_b32 s46, s51, 10
    s_add_u32 s52, s36, s46
    s_addc_u32 s53, s37, 0
    s_mov_b32 s54, 0x400
    s_mov_b32 s55, 0x20000
    v_subrev_u32 v18, 256, v0
    v_lshlrev_b32 v18, 2, v18
    v_perm_b32 v19, v7, v6, s44
    buffer_store_dword v19, v18, s[52:55], 0 offen
    s_endpgm
L_end:
    s_endpgm
.section .rodata,"a"
.p2align 6
.amdhsa_kernel interleave_layers__gqa_block_cached__mha_block_cached__decode_kernel
  .amdhsa_next_free_vgpr 256
  .amdhsa_next_free_sgpr 102
  .amdhsa_accum_offset 256
  .amdhsa_group_segment_fixed_size 0
  .amdhsa_kernarg_size 104
  .amdhsa_user_sgpr_count 2
  .amdhsa_user_sgpr_kernarg_segment_ptr 1
  .amdhsa_system_sgpr_workgroup_id_x 1
  .amdhsa_float_denorm_mode_32 3
.end_amdhsa_kernel
```
